```python
import torch

def _softmax(x, axis=-1):
    return torch.softmax(x, dim=axis)

def _gelu(x):
    return torch.nn.functional.gelu(x, approximate='tanh')

def _silu(x):
    return torch.nn.functional.silu(x)

def _sigmoid(x):
    return torch.sigmoid(x)

def _layernorm(x, axis=-1, eps=1e-05):
    m = x.mean(dim=axis, keepdim=True)
    v = x.var(dim=axis, keepdim=True, unbiased=False)
    return (x - m) / torch.sqrt(v + eps)

def _scatter_add(tgt, idx, src, axis=0):
    return tgt.clone().index_add_(axis, idx, src)

def _segment_sum(src, seg, n):
    out = torch.zeros((n,) + src.shape[1:], dtype=src.dtype)
    return out.index_add_(0, seg, src)

def _pad(x, pw):
    flat = tuple((v for pair in reversed(pw) for v in pair))
    return torch.nn.functional.pad(x, flat)
kernel_name = 'gated_mix__memory_aug_recurrent_mem_tr__sliding_block__prompt'

def setup_inputs():

    _w = lambda a: (lambda t: t.to(torch.bfloat16) if t.is_floating_point() else t)(torch.as_tensor(a))

    def _A_setup():
        B, S, Dm = (1, 2048, 640)
        H, Dh = (32, 128)
        M, seg = (8, 32)
        seg = min(seg, S)
        S = S // seg * seg
        return {'x': _w((lambda *s: torch.randn(*s, dtype=torch.bfloat16) * 0.05)(B, S, Dm)), 'mem0': _w((lambda *s: torch.randn(*s, dtype=torch.bfloat16) * 1.6)(B, M, Dm)), 'Wq': _w((lambda *s: torch.randn(*s, dtype=torch.bfloat16) * 0.8)(Dm, H, Dh) * Dm ** (-0.5)), 'Wk': _w((lambda *s: torch.randn(*s, dtype=torch.bfloat16) * 0.8)(Dm, H, Dh) * Dm ** (-0.5)), 'Wv': _w((lambda *s: torch.randn(*s, dtype=torch.bfloat16) * 1.6)(Dm, H, Dh) * Dm ** (-0.5)), 'Wo': _w((lambda *s: torch.randn(*s, dtype=torch.bfloat16) * 1.6)(H, Dh, Dm) * (H * Dh) ** (-0.5)), 'seg_len': seg}
    _A_in = _A_setup()

    def _B_setup():
        B, S, D = (1, 2048, 640)
        return {'x': _w((lambda *s: torch.randn(*s, dtype=torch.bfloat16) * 0.05)(B, S, D)), 'wqkv': _w((lambda *s: torch.randn(*s, dtype=torch.bfloat16) * 0.8)(D, 3 * D)), 'wo': _w((lambda *s: torch.randn(*s, dtype=torch.bfloat16) * 0.05)(D, D))}
    _B_in = _B_setup()
    return {'A_x': _A_in['x'], 'A_mem0': _A_in['mem0'], 'A_Wq': _A_in['Wq'], 'A_Wk': _A_in['Wk'], 'A_Wv': _A_in['Wv'], 'A_Wo': _A_in['Wo'], 'A_seg_len': _A_in['seg_len'], 'B_x': _B_in['x'], 'B_wqkv': _B_in['wqkv'], 'B_wo': _B_in['wo'], 'gate_w': _w((lambda *s: torch.randn(*s, dtype=torch.bfloat16) * 0.05)(640) * 16.0)}

def reference(A_x, A_mem0, A_Wq, A_Wk, A_Wv, A_Wo, A_seg_len, B_x, B_wqkv, B_wo, gate_w):

    def _A_ref(x, mem0, Wq, Wk, Wv, Wo, seg_len):
        B, S, Dm = x.shape
        H, Dh = (Wq.shape[1], Wq.shape[2])
        M = mem0.shape[1]
        scale = Dh ** (-0.5)
        n_seg = S // seg_len
        L = M + seg_len
        idx = torch.arange(L)
        mask = (idx[:, None] < M) | (idx[:, None] >= idx[None, :])
        mem = mem0
        outs = []
        for s in range(n_seg):
            xs = x[:, s * seg_len:(s + 1) * seg_len, :].clone()
            h = torch.concatenate([mem, xs], axis=1)
            q = torch.einsum('btd,dhe->bhte', h, Wq)
            k = torch.einsum('btd,dhe->bhte', h, Wk)
            v = torch.einsum('btd,dhe->bhte', h, Wv)
            scores = torch.einsum('bhqe,bhke->bhqk', q, k) * scale
            scores = torch.where(mask[None, None], scores, -1000000000.0)
            p = _softmax(scores, axis=-1)
            o = torch.einsum('bhqk,bhke->bhqe', p, v)
            o = torch.einsum('bhte,hed->btd', o, Wo)
            mem = o[:, :M, :].clone()
            outs.append(o[:, M:, :])
        return torch.concatenate(outs, axis=1)

    def _B_ref(x, wqkv, wo):
        B, S, D = x.shape
        H = 32
        Dh = D // H
        W = 256
        qkv = (lambda x, *d: x.permute(*d))((x @ wqkv).reshape(B, S, 3, H, Dh), 2, 0, 3, 1, 4)
        q, k, v = (qkv[0], qkv[1], qkv[2])
        scores = torch.einsum('bhqd,bhkd->bhqk', q, k) * Dh ** (-0.5)
        idx = torch.arange(S)
        mask = (idx[:, None] - idx[None, :] >= 0) & (idx[:, None] - idx[None, :] < W)
        scores = torch.where(mask[None, None], scores, -1000000000.0)
        p = _softmax(scores, axis=-1)
        o = torch.einsum('bhqk,bhkd->bhqd', p, v)
        return (lambda x, *d: x.permute(*d))(o, 0, 2, 1, 3).reshape(B, S, D) @ wo
    x = A_x
    g = _sigmoid((x * gate_w).sum(-1, keepdims=True))
    a = _A_ref(x, A_mem0, A_Wq, A_Wk, A_Wv, A_Wo, A_seg_len)
    b = _B_ref(x, B_wqkv, B_wo)
    return g * a + (1 - g) * b
```

```asm
; @launch grid=(256,1,1) block=(256,1,1) lds=163840
.amdgcn_target "amdgcn-amd-amdhsa--gfx950"
.text
.globl gated_mix__memory_aug_recurrent_mem_tr__sliding_block__prompt_kernel
.p2align 8
.type gated_mix__memory_aug_recurrent_mem_tr__sliding_block__prompt_kernel,@function
gated_mix__memory_aug_recurrent_mem_tr__sliding_block__prompt_kernel:
    s_cmp_ge_u32 s2, 256
    s_cbranch_scc1 L_end
    s_load_dwordx2 s[28:29], s[0:1], 96
    s_load_dwordx2 s[4:5], s[0:1], 104
    s_getreg_b32 s16, hwreg(HW_REG_XCC_ID, 0, 4)
    v_lshrrev_b32 v1, 6, v0
    s_nop 0
    v_readfirstlane_b32 s20, v1
    s_waitcnt lgkmcnt(0)
    s_mov_b32 s8, s4
    s_and_b32 s9, s5, 0xffff
    s_mov_b32 s10, 0x10000000
    s_mov_b32 s11, 0x20000
    s_cmp_lg_u32 s20, 0
    s_cbranch_scc1 L_noticket
    s_cmp_lt_u32 s16, 6
    s_cbranch_scc1 L_tik_now
    s_sleep 40
L_tik_now:
    s_lshl_b32 s30, s16, 2
    v_mov_b32 v1, s30
    v_mov_b32 v2, 1
    s_mov_b64 exec, 1
    global_atomic_add v3, v1, v2, s[28:29] sc0
    s_waitcnt vmcnt(0)
    v_mov_b32 v1, 0
    ds_write_b32 v1, v3
    s_waitcnt lgkmcnt(0)
    s_mov_b64 exec, -1
L_noticket:
    s_barrier
    v_mov_b32 v1, 0
    ds_read_b32 v2, v1
    s_waitcnt lgkmcnt(0)
    v_readfirstlane_b32 s17, v2
    s_barrier
    s_mov_b32 s3, 0
    s_mov_b32 s22, 0x100000
L_role:
    s_cmp_ge_u32 s17, 32
    s_cbranch_scc1 L_overfull
    s_cmp_lt_u32 s16, 4
    s_cbranch_scc1 L_chain
    s_sub_u32 s34, s16, 4
    s_lshl_b32 s34, s34, 5
    s_add_u32 s34, s34, s17
    s_cmp_lg_u32 s20, 1
    s_cbranch_scc1 L_b_nowarm
    s_load_dwordx2 s[4:5], s[0:1], 0
    s_waitcnt lgkmcnt(0)
    s_mov_b32 s12, s4
    s_and_b32 s13, s5, 0xffff
    s_mov_b32 s14, 2621440
    s_mov_b32 s15, 0x20000
    s_mul_i32 s30, s17, 2560
    v_and_b32 v1, 63, v0
    v_lshlrev_b32 v1, 4, v1
    buffer_load_dwordx4 v[244:247], v1, s[12:15], s30 offen offset:0
    buffer_load_dwordx4 v[244:247], v1, s[12:15], s30 offen offset:1024
    buffer_load_dwordx4 v[244:247], v1, s[12:15], s30 offen offset:1536
L_b_nowarm:
    s_cmp_lt_u32 s34, 64
    s_cbranch_scc1 L_b_go
    s_cmp_lg_u32 s34, 127
    s_cbranch_scc1 L_b_nocal
    s_lshl_b32 s30, s20, 15
    s_add_u32 s30, s30, 89784320
    s_mov_b32 s31, -1
    s_mov_b32 s32, -1
    s_mov_b32 s78, 4
L_cal_round:
    v_and_b32 v1, 3, v0
    v_lshrrev_b32 v2, 1, v1
    v_lshlrev_b32 v2, 14, v2
    v_and_b32 v1, 1, v1
    v_lshl_add_u32 v1, v1, 13, v2
    v_mov_b32 v2, 0
    buffer_store_dword v2, v1, s[8:11], s30 offen sc1
    s_waitcnt vmcnt(0)
    v_mov_b32 v1, 0
    s_memtime s[64:65]
    s_waitcnt lgkmcnt(0)
    buffer_load_dword v2, v1, s[8:11], s30 offen sc1
    s_waitcnt vmcnt(0)
    s_memtime s[66:67]
    s_waitcnt lgkmcnt(0)
    s_sub_u32 s64, s66, s64
    s_min_u32 s31, s31, s64
    v_mov_b32 v1, 8192
    s_memtime s[64:65]
    s_waitcnt lgkmcnt(0)
    buffer_load_dword v2, v1, s[8:11], s30 offen sc1
    s_waitcnt vmcnt(0)
    s_memtime s[66:67]
    s_waitcnt lgkmcnt(0)
    s_sub_u32 s64, s66, s64
    s_min_u32 s32, s32, s64
    v_mov_b32 v1, 16384
    s_memtime s[64:65]
    s_waitcnt lgkmcnt(0)
    buffer_load_dword v2, v1, s[8:11], s30 offen sc1
    s_waitcnt vmcnt(0)
    s_memtime s[66:67]
    s_waitcnt lgkmcnt(0)
    s_sub_u32 s64, s66, s64
    s_min_u32 s31, s31, s64
    v_mov_b32 v1, 24576
    s_memtime s[64:65]
    s_waitcnt lgkmcnt(0)
    buffer_load_dword v2, v1, s[8:11], s30 offen sc1
    s_waitcnt vmcnt(0)
    s_memtime s[66:67]
    s_waitcnt lgkmcnt(0)
    s_sub_u32 s64, s66, s64
    s_min_u32 s32, s32, s64
    s_lshl_b32 s79, s20, 3
    v_mov_b32 v1, s79
    v_mov_b32 v2, s31
    v_mov_b32 v3, s32
    ds_write_b64 v1, v[2:3]
    s_waitcnt lgkmcnt(0)
    s_barrier
    v_mov_b32 v1, 0
    ds_read_b128 v[4:7], v1
    ds_read_b128 v[8:11], v1 offset:16
    s_waitcnt lgkmcnt(0)
    s_barrier
    v_min_u32 v4, v4, v6
    v_min_u32 v8, v8, v10
    v_min_u32 v5, v5, v7
    v_min_u32 v9, v9, v11
    v_min_u32 v4, v4, v8
    v_min_u32 v5, v5, v9
    s_nop 0
    v_readfirstlane_b32 s31, v4
    v_readfirstlane_b32 s32, v5
    s_min_u32 s79, s31, s32
    s_max_u32 s80, s31, s32
    s_sub_u32 s80, s80, s79
    s_cmp_ge_u32 s80, 100
    s_cselect_b32 s80, 1, 0
    s_cmp_lt_u32 s79, 560
    s_cselect_b32 s80, s80, 0
    s_cmp_eq_u32 s80, 1
    s_cbranch_scc1 L_cal_done
    s_sub_u32 s78, s78, 1
    s_cmp_lg_u32 s78, 0
    s_cbranch_scc1 L_cal_round
L_cal_done:
    s_cmp_lt_u32 s31, s32
    s_cselect_b32 s79, 1, 0
    s_or_b32 s79, s79, 0x100
    v_mov_b32 v2, s79
    v_mov_b32 v1, 64
    global_store_dword v1, v2, s[28:29] sc1
    v_mov_b32 v1, 80
    global_store_dwordx2 v1, v[4:5], s[28:29] sc1
    s_waitcnt vmcnt(0)
L_b_nocal:
    s_cmp_lg_u32 s20, 0
    s_cbranch_scc1 L_b_zeroedq
    v_mov_b32 v242, 0
    v_mov_b32 v243, 0
    s_lshl_b32 s30, s34, 7
    s_add_u32 s30, s30, 105906176
    buffer_store_dword v243, v242, s[8:11], s30 offen sc1
    s_cmp_lg_u32 s34, 127
    s_cbranch_scc1 L_b_zeroedq
    v_lshlrev_b32 v242, 7, v0
    s_mov_b32 s30, 105938944
    buffer_store_dword v243, v242, s[8:11], s30 offen sc1
    s_mov_b32 s30, 105955328
    buffer_store_dword v243, v242, s[8:11], s30 offen sc1
    v_mov_b32 v242, 0
    s_mov_b32 s30, 105947136
    buffer_store_dword v243, v242, s[8:11], s30 offen sc1
L_b_zeroedq:
    s_sleep 64
    s_cmp_lg_u32 s20, 0
    s_cbranch_scc1 L_viq
    v_and_b32 v240, 7, v0
    v_lshlrev_b32 v240, 2, v240
    global_load_dword v241, v240, s[28:29] sc1
L_viq:
    s_waitcnt vmcnt(0)
    s_cmp_lg_u32 s20, 0
    s_cbranch_scc1 L_b_arrivedq
    s_mov_b32 s79, 0
    s_cmp_eq_u32 s3, 1
    s_cbranch_scc1 L_vdq_ok
L_vdq:
    v_readlane_b32 s4, v241, 0
    v_readlane_b32 s5, v241, 1
    v_readlane_b32 s6, v241, 2
    v_readlane_b32 s7, v241, 3
    v_readlane_b32 s80, v241, 4
    v_readlane_b32 s81, v241, 5
    v_readlane_b32 s82, v241, 6
    v_readlane_b32 s83, v241, 7
    s_add_u32 s78, s4, s5
    s_add_u32 s78, s78, s6
    s_add_u32 s78, s78, s7
    s_add_u32 s78, s78, s80
    s_add_u32 s78, s78, s81
    s_add_u32 s78, s78, s82
    s_add_u32 s78, s78, s83
    s_cmp_ge_u32 s78, 256
    s_cbranch_scc1 L_vdq_full
    s_sleep 16
    v_and_b32 v240, 7, v0
    v_lshlrev_b32 v240, 2, v240
    global_load_dword v241, v240, s[28:29] sc1
    s_waitcnt vmcnt(0)
    s_sub_u32 s22, s22, 1
    s_cbranch_scc0 L_vdq
    s_branch L_timeout
L_vdq_full:
    s_cmp_lg_u32 s4, 32
    s_cselect_b32 s79, 1, s79
    s_cmp_lg_u32 s5, 32
    s_cselect_b32 s79, 1, s79
    s_cmp_lg_u32 s6, 32
    s_cselect_b32 s79, 1, s79
    s_cmp_lg_u32 s7, 32
    s_cselect_b32 s79, 1, s79
    s_cmp_lg_u32 s80, 32
    s_cselect_b32 s79, 1, s79
    s_cmp_lg_u32 s81, 32
    s_cselect_b32 s79, 1, s79
    s_cmp_lg_u32 s82, 32
    s_cselect_b32 s79, 1, s79
    s_cmp_lg_u32 s83, 32
    s_cselect_b32 s79, 1, s79
L_vdq_ok:
    s_cmp_lg_u32 s79, 0
    s_cbranch_scc1 L_b_arrivedq
    v_mov_b32 v238, 192
    v_mov_b32 v239, 1
    s_mov_b64 exec, 1
    global_atomic_add v239, v238, v239, s[28:29] sc0
    s_mov_b64 exec, -1
L_b_arrivedq:
    s_cmp_lg_u32 s20, 0
    s_cbranch_scc1 L_afq
    s_cmp_lg_u32 s79, 0
    s_cbranch_scc1 L_afq
    s_waitcnt vmcnt(0)
    v_readfirstlane_b32 s78, v239
    s_cmp_lg_u32 s78, 255
    s_cbranch_scc1 L_afq
    v_mov_b32 v238, 96
    v_mov_b32 v239, 1
    global_store_dword v238, v239, s[28:29] sc1
L_afq:
    s_cmp_lg_u32 s20, 0
    s_cbranch_scc1 L_vbq
    v_mov_b32 v240, 0
    v_mov_b32 v241, s79
    ds_write_b32 v240, v241
    s_waitcnt lgkmcnt(0)
L_vbq:
    s_barrier
    v_mov_b32 v240, 0
    ds_read_b32 v241, v240
    s_waitcnt lgkmcnt(0)
    v_readfirstlane_b32 s79, v241
    s_barrier
    s_cmp_lg_u32 s79, 0
    s_cbranch_scc1 L_fallback
    s_cmp_lg_u32 s20, 0
    s_cbranch_scc1 L_b_censusa_ok
L_b_censusa:
    v_mov_b32 v240, 96
    global_load_dword v241, v240, s[28:29] sc1
    s_waitcnt vmcnt(0)
    v_readfirstlane_b32 s30, v241
    s_cmp_lg_u32 s30, 0
    s_cbranch_scc1 L_b_censusa_ok
    s_sleep 16
    s_sub_u32 s22, s22, 1
    s_cbranch_scc0 L_b_censusa
    s_branch L_timeout
L_b_censusa_ok:
    s_barrier
L_b_go:
    v_and_b32 v16, 63, v0
    s_mov_b32 s42, 3
    s_cmp_eq_u32 s34, 120
    s_cselect_b32 s42, 2, s42
    s_cmp_lt_u32 s34, 120
    s_cselect_b32 s42, 1, s42
    s_cmp_lt_u32 s34, 96
    s_cselect_b32 s42, 0, s42
    s_cmp_eq_u32 s42, 3
    s_cbranch_scc1 L_p1_end
    s_lshl_b32 s41, s34, 7
    s_add_u32 s41, s41, 105906176
    v_mov_b32 v19, 1073741824
    v_cmp_eq_u32 vcc, 0, v0
    v_mov_b32 v17, 0
    s_nop 0
    v_cndmask_b32 v15, v19, v17, vcc
    v_bfe_u32 v21, v16, 2, 2
    v_and_b32 v22, 3, v16
    v_bfe_u32 v23, v16, 4, 1
    v_lshrrev_b32 v24, 5, v16
    v_and_b32 v17, 1, v22
    v_lshlrev_b32 v17, 3, v17
    v_lshrrev_b32 v18, 1, v22
    v_lshl_add_u32 v17, v18, 2, v17
    v_lshl_add_u32 v20, v23, 4, v17
    s_cmp_eq_u32 s42, 0
    s_cbranch_scc0 L_p1_notA
    s_lshr_b32 s30, s34, 5
    s_cmp_eq_u32 s30, 0
    s_cselect_b32 s31, 24, 32
    s_cmp_eq_u32 s30, 2
    s_cselect_b32 s31, 16, s31
    s_load_dwordx2 s[4:5], s[0:1], s31
    s_load_dwordx2 s[6:7], s[0:1], 0
    s_cmp_eq_u32 s30, 0
    s_mov_b32 s36, 33554432
    s_cselect_b32 s36, 16777216, s36
    s_cmp_eq_u32 s30, 2
    s_cselect_b32 s36, 0, s36
    s_and_b32 s32, s34, 31
    s_lshl_b32 s33, s32, 13
    s_add_u32 s36, s36, s33
    s_mov_b32 s37, 262144
    s_waitcnt lgkmcnt(0)
    s_mov_b32 s12, s4
    s_and_b32 s13, s5, 0xffff
    s_mov_b32 s14, 5242880
    s_mov_b32 s15, 0x20000
    s_mov_b32 s24, s6
    s_and_b32 s25, s7, 0xffff
    s_mov_b32 s26, 2621440
    s_mov_b32 s27, 0x20000
    v_lshrrev_b32 v17, 4, v16
    v_lshlrev_b32 v17, 13, v17
    v_and_b32 v18, 15, v16
    v_lshl_add_u32 v17, v18, 4, v17
    s_lshl_b32 s33, s32, 8
    v_add_u32 v17, s33, v17
    s_lshl_b32 s30, s20, 15
    s_lshl_b32 s31, s20, 10
    s_mov_b32 m0, s31
    s_add_u32 s31, s31, 4096
    buffer_load_dwordx4 v17, s[12:15], s30 offen lds
    s_add_u32 s30, s30, 131072
    s_mov_b32 m0, s31
    s_add_u32 s31, s31, 4096
    buffer_load_dwordx4 v17, s[12:15], s30 offen lds
    s_add_u32 s30, s30, 131072
    s_mov_b32 m0, s31
    s_add_u32 s31, s31, 4096
    buffer_load_dwordx4 v17, s[12:15], s30 offen lds
    s_add_u32 s30, s30, 131072
    s_mov_b32 m0, s31
    s_add_u32 s31, s31, 4096
    buffer_load_dwordx4 v17, s[12:15], s30 offen lds
    s_add_u32 s30, s30, 131072
    s_mov_b32 m0, s31
    s_add_u32 s31, s31, 4096
    buffer_load_dwordx4 v17, s[12:15], s30 offen lds
    s_add_u32 s30, s30, 131072
    s_mov_b32 m0, s31
    s_add_u32 s31, s31, 4096
    buffer_load_dwordx4 v17, s[12:15], s30 offen lds
    s_add_u32 s30, s30, 131072
    s_mov_b32 m0, s31
    s_add_u32 s31, s31, 4096
    buffer_load_dwordx4 v17, s[12:15], s30 offen lds
    s_add_u32 s30, s30, 131072
    s_mov_b32 m0, s31
    s_add_u32 s31, s31, 4096
    buffer_load_dwordx4 v17, s[12:15], s30 offen lds
    s_add_u32 s30, s30, 131072
    s_mov_b32 m0, s31
    s_add_u32 s31, s31, 4096
    buffer_load_dwordx4 v17, s[12:15], s30 offen lds
    s_add_u32 s30, s30, 131072
    s_mov_b32 m0, s31
    s_add_u32 s31, s31, 4096
    buffer_load_dwordx4 v17, s[12:15], s30 offen lds
    s_add_u32 s30, s30, 131072
    s_mov_b32 m0, s31
    s_add_u32 s31, s31, 4096
    buffer_load_dwordx4 v17, s[12:15], s30 offen lds
    s_add_u32 s30, s30, 131072
    s_mov_b32 m0, s31
    s_add_u32 s31, s31, 4096
    buffer_load_dwordx4 v17, s[12:15], s30 offen lds
    s_add_u32 s30, s30, 131072
    s_mov_b32 m0, s31
    s_add_u32 s31, s31, 4096
    buffer_load_dwordx4 v17, s[12:15], s30 offen lds
    s_add_u32 s30, s30, 131072
    s_mov_b32 m0, s31
    s_add_u32 s31, s31, 4096
    buffer_load_dwordx4 v17, s[12:15], s30 offen lds
    s_add_u32 s30, s30, 131072
    s_mov_b32 m0, s31
    s_add_u32 s31, s31, 4096
    buffer_load_dwordx4 v17, s[12:15], s30 offen lds
    s_add_u32 s30, s30, 131072
    s_mov_b32 m0, s31
    s_add_u32 s31, s31, 4096
    buffer_load_dwordx4 v17, s[12:15], s30 offen lds
    s_add_u32 s30, s30, 131072
    s_mov_b32 m0, s31
    s_add_u32 s31, s31, 4096
    buffer_load_dwordx4 v17, s[12:15], s30 offen lds
    s_add_u32 s30, s30, 131072
    s_mov_b32 m0, s31
    s_add_u32 s31, s31, 4096
    buffer_load_dwordx4 v17, s[12:15], s30 offen lds
    s_add_u32 s30, s30, 131072
    s_mov_b32 m0, s31
    s_add_u32 s31, s31, 4096
    buffer_load_dwordx4 v17, s[12:15], s30 offen lds
    s_add_u32 s30, s30, 131072
    s_mov_b32 m0, s31
    s_add_u32 s31, s31, 4096
    buffer_load_dwordx4 v17, s[12:15], s30 offen lds
    s_add_u32 s30, s30, 131072
    s_mov_b32 m0, s31
    s_add_u32 s31, s31, 4096
    buffer_load_dwordx4 v17, s[12:15], s30 offen lds
    s_add_u32 s30, s30, 131072
    s_mov_b32 m0, s31
    s_add_u32 s31, s31, 4096
    buffer_load_dwordx4 v17, s[12:15], s30 offen lds
    s_add_u32 s30, s30, 131072
    s_mov_b32 m0, s31
    s_add_u32 s31, s31, 4096
    buffer_load_dwordx4 v17, s[12:15], s30 offen lds
    s_add_u32 s30, s30, 131072
    s_mov_b32 m0, s31
    s_add_u32 s31, s31, 4096
    buffer_load_dwordx4 v17, s[12:15], s30 offen lds
    s_add_u32 s30, s30, 131072
    s_mov_b32 m0, s31
    s_add_u32 s31, s31, 4096
    buffer_load_dwordx4 v17, s[12:15], s30 offen lds
    s_add_u32 s30, s30, 131072
    s_mov_b32 m0, s31
    s_add_u32 s31, s31, 4096
    buffer_load_dwordx4 v17, s[12:15], s30 offen lds
    s_add_u32 s30, s30, 131072
    s_mov_b32 m0, s31
    s_add_u32 s31, s31, 4096
    buffer_load_dwordx4 v17, s[12:15], s30 offen lds
    s_add_u32 s30, s30, 131072
    s_mov_b32 m0, s31
    s_add_u32 s31, s31, 4096
    buffer_load_dwordx4 v17, s[12:15], s30 offen lds
    s_add_u32 s30, s30, 131072
    s_mov_b32 m0, s31
    s_add_u32 s31, s31, 4096
    buffer_load_dwordx4 v17, s[12:15], s30 offen lds
    s_add_u32 s30, s30, 131072
    s_mov_b32 m0, s31
    s_add_u32 s31, s31, 4096
    buffer_load_dwordx4 v17, s[12:15], s30 offen lds
    s_add_u32 s30, s30, 131072
    s_mov_b32 m0, s31
    s_add_u32 s31, s31, 4096
    buffer_load_dwordx4 v17, s[12:15], s30 offen lds
    s_add_u32 s30, s30, 131072
    s_mov_b32 m0, s31
    s_add_u32 s31, s31, 4096
    buffer_load_dwordx4 v17, s[12:15], s30 offen lds
    s_add_u32 s30, s30, 131072
    s_mov_b32 m0, s31
    s_add_u32 s31, s31, 4096
    buffer_load_dwordx4 v17, s[12:15], s30 offen lds
    s_add_u32 s30, s30, 131072
    s_mov_b32 m0, s31
    s_add_u32 s31, s31, 4096
    buffer_load_dwordx4 v17, s[12:15], s30 offen lds
    s_add_u32 s30, s30, 131072
    s_mov_b32 m0, s31
    s_add_u32 s31, s31, 4096
    buffer_load_dwordx4 v17, s[12:15], s30 offen lds
    s_add_u32 s30, s30, 131072
    s_mov_b32 m0, s31
    s_add_u32 s31, s31, 4096
    buffer_load_dwordx4 v17, s[12:15], s30 offen lds
    s_add_u32 s30, s30, 131072
    s_mov_b32 m0, s31
    s_add_u32 s31, s31, 4096
    buffer_load_dwordx4 v17, s[12:15], s30 offen lds
    s_add_u32 s30, s30, 131072
    s_mov_b32 m0, s31
    s_add_u32 s31, s31, 4096
    buffer_load_dwordx4 v17, s[12:15], s30 offen lds
    s_add_u32 s30, s30, 131072
    s_mov_b32 m0, s31
    s_add_u32 s31, s31, 4096
    buffer_load_dwordx4 v17, s[12:15], s30 offen lds
    s_add_u32 s30, s30, 131072
    s_mov_b32 m0, s31
    s_add_u32 s31, s31, 4096
    buffer_load_dwordx4 v17, s[12:15], s30 offen lds
    s_add_u32 s30, s30, 131072
    v_lshl_add_u32 v17, v24, 3, v21
    v_lshlrev_b32 v17, 8, v17
    v_lshl_add_u32 v17, v20, 1, v17
    s_lshl_b32 s30, s20, 6
    v_add_u32 v17, s30, v17
    v_lshlrev_b32 v14, 4, v16
    s_lshl_b32 s30, s20, 11
    v_add_u32 v14, s30, v14
    s_cmp_ge_u32 s34, 64
    s_cbranch_scc1 L_b_hook1
    s_cmp_lg_u32 s20, 0
    s_cbranch_scc1 L_b_zeroedk
    v_mov_b32 v242, 0
    v_mov_b32 v243, 0
    s_lshl_b32 s30, s34, 7
    s_add_u32 s30, s30, 105906176
    buffer_store_dword v243, v242, s[8:11], s30 offen sc1
L_b_zeroedk:
    s_waitcnt vmcnt(8)
    s_cmp_lg_u32 s20, 0
    s_cbranch_scc1 L_vik
    v_and_b32 v240, 7, v0
    v_lshlrev_b32 v240, 2, v240
    global_load_dword v241, v240, s[28:29] sc1
L_vik:
L_b_hook1:
    s_waitcnt vmcnt(0)
    s_barrier
    s_cmp_ge_u32 s34, 64
    s_cbranch_scc1 L_b_hook2
    s_cmp_lg_u32 s20, 0
    s_cbranch_scc1 L_b_arrivedk
    s_mov_b32 s79, 0
    s_cmp_eq_u32 s3, 1
    s_cbranch_scc1 L_vdk_ok
L_vdk:
    v_readlane_b32 s4, v241, 0
    v_readlane_b32 s5, v241, 1
    v_readlane_b32 s6, v241, 2
    v_readlane_b32 s7, v241, 3
    v_readlane_b32 s80, v241, 4
    v_readlane_b32 s81, v241, 5
    v_readlane_b32 s82, v241, 6
    v_readlane_b32 s83, v241, 7
    s_add_u32 s78, s4, s5
    s_add_u32 s78, s78, s6
    s_add_u32 s78, s78, s7
    s_add_u32 s78, s78, s80
    s_add_u32 s78, s78, s81
    s_add_u32 s78, s78, s82
    s_add_u32 s78, s78, s83
    s_cmp_ge_u32 s78, 256
    s_cbranch_scc1 L_vdk_full
    s_sleep 16
    v_and_b32 v240, 7, v0
    v_lshlrev_b32 v240, 2, v240
    global_load_dword v241, v240, s[28:29] sc1
    s_waitcnt vmcnt(0)
    s_sub_u32 s22, s22, 1
    s_cbranch_scc0 L_vdk
    s_branch L_timeout
L_vdk_full:
    s_cmp_lg_u32 s4, 32
    s_cselect_b32 s79, 1, s79
    s_cmp_lg_u32 s5, 32
    s_cselect_b32 s79, 1, s79
    s_cmp_lg_u32 s6, 32
    s_cselect_b32 s79, 1, s79
    s_cmp_lg_u32 s7, 32
    s_cselect_b32 s79, 1, s79
    s_cmp_lg_u32 s80, 32
    s_cselect_b32 s79, 1, s79
    s_cmp_lg_u32 s81, 32
    s_cselect_b32 s79, 1, s79
    s_cmp_lg_u32 s82, 32
    s_cselect_b32 s79, 1, s79
    s_cmp_lg_u32 s83, 32
    s_cselect_b32 s79, 1, s79
L_vdk_ok:
    s_cmp_lg_u32 s79, 0
    s_cbranch_scc1 L_b_arrivedk
    v_mov_b32 v238, 192
    v_mov_b32 v239, 1
    s_mov_b64 exec, 1
    global_atomic_add v239, v238, v239, s[28:29] sc0
    s_mov_b64 exec, -1
L_b_arrivedk:
L_b_hook2:
    ds_read_b64_tr_b16 a[0:1], v17 offset:0
    ds_read_b64_tr_b16 a[2:3], v17 offset:1024
    ds_read_b64_tr_b16 a[4:5], v17 offset:4096
    ds_read_b64_tr_b16 a[6:7], v17 offset:5120
    ds_read_b64_tr_b16 a[8:9], v17 offset:8192
    ds_read_b64_tr_b16 a[10:11], v17 offset:9216
    ds_read_b64_tr_b16 a[12:13], v17 offset:12288
    ds_read_b64_tr_b16 a[14:15], v17 offset:13312
    s_waitcnt lgkmcnt(0)
    ds_read_b64_tr_b16 a[16:17], v17 offset:16384
    ds_read_b64_tr_b16 a[18:19], v17 offset:17408
    ds_read_b64_tr_b16 a[20:21], v17 offset:20480
    ds_read_b64_tr_b16 a[22:23], v17 offset:21504
    ds_read_b64_tr_b16 a[24:25], v17 offset:24576
    ds_read_b64_tr_b16 a[26:27], v17 offset:25600
    ds_read_b64_tr_b16 a[28:29], v17 offset:28672
    ds_read_b64_tr_b16 a[30:31], v17 offset:29696
    s_waitcnt lgkmcnt(0)
    ds_read_b64_tr_b16 a[32:33], v17 offset:32768
    ds_read_b64_tr_b16 a[34:35], v17 offset:33792
    ds_read_b64_tr_b16 a[36:37], v17 offset:36864
    ds_read_b64_tr_b16 a[38:39], v17 offset:37888
    v_add_u32 v17, 40960, v17
    ds_read_b64_tr_b16 a[40:41], v17 offset:0
    ds_read_b64_tr_b16 a[42:43], v17 offset:1024
    ds_read_b64_tr_b16 a[44:45], v17 offset:4096
    ds_read_b64_tr_b16 a[46:47], v17 offset:5120
    s_waitcnt lgkmcnt(0)
    ds_read_b64_tr_b16 a[48:49], v17 offset:8192
    ds_read_b64_tr_b16 a[50:51], v17 offset:9216
    ds_read_b64_tr_b16 a[52:53], v17 offset:12288
    ds_read_b64_tr_b16 a[54:55], v17 offset:13312
    ds_read_b64_tr_b16 a[56:57], v17 offset:16384
    ds_read_b64_tr_b16 a[58:59], v17 offset:17408
    ds_read_b64_tr_b16 a[60:61], v17 offset:20480
    ds_read_b64_tr_b16 a[62:63], v17 offset:21504
    s_waitcnt lgkmcnt(0)
    ds_read_b64_tr_b16 a[64:65], v17 offset:24576
    ds_read_b64_tr_b16 a[66:67], v17 offset:25600
    ds_read_b64_tr_b16 a[68:69], v17 offset:28672
    ds_read_b64_tr_b16 a[70:71], v17 offset:29696
    ds_read_b64_tr_b16 a[72:73], v17 offset:32768
    ds_read_b64_tr_b16 a[74:75], v17 offset:33792
    ds_read_b64_tr_b16 a[76:77], v17 offset:36864
    ds_read_b64_tr_b16 a[78:79], v17 offset:37888
    s_waitcnt lgkmcnt(0)
    v_add_u32 v17, 40960, v17
    ds_read_b64_tr_b16 a[80:81], v17 offset:0
    ds_read_b64_tr_b16 a[82:83], v17 offset:1024
    ds_read_b64_tr_b16 a[84:85], v17 offset:4096
    ds_read_b64_tr_b16 a[86:87], v17 offset:5120
    ds_read_b64_tr_b16 a[88:89], v17 offset:8192
    ds_read_b64_tr_b16 a[90:91], v17 offset:9216
    ds_read_b64_tr_b16 a[92:93], v17 offset:12288
    ds_read_b64_tr_b16 a[94:95], v17 offset:13312
    s_waitcnt lgkmcnt(0)
    ds_read_b64_tr_b16 a[96:97], v17 offset:16384
    ds_read_b64_tr_b16 a[98:99], v17 offset:17408
    ds_read_b64_tr_b16 a[100:101], v17 offset:20480
    ds_read_b64_tr_b16 a[102:103], v17 offset:21504
    ds_read_b64_tr_b16 a[104:105], v17 offset:24576
    ds_read_b64_tr_b16 a[106:107], v17 offset:25600
    ds_read_b64_tr_b16 a[108:109], v17 offset:28672
    ds_read_b64_tr_b16 a[110:111], v17 offset:29696
    s_waitcnt lgkmcnt(0)
    ds_read_b64_tr_b16 a[112:113], v17 offset:32768
    ds_read_b64_tr_b16 a[114:115], v17 offset:33792
    ds_read_b64_tr_b16 a[116:117], v17 offset:36864
    ds_read_b64_tr_b16 a[118:119], v17 offset:37888
    v_add_u32 v17, 40960, v17
    ds_read_b64_tr_b16 a[120:121], v17 offset:0
    ds_read_b64_tr_b16 a[122:123], v17 offset:1024
    ds_read_b64_tr_b16 a[124:125], v17 offset:4096
    ds_read_b64_tr_b16 a[126:127], v17 offset:5120
    s_waitcnt lgkmcnt(0)
    ds_read_b64_tr_b16 a[128:129], v17 offset:8192
    ds_read_b64_tr_b16 a[130:131], v17 offset:9216
    ds_read_b64_tr_b16 a[132:133], v17 offset:12288
    ds_read_b64_tr_b16 a[134:135], v17 offset:13312
    ds_read_b64_tr_b16 a[136:137], v17 offset:16384
    ds_read_b64_tr_b16 a[138:139], v17 offset:17408
    ds_read_b64_tr_b16 a[140:141], v17 offset:20480
    ds_read_b64_tr_b16 a[142:143], v17 offset:21504
    s_waitcnt lgkmcnt(0)
    ds_read_b64_tr_b16 a[144:145], v17 offset:24576
    ds_read_b64_tr_b16 a[146:147], v17 offset:25600
    ds_read_b64_tr_b16 a[148:149], v17 offset:28672
    ds_read_b64_tr_b16 a[150:151], v17 offset:29696
    ds_read_b64_tr_b16 a[152:153], v17 offset:32768
    ds_read_b64_tr_b16 a[154:155], v17 offset:33792
    ds_read_b64_tr_b16 a[156:157], v17 offset:36864
    ds_read_b64_tr_b16 a[158:159], v17 offset:37888
    s_waitcnt lgkmcnt(0)
    s_branch L_p1_wdone
L_p1_notA:
    s_cmp_eq_u32 s42, 1
    s_cbranch_scc0 L_p1_gate
    s_load_dwordx2 s[4:5], s[0:1], 64
    s_load_dwordx2 s[6:7], s[0:1], 0
    s_sub_u32 s30, s34, 96
    s_lshl_b32 s30, s30, 2
    s_add_u32 s30, s30, s20
    s_lshl_b32 s36, s30, 11
    s_add_u32 s36, s36, 92274688
    s_mov_b32 s37, 196608
    s_lshr_b32 s31, s30, 5
    s_and_b32 s32, s30, 31
    s_mul_i32 s31, s31, 1280
    s_mul_i32 s32, s32, 40
    s_add_u32 s32, s32, s31
    s_waitcnt lgkmcnt(0)
    s_mov_b32 s12, s4
    s_and_b32 s13, s5, 0xffff
    s_mov_b32 s14, 2457600
    s_mov_b32 s15, 0x20000
    s_mov_b32 s24, s6
    s_and_b32 s25, s7, 0xffff
    s_mov_b32 s26, 2621440
    s_mov_b32 s27, 0x20000
    v_lshrrev_b32 v17, 2, v16
    v_mul_u32_u24 v17, 3840, v17
    v_and_b32 v18, 3, v16
    v_lshl_add_u32 v17, v18, 4, v17
    v_add_u32 v17, s32, v17
    v_cmp_eq_u32 vcc, 3, v18
    s_mul_i32 s31, s20, 40960
    s_mov_b32 s30, 0
    v_cndmask_b32 v17, v17, v19, vcc
    s_mov_b32 m0, s31
    s_add_u32 s31, s31, 1024
    buffer_load_dwordx4 v17, s[12:15], s30 offen lds
    s_add_u32 s30, s30, 61440
    s_mov_b32 m0, s31
    s_add_u32 s31, s31, 1024
    buffer_load_dwordx4 v17, s[12:15], s30 offen lds
    s_add_u32 s30, s30, 61440
    s_mov_b32 m0, s31
    s_add_u32 s31, s31, 1024
    buffer_load_dwordx4 v17, s[12:15], s30 offen lds
    s_add_u32 s30, s30, 61440
    s_mov_b32 m0, s31
    s_add_u32 s31, s31, 1024
    buffer_load_dwordx4 v17, s[12:15], s30 offen lds
    s_add_u32 s30, s30, 61440
    s_mov_b32 m0, s31
    s_add_u32 s31, s31, 1024
    buffer_load_dwordx4 v17, s[12:15], s30 offen lds
    s_add_u32 s30, s30, 61440
    s_mov_b32 m0, s31
    s_add_u32 s31, s31, 1024
    buffer_load_dwordx4 v17, s[12:15], s30 offen lds
    s_add_u32 s30, s30, 61440
    s_mov_b32 m0, s31
    s_add_u32 s31, s31, 1024
    buffer_load_dwordx4 v17, s[12:15], s30 offen lds
    s_add_u32 s30, s30, 61440
    s_mov_b32 m0, s31
    s_add_u32 s31, s31, 1024
    buffer_load_dwordx4 v17, s[12:15], s30 offen lds
    s_add_u32 s30, s30, 61440
    s_mov_b32 m0, s31
    s_add_u32 s31, s31, 1024
    buffer_load_dwordx4 v17, s[12:15], s30 offen lds
    s_add_u32 s30, s30, 61440
    s_mov_b32 m0, s31
    s_add_u32 s31, s31, 1024
    buffer_load_dwordx4 v17, s[12:15], s30 offen lds
    s_add_u32 s30, s30, 61440
    s_mov_b32 m0, s31
    s_add_u32 s31, s31, 1024
    buffer_load_dwordx4 v17, s[12:15], s30 offen lds
    s_add_u32 s30, s30, 61440
    s_mov_b32 m0, s31
    s_add_u32 s31, s31, 1024
    buffer_load_dwordx4 v17, s[12:15], s30 offen lds
    s_add_u32 s30, s30, 61440
    s_mov_b32 m0, s31
    s_add_u32 s31, s31, 1024
    buffer_load_dwordx4 v17, s[12:15], s30 offen lds
    s_add_u32 s30, s30, 61440
    s_mov_b32 m0, s31
    s_add_u32 s31, s31, 1024
    buffer_load_dwordx4 v17, s[12:15], s30 offen lds
    s_add_u32 s30, s30, 61440
    s_mov_b32 m0, s31
    s_add_u32 s31, s31, 1024
    buffer_load_dwordx4 v17, s[12:15], s30 offen lds
    s_add_u32 s30, s30, 61440
    s_mov_b32 m0, s31
    s_add_u32 s31, s31, 1024
    buffer_load_dwordx4 v17, s[12:15], s30 offen lds
    s_add_u32 s30, s30, 61440
    s_mov_b32 m0, s31
    s_add_u32 s31, s31, 1024
    buffer_load_dwordx4 v17, s[12:15], s30 offen lds
    s_add_u32 s30, s30, 61440
    s_mov_b32 m0, s31
    s_add_u32 s31, s31, 1024
    buffer_load_dwordx4 v17, s[12:15], s30 offen lds
    s_add_u32 s30, s30, 61440
    s_mov_b32 m0, s31
    s_add_u32 s31, s31, 1024
    buffer_load_dwordx4 v17, s[12:15], s30 offen lds
    s_add_u32 s30, s30, 61440
    s_mov_b32 m0, s31
    s_add_u32 s31, s31, 1024
    buffer_load_dwordx4 v17, s[12:15], s30 offen lds
    s_add_u32 s30, s30, 61440
    s_mov_b32 m0, s31
    s_add_u32 s31, s31, 1024
    buffer_load_dwordx4 v17, s[12:15], s30 offen lds
    s_add_u32 s30, s30, 61440
    s_mov_b32 m0, s31
    s_add_u32 s31, s31, 1024
    buffer_load_dwordx4 v17, s[12:15], s30 offen lds
    s_add_u32 s30, s30, 61440
    s_mov_b32 m0, s31
    s_add_u32 s31, s31, 1024
    buffer_load_dwordx4 v17, s[12:15], s30 offen lds
    s_add_u32 s30, s30, 61440
    s_mov_b32 m0, s31
    s_add_u32 s31, s31, 1024
    buffer_load_dwordx4 v17, s[12:15], s30 offen lds
    s_add_u32 s30, s30, 61440
    s_mov_b32 m0, s31
    s_add_u32 s31, s31, 1024
    buffer_load_dwordx4 v17, s[12:15], s30 offen lds
    s_add_u32 s30, s30, 61440
    s_mov_b32 m0, s31
    s_add_u32 s31, s31, 1024
    buffer_load_dwordx4 v17, s[12:15], s30 offen lds
    s_add_u32 s30, s30, 61440
    s_mov_b32 m0, s31
    s_add_u32 s31, s31, 1024
    buffer_load_dwordx4 v17, s[12:15], s30 offen lds
    s_add_u32 s30, s30, 61440
    s_mov_b32 m0, s31
    s_add_u32 s31, s31, 1024
    buffer_load_dwordx4 v17, s[12:15], s30 offen lds
    s_add_u32 s30, s30, 61440
    s_mov_b32 m0, s31
    s_add_u32 s31, s31, 1024
    buffer_load_dwordx4 v17, s[12:15], s30 offen lds
    s_add_u32 s30, s30, 61440
    s_mov_b32 m0, s31
    s_add_u32 s31, s31, 1024
    buffer_load_dwordx4 v17, s[12:15], s30 offen lds
    s_add_u32 s30, s30, 61440
    s_mov_b32 m0, s31
    s_add_u32 s31, s31, 1024
    buffer_load_dwordx4 v17, s[12:15], s30 offen lds
    s_add_u32 s30, s30, 61440
    s_mov_b32 m0, s31
    s_add_u32 s31, s31, 1024
    buffer_load_dwordx4 v17, s[12:15], s30 offen lds
    s_add_u32 s30, s30, 61440
    s_mov_b32 m0, s31
    s_add_u32 s31, s31, 1024
    buffer_load_dwordx4 v17, s[12:15], s30 offen lds
    s_add_u32 s30, s30, 61440
    s_mov_b32 m0, s31
    s_add_u32 s31, s31, 1024
    buffer_load_dwordx4 v17, s[12:15], s30 offen lds
    s_add_u32 s30, s30, 61440
    s_mov_b32 m0, s31
    s_add_u32 s31, s31, 1024
    buffer_load_dwordx4 v17, s[12:15], s30 offen lds
    s_add_u32 s30, s30, 61440
    s_mov_b32 m0, s31
    s_add_u32 s31, s31, 1024
    buffer_load_dwordx4 v17, s[12:15], s30 offen lds
    s_add_u32 s30, s30, 61440
    s_mov_b32 m0, s31
    s_add_u32 s31, s31, 1024
    buffer_load_dwordx4 v17, s[12:15], s30 offen lds
    s_add_u32 s30, s30, 61440
    s_mov_b32 m0, s31
    s_add_u32 s31, s31, 1024
    buffer_load_dwordx4 v17, s[12:15], s30 offen lds
    s_add_u32 s30, s30, 61440
    s_mov_b32 m0, s31
    s_add_u32 s31, s31, 1024
    buffer_load_dwordx4 v17, s[12:15], s30 offen lds
    s_add_u32 s30, s30, 61440
    s_mov_b32 m0, s31
    s_add_u32 s31, s31, 1024
    buffer_load_dwordx4 v17, s[12:15], s30 offen lds
    s_add_u32 s30, s30, 61440
    s_waitcnt vmcnt(0)
    s_branch L_p1_priv
L_p1_gate:
    s_load_dwordx2 s[4:5], s[0:1], 80
    s_load_dwordx2 s[6:7], s[0:1], 0
    s_mov_b32 s36, 104857600
    s_cmp_eq_u32 s20, 0
    s_cselect_b32 s36, s36, 1073741824
    s_mov_b32 s37, 2048
    s_waitcnt lgkmcnt(0)
    s_mov_b32 s12, s4
    s_and_b32 s13, s5, 0xffff
    s_mov_b32 s14, 1280
    s_mov_b32 s15, 0x20000
    s_mov_b32 s24, s6
    s_and_b32 s25, s7, 0xffff
    s_mov_b32 s26, 2621440
    s_mov_b32 s27, 0x20000
    s_mul_i32 s31, s20, 40960
    v_lshlrev_b32 v17, 4, v16
    v_add_u32 v17, s31, v17
    v_mov_b32 v32, 0
    v_mov_b32 v33, 0
    v_mov_b32 v34, 0
    v_mov_b32 v35, 0
    ds_write_b128 v17, v[32:35] offset:0
    ds_write_b128 v17, v[32:35] offset:1024
    ds_write_b128 v17, v[32:35] offset:2048
    ds_write_b128 v17, v[32:35] offset:3072
    ds_write_b128 v17, v[32:35] offset:4096
    ds_write_b128 v17, v[32:35] offset:5120
    ds_write_b128 v17, v[32:35] offset:6144
    ds_write_b128 v17, v[32:35] offset:7168
    ds_write_b128 v17, v[32:35] offset:8192
    ds_write_b128 v17, v[32:35] offset:9216
    ds_write_b128 v17, v[32:35] offset:10240
    ds_write_b128 v17, v[32:35] offset:11264
    ds_write_b128 v17, v[32:35] offset:12288
    ds_write_b128 v17, v[32:35] offset:13312
    ds_write_b128 v17, v[32:35] offset:14336
    ds_write_b128 v17, v[32:35] offset:15360
    ds_write_b128 v17, v[32:35] offset:16384
    ds_write_b128 v17, v[32:35] offset:17408
    ds_write_b128 v17, v[32:35] offset:18432
    ds_write_b128 v17, v[32:35] offset:19456
    ds_write_b128 v17, v[32:35] offset:20480
    ds_write_b128 v17, v[32:35] offset:21504
    ds_write_b128 v17, v[32:35] offset:22528
    ds_write_b128 v17, v[32:35] offset:23552
    ds_write_b128 v17, v[32:35] offset:24576
    ds_write_b128 v17, v[32:35] offset:25600
    ds_write_b128 v17, v[32:35] offset:26624
    ds_write_b128 v17, v[32:35] offset:27648
    ds_write_b128 v17, v[32:35] offset:28672
    ds_write_b128 v17, v[32:35] offset:29696
    ds_write_b128 v17, v[32:35] offset:30720
    ds_write_b128 v17, v[32:35] offset:31744
    ds_write_b128 v17, v[32:35] offset:32768
    ds_write_b128 v17, v[32:35] offset:33792
    ds_write_b128 v17, v[32:35] offset:34816
    ds_write_b128 v17, v[32:35] offset:35840
    ds_write_b128 v17, v[32:35] offset:36864
    ds_write_b128 v17, v[32:35] offset:37888
    ds_write_b128 v17, v[32:35] offset:38912
    ds_write_b128 v17, v[32:35] offset:39936
    v_lshlrev_b32 v18, 1, v16
    buffer_load_ushort v36, v18, s[12:15], 0 offen offset:0
    buffer_load_ushort v37, v18, s[12:15], 0 offen offset:128
    buffer_load_ushort v38, v18, s[12:15], 0 offen offset:256
    buffer_load_ushort v39, v18, s[12:15], 0 offen offset:384
    buffer_load_ushort v40, v18, s[12:15], 0 offen offset:512
    buffer_load_ushort v41, v18, s[12:15], 0 offen offset:640
    buffer_load_ushort v42, v18, s[12:15], 0 offen offset:768
    buffer_load_ushort v43, v18, s[12:15], 0 offen offset:896
    buffer_load_ushort v44, v18, s[12:15], 0 offen offset:1024
    buffer_load_ushort v45, v18, s[12:15], 0 offen offset:1152
    v_lshlrev_b32 v17, 6, v16
    v_add_u32 v17, s31, v17
    s_waitcnt vmcnt(0) lgkmcnt(0)
    ds_write_b16 v17, v36 offset:0
    ds_write_b16 v17, v37 offset:4096
    ds_write_b16 v17, v38 offset:8192
    ds_write_b16 v17, v39 offset:12288
    ds_write_b16 v17, v40 offset:16384
    ds_write_b16 v17, v41 offset:20480
    ds_write_b16 v17, v42 offset:24576
    ds_write_b16 v17, v43 offset:28672
    ds_write_b16 v17, v44 offset:32768
    ds_write_b16 v17, v45 offset:36864
    s_waitcnt lgkmcnt(0)
L_p1_priv:
    v_lshl_add_u32 v17, v24, 3, v21
    v_lshlrev_b32 v17, 6, v17
    v_lshlrev_b32 v18, 1, v20
    v_cmp_le_u32 vcc, 20, v20
    v_mov_b32 v19, 48
    s_nop 0
    v_cndmask_b32 v18, v18, v19, vcc
    v_add_u32 v17, v17, v18
    s_mul_i32 s31, s20, 40960
    v_add_u32 v17, s31, v17
    v_lshlrev_b32 v14, 4, v16
    ds_read_b64_tr_b16 a[0:1], v17 offset:0
    ds_read_b64_tr_b16 a[2:3], v17 offset:256
    ds_read_b64_tr_b16 a[4:5], v17 offset:1024
    ds_read_b64_tr_b16 a[6:7], v17 offset:1280
    ds_read_b64_tr_b16 a[8:9], v17 offset:2048
    ds_read_b64_tr_b16 a[10:11], v17 offset:2304
    ds_read_b64_tr_b16 a[12:13], v17 offset:3072
    ds_read_b64_tr_b16 a[14:15], v17 offset:3328
    s_waitcnt lgkmcnt(0)
    ds_read_b64_tr_b16 a[16:17], v17 offset:4096
    ds_read_b64_tr_b16 a[18:19], v17 offset:4352
    ds_read_b64_tr_b16 a[20:21], v17 offset:5120
    ds_read_b64_tr_b16 a[22:23], v17 offset:5376
    ds_read_b64_tr_b16 a[24:25], v17 offset:6144
    ds_read_b64_tr_b16 a[26:27], v17 offset:6400
    ds_read_b64_tr_b16 a[28:29], v17 offset:7168
    ds_read_b64_tr_b16 a[30:31], v17 offset:7424
    s_waitcnt lgkmcnt(0)
    ds_read_b64_tr_b16 a[32:33], v17 offset:8192
    ds_read_b64_tr_b16 a[34:35], v17 offset:8448
    ds_read_b64_tr_b16 a[36:37], v17 offset:9216
    ds_read_b64_tr_b16 a[38:39], v17 offset:9472
    ds_read_b64_tr_b16 a[40:41], v17 offset:10240
    ds_read_b64_tr_b16 a[42:43], v17 offset:10496
    ds_read_b64_tr_b16 a[44:45], v17 offset:11264
    ds_read_b64_tr_b16 a[46:47], v17 offset:11520
    s_waitcnt lgkmcnt(0)
    ds_read_b64_tr_b16 a[48:49], v17 offset:12288
    ds_read_b64_tr_b16 a[50:51], v17 offset:12544
    ds_read_b64_tr_b16 a[52:53], v17 offset:13312
    ds_read_b64_tr_b16 a[54:55], v17 offset:13568
    ds_read_b64_tr_b16 a[56:57], v17 offset:14336
    ds_read_b64_tr_b16 a[58:59], v17 offset:14592
    ds_read_b64_tr_b16 a[60:61], v17 offset:15360
    ds_read_b64_tr_b16 a[62:63], v17 offset:15616
    s_waitcnt lgkmcnt(0)
    ds_read_b64_tr_b16 a[64:65], v17 offset:16384
    ds_read_b64_tr_b16 a[66:67], v17 offset:16640
    ds_read_b64_tr_b16 a[68:69], v17 offset:17408
    ds_read_b64_tr_b16 a[70:71], v17 offset:17664
    ds_read_b64_tr_b16 a[72:73], v17 offset:18432
    ds_read_b64_tr_b16 a[74:75], v17 offset:18688
    ds_read_b64_tr_b16 a[76:77], v17 offset:19456
    ds_read_b64_tr_b16 a[78:79], v17 offset:19712
    s_waitcnt lgkmcnt(0)
    ds_read_b64_tr_b16 a[80:81], v17 offset:20480
    ds_read_b64_tr_b16 a[82:83], v17 offset:20736
    ds_read_b64_tr_b16 a[84:85], v17 offset:21504
    ds_read_b64_tr_b16 a[86:87], v17 offset:21760
    ds_read_b64_tr_b16 a[88:89], v17 offset:22528
    ds_read_b64_tr_b16 a[90:91], v17 offset:22784
    ds_read_b64_tr_b16 a[92:93], v17 offset:23552
    ds_read_b64_tr_b16 a[94:95], v17 offset:23808
    s_waitcnt lgkmcnt(0)
    ds_read_b64_tr_b16 a[96:97], v17 offset:24576
    ds_read_b64_tr_b16 a[98:99], v17 offset:24832
    ds_read_b64_tr_b16 a[100:101], v17 offset:25600
    ds_read_b64_tr_b16 a[102:103], v17 offset:25856
    ds_read_b64_tr_b16 a[104:105], v17 offset:26624
    ds_read_b64_tr_b16 a[106:107], v17 offset:26880
    ds_read_b64_tr_b16 a[108:109], v17 offset:27648
    ds_read_b64_tr_b16 a[110:111], v17 offset:27904
    s_waitcnt lgkmcnt(0)
    ds_read_b64_tr_b16 a[112:113], v17 offset:28672
    ds_read_b64_tr_b16 a[114:115], v17 offset:28928
    ds_read_b64_tr_b16 a[116:117], v17 offset:29696
    ds_read_b64_tr_b16 a[118:119], v17 offset:29952
    ds_read_b64_tr_b16 a[120:121], v17 offset:30720
    ds_read_b64_tr_b16 a[122:123], v17 offset:30976
    ds_read_b64_tr_b16 a[124:125], v17 offset:31744
    ds_read_b64_tr_b16 a[126:127], v17 offset:32000
    s_waitcnt lgkmcnt(0)
    ds_read_b64_tr_b16 a[128:129], v17 offset:32768
    ds_read_b64_tr_b16 a[130:131], v17 offset:33024
    ds_read_b64_tr_b16 a[132:133], v17 offset:33792
    ds_read_b64_tr_b16 a[134:135], v17 offset:34048
    ds_read_b64_tr_b16 a[136:137], v17 offset:34816
    ds_read_b64_tr_b16 a[138:139], v17 offset:35072
    ds_read_b64_tr_b16 a[140:141], v17 offset:35840
    ds_read_b64_tr_b16 a[142:143], v17 offset:36096
    s_waitcnt lgkmcnt(0)
    ds_read_b64_tr_b16 a[144:145], v17 offset:36864
    ds_read_b64_tr_b16 a[146:147], v17 offset:37120
    ds_read_b64_tr_b16 a[148:149], v17 offset:37888
    ds_read_b64_tr_b16 a[150:151], v17 offset:38144
    ds_read_b64_tr_b16 a[152:153], v17 offset:38912
    ds_read_b64_tr_b16 a[154:155], v17 offset:39168
    ds_read_b64_tr_b16 a[156:157], v17 offset:39936
    ds_read_b64_tr_b16 a[158:159], v17 offset:40192
    s_waitcnt lgkmcnt(0)
L_p1_wdone:
    s_waitcnt lgkmcnt(0)
    s_barrier
    s_cmp_ge_u32 s34, 64
    s_cbranch_scc1 L_b_hook3
    s_cmp_lg_u32 s20, 0
    s_cbranch_scc1 L_afk
    s_cmp_lg_u32 s79, 0
    s_cbranch_scc1 L_afk
    s_waitcnt vmcnt(0)
    v_readfirstlane_b32 s78, v239
    s_cmp_lg_u32 s78, 255
    s_cbranch_scc1 L_afk
    v_mov_b32 v238, 96
    v_mov_b32 v239, 1
    global_store_dword v238, v239, s[28:29] sc1
L_afk:
    s_cmp_lg_u32 s20, 0
    s_cbranch_scc1 L_vbk
    v_mov_b32 v240, 0
    v_mov_b32 v241, s79
    ds_write_b32 v240, v241
    s_waitcnt lgkmcnt(0)
L_vbk:
    s_barrier
    v_mov_b32 v240, 0
    ds_read_b32 v241, v240
    s_waitcnt lgkmcnt(0)
    v_readfirstlane_b32 s79, v241
    s_barrier
    s_cmp_lg_u32 s79, 0
    s_cbranch_scc1 L_fallback
    s_cmp_eq_u32 s3, 0
    s_cbranch_scc1 L_b_hook3
    s_cmp_lg_u32 s20, 0
    s_cbranch_scc1 L_b_censusk_ok
L_b_censusk:
    v_mov_b32 v240, 96
    global_load_dword v241, v240, s[28:29] sc1
    s_waitcnt vmcnt(0)
    v_readfirstlane_b32 s30, v241
    s_cmp_lg_u32 s30, 0
    s_cbranch_scc1 L_b_censusk_ok
    s_sleep 16
    s_sub_u32 s22, s22, 1
    s_cbranch_scc0 L_b_censusk
    s_branch L_timeout
L_b_censusk_ok:
    s_barrier
L_b_hook3:
    s_lshl_b32 s30, s20, 6
    s_add_u32 s30, s30, 0
    v_add_u32 v17, s30, v16
    v_mul_u32_u24 v18, 12946, v17
    v_lshrrev_b32 v18, 20, v18
    v_mul_u32_u24 v19, 81, v18
    v_sub_u32 v19, v17, v19
    v_mul_u32_u24 v20, 1280, v18
    v_lshl_add_u32 v20, v19, 4, v20
    v_cmp_gt_u32 vcc, 80, v19
    v_cmp_gt_u32 s[32:33], 32, v18
    s_nop 3
    s_and_b64 vcc, vcc, s[32:33]
    v_mov_b32 v17, 1073741824
    s_nop 0
    v_cndmask_b32 v1, v17, v20, vcc
    s_lshl_b32 s30, s20, 6
    s_add_u32 s30, s30, 256
    v_add_u32 v17, s30, v16
    v_mul_u32_u24 v18, 12946, v17
    v_lshrrev_b32 v18, 20, v18
    v_mul_u32_u24 v19, 81, v18
    v_sub_u32 v19, v17, v19
    v_mul_u32_u24 v20, 1280, v18
    v_lshl_add_u32 v20, v19, 4, v20
    v_cmp_gt_u32 vcc, 80, v19
    v_cmp_gt_u32 s[32:33], 32, v18
    s_nop 3
    s_and_b64 vcc, vcc, s[32:33]
    v_mov_b32 v17, 1073741824
    s_nop 0
    v_cndmask_b32 v2, v17, v20, vcc
    s_lshl_b32 s30, s20, 6
    s_add_u32 s30, s30, 512
    v_add_u32 v17, s30, v16
    v_mul_u32_u24 v18, 12946, v17
    v_lshrrev_b32 v18, 20, v18
    v_mul_u32_u24 v19, 81, v18
    v_sub_u32 v19, v17, v19
    v_mul_u32_u24 v20, 1280, v18
    v_lshl_add_u32 v20, v19, 4, v20
    v_cmp_gt_u32 vcc, 80, v19
    v_cmp_gt_u32 s[32:33], 32, v18
    s_nop 3
    s_and_b64 vcc, vcc, s[32:33]
    v_mov_b32 v17, 1073741824
    s_nop 0
    v_cndmask_b32 v3, v17, v20, vcc
    s_lshl_b32 s30, s20, 6
    s_add_u32 s30, s30, 768
    v_add_u32 v17, s30, v16
    v_mul_u32_u24 v18, 12946, v17
    v_lshrrev_b32 v18, 20, v18
    v_mul_u32_u24 v19, 81, v18
    v_sub_u32 v19, v17, v19
    v_mul_u32_u24 v20, 1280, v18
    v_lshl_add_u32 v20, v19, 4, v20
    v_cmp_gt_u32 vcc, 80, v19
    v_cmp_gt_u32 s[32:33], 32, v18
    s_nop 3
    s_and_b64 vcc, vcc, s[32:33]
    v_mov_b32 v17, 1073741824
    s_nop 0
    v_cndmask_b32 v4, v17, v20, vcc
    s_lshl_b32 s30, s20, 6
    s_add_u32 s30, s30, 1024
    v_add_u32 v17, s30, v16
    v_mul_u32_u24 v18, 12946, v17
    v_lshrrev_b32 v18, 20, v18
    v_mul_u32_u24 v19, 81, v18
    v_sub_u32 v19, v17, v19
    v_mul_u32_u24 v20, 1280, v18
    v_lshl_add_u32 v20, v19, 4, v20
    v_cmp_gt_u32 vcc, 80, v19
    v_cmp_gt_u32 s[32:33], 32, v18
    s_nop 3
    s_and_b64 vcc, vcc, s[32:33]
    v_mov_b32 v17, 1073741824
    s_nop 0
    v_cndmask_b32 v5, v17, v20, vcc
    s_lshl_b32 s30, s20, 6
    s_add_u32 s30, s30, 1280
    v_add_u32 v17, s30, v16
    v_mul_u32_u24 v18, 12946, v17
    v_lshrrev_b32 v18, 20, v18
    v_mul_u32_u24 v19, 81, v18
    v_sub_u32 v19, v17, v19
    v_mul_u32_u24 v20, 1280, v18
    v_lshl_add_u32 v20, v19, 4, v20
    v_cmp_gt_u32 vcc, 80, v19
    v_cmp_gt_u32 s[32:33], 32, v18
    s_nop 3
    s_and_b64 vcc, vcc, s[32:33]
    v_mov_b32 v17, 1073741824
    s_nop 0
    v_cndmask_b32 v6, v17, v20, vcc
    s_lshl_b32 s30, s20, 6
    s_add_u32 s30, s30, 1536
    v_add_u32 v17, s30, v16
    v_mul_u32_u24 v18, 12946, v17
    v_lshrrev_b32 v18, 20, v18
    v_mul_u32_u24 v19, 81, v18
    v_sub_u32 v19, v17, v19
    v_mul_u32_u24 v20, 1280, v18
    v_lshl_add_u32 v20, v19, 4, v20
    v_cmp_gt_u32 vcc, 80, v19
    v_cmp_gt_u32 s[32:33], 32, v18
    s_nop 3
    s_and_b64 vcc, vcc, s[32:33]
    v_mov_b32 v17, 1073741824
    s_nop 0
    v_cndmask_b32 v7, v17, v20, vcc
    s_lshl_b32 s30, s20, 6
    s_add_u32 s30, s30, 1792
    v_add_u32 v17, s30, v16
    v_mul_u32_u24 v18, 12946, v17
    v_lshrrev_b32 v18, 20, v18
    v_mul_u32_u24 v19, 81, v18
    v_sub_u32 v19, v17, v19
    v_mul_u32_u24 v20, 1280, v18
    v_lshl_add_u32 v20, v19, 4, v20
    v_cmp_gt_u32 vcc, 80, v19
    v_cmp_gt_u32 s[32:33], 32, v18
    s_nop 3
    s_and_b64 vcc, vcc, s[32:33]
    v_mov_b32 v17, 1073741824
    s_nop 0
    v_cndmask_b32 v8, v17, v20, vcc
    s_lshl_b32 s30, s20, 6
    s_add_u32 s30, s30, 2048
    v_add_u32 v17, s30, v16
    v_mul_u32_u24 v18, 12946, v17
    v_lshrrev_b32 v18, 20, v18
    v_mul_u32_u24 v19, 81, v18
    v_sub_u32 v19, v17, v19
    v_mul_u32_u24 v20, 1280, v18
    v_lshl_add_u32 v20, v19, 4, v20
    v_cmp_gt_u32 vcc, 80, v19
    v_cmp_gt_u32 s[32:33], 32, v18
    s_nop 3
    s_and_b64 vcc, vcc, s[32:33]
    v_mov_b32 v17, 1073741824
    s_nop 0
    v_cndmask_b32 v9, v17, v20, vcc
    s_lshl_b32 s30, s20, 6
    s_add_u32 s30, s30, 2304
    v_add_u32 v17, s30, v16
    v_mul_u32_u24 v18, 12946, v17
    v_lshrrev_b32 v18, 20, v18
    v_mul_u32_u24 v19, 81, v18
    v_sub_u32 v19, v17, v19
    v_mul_u32_u24 v20, 1280, v18
    v_lshl_add_u32 v20, v19, 4, v20
    v_cmp_gt_u32 vcc, 80, v19
    v_cmp_gt_u32 s[32:33], 32, v18
    s_nop 3
    s_and_b64 vcc, vcc, s[32:33]
    v_mov_b32 v17, 1073741824
    s_nop 0
    v_cndmask_b32 v10, v17, v20, vcc
    s_lshl_b32 s30, s20, 6
    s_add_u32 s30, s30, 2560
    v_add_u32 v17, s30, v16
    v_mul_u32_u24 v18, 12946, v17
    v_lshrrev_b32 v18, 20, v18
    v_mul_u32_u24 v19, 81, v18
    v_sub_u32 v19, v17, v19
    v_mul_u32_u24 v20, 1280, v18
    v_lshl_add_u32 v20, v19, 4, v20
    v_cmp_gt_u32 vcc, 80, v19
    v_cmp_gt_u32 s[32:33], 32, v18
    s_nop 3
    s_and_b64 vcc, vcc, s[32:33]
    v_mov_b32 v17, 1073741824
    s_nop 0
    v_cndmask_b32 v11, v17, v20, vcc
    v_and_b32 v17, 31, v16
    v_mul_u32_u24 v17, 1296, v17
    v_lshrrev_b32 v18, 5, v16
    v_lshl_add_u32 v12, v18, 4, v17
    s_lshl_b32 s31, s20, 10
    s_add_u32 s31, s31, 0
    s_mov_b32 s40, 0
    s_add_u32 m0, s31, 0
    s_nop 0
    buffer_load_dwordx4 v1, s[24:27], s40 offen lds
    s_add_u32 m0, s31, 4096
    s_nop 0
    buffer_load_dwordx4 v2, s[24:27], s40 offen lds
    s_add_u32 m0, s31, 8192
    s_nop 0
    buffer_load_dwordx4 v3, s[24:27], s40 offen lds
    s_add_u32 m0, s31, 12288
    s_nop 0
    buffer_load_dwordx4 v4, s[24:27], s40 offen lds
    s_add_u32 m0, s31, 16384
    s_nop 0
    buffer_load_dwordx4 v5, s[24:27], s40 offen lds
    s_add_u32 m0, s31, 20480
    s_nop 0
    buffer_load_dwordx4 v6, s[24:27], s40 offen lds
    s_add_u32 m0, s31, 24576
    s_nop 0
    buffer_load_dwordx4 v7, s[24:27], s40 offen lds
    s_add_u32 m0, s31, 28672
    s_nop 0
    buffer_load_dwordx4 v8, s[24:27], s40 offen lds
    s_add_u32 m0, s31, 32768
    s_nop 0
    buffer_load_dwordx4 v9, s[24:27], s40 offen lds
    s_add_u32 m0, s31, 36864
    s_nop 0
    buffer_load_dwordx4 v10, s[24:27], s40 offen lds
    s_add_u32 m0, s31, 40960
    s_nop 0
    buffer_load_dwordx4 v11, s[24:27], s40 offen lds
    s_lshl_b32 s31, s20, 10
    s_add_u32 s31, s31, 45056
    s_mov_b32 s40, 40960
    s_add_u32 m0, s31, 0
    s_nop 0
    buffer_load_dwordx4 v1, s[24:27], s40 offen lds
    s_add_u32 m0, s31, 4096
    s_nop 0
    buffer_load_dwordx4 v2, s[24:27], s40 offen lds
    s_add_u32 m0, s31, 8192
    s_nop 0
    buffer_load_dwordx4 v3, s[24:27], s40 offen lds
    s_add_u32 m0, s31, 12288
    s_nop 0
    buffer_load_dwordx4 v4, s[24:27], s40 offen lds
    s_add_u32 m0, s31, 16384
    s_nop 0
    buffer_load_dwordx4 v5, s[24:27], s40 offen lds
    s_add_u32 m0, s31, 20480
    s_nop 0
    buffer_load_dwordx4 v6, s[24:27], s40 offen lds
    s_add_u32 m0, s31, 24576
    s_nop 0
    buffer_load_dwordx4 v7, s[24:27], s40 offen lds
    s_add_u32 m0, s31, 28672
    s_nop 0
    buffer_load_dwordx4 v8, s[24:27], s40 offen lds
    s_add_u32 m0, s31, 32768
    s_nop 0
    buffer_load_dwordx4 v9, s[24:27], s40 offen lds
    s_add_u32 m0, s31, 36864
    s_nop 0
    buffer_load_dwordx4 v10, s[24:27], s40 offen lds
    s_add_u32 m0, s31, 40960
    s_nop 0
    buffer_load_dwordx4 v11, s[24:27], s40 offen lds
    s_lshl_b32 s31, s20, 10
    s_add_u32 s31, s31, 90112
    s_mov_b32 s40, 81920
    s_add_u32 m0, s31, 0
    s_nop 0
    buffer_load_dwordx4 v1, s[24:27], s40 offen lds
    s_add_u32 m0, s31, 4096
    s_nop 0
    buffer_load_dwordx4 v2, s[24:27], s40 offen lds
    s_add_u32 m0, s31, 8192
    s_nop 0
    buffer_load_dwordx4 v3, s[24:27], s40 offen lds
    s_add_u32 m0, s31, 12288
    s_nop 0
    buffer_load_dwordx4 v4, s[24:27], s40 offen lds
    s_add_u32 m0, s31, 16384
    s_nop 0
    buffer_load_dwordx4 v5, s[24:27], s40 offen lds
    s_add_u32 m0, s31, 20480
    s_nop 0
    buffer_load_dwordx4 v6, s[24:27], s40 offen lds
    s_add_u32 m0, s31, 24576
    s_nop 0
    buffer_load_dwordx4 v7, s[24:27], s40 offen lds
    s_add_u32 m0, s31, 28672
    s_nop 0
    buffer_load_dwordx4 v8, s[24:27], s40 offen lds
    s_add_u32 m0, s31, 32768
    s_nop 0
    buffer_load_dwordx4 v9, s[24:27], s40 offen lds
    s_add_u32 m0, s31, 36864
    s_nop 0
    buffer_load_dwordx4 v10, s[24:27], s40 offen lds
    s_add_u32 m0, s31, 40960
    s_nop 0
    buffer_load_dwordx4 v11, s[24:27], s40 offen lds
    s_mov_b32 s35, 0
    s_mov_b32 s38, 0
    s_mov_b32 s39, 90112
    s_mov_b32 s40, 81920
    s_sub_u32 s36, s36, s37
    s_waitcnt vmcnt(22)
    s_barrier
    v_add_u32 v13, s38, v12
    s_max_i32 s30, s35, 3
    s_sub_u32 s30, s30, 1
    v_mov_b32 v24, s30
    s_lshl_b32 s31, s20, 10
    s_add_u32 s31, s31, s39
    ds_read_b128 v[32:35], v13 offset:0
    ds_read_b128 v[36:39], v13 offset:32
    ds_read_b128 v[40:43], v13 offset:64
    ds_read_b128 v[44:47], v13 offset:96
    ds_read_b128 v[48:51], v13 offset:128
    ds_read_b128 v[52:55], v13 offset:160
    ds_read_b128 v[56:59], v13 offset:192
    ds_read_b128 v[60:63], v13 offset:224
    s_waitcnt lgkmcnt(7)
    v_mfma_f32_32x32x16_bf16 v[64:79], a[0:3], v[32:35], 0
    ds_read_b128 v[32:35], v13 offset:256
    s_waitcnt lgkmcnt(7)
    v_mfma_f32_32x32x16_bf16 v[64:79], a[4:7], v[36:39], v[64:79]
    ds_read_b128 v[36:39], v13 offset:288
    s_waitcnt lgkmcnt(7)
    v_mfma_f32_32x32x16_bf16 v[64:79], a[8:11], v[40:43], v[64:79]
    ds_read_b128 v[40:43], v13 offset:320
    s_waitcnt lgkmcnt(7)
    v_mfma_f32_32x32x16_bf16 v[64:79], a[12:15], v[44:47], v[64:79]
    ds_read_b128 v[44:47], v13 offset:352
    s_waitcnt lgkmcnt(7)
    v_mfma_f32_32x32x16_bf16 v[64:79], a[16:19], v[48:51], v[64:79]
    ds_read_b128 v[48:51], v13 offset:384
    s_waitcnt lgkmcnt(7)
    v_mfma_f32_32x32x16_bf16 v[64:79], a[20:23], v[52:55], v[64:79]
    ds_read_b128 v[52:55], v13 offset:416
    s_waitcnt lgkmcnt(7)
    v_mfma_f32_32x32x16_bf16 v[64:79], a[24:27], v[56:59], v[64:79]
    ds_read_b128 v[56:59], v13 offset:448
    s_waitcnt lgkmcnt(7)
    v_mfma_f32_32x32x16_bf16 v[64:79], a[28:31], v[60:63], v[64:79]
    ds_read_b128 v[60:63], v13 offset:480
    s_waitcnt lgkmcnt(7)
    v_mfma_f32_32x32x16_bf16 v[64:79], a[32:35], v[32:35], v[64:79]
    ds_read_b128 v[32:35], v13 offset:512
    s_waitcnt lgkmcnt(7)
    v_mfma_f32_32x32x16_bf16 v[64:79], a[36:39], v[36:39], v[64:79]
    ds_read_b128 v[36:39], v13 offset:544
    s_waitcnt lgkmcnt(7)
    v_mfma_f32_32x32x16_bf16 v[64:79], a[40:43], v[40:43], v[64:79]
    ds_read_b128 v[40:43], v13 offset:576
    s_waitcnt lgkmcnt(7)
    v_mfma_f32_32x32x16_bf16 v[64:79], a[44:47], v[44:47], v[64:79]
    ds_read_b128 v[44:47], v13 offset:608
    s_waitcnt lgkmcnt(7)
    v_mfma_f32_32x32x16_bf16 v[64:79], a[48:51], v[48:51], v[64:79]
    ds_read_b128 v[48:51], v13 offset:640
    s_waitcnt lgkmcnt(7)
    v_mfma_f32_32x32x16_bf16 v[64:79], a[52:55], v[52:55], v[64:79]
    ds_read_b128 v[52:55], v13 offset:672
    s_waitcnt lgkmcnt(7)
    v_mfma_f32_32x32x16_bf16 v[64:79], a[56:59], v[56:59], v[64:79]
    ds_read_b128 v[56:59], v13 offset:704
    s_waitcnt lgkmcnt(7)
    v_mfma_f32_32x32x16_bf16 v[64:79], a[60:63], v[60:63], v[64:79]
    ds_read_b128 v[60:63], v13 offset:736
    s_waitcnt lgkmcnt(7)
    v_mfma_f32_32x32x16_bf16 v[64:79], a[64:67], v[32:35], v[64:79]
    ds_read_b128 v[32:35], v13 offset:768
    s_waitcnt lgkmcnt(7)
    v_mfma_f32_32x32x16_bf16 v[64:79], a[68:71], v[36:39], v[64:79]
    ds_read_b128 v[36:39], v13 offset:800
    s_waitcnt lgkmcnt(7)
    v_mfma_f32_32x32x16_bf16 v[64:79], a[72:75], v[40:43], v[64:79]
    ds_read_b128 v[40:43], v13 offset:832
    s_waitcnt lgkmcnt(7)
    v_mfma_f32_32x32x16_bf16 v[64:79], a[76:79], v[44:47], v[64:79]
    ds_read_b128 v[44:47], v13 offset:864
    s_waitcnt lgkmcnt(7)
    v_mfma_f32_32x32x16_bf16 v[64:79], a[80:83], v[48:51], v[64:79]
    ds_read_b128 v[48:51], v13 offset:896
    s_waitcnt lgkmcnt(7)
    v_mfma_f32_32x32x16_bf16 v[64:79], a[84:87], v[52:55], v[64:79]
    ds_read_b128 v[52:55], v13 offset:928
    s_waitcnt lgkmcnt(7)
    v_mfma_f32_32x32x16_bf16 v[64:79], a[88:91], v[56:59], v[64:79]
    ds_read_b128 v[56:59], v13 offset:960
    s_waitcnt lgkmcnt(7)
    v_mfma_f32_32x32x16_bf16 v[64:79], a[92:95], v[60:63], v[64:79]
    ds_read_b128 v[60:63], v13 offset:992
    s_waitcnt lgkmcnt(7)
    v_mfma_f32_32x32x16_bf16 v[64:79], a[96:99], v[32:35], v[64:79]
    ds_read_b128 v[32:35], v13 offset:1024
    s_waitcnt lgkmcnt(7)
    v_mfma_f32_32x32x16_bf16 v[64:79], a[100:103], v[36:39], v[64:79]
    ds_read_b128 v[36:39], v13 offset:1056
    s_waitcnt lgkmcnt(7)
    v_mfma_f32_32x32x16_bf16 v[64:79], a[104:107], v[40:43], v[64:79]
    ds_read_b128 v[40:43], v13 offset:1088
    s_waitcnt lgkmcnt(7)
    v_mfma_f32_32x32x16_bf16 v[64:79], a[108:111], v[44:47], v[64:79]
    ds_read_b128 v[44:47], v13 offset:1120
    s_waitcnt lgkmcnt(7)
    v_mfma_f32_32x32x16_bf16 v[64:79], a[112:115], v[48:51], v[64:79]
    ds_read_b128 v[48:51], v13 offset:1152
    s_waitcnt lgkmcnt(7)
    v_mfma_f32_32x32x16_bf16 v[64:79], a[116:119], v[52:55], v[64:79]
    ds_read_b128 v[52:55], v13 offset:1184
    s_waitcnt lgkmcnt(7)
    v_mfma_f32_32x32x16_bf16 v[64:79], a[120:123], v[56:59], v[64:79]
    ds_read_b128 v[56:59], v13 offset:1216
    s_waitcnt lgkmcnt(7)
    v_mfma_f32_32x32x16_bf16 v[64:79], a[124:127], v[60:63], v[64:79]
    ds_read_b128 v[60:63], v13 offset:1248
    s_waitcnt lgkmcnt(7)
    v_mfma_f32_32x32x16_bf16 v[64:79], a[128:131], v[32:35], v[64:79]
    s_waitcnt lgkmcnt(6)
    v_mfma_f32_32x32x16_bf16 v[64:79], a[132:135], v[36:39], v[64:79]
    s_waitcnt lgkmcnt(5)
    v_mfma_f32_32x32x16_bf16 v[64:79], a[136:139], v[40:43], v[64:79]
    s_waitcnt lgkmcnt(4)
    v_mfma_f32_32x32x16_bf16 v[64:79], a[140:143], v[44:47], v[64:79]
    s_waitcnt lgkmcnt(3)
    v_mfma_f32_32x32x16_bf16 v[64:79], a[144:147], v[48:51], v[64:79]
    s_waitcnt lgkmcnt(2)
    v_mfma_f32_32x32x16_bf16 v[64:79], a[148:151], v[52:55], v[64:79]
    s_waitcnt lgkmcnt(1)
    v_mfma_f32_32x32x16_bf16 v[64:79], a[152:155], v[56:59], v[64:79]
    s_waitcnt lgkmcnt(0)
    v_mfma_f32_32x32x16_bf16 v[64:79], a[156:159], v[60:63], v[64:79]
    s_add_u32 s35, s35, 1
    s_add_u32 s36, s36, s37
    s_add_u32 s40, s40, 40960
    s_add_u32 s38, s38, 45056
    s_cmp_eq_u32 s38, 135168
    s_cselect_b32 s38, 0, s38
    s_add_u32 s39, s39, 45056
    s_cmp_eq_u32 s39, 135168
    s_cselect_b32 s39, 0, s39
    s_waitcnt vmcnt(11)
    s_barrier
    v_add_u32 v13, s38, v12
    s_max_i32 s30, s35, 3
    s_sub_u32 s30, s30, 1
    v_mov_b32 v24, s30
    s_lshl_b32 s31, s20, 10
    s_add_u32 s31, s31, s39
    ds_read_b128 v[32:35], v13 offset:0
    ds_read_b128 v[36:39], v13 offset:32
    ds_read_b128 v[40:43], v13 offset:64
    ds_read_b128 v[44:47], v13 offset:96
    ds_read_b128 v[48:51], v13 offset:128
    ds_read_b128 v[52:55], v13 offset:160
    ds_read_b128 v[56:59], v13 offset:192
    ds_read_b128 v[60:63], v13 offset:224
    s_waitcnt lgkmcnt(7)
    v_mfma_f32_32x32x16_bf16 v[80:95], a[0:3], v[32:35], 0
    ds_read_b128 v[32:35], v13 offset:256
    s_waitcnt lgkmcnt(7)
    v_mfma_f32_32x32x16_bf16 v[80:95], a[4:7], v[36:39], v[80:95]
    ds_read_b128 v[36:39], v13 offset:288
    s_waitcnt lgkmcnt(7)
    v_mfma_f32_32x32x16_bf16 v[80:95], a[8:11], v[40:43], v[80:95]
    ds_read_b128 v[40:43], v13 offset:320
    v_cvt_pk_bf16_f32 v96, v64, v65
    v_cvt_pk_bf16_f32 v97, v66, v67
    s_waitcnt lgkmcnt(7)
    v_mfma_f32_32x32x16_bf16 v[80:95], a[12:15], v[44:47], v[80:95]
    ds_read_b128 v[44:47], v13 offset:352
    v_cvt_pk_bf16_f32 v98, v68, v69
    v_cvt_pk_bf16_f32 v99, v70, v71
    s_waitcnt lgkmcnt(7)
    v_mfma_f32_32x32x16_bf16 v[80:95], a[16:19], v[48:51], v[80:95]
    ds_read_b128 v[48:51], v13 offset:384
    v_cvt_pk_bf16_f32 v100, v72, v73
    v_cvt_pk_bf16_f32 v101, v74, v75
    s_waitcnt lgkmcnt(7)
    v_mfma_f32_32x32x16_bf16 v[80:95], a[20:23], v[52:55], v[80:95]
    ds_read_b128 v[52:55], v13 offset:416
    v_cvt_pk_bf16_f32 v102, v76, v77
    v_cvt_pk_bf16_f32 v103, v78, v79
    s_waitcnt lgkmcnt(7)
    v_mfma_f32_32x32x16_bf16 v[80:95], a[24:27], v[56:59], v[80:95]
    ds_read_b128 v[56:59], v13 offset:448
    s_waitcnt lgkmcnt(7)
    v_mfma_f32_32x32x16_bf16 v[80:95], a[28:31], v[60:63], v[80:95]
    ds_read_b128 v[60:63], v13 offset:480
    buffer_store_dwordx4 v[96:99], v14, s[8:11], s36 offen sc1
    buffer_store_dwordx4 v[100:103], v14, s[8:11], s36 offen offset:1024 sc1
    s_waitcnt lgkmcnt(7)
    v_mfma_f32_32x32x16_bf16 v[80:95], a[32:35], v[32:35], v[80:95]
    ds_read_b128 v[32:35], v13 offset:512
    s_waitcnt lgkmcnt(7)
    v_mfma_f32_32x32x16_bf16 v[80:95], a[36:39], v[36:39], v[80:95]
    ds_read_b128 v[36:39], v13 offset:544
    s_waitcnt lgkmcnt(7)
    v_mfma_f32_32x32x16_bf16 v[80:95], a[40:43], v[40:43], v[80:95]
    ds_read_b128 v[40:43], v13 offset:576
    s_waitcnt lgkmcnt(7)
    v_mfma_f32_32x32x16_bf16 v[80:95], a[44:47], v[44:47], v[80:95]
    ds_read_b128 v[44:47], v13 offset:608
    s_waitcnt lgkmcnt(7)
    v_mfma_f32_32x32x16_bf16 v[80:95], a[48:51], v[48:51], v[80:95]
    ds_read_b128 v[48:51], v13 offset:640
    s_waitcnt lgkmcnt(7)
    v_mfma_f32_32x32x16_bf16 v[80:95], a[52:55], v[52:55], v[80:95]
    ds_read_b128 v[52:55], v13 offset:672
    s_waitcnt lgkmcnt(7)
    v_mfma_f32_32x32x16_bf16 v[80:95], a[56:59], v[56:59], v[80:95]
    ds_read_b128 v[56:59], v13 offset:704
    s_waitcnt lgkmcnt(7)
    v_mfma_f32_32x32x16_bf16 v[80:95], a[60:63], v[60:63], v[80:95]
    ds_read_b128 v[60:63], v13 offset:736
    s_waitcnt lgkmcnt(7)
    v_mfma_f32_32x32x16_bf16 v[80:95], a[64:67], v[32:35], v[80:95]
    ds_read_b128 v[32:35], v13 offset:768
    s_waitcnt lgkmcnt(7)
    v_mfma_f32_32x32x16_bf16 v[80:95], a[68:71], v[36:39], v[80:95]
    ds_read_b128 v[36:39], v13 offset:800
    s_waitcnt lgkmcnt(7)
    v_mfma_f32_32x32x16_bf16 v[80:95], a[72:75], v[40:43], v[80:95]
    ds_read_b128 v[40:43], v13 offset:832
    s_waitcnt lgkmcnt(7)
    v_mfma_f32_32x32x16_bf16 v[80:95], a[76:79], v[44:47], v[80:95]
    ds_read_b128 v[44:47], v13 offset:864
    s_waitcnt lgkmcnt(7)
    v_mfma_f32_32x32x16_bf16 v[80:95], a[80:83], v[48:51], v[80:95]
    ds_read_b128 v[48:51], v13 offset:896
    s_waitcnt lgkmcnt(7)
    v_mfma_f32_32x32x16_bf16 v[80:95], a[84:87], v[52:55], v[80:95]
    ds_read_b128 v[52:55], v13 offset:928
    s_waitcnt lgkmcnt(7)
    v_mfma_f32_32x32x16_bf16 v[80:95], a[88:91], v[56:59], v[80:95]
    ds_read_b128 v[56:59], v13 offset:960
    s_waitcnt lgkmcnt(7)
    v_mfma_f32_32x32x16_bf16 v[80:95], a[92:95], v[60:63], v[80:95]
    ds_read_b128 v[60:63], v13 offset:992
    s_waitcnt lgkmcnt(7)
    v_mfma_f32_32x32x16_bf16 v[80:95], a[96:99], v[32:35], v[80:95]
    ds_read_b128 v[32:35], v13 offset:1024
    s_waitcnt lgkmcnt(7)
    v_mfma_f32_32x32x16_bf16 v[80:95], a[100:103], v[36:39], v[80:95]
    ds_read_b128 v[36:39], v13 offset:1056
    s_waitcnt lgkmcnt(7)
    v_mfma_f32_32x32x16_bf16 v[80:95], a[104:107], v[40:43], v[80:95]
    ds_read_b128 v[40:43], v13 offset:1088
    s_waitcnt lgkmcnt(7)
    v_mfma_f32_32x32x16_bf16 v[80:95], a[108:111], v[44:47], v[80:95]
    ds_read_b128 v[44:47], v13 offset:1120
    s_waitcnt lgkmcnt(7)
    v_mfma_f32_32x32x16_bf16 v[80:95], a[112:115], v[48:51], v[80:95]
    ds_read_b128 v[48:51], v13 offset:1152
    s_waitcnt lgkmcnt(7)
    v_mfma_f32_32x32x16_bf16 v[80:95], a[116:119], v[52:55], v[80:95]
    ds_read_b128 v[52:55], v13 offset:1184
    s_waitcnt lgkmcnt(7)
    v_mfma_f32_32x32x16_bf16 v[80:95], a[120:123], v[56:59], v[80:95]
    ds_read_b128 v[56:59], v13 offset:1216
    s_waitcnt lgkmcnt(7)
    v_mfma_f32_32x32x16_bf16 v[80:95], a[124:127], v[60:63], v[80:95]
    ds_read_b128 v[60:63], v13 offset:1248
    s_waitcnt lgkmcnt(7)
    v_mfma_f32_32x32x16_bf16 v[80:95], a[128:131], v[32:35], v[80:95]
    s_waitcnt lgkmcnt(6)
    v_mfma_f32_32x32x16_bf16 v[80:95], a[132:135], v[36:39], v[80:95]
    s_waitcnt lgkmcnt(5)
    v_mfma_f32_32x32x16_bf16 v[80:95], a[136:139], v[40:43], v[80:95]
    s_waitcnt lgkmcnt(4)
    v_mfma_f32_32x32x16_bf16 v[80:95], a[140:143], v[44:47], v[80:95]
    s_waitcnt lgkmcnt(3)
    v_mfma_f32_32x32x16_bf16 v[80:95], a[144:147], v[48:51], v[80:95]
    s_waitcnt lgkmcnt(2)
    v_mfma_f32_32x32x16_bf16 v[80:95], a[148:151], v[52:55], v[80:95]
    s_waitcnt lgkmcnt(1)
    v_mfma_f32_32x32x16_bf16 v[80:95], a[152:155], v[56:59], v[80:95]
    s_waitcnt lgkmcnt(0)
    v_mfma_f32_32x32x16_bf16 v[80:95], a[156:159], v[60:63], v[80:95]
    s_add_u32 s35, s35, 1
    s_add_u32 s36, s36, s37
    s_add_u32 s40, s40, 40960
    s_add_u32 s38, s38, 45056
    s_cmp_eq_u32 s38, 135168
    s_cselect_b32 s38, 0, s38
    s_add_u32 s39, s39, 45056
    s_cmp_eq_u32 s39, 135168
    s_cselect_b32 s39, 0, s39
    s_nop 15
    v_cvt_pk_bf16_f32 v96, v80, v81
    v_cvt_pk_bf16_f32 v97, v82, v83
    v_cvt_pk_bf16_f32 v98, v84, v85
    v_cvt_pk_bf16_f32 v99, v86, v87
    v_cvt_pk_bf16_f32 v100, v88, v89
    v_cvt_pk_bf16_f32 v101, v90, v91
    v_cvt_pk_bf16_f32 v102, v92, v93
    v_cvt_pk_bf16_f32 v103, v94, v95
    buffer_store_dwordx4 v[96:99], v14, s[8:11], s36 offen sc1
    buffer_store_dwordx4 v[100:103], v14, s[8:11], s36 offen offset:1024 sc1
    s_waitcnt vmcnt(0)
    s_barrier
    v_mov_b32 v24, 2
    buffer_store_dword v24, v15, s[8:11], s41 offen sc1
    s_lshl_b32 s31, s20, 10
    s_mov_b32 s40, 122880
    s_add_u32 m0, s31, 0
    s_nop 0
    buffer_load_dwordx4 v1, s[24:27], s40 offen lds
    s_add_u32 m0, s31, 4096
    s_nop 0
    buffer_load_dwordx4 v2, s[24:27], s40 offen lds
    s_add_u32 m0, s31, 8192
    s_nop 0
    buffer_load_dwordx4 v3, s[24:27], s40 offen lds
    s_add_u32 m0, s31, 12288
    s_nop 0
    buffer_load_dwordx4 v4, s[24:27], s40 offen lds
    s_add_u32 m0, s31, 16384
    s_nop 0
    buffer_load_dwordx4 v5, s[24:27], s40 offen lds
    s_add_u32 m0, s31, 20480
    s_nop 0
    buffer_load_dwordx4 v6, s[24:27], s40 offen lds
    s_add_u32 m0, s31, 24576
    s_nop 0
    buffer_load_dwordx4 v7, s[24:27], s40 offen lds
    s_add_u32 m0, s31, 28672
    s_nop 0
    buffer_load_dwordx4 v8, s[24:27], s40 offen lds
    s_add_u32 m0, s31, 32768
    s_nop 0
    buffer_load_dwordx4 v9, s[24:27], s40 offen lds
    s_add_u32 m0, s31, 36864
    s_nop 0
    buffer_load_dwordx4 v10, s[24:27], s40 offen lds
    s_add_u32 m0, s31, 40960
    s_nop 0
    buffer_load_dwordx4 v11, s[24:27], s40 offen lds
    s_mov_b32 s40, 163840
L_p1_loop:
    s_waitcnt vmcnt(11)
    s_barrier
    v_add_u32 v13, s38, v12
    s_max_i32 s30, s35, 3
    s_sub_u32 s30, s30, 1
    v_mov_b32 v24, s30
    s_lshl_b32 s31, s20, 10
    s_add_u32 s31, s31, s39
    ds_read_b128 v[32:35], v13 offset:0
    ds_read_b128 v[36:39], v13 offset:32
    ds_read_b128 v[40:43], v13 offset:64
    ds_read_b128 v[44:47], v13 offset:96
    ds_read_b128 v[48:51], v13 offset:128
    ds_read_b128 v[52:55], v13 offset:160
    ds_read_b128 v[56:59], v13 offset:192
    ds_read_b128 v[60:63], v13 offset:224
    buffer_store_dword v24, v15, s[8:11], s41 offen sc1
    s_waitcnt lgkmcnt(7)
    v_mfma_f32_32x32x16_bf16 v[64:79], a[0:3], v[32:35], 0
    ds_read_b128 v[32:35], v13 offset:256
    s_waitcnt lgkmcnt(7)
    v_mfma_f32_32x32x16_bf16 v[64:79], a[4:7], v[36:39], v[64:79]
    ds_read_b128 v[36:39], v13 offset:288
    s_waitcnt lgkmcnt(7)
    v_mfma_f32_32x32x16_bf16 v[64:79], a[8:11], v[40:43], v[64:79]
    ds_read_b128 v[40:43], v13 offset:320
    v_cvt_pk_bf16_f32 v96, v80, v81
    v_cvt_pk_bf16_f32 v97, v82, v83
    s_waitcnt lgkmcnt(7)
    v_mfma_f32_32x32x16_bf16 v[64:79], a[12:15], v[44:47], v[64:79]
    ds_read_b128 v[44:47], v13 offset:352
    v_cvt_pk_bf16_f32 v98, v84, v85
    v_cvt_pk_bf16_f32 v99, v86, v87
    s_waitcnt lgkmcnt(7)
    v_mfma_f32_32x32x16_bf16 v[64:79], a[16:19], v[48:51], v[64:79]
    ds_read_b128 v[48:51], v13 offset:384
    v_cvt_pk_bf16_f32 v100, v88, v89
    v_cvt_pk_bf16_f32 v101, v90, v91
    s_waitcnt lgkmcnt(7)
    v_mfma_f32_32x32x16_bf16 v[64:79], a[20:23], v[52:55], v[64:79]
    ds_read_b128 v[52:55], v13 offset:416
    v_cvt_pk_bf16_f32 v102, v92, v93
    v_cvt_pk_bf16_f32 v103, v94, v95
    s_waitcnt lgkmcnt(7)
    v_mfma_f32_32x32x16_bf16 v[64:79], a[24:27], v[56:59], v[64:79]
    ds_read_b128 v[56:59], v13 offset:448
    s_waitcnt lgkmcnt(7)
    v_mfma_f32_32x32x16_bf16 v[64:79], a[28:31], v[60:63], v[64:79]
    ds_read_b128 v[60:63], v13 offset:480
    buffer_store_dwordx4 v[96:99], v14, s[8:11], s36 offen sc1
    buffer_store_dwordx4 v[100:103], v14, s[8:11], s36 offen offset:1024 sc1
    s_waitcnt lgkmcnt(7)
    v_mfma_f32_32x32x16_bf16 v[64:79], a[32:35], v[32:35], v[64:79]
    ds_read_b128 v[32:35], v13 offset:512
    s_add_u32 m0, s31, 0
    s_nop 0
    buffer_load_dwordx4 v1, s[24:27], s40 offen lds
    s_waitcnt lgkmcnt(7)
    v_mfma_f32_32x32x16_bf16 v[64:79], a[36:39], v[36:39], v[64:79]
    ds_read_b128 v[36:39], v13 offset:544
    s_waitcnt lgkmcnt(7)
    v_mfma_f32_32x32x16_bf16 v[64:79], a[40:43], v[40:43], v[64:79]
    ds_read_b128 v[40:43], v13 offset:576
    s_waitcnt lgkmcnt(7)
    v_mfma_f32_32x32x16_bf16 v[64:79], a[44:47], v[44:47], v[64:79]
    ds_read_b128 v[44:47], v13 offset:608
    s_add_u32 m0, s31, 4096
    s_nop 0
    buffer_load_dwordx4 v2, s[24:27], s40 offen lds
    s_waitcnt lgkmcnt(7)
    v_mfma_f32_32x32x16_bf16 v[64:79], a[48:51], v[48:51], v[64:79]
    ds_read_b128 v[48:51], v13 offset:640
    s_waitcnt lgkmcnt(7)
    v_mfma_f32_32x32x16_bf16 v[64:79], a[52:55], v[52:55], v[64:79]
    ds_read_b128 v[52:55], v13 offset:672
    s_waitcnt lgkmcnt(7)
    v_mfma_f32_32x32x16_bf16 v[64:79], a[56:59], v[56:59], v[64:79]
    ds_read_b128 v[56:59], v13 offset:704
    s_add_u32 m0, s31, 8192
    s_nop 0
    buffer_load_dwordx4 v3, s[24:27], s40 offen lds
    s_waitcnt lgkmcnt(7)
    v_mfma_f32_32x32x16_bf16 v[64:79], a[60:63], v[60:63], v[64:79]
    ds_read_b128 v[60:63], v13 offset:736
    s_waitcnt lgkmcnt(7)
    v_mfma_f32_32x32x16_bf16 v[64:79], a[64:67], v[32:35], v[64:79]
    ds_read_b128 v[32:35], v13 offset:768
    s_waitcnt lgkmcnt(7)
    v_mfma_f32_32x32x16_bf16 v[64:79], a[68:71], v[36:39], v[64:79]
    ds_read_b128 v[36:39], v13 offset:800
    s_add_u32 m0, s31, 12288
    s_nop 0
    buffer_load_dwordx4 v4, s[24:27], s40 offen lds
    s_waitcnt lgkmcnt(7)
    v_mfma_f32_32x32x16_bf16 v[64:79], a[72:75], v[40:43], v[64:79]
    ds_read_b128 v[40:43], v13 offset:832
    s_waitcnt lgkmcnt(7)
    v_mfma_f32_32x32x16_bf16 v[64:79], a[76:79], v[44:47], v[64:79]
    ds_read_b128 v[44:47], v13 offset:864
    s_waitcnt lgkmcnt(7)
    v_mfma_f32_32x32x16_bf16 v[64:79], a[80:83], v[48:51], v[64:79]
    ds_read_b128 v[48:51], v13 offset:896
    s_add_u32 m0, s31, 16384
    s_nop 0
    buffer_load_dwordx4 v5, s[24:27], s40 offen lds
    s_waitcnt lgkmcnt(7)
    v_mfma_f32_32x32x16_bf16 v[64:79], a[84:87], v[52:55], v[64:79]
    ds_read_b128 v[52:55], v13 offset:928
    s_waitcnt lgkmcnt(7)
    v_mfma_f32_32x32x16_bf16 v[64:79], a[88:91], v[56:59], v[64:79]
    ds_read_b128 v[56:59], v13 offset:960
    s_waitcnt lgkmcnt(7)
    v_mfma_f32_32x32x16_bf16 v[64:79], a[92:95], v[60:63], v[64:79]
    ds_read_b128 v[60:63], v13 offset:992
    s_add_u32 m0, s31, 20480
    s_nop 0
    buffer_load_dwordx4 v6, s[24:27], s40 offen lds
    s_waitcnt lgkmcnt(7)
    v_mfma_f32_32x32x16_bf16 v[64:79], a[96:99], v[32:35], v[64:79]
    ds_read_b128 v[32:35], v13 offset:1024
    s_waitcnt lgkmcnt(7)
    v_mfma_f32_32x32x16_bf16 v[64:79], a[100:103], v[36:39], v[64:79]
    ds_read_b128 v[36:39], v13 offset:1056
    s_waitcnt lgkmcnt(7)
    v_mfma_f32_32x32x16_bf16 v[64:79], a[104:107], v[40:43], v[64:79]
    ds_read_b128 v[40:43], v13 offset:1088
    s_add_u32 m0, s31, 24576
    s_nop 0
    buffer_load_dwordx4 v7, s[24:27], s40 offen lds
    s_waitcnt lgkmcnt(7)
    v_mfma_f32_32x32x16_bf16 v[64:79], a[108:111], v[44:47], v[64:79]
    ds_read_b128 v[44:47], v13 offset:1120
    s_waitcnt lgkmcnt(7)
    v_mfma_f32_32x32x16_bf16 v[64:79], a[112:115], v[48:51], v[64:79]
    ds_read_b128 v[48:51], v13 offset:1152
    s_waitcnt lgkmcnt(7)
    v_mfma_f32_32x32x16_bf16 v[64:79], a[116:119], v[52:55], v[64:79]
    ds_read_b128 v[52:55], v13 offset:1184
    s_add_u32 m0, s31, 28672
    s_nop 0
    buffer_load_dwordx4 v8, s[24:27], s40 offen lds
    s_waitcnt lgkmcnt(7)
    v_mfma_f32_32x32x16_bf16 v[64:79], a[120:123], v[56:59], v[64:79]
    ds_read_b128 v[56:59], v13 offset:1216
    s_waitcnt lgkmcnt(7)
    v_mfma_f32_32x32x16_bf16 v[64:79], a[124:127], v[60:63], v[64:79]
    ds_read_b128 v[60:63], v13 offset:1248
    s_waitcnt lgkmcnt(7)
    v_mfma_f32_32x32x16_bf16 v[64:79], a[128:131], v[32:35], v[64:79]
    s_add_u32 m0, s31, 32768
    s_nop 0
    buffer_load_dwordx4 v9, s[24:27], s40 offen lds
    s_waitcnt lgkmcnt(6)
    v_mfma_f32_32x32x16_bf16 v[64:79], a[132:135], v[36:39], v[64:79]
    s_waitcnt lgkmcnt(5)
    v_mfma_f32_32x32x16_bf16 v[64:79], a[136:139], v[40:43], v[64:79]
    s_waitcnt lgkmcnt(4)
    v_mfma_f32_32x32x16_bf16 v[64:79], a[140:143], v[44:47], v[64:79]
    s_add_u32 m0, s31, 36864
    s_nop 0
    buffer_load_dwordx4 v10, s[24:27], s40 offen lds
    s_waitcnt lgkmcnt(3)
    v_mfma_f32_32x32x16_bf16 v[64:79], a[144:147], v[48:51], v[64:79]
    s_waitcnt lgkmcnt(2)
    v_mfma_f32_32x32x16_bf16 v[64:79], a[148:151], v[52:55], v[64:79]
    s_waitcnt lgkmcnt(1)
    v_mfma_f32_32x32x16_bf16 v[64:79], a[152:155], v[56:59], v[64:79]
    s_add_u32 m0, s31, 40960
    s_nop 0
    buffer_load_dwordx4 v11, s[24:27], s40 offen lds
    s_waitcnt lgkmcnt(0)
    v_mfma_f32_32x32x16_bf16 v[64:79], a[156:159], v[60:63], v[64:79]
    s_add_u32 s35, s35, 1
    s_add_u32 s36, s36, s37
    s_add_u32 s40, s40, 40960
    s_add_u32 s38, s38, 45056
    s_cmp_eq_u32 s38, 135168
    s_cselect_b32 s38, 0, s38
    s_add_u32 s39, s39, 45056
    s_cmp_eq_u32 s39, 135168
    s_cselect_b32 s39, 0, s39
    s_waitcnt vmcnt(11)
    s_barrier
    v_add_u32 v13, s38, v12
    s_max_i32 s30, s35, 3
    s_sub_u32 s30, s30, 1
    v_mov_b32 v24, s30
    s_lshl_b32 s31, s20, 10
    s_add_u32 s31, s31, s39
    ds_read_b128 v[32:35], v13 offset:0
    ds_read_b128 v[36:39], v13 offset:32
    ds_read_b128 v[40:43], v13 offset:64
    ds_read_b128 v[44:47], v13 offset:96
    ds_read_b128 v[48:51], v13 offset:128
    ds_read_b128 v[52:55], v13 offset:160
    ds_read_b128 v[56:59], v13 offset:192
    ds_read_b128 v[60:63], v13 offset:224
    buffer_store_dword v24, v15, s[8:11], s41 offen sc1
    s_waitcnt lgkmcnt(7)
    v_mfma_f32_32x32x16_bf16 v[80:95], a[0:3], v[32:35], 0
    ds_read_b128 v[32:35], v13 offset:256
    s_waitcnt lgkmcnt(7)
    v_mfma_f32_32x32x16_bf16 v[80:95], a[4:7], v[36:39], v[80:95]
    ds_read_b128 v[36:39], v13 offset:288
    s_waitcnt lgkmcnt(7)
    v_mfma_f32_32x32x16_bf16 v[80:95], a[8:11], v[40:43], v[80:95]
    ds_read_b128 v[40:43], v13 offset:320
    v_cvt_pk_bf16_f32 v96, v64, v65
    v_cvt_pk_bf16_f32 v97, v66, v67
    s_waitcnt lgkmcnt(7)
    v_mfma_f32_32x32x16_bf16 v[80:95], a[12:15], v[44:47], v[80:95]
    ds_read_b128 v[44:47], v13 offset:352
    v_cvt_pk_bf16_f32 v98, v68, v69
    v_cvt_pk_bf16_f32 v99, v70, v71
    s_waitcnt lgkmcnt(7)
    v_mfma_f32_32x32x16_bf16 v[80:95], a[16:19], v[48:51], v[80:95]
    ds_read_b128 v[48:51], v13 offset:384
    v_cvt_pk_bf16_f32 v100, v72, v73
    v_cvt_pk_bf16_f32 v101, v74, v75
    s_waitcnt lgkmcnt(7)
    v_mfma_f32_32x32x16_bf16 v[80:95], a[20:23], v[52:55], v[80:95]
    ds_read_b128 v[52:55], v13 offset:416
    v_cvt_pk_bf16_f32 v102, v76, v77
    v_cvt_pk_bf16_f32 v103, v78, v79
    s_waitcnt lgkmcnt(7)
    v_mfma_f32_32x32x16_bf16 v[80:95], a[24:27], v[56:59], v[80:95]
    ds_read_b128 v[56:59], v13 offset:448
    s_waitcnt lgkmcnt(7)
    v_mfma_f32_32x32x16_bf16 v[80:95], a[28:31], v[60:63], v[80:95]
    ds_read_b128 v[60:63], v13 offset:480
    buffer_store_dwordx4 v[96:99], v14, s[8:11], s36 offen sc1
    buffer_store_dwordx4 v[100:103], v14, s[8:11], s36 offen offset:1024 sc1
    s_waitcnt lgkmcnt(7)
    v_mfma_f32_32x32x16_bf16 v[80:95], a[32:35], v[32:35], v[80:95]
    ds_read_b128 v[32:35], v13 offset:512
    s_add_u32 m0, s31, 0
    s_nop 0
    buffer_load_dwordx4 v1, s[24:27], s40 offen lds
    s_waitcnt lgkmcnt(7)
    v_mfma_f32_32x32x16_bf16 v[80:95], a[36:39], v[36:39], v[80:95]
    ds_read_b128 v[36:39], v13 offset:544
    s_waitcnt lgkmcnt(7)
    v_mfma_f32_32x32x16_bf16 v[80:95], a[40:43], v[40:43], v[80:95]
    ds_read_b128 v[40:43], v13 offset:576
    s_waitcnt lgkmcnt(7)
    v_mfma_f32_32x32x16_bf16 v[80:95], a[44:47], v[44:47], v[80:95]
    ds_read_b128 v[44:47], v13 offset:608
    s_add_u32 m0, s31, 4096
    s_nop 0
    buffer_load_dwordx4 v2, s[24:27], s40 offen lds
    s_waitcnt lgkmcnt(7)
    v_mfma_f32_32x32x16_bf16 v[80:95], a[48:51], v[48:51], v[80:95]
    ds_read_b128 v[48:51], v13 offset:640
    s_waitcnt lgkmcnt(7)
    v_mfma_f32_32x32x16_bf16 v[80:95], a[52:55], v[52:55], v[80:95]
    ds_read_b128 v[52:55], v13 offset:672
    s_waitcnt lgkmcnt(7)
    v_mfma_f32_32x32x16_bf16 v[80:95], a[56:59], v[56:59], v[80:95]
    ds_read_b128 v[56:59], v13 offset:704
    s_add_u32 m0, s31, 8192
    s_nop 0
    buffer_load_dwordx4 v3, s[24:27], s40 offen lds
    s_waitcnt lgkmcnt(7)
    v_mfma_f32_32x32x16_bf16 v[80:95], a[60:63], v[60:63], v[80:95]
    ds_read_b128 v[60:63], v13 offset:736
    s_waitcnt lgkmcnt(7)
    v_mfma_f32_32x32x16_bf16 v[80:95], a[64:67], v[32:35], v[80:95]
    ds_read_b128 v[32:35], v13 offset:768
    s_waitcnt lgkmcnt(7)
    v_mfma_f32_32x32x16_bf16 v[80:95], a[68:71], v[36:39], v[80:95]
    ds_read_b128 v[36:39], v13 offset:800
    s_add_u32 m0, s31, 12288
    s_nop 0
    buffer_load_dwordx4 v4, s[24:27], s40 offen lds
    s_waitcnt lgkmcnt(7)
    v_mfma_f32_32x32x16_bf16 v[80:95], a[72:75], v[40:43], v[80:95]
    ds_read_b128 v[40:43], v13 offset:832
    s_waitcnt lgkmcnt(7)
    v_mfma_f32_32x32x16_bf16 v[80:95], a[76:79], v[44:47], v[80:95]
    ds_read_b128 v[44:47], v13 offset:864
    s_waitcnt lgkmcnt(7)
    v_mfma_f32_32x32x16_bf16 v[80:95], a[80:83], v[48:51], v[80:95]
    ds_read_b128 v[48:51], v13 offset:896
    s_add_u32 m0, s31, 16384
    s_nop 0
    buffer_load_dwordx4 v5, s[24:27], s40 offen lds
    s_waitcnt lgkmcnt(7)
    v_mfma_f32_32x32x16_bf16 v[80:95], a[84:87], v[52:55], v[80:95]
    ds_read_b128 v[52:55], v13 offset:928
    s_waitcnt lgkmcnt(7)
    v_mfma_f32_32x32x16_bf16 v[80:95], a[88:91], v[56:59], v[80:95]
    ds_read_b128 v[56:59], v13 offset:960
    s_waitcnt lgkmcnt(7)
    v_mfma_f32_32x32x16_bf16 v[80:95], a[92:95], v[60:63], v[80:95]
    ds_read_b128 v[60:63], v13 offset:992
    s_add_u32 m0, s31, 20480
    s_nop 0
    buffer_load_dwordx4 v6, s[24:27], s40 offen lds
    s_waitcnt lgkmcnt(7)
    v_mfma_f32_32x32x16_bf16 v[80:95], a[96:99], v[32:35], v[80:95]
    ds_read_b128 v[32:35], v13 offset:1024
    s_waitcnt lgkmcnt(7)
    v_mfma_f32_32x32x16_bf16 v[80:95], a[100:103], v[36:39], v[80:95]
    ds_read_b128 v[36:39], v13 offset:1056
    s_waitcnt lgkmcnt(7)
    v_mfma_f32_32x32x16_bf16 v[80:95], a[104:107], v[40:43], v[80:95]
    ds_read_b128 v[40:43], v13 offset:1088
    s_add_u32 m0, s31, 24576
    s_nop 0
    buffer_load_dwordx4 v7, s[24:27], s40 offen lds
    s_waitcnt lgkmcnt(7)
    v_mfma_f32_32x32x16_bf16 v[80:95], a[108:111], v[44:47], v[80:95]
    ds_read_b128 v[44:47], v13 offset:1120
    s_waitcnt lgkmcnt(7)
    v_mfma_f32_32x32x16_bf16 v[80:95], a[112:115], v[48:51], v[80:95]
    ds_read_b128 v[48:51], v13 offset:1152
    s_waitcnt lgkmcnt(7)
    v_mfma_f32_32x32x16_bf16 v[80:95], a[116:119], v[52:55], v[80:95]
    ds_read_b128 v[52:55], v13 offset:1184
    s_add_u32 m0, s31, 28672
    s_nop 0
    buffer_load_dwordx4 v8, s[24:27], s40 offen lds
    s_waitcnt lgkmcnt(7)
    v_mfma_f32_32x32x16_bf16 v[80:95], a[120:123], v[56:59], v[80:95]
    ds_read_b128 v[56:59], v13 offset:1216
    s_waitcnt lgkmcnt(7)
    v_mfma_f32_32x32x16_bf16 v[80:95], a[124:127], v[60:63], v[80:95]
    ds_read_b128 v[60:63], v13 offset:1248
    s_waitcnt lgkmcnt(7)
    v_mfma_f32_32x32x16_bf16 v[80:95], a[128:131], v[32:35], v[80:95]
    s_add_u32 m0, s31, 32768
    s_nop 0
    buffer_load_dwordx4 v9, s[24:27], s40 offen lds
    s_waitcnt lgkmcnt(6)
    v_mfma_f32_32x32x16_bf16 v[80:95], a[132:135], v[36:39], v[80:95]
    s_waitcnt lgkmcnt(5)
    v_mfma_f32_32x32x16_bf16 v[80:95], a[136:139], v[40:43], v[80:95]
    s_waitcnt lgkmcnt(4)
    v_mfma_f32_32x32x16_bf16 v[80:95], a[140:143], v[44:47], v[80:95]
    s_add_u32 m0, s31, 36864
    s_nop 0
    buffer_load_dwordx4 v10, s[24:27], s40 offen lds
    s_waitcnt lgkmcnt(3)
    v_mfma_f32_32x32x16_bf16 v[80:95], a[144:147], v[48:51], v[80:95]
    s_waitcnt lgkmcnt(2)
    v_mfma_f32_32x32x16_bf16 v[80:95], a[148:151], v[52:55], v[80:95]
    s_waitcnt lgkmcnt(1)
    v_mfma_f32_32x32x16_bf16 v[80:95], a[152:155], v[56:59], v[80:95]
    s_add_u32 m0, s31, 40960
    s_nop 0
    buffer_load_dwordx4 v11, s[24:27], s40 offen lds
    s_waitcnt lgkmcnt(0)
    v_mfma_f32_32x32x16_bf16 v[80:95], a[156:159], v[60:63], v[80:95]
    s_add_u32 s35, s35, 1
    s_add_u32 s36, s36, s37
    s_add_u32 s40, s40, 40960
    s_add_u32 s38, s38, 45056
    s_cmp_eq_u32 s38, 135168
    s_cselect_b32 s38, 0, s38
    s_add_u32 s39, s39, 45056
    s_cmp_eq_u32 s39, 135168
    s_cselect_b32 s39, 0, s39
    s_cmp_lt_u32 s35, 64
    s_cbranch_scc1 L_p1_loop
    s_nop 15
    v_cvt_pk_bf16_f32 v96, v80, v81
    v_cvt_pk_bf16_f32 v97, v82, v83
    v_cvt_pk_bf16_f32 v98, v84, v85
    v_cvt_pk_bf16_f32 v99, v86, v87
    v_cvt_pk_bf16_f32 v100, v88, v89
    v_cvt_pk_bf16_f32 v101, v90, v91
    v_cvt_pk_bf16_f32 v102, v92, v93
    v_cvt_pk_bf16_f32 v103, v94, v95
    buffer_store_dwordx4 v[96:99], v14, s[8:11], s36 offen sc1
    buffer_store_dwordx4 v[100:103], v14, s[8:11], s36 offen offset:1024 sc1
    s_waitcnt vmcnt(0)
    s_barrier
    v_mov_b32 v24, 64
    buffer_store_dword v24, v15, s[8:11], s41 offen sc1
L_p1_end:
    s_cmp_lg_u32 s20, 0
    s_cbranch_scc1 L_b_censusb_ok
L_b_censusb:
    v_mov_b32 v240, 96
    global_load_dword v241, v240, s[28:29] sc1
    s_waitcnt vmcnt(0)
    v_readfirstlane_b32 s30, v241
    s_cmp_lg_u32 s30, 0
    s_cbranch_scc1 L_b_censusb_ok
    s_sleep 16
    s_sub_u32 s22, s22, 1
    s_cbranch_scc0 L_b_censusb
    s_branch L_timeout
L_b_censusb_ok:
    s_barrier
    v_and_b32 v4, 63, v0
    v_cmp_gt_u32 vcc, 25, v4
    v_mul_u32_u24 v4, 128, v4
    v_mov_b32 v5, 1073741824
    v_cndmask_b32 v4, v5, v4, vcc
    s_mov_b64 s[32:33], vcc
    s_mov_b32 s30, 105918464
L_p2_wait:
    buffer_load_dword v5, v4, s[8:11], s30 offen sc1
    s_waitcnt vmcnt(0)
    v_cmp_gt_u32 vcc, 64, v5
    s_nop 3
    s_and_b64 vcc, vcc, s[32:33]
    s_cbranch_vccz L_p2_wait_ok
    s_sleep 32
    s_sub_u32 s22, s22, 1
    s_cbranch_scc0 L_p2_wait
    s_branch L_timeout
L_p2_wait_ok:
    v_and_b32 v1, 63, v0
    v_and_b32 v2, 15, v0
    v_bfe_u32 v3, v0, 4, 2
    s_mov_b32 s42, 0x3ea52b5c
    s_mov_b32 s43, 0x3ea52b5c
    v_mov_b32 v24, 0xff800000
    v_lshrrev_b32 v4, 1, v3
    v_lshlrev_b32 v4, 10, v4
    v_and_b32 v5, 1, v3
    v_lshl_add_u32 v4, v5, 9, v4
    v_lshl_add_u32 v12, v2, 4, v4
    v_mov_b32 v14, v12
    v_bfe_u32 v4, v1, 2, 2
    v_lshl_add_u32 v4, v3, 2, v4
    v_lshlrev_b32 v4, 4, v4
    v_and_b32 v5, 3, v1
    v_lshrrev_b32 v6, 1, v5
    v_lshl_add_u32 v4, v6, 10, v4
    v_and_b32 v6, 1, v5
    v_lshl_add_u32 v4, v6, 9, v4
    v_add_u32 v13, 32768, v4
    v_lshlrev_b32 v4, 9, v3
    v_lshl_add_u32 v4, v2, 4, v4
    v_cmp_gt_u32 vcc, 3, v3
    v_mov_b32 v5, 1073741824
    s_nop 0
    v_cndmask_b32 v18, v5, v4, vcc
    s_mov_b32 s35, s34
L_p2_job:
    s_and_b32 s36, s35, 31
    s_lshr_b32 s37, s35, 5
    s_barrier
    v_lshlrev_b32 v4, 4, v1
    s_lshl_b32 s30, s20, 2
    s_add_u32 s30, s30, 0
    s_lshl_b32 s31, s37, 3
    s_add_u32 s31, s31, s30
    s_sub_i32 s31, s31, 8
    s_cmp_lt_i32 s31, 0
    s_cselect_b32 s32, 1073741824, 0
    s_max_i32 s31, s31, 0
    s_mul_i32 s31, s31, 196608
    s_add_u32 s31, s31, s32
    s_lshl_b32 s32, s36, 11
    s_add_u32 s31, s31, s32
    s_add_u32 s31, s31, 92274688
    s_lshl_b32 s30, s30, 11
    s_add_u32 m0, s30, 0
    s_add_u32 s32, s31, 65536
    buffer_load_dwordx4 v4, s[8:11], s32 offen sc1 lds
    s_add_u32 m0, s30, 1024
    s_add_u32 s32, s31, 66560
    buffer_load_dwordx4 v4, s[8:11], s32 offen sc1 lds
    s_add_u32 m0, s30, 32768
    s_add_u32 s32, s31, 131072
    buffer_load_dwordx4 v4, s[8:11], s32 offen sc1 lds
    s_add_u32 m0, s30, 33792
    s_add_u32 s32, s31, 132096
    buffer_load_dwordx4 v4, s[8:11], s32 offen sc1 lds
    s_lshl_b32 s30, s20, 2
    s_add_u32 s30, s30, 1
    s_lshl_b32 s31, s37, 3
    s_add_u32 s31, s31, s30
    s_sub_i32 s31, s31, 8
    s_cmp_lt_i32 s31, 0
    s_cselect_b32 s32, 1073741824, 0
    s_max_i32 s31, s31, 0
    s_mul_i32 s31, s31, 196608
    s_add_u32 s31, s31, s32
    s_lshl_b32 s32, s36, 11
    s_add_u32 s31, s31, s32
    s_add_u32 s31, s31, 92274688
    s_lshl_b32 s30, s30, 11
    s_add_u32 m0, s30, 0
    s_add_u32 s32, s31, 65536
    buffer_load_dwordx4 v4, s[8:11], s32 offen sc1 lds
    s_add_u32 m0, s30, 1024
    s_add_u32 s32, s31, 66560
    buffer_load_dwordx4 v4, s[8:11], s32 offen sc1 lds
    s_add_u32 m0, s30, 32768
    s_add_u32 s32, s31, 131072
    buffer_load_dwordx4 v4, s[8:11], s32 offen sc1 lds
    s_add_u32 m0, s30, 33792
    s_add_u32 s32, s31, 132096
    buffer_load_dwordx4 v4, s[8:11], s32 offen sc1 lds
    s_lshl_b32 s30, s20, 2
    s_add_u32 s30, s30, 2
    s_lshl_b32 s31, s37, 3
    s_add_u32 s31, s31, s30
    s_sub_i32 s31, s31, 8
    s_cmp_lt_i32 s31, 0
    s_cselect_b32 s32, 1073741824, 0
    s_max_i32 s31, s31, 0
    s_mul_i32 s31, s31, 196608
    s_add_u32 s31, s31, s32
    s_lshl_b32 s32, s36, 11
    s_add_u32 s31, s31, s32
    s_add_u32 s31, s31, 92274688
    s_lshl_b32 s30, s30, 11
    s_add_u32 m0, s30, 0
    s_add_u32 s32, s31, 65536
    buffer_load_dwordx4 v4, s[8:11], s32 offen sc1 lds
    s_add_u32 m0, s30, 1024
    s_add_u32 s32, s31, 66560
    buffer_load_dwordx4 v4, s[8:11], s32 offen sc1 lds
    s_add_u32 m0, s30, 32768
    s_add_u32 s32, s31, 131072
    buffer_load_dwordx4 v4, s[8:11], s32 offen sc1 lds
    s_add_u32 m0, s30, 33792
    s_add_u32 s32, s31, 132096
    buffer_load_dwordx4 v4, s[8:11], s32 offen sc1 lds
    s_lshl_b32 s30, s20, 2
    s_add_u32 s30, s30, 3
    s_lshl_b32 s31, s37, 3
    s_add_u32 s31, s31, s30
    s_sub_i32 s31, s31, 8
    s_cmp_lt_i32 s31, 0
    s_cselect_b32 s32, 1073741824, 0
    s_max_i32 s31, s31, 0
    s_mul_i32 s31, s31, 196608
    s_add_u32 s31, s31, s32
    s_lshl_b32 s32, s36, 11
    s_add_u32 s31, s31, s32
    s_add_u32 s31, s31, 92274688
    s_lshl_b32 s30, s30, 11
    s_add_u32 m0, s30, 0
    s_add_u32 s32, s31, 65536
    buffer_load_dwordx4 v4, s[8:11], s32 offen sc1 lds
    s_add_u32 m0, s30, 1024
    s_add_u32 s32, s31, 66560
    buffer_load_dwordx4 v4, s[8:11], s32 offen sc1 lds
    s_add_u32 m0, s30, 32768
    s_add_u32 s32, s31, 131072
    buffer_load_dwordx4 v4, s[8:11], s32 offen sc1 lds
    s_add_u32 m0, s30, 33792
    s_add_u32 s32, s31, 132096
    buffer_load_dwordx4 v4, s[8:11], s32 offen sc1 lds
    s_waitcnt vmcnt(0)
    s_barrier
    s_mov_b32 s38, 0
L_p2_tile:
    s_lshr_b32 s30, s38, 1
    s_lshl_b32 s31, s20, 1
    s_add_u32 s30, s30, s31
    s_mov_b32 s39, s30
    s_lshl_b32 s31, s37, 3
    s_add_u32 s40, s31, s30
    s_and_b32 s33, s38, 1
    s_mul_i32 s31, s40, 196608
    s_lshl_b32 s32, s36, 11
    s_add_u32 s31, s31, s32
    s_lshl_b32 s32, s33, 8
    s_add_u32 s31, s31, s32
    s_add_u32 s31, s31, 92274688
    buffer_load_dwordx4 v[28:31], v14, s[8:11], s31 offen sc1
    s_lshl_b32 s31, s40, 11
    s_add_u32 s31, s31, s32
    s_add_u32 s31, s31, 104857600
    v_lshlrev_b32 v4, 4, v2
    buffer_load_ushort v19, v4, s[8:11], s31 offen sc1
    s_lshl_b32 s32, s33, 4
    v_lshlrev_b32 v4, 2, v3
    v_sub_u32 v15, v2, v4
    v_add_u32 v15, s32, v15
    v_cmp_le_i32 s[44:45], 0, v15
    v_cmp_le_i32 s[46:47], 1, v15
    v_cmp_le_i32 s[48:49], 2, v15
    v_cmp_le_i32 s[50:51], 3, v15
    v_cmp_le_i32 s[52:53], 16, v15
    v_cmp_le_i32 s[54:55], 17, v15
    v_cmp_le_i32 s[56:57], 18, v15
    v_cmp_le_i32 s[58:59], 19, v15
    s_lshl_b32 s30, s39, 11
    v_add_u32 v16, s30, v12
    v_add_u32 v17, s30, v13
    ds_read_b128 v[104:107], v16 offset:0
    ds_read_b128 v[108:111], v16 offset:256
    ds_read_b128 v[112:115], v16 offset:2048
    ds_read_b128 v[116:119], v16 offset:2304
    ds_read_b128 v[120:123], v16 offset:4096
    ds_read_b128 v[124:127], v16 offset:4352
    ds_read_b128 v[128:131], v16 offset:6144
    ds_read_b128 v[132:135], v16 offset:6400
    s_waitcnt vmcnt(0)
    s_waitcnt lgkmcnt(7)
    v_mfma_f32_16x16x32_bf16 v[32:35], v[104:107], v[28:31], 0
    ds_read_b128 v[104:107], v16 offset:8192
    s_waitcnt lgkmcnt(7)
    v_mfma_f32_16x16x32_bf16 v[36:39], v[108:111], v[28:31], 0
    ds_read_b128 v[108:111], v16 offset:8448
    s_waitcnt lgkmcnt(7)
    v_mfma_f32_16x16x32_bf16 v[40:43], v[112:115], v[28:31], 0
    ds_read_b128 v[112:115], v16 offset:10240
    s_waitcnt lgkmcnt(7)
    v_mfma_f32_16x16x32_bf16 v[44:47], v[116:119], v[28:31], 0
    ds_read_b128 v[116:119], v16 offset:10496
    s_waitcnt lgkmcnt(7)
    v_mfma_f32_16x16x32_bf16 v[48:51], v[120:123], v[28:31], 0
    ds_read_b128 v[120:123], v16 offset:12288
    s_waitcnt lgkmcnt(7)
    v_mfma_f32_16x16x32_bf16 v[52:55], v[124:127], v[28:31], 0
    ds_read_b128 v[124:127], v16 offset:12544
    s_waitcnt lgkmcnt(7)
    v_mfma_f32_16x16x32_bf16 v[56:59], v[128:131], v[28:31], 0
    ds_read_b128 v[128:131], v16 offset:14336
    s_waitcnt lgkmcnt(7)
    v_mfma_f32_16x16x32_bf16 v[60:63], v[132:135], v[28:31], 0
    ds_read_b128 v[132:135], v16 offset:14592
    s_waitcnt lgkmcnt(7)
    v_mfma_f32_16x16x32_bf16 v[64:67], v[104:107], v[28:31], 0
    ds_read_b128 v[104:107], v16 offset:16384
    s_waitcnt lgkmcnt(7)
    v_mfma_f32_16x16x32_bf16 v[68:71], v[108:111], v[28:31], 0
    ds_read_b128 v[108:111], v16 offset:16640
    s_waitcnt lgkmcnt(7)
    v_mfma_f32_16x16x32_bf16 v[72:75], v[112:115], v[28:31], 0
    s_waitcnt lgkmcnt(6)
    v_mfma_f32_16x16x32_bf16 v[76:79], v[116:119], v[28:31], 0
    s_waitcnt lgkmcnt(5)
    v_mfma_f32_16x16x32_bf16 v[80:83], v[120:123], v[28:31], 0
    s_waitcnt lgkmcnt(4)
    v_mfma_f32_16x16x32_bf16 v[84:87], v[124:127], v[28:31], 0
    s_waitcnt lgkmcnt(3)
    v_mfma_f32_16x16x32_bf16 v[88:91], v[128:131], v[28:31], 0
    s_waitcnt lgkmcnt(2)
    v_mfma_f32_16x16x32_bf16 v[92:95], v[132:135], v[28:31], 0
    s_waitcnt lgkmcnt(1)
    v_mfma_f32_16x16x32_bf16 v[96:99], v[104:107], v[28:31], 0
    s_waitcnt lgkmcnt(0)
    v_mfma_f32_16x16x32_bf16 v[100:103], v[108:111], v[28:31], 0
    ds_read_b64_tr_b16 v[172:173], v17 offset:0
    ds_read_b64_tr_b16 v[174:175], v17 offset:256
    ds_read_b64_tr_b16 v[176:177], v17 offset:8
    ds_read_b64_tr_b16 v[178:179], v17 offset:264
    ds_read_b64_tr_b16 v[180:181], v17 offset:2048
    ds_read_b64_tr_b16 v[182:183], v17 offset:2304
    ds_read_b64_tr_b16 v[184:185], v17 offset:2056
    ds_read_b64_tr_b16 v[186:187], v17 offset:2312
    v_lshlrev_b32 v19, 16, v19
    v_mul_f32 v19, 0x3fb8aa3b, v19
    v_exp_f32 v19, v19
    s_nop 0
    v_add_f32 v19, 1.0, v19
    s_nop 2
    v_cndmask_b32 v32, v32, v24, s[44:45]
    v_cndmask_b32 v96, v24, v96, s[44:45]
    v_cndmask_b32 v33, v33, v24, s[46:47]
    v_cndmask_b32 v97, v24, v97, s[46:47]
    v_cndmask_b32 v34, v34, v24, s[48:49]
    v_cndmask_b32 v98, v24, v98, s[48:49]
    v_cndmask_b32 v35, v35, v24, s[50:51]
    v_cndmask_b32 v99, v24, v99, s[50:51]
    v_cndmask_b32 v36, v36, v24, s[52:53]
    v_cndmask_b32 v100, v24, v100, s[52:53]
    v_cndmask_b32 v37, v37, v24, s[54:55]
    v_cndmask_b32 v101, v24, v101, s[54:55]
    v_cndmask_b32 v38, v38, v24, s[56:57]
    v_cndmask_b32 v102, v24, v102, s[56:57]
    v_cndmask_b32 v39, v39, v24, s[58:59]
    v_cndmask_b32 v103, v24, v103, s[58:59]
    s_cmp_ge_u32 s40, 8
    s_cbranch_scc1 L_p2_nk_1
    v_mov_b32 v32, v24
    v_mov_b32 v33, v24
    v_mov_b32 v34, v24
    v_mov_b32 v35, v24
    v_mov_b32 v36, v24
    v_mov_b32 v37, v24
    v_mov_b32 v38, v24
    v_mov_b32 v39, v24
L_p2_nk_1:
    s_cmp_ge_u32 s40, 7
    s_cbranch_scc1 L_p2_nk_2
    v_mov_b32 v40, v24
    v_mov_b32 v41, v24
    v_mov_b32 v42, v24
    v_mov_b32 v43, v24
    v_mov_b32 v44, v24
    v_mov_b32 v45, v24
    v_mov_b32 v46, v24
    v_mov_b32 v47, v24
L_p2_nk_2:
    s_cmp_ge_u32 s40, 6
    s_cbranch_scc1 L_p2_nk_3
    v_mov_b32 v48, v24
    v_mov_b32 v49, v24
    v_mov_b32 v50, v24
    v_mov_b32 v51, v24
    v_mov_b32 v52, v24
    v_mov_b32 v53, v24
    v_mov_b32 v54, v24
    v_mov_b32 v55, v24
L_p2_nk_3:
    s_cmp_ge_u32 s40, 5
    s_cbranch_scc1 L_p2_nk_4
    v_mov_b32 v56, v24
    v_mov_b32 v57, v24
    v_mov_b32 v58, v24
    v_mov_b32 v59, v24
    v_mov_b32 v60, v24
    v_mov_b32 v61, v24
    v_mov_b32 v62, v24
    v_mov_b32 v63, v24
L_p2_nk_4:
    s_cmp_ge_u32 s40, 4
    s_cbranch_scc1 L_p2_nk_5
    v_mov_b32 v64, v24
    v_mov_b32 v65, v24
    v_mov_b32 v66, v24
    v_mov_b32 v67, v24
    v_mov_b32 v68, v24
    v_mov_b32 v69, v24
    v_mov_b32 v70, v24
    v_mov_b32 v71, v24
L_p2_nk_5:
    s_cmp_ge_u32 s40, 3
    s_cbranch_scc1 L_p2_nk_6
    v_mov_b32 v72, v24
    v_mov_b32 v73, v24
    v_mov_b32 v74, v24
    v_mov_b32 v75, v24
    v_mov_b32 v76, v24
    v_mov_b32 v77, v24
    v_mov_b32 v78, v24
    v_mov_b32 v79, v24
L_p2_nk_6:
    s_cmp_ge_u32 s40, 2
    s_cbranch_scc1 L_p2_nk_7
    v_mov_b32 v80, v24
    v_mov_b32 v81, v24
    v_mov_b32 v82, v24
    v_mov_b32 v83, v24
    v_mov_b32 v84, v24
    v_mov_b32 v85, v24
    v_mov_b32 v86, v24
    v_mov_b32 v87, v24
L_p2_nk_7:
    s_cmp_ge_u32 s40, 1
    s_cbranch_scc1 L_p2_nk_8
    v_mov_b32 v88, v24
    v_mov_b32 v89, v24
    v_mov_b32 v90, v24
    v_mov_b32 v91, v24
    v_mov_b32 v92, v24
    v_mov_b32 v93, v24
    v_mov_b32 v94, v24
    v_mov_b32 v95, v24
L_p2_nk_8:
    v_max3_f32 v20, v32, v33, v34
    v_max3_f32 v21, v35, v36, v37
    v_max3_f32 v20, v20, v38, v39
    v_max3_f32 v21, v21, v40, v41
    v_max3_f32 v20, v20, v42, v43
    v_max3_f32 v21, v21, v44, v45
    v_max3_f32 v20, v20, v46, v47
    v_max3_f32 v21, v21, v48, v49
    v_max3_f32 v20, v20, v50, v51
    v_max3_f32 v21, v21, v52, v53
    v_max3_f32 v20, v20, v54, v55
    v_max3_f32 v21, v21, v56, v57
    v_max3_f32 v20, v20, v58, v59
    v_max3_f32 v21, v21, v60, v61
    v_max3_f32 v20, v20, v62, v63
    v_max3_f32 v21, v21, v64, v65
    v_max3_f32 v20, v20, v66, v67
    v_max3_f32 v21, v21, v68, v69
    v_max3_f32 v20, v20, v70, v71
    v_max3_f32 v21, v21, v72, v73
    v_max3_f32 v20, v20, v74, v75
    v_max3_f32 v21, v21, v76, v77
    v_max3_f32 v20, v20, v78, v79
    v_max3_f32 v21, v21, v80, v81
    v_max3_f32 v20, v20, v82, v83
    v_max3_f32 v21, v21, v84, v85
    v_max3_f32 v20, v20, v86, v87
    v_max3_f32 v21, v21, v88, v89
    v_max3_f32 v20, v20, v90, v91
    v_max3_f32 v21, v21, v92, v93
    v_max3_f32 v20, v20, v94, v95
    v_max3_f32 v21, v21, v96, v97
    v_max3_f32 v20, v20, v98, v99
    v_max3_f32 v21, v21, v100, v101
    v_max3_f32 v20, v20, v102, v103
    v_max_f32 v20, v20, v21
    v_mov_b32 v21, v20
    s_nop 1
    v_permlane16_swap_b32 v21, v20
    v_max_f32 v20, v20, v21
    v_mov_b32 v21, v20
    s_nop 1
    v_permlane32_swap_b32 v21, v20
    v_max_f32 v20, v20, v21
    v_mul_f32 v20, s42, v20
    v_pk_fma_f32 v[32:33], v[32:33], s[42:43], v[20:21] op_sel_hi:[1,1,0] neg_lo:[0,0,1] neg_hi:[0,0,1]
    v_pk_fma_f32 v[34:35], v[34:35], s[42:43], v[20:21] op_sel_hi:[1,1,0] neg_lo:[0,0,1] neg_hi:[0,0,1]
    v_pk_fma_f32 v[36:37], v[36:37], s[42:43], v[20:21] op_sel_hi:[1,1,0] neg_lo:[0,0,1] neg_hi:[0,0,1]
    v_pk_fma_f32 v[38:39], v[38:39], s[42:43], v[20:21] op_sel_hi:[1,1,0] neg_lo:[0,0,1] neg_hi:[0,0,1]
    v_pk_fma_f32 v[40:41], v[40:41], s[42:43], v[20:21] op_sel_hi:[1,1,0] neg_lo:[0,0,1] neg_hi:[0,0,1]
    v_pk_fma_f32 v[42:43], v[42:43], s[42:43], v[20:21] op_sel_hi:[1,1,0] neg_lo:[0,0,1] neg_hi:[0,0,1]
    v_pk_fma_f32 v[44:45], v[44:45], s[42:43], v[20:21] op_sel_hi:[1,1,0] neg_lo:[0,0,1] neg_hi:[0,0,1]
    v_pk_fma_f32 v[46:47], v[46:47], s[42:43], v[20:21] op_sel_hi:[1,1,0] neg_lo:[0,0,1] neg_hi:[0,0,1]
    v_pk_fma_f32 v[48:49], v[48:49], s[42:43], v[20:21] op_sel_hi:[1,1,0] neg_lo:[0,0,1] neg_hi:[0,0,1]
    v_pk_fma_f32 v[50:51], v[50:51], s[42:43], v[20:21] op_sel_hi:[1,1,0] neg_lo:[0,0,1] neg_hi:[0,0,1]
    v_pk_fma_f32 v[52:53], v[52:53], s[42:43], v[20:21] op_sel_hi:[1,1,0] neg_lo:[0,0,1] neg_hi:[0,0,1]
    v_pk_fma_f32 v[54:55], v[54:55], s[42:43], v[20:21] op_sel_hi:[1,1,0] neg_lo:[0,0,1] neg_hi:[0,0,1]
    v_pk_fma_f32 v[56:57], v[56:57], s[42:43], v[20:21] op_sel_hi:[1,1,0] neg_lo:[0,0,1] neg_hi:[0,0,1]
    v_pk_fma_f32 v[58:59], v[58:59], s[42:43], v[20:21] op_sel_hi:[1,1,0] neg_lo:[0,0,1] neg_hi:[0,0,1]
    v_pk_fma_f32 v[60:61], v[60:61], s[42:43], v[20:21] op_sel_hi:[1,1,0] neg_lo:[0,0,1] neg_hi:[0,0,1]
    v_pk_fma_f32 v[62:63], v[62:63], s[42:43], v[20:21] op_sel_hi:[1,1,0] neg_lo:[0,0,1] neg_hi:[0,0,1]
    v_pk_fma_f32 v[64:65], v[64:65], s[42:43], v[20:21] op_sel_hi:[1,1,0] neg_lo:[0,0,1] neg_hi:[0,0,1]
    v_pk_fma_f32 v[66:67], v[66:67], s[42:43], v[20:21] op_sel_hi:[1,1,0] neg_lo:[0,0,1] neg_hi:[0,0,1]
    v_pk_fma_f32 v[68:69], v[68:69], s[42:43], v[20:21] op_sel_hi:[1,1,0] neg_lo:[0,0,1] neg_hi:[0,0,1]
    v_pk_fma_f32 v[70:71], v[70:71], s[42:43], v[20:21] op_sel_hi:[1,1,0] neg_lo:[0,0,1] neg_hi:[0,0,1]
    v_pk_fma_f32 v[72:73], v[72:73], s[42:43], v[20:21] op_sel_hi:[1,1,0] neg_lo:[0,0,1] neg_hi:[0,0,1]
    v_pk_fma_f32 v[74:75], v[74:75], s[42:43], v[20:21] op_sel_hi:[1,1,0] neg_lo:[0,0,1] neg_hi:[0,0,1]
    v_pk_fma_f32 v[76:77], v[76:77], s[42:43], v[20:21] op_sel_hi:[1,1,0] neg_lo:[0,0,1] neg_hi:[0,0,1]
    v_pk_fma_f32 v[78:79], v[78:79], s[42:43], v[20:21] op_sel_hi:[1,1,0] neg_lo:[0,0,1] neg_hi:[0,0,1]
    v_pk_fma_f32 v[80:81], v[80:81], s[42:43], v[20:21] op_sel_hi:[1,1,0] neg_lo:[0,0,1] neg_hi:[0,0,1]
    v_pk_fma_f32 v[82:83], v[82:83], s[42:43], v[20:21] op_sel_hi:[1,1,0] neg_lo:[0,0,1] neg_hi:[0,0,1]
    v_pk_fma_f32 v[84:85], v[84:85], s[42:43], v[20:21] op_sel_hi:[1,1,0] neg_lo:[0,0,1] neg_hi:[0,0,1]
    v_pk_fma_f32 v[86:87], v[86:87], s[42:43], v[20:21] op_sel_hi:[1,1,0] neg_lo:[0,0,1] neg_hi:[0,0,1]
    v_pk_fma_f32 v[88:89], v[88:89], s[42:43], v[20:21] op_sel_hi:[1,1,0] neg_lo:[0,0,1] neg_hi:[0,0,1]
    v_pk_fma_f32 v[90:91], v[90:91], s[42:43], v[20:21] op_sel_hi:[1,1,0] neg_lo:[0,0,1] neg_hi:[0,0,1]
    v_pk_fma_f32 v[92:93], v[92:93], s[42:43], v[20:21] op_sel_hi:[1,1,0] neg_lo:[0,0,1] neg_hi:[0,0,1]
    v_pk_fma_f32 v[94:95], v[94:95], s[42:43], v[20:21] op_sel_hi:[1,1,0] neg_lo:[0,0,1] neg_hi:[0,0,1]
    v_pk_fma_f32 v[96:97], v[96:97], s[42:43], v[20:21] op_sel_hi:[1,1,0] neg_lo:[0,0,1] neg_hi:[0,0,1]
    v_pk_fma_f32 v[98:99], v[98:99], s[42:43], v[20:21] op_sel_hi:[1,1,0] neg_lo:[0,0,1] neg_hi:[0,0,1]
    v_pk_fma_f32 v[100:101], v[100:101], s[42:43], v[20:21] op_sel_hi:[1,1,0] neg_lo:[0,0,1] neg_hi:[0,0,1]
    v_pk_fma_f32 v[102:103], v[102:103], s[42:43], v[20:21] op_sel_hi:[1,1,0] neg_lo:[0,0,1] neg_hi:[0,0,1]
    v_exp_f32 v32, v32
    v_exp_f32 v33, v33
    v_exp_f32 v34, v34
    v_exp_f32 v35, v35
    v_exp_f32 v36, v36
    v_exp_f32 v37, v37
    v_exp_f32 v38, v38
    v_exp_f32 v39, v39
    v_exp_f32 v40, v40
    v_exp_f32 v41, v41
    v_exp_f32 v42, v42
    v_exp_f32 v43, v43
    v_exp_f32 v44, v44
    v_exp_f32 v45, v45
    v_exp_f32 v46, v46
    v_exp_f32 v47, v47
    v_exp_f32 v48, v48
    v_exp_f32 v49, v49
    v_exp_f32 v50, v50
    v_exp_f32 v51, v51
    v_exp_f32 v52, v52
    v_exp_f32 v53, v53
    v_exp_f32 v54, v54
    v_exp_f32 v55, v55
    v_exp_f32 v56, v56
    v_exp_f32 v57, v57
    v_exp_f32 v58, v58
    v_exp_f32 v59, v59
    v_exp_f32 v60, v60
    v_exp_f32 v61, v61
    v_exp_f32 v62, v62
    v_exp_f32 v63, v63
    v_exp_f32 v64, v64
    v_exp_f32 v65, v65
    v_exp_f32 v66, v66
    v_exp_f32 v67, v67
    v_exp_f32 v68, v68
    v_exp_f32 v69, v69
    v_exp_f32 v70, v70
    v_exp_f32 v71, v71
    v_exp_f32 v72, v72
    v_exp_f32 v73, v73
    v_exp_f32 v74, v74
    v_exp_f32 v75, v75
    v_exp_f32 v76, v76
    v_exp_f32 v77, v77
    v_exp_f32 v78, v78
    v_exp_f32 v79, v79
    v_exp_f32 v80, v80
    v_exp_f32 v81, v81
    v_exp_f32 v82, v82
    v_exp_f32 v83, v83
    v_exp_f32 v84, v84
    v_exp_f32 v85, v85
    v_exp_f32 v86, v86
    v_exp_f32 v87, v87
    v_exp_f32 v88, v88
    v_exp_f32 v89, v89
    v_exp_f32 v90, v90
    v_exp_f32 v91, v91
    v_exp_f32 v92, v92
    v_exp_f32 v93, v93
    v_exp_f32 v94, v94
    v_exp_f32 v95, v95
    v_exp_f32 v96, v96
    v_exp_f32 v97, v97
    v_exp_f32 v98, v98
    v_exp_f32 v99, v99
    v_exp_f32 v100, v100
    v_exp_f32 v101, v101
    v_exp_f32 v102, v102
    v_exp_f32 v103, v103
    s_nop 0
    v_cvt_pk_bf16_f32 v136, v32, v33
    v_cvt_pk_bf16_f32 v137, v34, v35
    v_cvt_pk_bf16_f32 v138, v36, v37
    v_cvt_pk_bf16_f32 v139, v38, v39
    v_cvt_pk_bf16_f32 v140, v40, v41
    v_cvt_pk_bf16_f32 v141, v42, v43
    v_cvt_pk_bf16_f32 v142, v44, v45
    v_cvt_pk_bf16_f32 v143, v46, v47
    v_cvt_pk_bf16_f32 v144, v48, v49
    v_cvt_pk_bf16_f32 v145, v50, v51
    v_cvt_pk_bf16_f32 v146, v52, v53
    v_cvt_pk_bf16_f32 v147, v54, v55
    v_cvt_pk_bf16_f32 v148, v56, v57
    v_cvt_pk_bf16_f32 v149, v58, v59
    v_cvt_pk_bf16_f32 v150, v60, v61
    v_cvt_pk_bf16_f32 v151, v62, v63
    v_cvt_pk_bf16_f32 v152, v64, v65
    v_cvt_pk_bf16_f32 v153, v66, v67
    v_cvt_pk_bf16_f32 v154, v68, v69
    v_cvt_pk_bf16_f32 v155, v70, v71
    v_cvt_pk_bf16_f32 v156, v72, v73
    v_cvt_pk_bf16_f32 v157, v74, v75
    v_cvt_pk_bf16_f32 v158, v76, v77
    v_cvt_pk_bf16_f32 v159, v78, v79
    v_cvt_pk_bf16_f32 v160, v80, v81
    v_cvt_pk_bf16_f32 v161, v82, v83
    v_cvt_pk_bf16_f32 v162, v84, v85
    v_cvt_pk_bf16_f32 v163, v86, v87
    v_cvt_pk_bf16_f32 v164, v88, v89
    v_cvt_pk_bf16_f32 v165, v90, v91
    v_cvt_pk_bf16_f32 v166, v92, v93
    v_cvt_pk_bf16_f32 v167, v94, v95
    v_cvt_pk_bf16_f32 v168, v96, v97
    v_cvt_pk_bf16_f32 v169, v98, v99
    v_cvt_pk_bf16_f32 v170, v100, v101
    v_cvt_pk_bf16_f32 v171, v102, v103
    v_pk_add_f32 v[22:23], v[32:33], v[34:35]
    v_pk_add_f32 v[22:23], v[22:23], v[36:37]
    v_pk_add_f32 v[22:23], v[22:23], v[38:39]
    v_pk_add_f32 v[22:23], v[22:23], v[40:41]
    v_pk_add_f32 v[22:23], v[22:23], v[42:43]
    v_pk_add_f32 v[22:23], v[22:23], v[44:45]
    v_pk_add_f32 v[22:23], v[22:23], v[46:47]
    v_pk_add_f32 v[22:23], v[22:23], v[48:49]
    v_pk_add_f32 v[22:23], v[22:23], v[50:51]
    v_pk_add_f32 v[22:23], v[22:23], v[52:53]
    v_pk_add_f32 v[22:23], v[22:23], v[54:55]
    v_pk_add_f32 v[22:23], v[22:23], v[56:57]
    v_pk_add_f32 v[22:23], v[22:23], v[58:59]
    v_pk_add_f32 v[22:23], v[22:23], v[60:61]
    v_pk_add_f32 v[22:23], v[22:23], v[62:63]
    v_pk_add_f32 v[22:23], v[22:23], v[64:65]
    v_pk_add_f32 v[22:23], v[22:23], v[66:67]
    v_pk_add_f32 v[22:23], v[22:23], v[68:69]
    v_pk_add_f32 v[22:23], v[22:23], v[70:71]
    v_pk_add_f32 v[22:23], v[22:23], v[72:73]
    v_pk_add_f32 v[22:23], v[22:23], v[74:75]
    v_pk_add_f32 v[22:23], v[22:23], v[76:77]
    v_pk_add_f32 v[22:23], v[22:23], v[78:79]
    v_pk_add_f32 v[22:23], v[22:23], v[80:81]
    v_pk_add_f32 v[22:23], v[22:23], v[82:83]
    v_pk_add_f32 v[22:23], v[22:23], v[84:85]
    v_pk_add_f32 v[22:23], v[22:23], v[86:87]
    v_pk_add_f32 v[22:23], v[22:23], v[88:89]
    v_pk_add_f32 v[22:23], v[22:23], v[90:91]
    v_pk_add_f32 v[22:23], v[22:23], v[92:93]
    v_pk_add_f32 v[22:23], v[22:23], v[94:95]
    v_pk_add_f32 v[22:23], v[22:23], v[96:97]
    v_pk_add_f32 v[22:23], v[22:23], v[98:99]
    v_pk_add_f32 v[22:23], v[22:23], v[100:101]
    v_pk_add_f32 v[22:23], v[22:23], v[102:103]
    v_add_f32 v22, v22, v23
    s_waitcnt lgkmcnt(6)
    v_mfma_f32_16x16x32_bf16 v[204:207], v[172:175], v[136:139], 0
    ds_read_b64_tr_b16 v[188:189], v17 offset:4096
    ds_read_b64_tr_b16 v[190:191], v17 offset:4352
    s_waitcnt lgkmcnt(6)
    v_mfma_f32_16x16x32_bf16 v[208:211], v[176:179], v[136:139], 0
    ds_read_b64_tr_b16 v[192:193], v17 offset:4104
    ds_read_b64_tr_b16 v[194:195], v17 offset:4360
    s_waitcnt lgkmcnt(6)
    v_mfma_f32_16x16x32_bf16 v[204:207], v[180:183], v[140:143], v[204:207]
    ds_read_b64_tr_b16 v[196:197], v17 offset:6144
    ds_read_b64_tr_b16 v[198:199], v17 offset:6400
    s_waitcnt lgkmcnt(6)
    v_mfma_f32_16x16x32_bf16 v[208:211], v[184:187], v[140:143], v[208:211]
    ds_read_b64_tr_b16 v[200:201], v17 offset:6152
    ds_read_b64_tr_b16 v[202:203], v17 offset:6408
    s_waitcnt lgkmcnt(6)
    v_mfma_f32_16x16x32_bf16 v[204:207], v[188:191], v[144:147], v[204:207]
    ds_read_b64_tr_b16 v[172:173], v17 offset:8192
    ds_read_b64_tr_b16 v[174:175], v17 offset:8448
    s_waitcnt lgkmcnt(6)
    v_mfma_f32_16x16x32_bf16 v[208:211], v[192:195], v[144:147], v[208:211]
    ds_read_b64_tr_b16 v[176:177], v17 offset:8200
    ds_read_b64_tr_b16 v[178:179], v17 offset:8456
    s_waitcnt lgkmcnt(6)
    v_mfma_f32_16x16x32_bf16 v[204:207], v[196:199], v[148:151], v[204:207]
    ds_read_b64_tr_b16 v[180:181], v17 offset:10240
    ds_read_b64_tr_b16 v[182:183], v17 offset:10496
    s_waitcnt lgkmcnt(6)
    v_mfma_f32_16x16x32_bf16 v[208:211], v[200:203], v[148:151], v[208:211]
    ds_read_b64_tr_b16 v[184:185], v17 offset:10248
    ds_read_b64_tr_b16 v[186:187], v17 offset:10504
    s_waitcnt lgkmcnt(6)
    v_mfma_f32_16x16x32_bf16 v[204:207], v[172:175], v[152:155], v[204:207]
    ds_read_b64_tr_b16 v[188:189], v17 offset:12288
    ds_read_b64_tr_b16 v[190:191], v17 offset:12544
    s_waitcnt lgkmcnt(6)
    v_mfma_f32_16x16x32_bf16 v[208:211], v[176:179], v[152:155], v[208:211]
    ds_read_b64_tr_b16 v[192:193], v17 offset:12296
    ds_read_b64_tr_b16 v[194:195], v17 offset:12552
    s_waitcnt lgkmcnt(6)
    v_mfma_f32_16x16x32_bf16 v[204:207], v[180:183], v[156:159], v[204:207]
    ds_read_b64_tr_b16 v[196:197], v17 offset:14336
    ds_read_b64_tr_b16 v[198:199], v17 offset:14592
    s_waitcnt lgkmcnt(6)
    v_mfma_f32_16x16x32_bf16 v[208:211], v[184:187], v[156:159], v[208:211]
    ds_read_b64_tr_b16 v[200:201], v17 offset:14344
    ds_read_b64_tr_b16 v[202:203], v17 offset:14600
    s_waitcnt lgkmcnt(6)
    v_mfma_f32_16x16x32_bf16 v[204:207], v[188:191], v[160:163], v[204:207]
    ds_read_b64_tr_b16 v[172:173], v17 offset:16384
    ds_read_b64_tr_b16 v[174:175], v17 offset:16640
    s_waitcnt lgkmcnt(6)
    v_mfma_f32_16x16x32_bf16 v[208:211], v[192:195], v[160:163], v[208:211]
    ds_read_b64_tr_b16 v[176:177], v17 offset:16392
    ds_read_b64_tr_b16 v[178:179], v17 offset:16648
    s_waitcnt lgkmcnt(6)
    v_mfma_f32_16x16x32_bf16 v[204:207], v[196:199], v[164:167], v[204:207]
    s_waitcnt lgkmcnt(4)
    v_mfma_f32_16x16x32_bf16 v[208:211], v[200:203], v[164:167], v[208:211]
    s_waitcnt lgkmcnt(2)
    v_mfma_f32_16x16x32_bf16 v[204:207], v[172:175], v[168:171], v[204:207]
    s_waitcnt lgkmcnt(0)
    v_mfma_f32_16x16x32_bf16 v[208:211], v[176:179], v[168:171], v[208:211]
    v_mov_b32 v23, v22
    s_nop 1
    v_permlane16_swap_b32 v23, v22
    v_add_f32 v22, v22, v23
    v_mov_b32 v23, v22
    s_nop 1
    v_permlane32_swap_b32 v23, v22
    v_add_f32 v22, v22, v23
    v_mul_f32 v22, v22, v19
    v_rcp_f32 v22, v22
    s_nop 2
    v_pk_mul_f32 v[204:205], v[204:205], v[22:23] op_sel_hi:[1,0]
    v_pk_mul_f32 v[206:207], v[206:207], v[22:23] op_sel_hi:[1,0]
    v_pk_mul_f32 v[208:209], v[208:209], v[22:23] op_sel_hi:[1,0]
    v_pk_mul_f32 v[210:211], v[210:211], v[22:23] op_sel_hi:[1,0]
    v_cvt_pk_bf16_f32 v212, v204, v205
    v_cvt_pk_bf16_f32 v213, v206, v207
    v_cvt_pk_bf16_f32 v214, v208, v209
    v_cvt_pk_bf16_f32 v215, v210, v211
    s_mul_i32 s31, s40, 311296
    s_mul_i32 s32, s36, 1536
    s_add_u32 s31, s31, s32
    s_and_b32 s33, s38, 1
    s_lshl_b32 s33, s33, 8
    s_add_u32 s31, s31, s33
    s_add_u32 s31, s31, 50593792
    buffer_store_dwordx4 v[212:215], v18, s[8:11], s31 offen sc1
    s_add_u32 s38, s38, 1
    s_cmp_lt_u32 s38, 4
    s_cbranch_scc1 L_p2_tile
    s_add_u32 s35, s35, 128
    s_cmp_lt_u32 s35, 256
    s_cbranch_scc1 L_p2_job
    s_waitcnt vmcnt(0)
    s_barrier
    s_cmp_lg_u32 s20, 0
    s_cbranch_scc1 L_p2_end
    v_mov_b32 v4, 0
    v_mov_b32 v5, 1
    s_mov_b32 s30, 105947136
    s_mov_b64 exec, 1
    buffer_atomic_add v5, v4, s[8:11], s30 offen
    s_mov_b64 exec, -1
L_p2_end:
    s_lshr_b32 s39, s34, 5
    s_and_b32 s17, s34, 31
    s_barrier
    s_cmp_lt_u32 s17, 20
    s_cbranch_scc1 L_p3_out
    v_and_b32 v1, 63, v0
    v_and_b32 v2, 15, v0
    v_bfe_u32 v3, v0, 4, 2
    s_mul_i32 s30, s39, 48
    s_sub_u32 s31, s17, 20
    s_lshl_b32 s31, s31, 2
    s_add_u32 s30, s30, s31
    s_add_u32 s30, s30, s20
    s_and_b32 s36, s30, 31
    s_lshr_b32 s37, s30, 5
    s_mov_b32 s42, 0x3e0293ee
    s_mov_b32 s43, 0x3e0293ee
    v_mov_b32 v26, 0xff800000
    v_lshrrev_b32 v4, 1, v3
    v_lshlrev_b32 v5, 10, v4
    v_and_b32 v6, 1, v3
    v_lshl_add_u32 v5, v6, 9, v5
    v_lshl_add_u32 v12, v2, 4, v5
    v_and_b32 v7, 7, v2
    v_lshlrev_b32 v5, 8, v4
    v_lshl_add_u32 v5, v7, 5, v5
    v_lshl_add_u32 v13, v6, 4, v5
    s_mul_i32 s52, s20, 12288
    v_bfe_u32 v4, v1, 2, 2
    v_and_b32 v5, 3, v1
    v_lshl_add_u32 v6, v3, 2, v4
    v_lshlrev_b32 v6, 4, v6
    v_lshrrev_b32 v7, 1, v5
    v_lshl_add_u32 v6, v7, 10, v6
    v_and_b32 v7, 1, v5
    v_lshl_add_u32 v6, v7, 9, v6
    v_add_u32 v14, s52, v6
    v_and_b32 v6, 1, v3
    v_lshl_add_u32 v6, v6, 2, v4
    v_lshlrev_b32 v6, 5, v6
    v_lshrrev_b32 v7, 1, v3
    v_lshl_add_u32 v6, v7, 11, v6
    v_lshrrev_b32 v7, 1, v5
    v_lshl_add_u32 v6, v7, 8, v6
    v_and_b32 v7, 1, v5
    v_lshl_add_u32 v6, v7, 4, v6
    v_add_u32 v6, s52, v6
    v_add_u32 v15, 8192, v6
    v_lshlrev_b32 v4, 9, v3
    v_lshl_add_u32 v16, v2, 4, v4
    v_lshlrev_b32 v17, 4, v1
    v_cmp_gt_u32 vcc, 4, v1
    s_lshl_b32 s30, s36, 9
    v_lshlrev_b32 v4, 7, v1
    v_add_u32 v4, s30, v4
    v_mov_b32 v5, 1073741824
    v_cndmask_b32 v18, v5, v4, vcc
    v_mov_b32 v166, 0
    v_mov_b32 v167, 0
    v_mov_b32 v170, 0
    v_mov_b32 v171, 0
    v_mov_b32 v174, 0
    v_mov_b32 v175, 0
    v_mov_b32 v178, 0
    v_mov_b32 v179, 0
    v_mov_b32 v142, 0
    v_mov_b32 v143, 0
    v_mov_b32 v146, 0
    v_mov_b32 v147, 0
    v_mov_b32 v134, 0
    v_mov_b32 v135, 0
    v_lshlrev_b32 v4, 2, v3
    v_sub_u32 v4, v2, v4
    v_cmp_le_i32 s[44:45], 0, v4
    v_cmp_le_i32 s[46:47], 1, v4
    v_cmp_le_i32 s[48:49], 2, v4
    v_cmp_le_i32 s[50:51], 3, v4
    v_cmp_gt_u32 vcc, 3, v1
    v_lshlrev_b32 v4, 12, v1
    s_lshl_b32 s30, s36, 7
    v_add_u32 v4, s30, v4
    v_mov_b32 v5, 1073741824
    v_cndmask_b32 v4, v5, v4, vcc
    s_mov_b64 s[32:33], vcc
    s_mov_b32 s30, 105906176
L_x_w1:
    buffer_load_dword v5, v4, s[8:11], s30 offen sc1
    s_waitcnt vmcnt(0)
    v_cmp_gt_u32 vcc, 64, v5
    s_nop 3
    s_and_b64 vcc, vcc, s[32:33]
    s_cbranch_vccz L_x_unit
    s_sleep 32
    s_sub_u32 s22, s22, 1
    s_cbranch_scc0 L_x_w1
    s_branch L_timeout
L_x_unit:
    s_lshl_b32 s30, s37, 5
    s_add_u32 s30, s30, s36
    s_lshl_b32 s53, s30, 13
    s_add_u32 s31, s53, 0
    s_add_u32 s32, s31, 0
    buffer_load_dwordx4 v[32:35], v12, s[8:11], s32 offen sc1
    s_add_u32 s32, s31, 2048
    buffer_load_dwordx4 v[36:39], v12, s[8:11], s32 offen sc1
    s_add_u32 s32, s31, 4096
    buffer_load_dwordx4 v[40:43], v12, s[8:11], s32 offen sc1
    s_add_u32 s32, s31, 6144
    buffer_load_dwordx4 v[44:47], v12, s[8:11], s32 offen sc1
    s_add_u32 s32, s31, 256
    buffer_load_dwordx4 v[48:51], v12, s[8:11], s32 offen sc1
    s_add_u32 s32, s31, 2304
    buffer_load_dwordx4 v[52:55], v12, s[8:11], s32 offen sc1
    s_add_u32 s32, s31, 4352
    buffer_load_dwordx4 v[56:59], v12, s[8:11], s32 offen sc1
    s_add_u32 s32, s31, 6400
    buffer_load_dwordx4 v[60:63], v12, s[8:11], s32 offen sc1
    s_add_u32 s31, s53, 16777216
    s_add_u32 s32, s31, 0
    buffer_load_dwordx4 v[64:67], v12, s[8:11], s32 offen sc1
    s_add_u32 s32, s31, 2048
    buffer_load_dwordx4 v[68:71], v12, s[8:11], s32 offen sc1
    s_add_u32 s32, s31, 4096
    buffer_load_dwordx4 v[72:75], v12, s[8:11], s32 offen sc1
    s_add_u32 s32, s31, 6144
    buffer_load_dwordx4 v[76:79], v12, s[8:11], s32 offen sc1
    s_add_u32 s32, s31, 256
    buffer_load_dwordx4 v[80:83], v12, s[8:11], s32 offen sc1
    s_add_u32 s32, s31, 2304
    buffer_load_dwordx4 v[84:87], v12, s[8:11], s32 offen sc1
    s_add_u32 s32, s31, 4352
    buffer_load_dwordx4 v[88:91], v12, s[8:11], s32 offen sc1
    s_add_u32 s32, s31, 6400
    buffer_load_dwordx4 v[92:95], v12, s[8:11], s32 offen sc1
    s_add_u32 s31, s53, 33554432
    s_add_u32 m0, s52, 0
    s_add_u32 s32, s31, 0
    buffer_load_dwordx4 v17, s[8:11], s32 offen sc1 lds
    s_add_u32 m0, s52, 1024
    s_add_u32 s32, s31, 1024
    buffer_load_dwordx4 v17, s[8:11], s32 offen sc1 lds
    s_add_u32 m0, s52, 2048
    s_add_u32 s32, s31, 2048
    buffer_load_dwordx4 v17, s[8:11], s32 offen sc1 lds
    s_add_u32 m0, s52, 3072
    s_add_u32 s32, s31, 3072
    buffer_load_dwordx4 v17, s[8:11], s32 offen sc1 lds
    s_add_u32 m0, s52, 4096
    s_add_u32 s32, s31, 4096
    buffer_load_dwordx4 v17, s[8:11], s32 offen sc1 lds
    s_add_u32 m0, s52, 5120
    s_add_u32 s32, s31, 5120
    buffer_load_dwordx4 v17, s[8:11], s32 offen sc1 lds
    s_add_u32 m0, s52, 6144
    s_add_u32 s32, s31, 6144
    buffer_load_dwordx4 v17, s[8:11], s32 offen sc1 lds
    s_add_u32 m0, s52, 7168
    s_add_u32 s32, s31, 7168
    buffer_load_dwordx4 v17, s[8:11], s32 offen sc1 lds
    s_lshl_b32 s31, s37, 11
    s_add_u32 s31, s31, 104857600
    v_lshlrev_b32 v4, 4, v2
    buffer_load_ushort v20, v4, s[8:11], s31 offen sc1
    buffer_load_ushort v21, v4, s[8:11], s31 offen offset:256 sc1
    s_waitcnt vmcnt(0)
    v_mfma_f32_16x16x32_bf16 v[112:115], v[64:67], v[32:35], 0
    v_mfma_f32_16x16x32_bf16 v[120:123], v[64:67], v[48:51], 0
    v_mfma_f32_16x16x32_bf16 v[124:127], v[80:83], v[48:51], 0
    v_mfma_f32_16x16x32_bf16 v[112:115], v[68:71], v[36:39], v[112:115]
    v_mfma_f32_16x16x32_bf16 v[120:123], v[68:71], v[52:55], v[120:123]
    v_mfma_f32_16x16x32_bf16 v[124:127], v[84:87], v[52:55], v[124:127]
    v_mfma_f32_16x16x32_bf16 v[112:115], v[72:75], v[40:43], v[112:115]
    v_mfma_f32_16x16x32_bf16 v[120:123], v[72:75], v[56:59], v[120:123]
    v_mfma_f32_16x16x32_bf16 v[124:127], v[88:91], v[56:59], v[124:127]
    v_mfma_f32_16x16x32_bf16 v[112:115], v[76:79], v[44:47], v[112:115]
    v_mfma_f32_16x16x32_bf16 v[120:123], v[76:79], v[60:63], v[120:123]
    v_mfma_f32_16x16x32_bf16 v[124:127], v[92:95], v[60:63], v[124:127]
    v_lshlrev_b32 v20, 16, v20
    v_mul_f32 v20, 0xbfb8aa3b, v20
    v_exp_f32 v20, v20
    s_nop 0
    v_add_f32 v20, 1.0, v20
    v_lshlrev_b32 v21, 16, v21
    v_mul_f32 v21, 0xbfb8aa3b, v21
    v_exp_f32 v21, v21
    s_nop 0
    v_add_f32 v21, 1.0, v21
    s_nop 2
    v_cndmask_b32 v112, v26, v112, s[44:45]
    v_cndmask_b32 v124, v26, v124, s[44:45]
    v_cndmask_b32 v113, v26, v113, s[46:47]
    v_cndmask_b32 v125, v26, v125, s[46:47]
    v_cndmask_b32 v114, v26, v114, s[48:49]
    v_cndmask_b32 v126, v26, v126, s[48:49]
    v_cndmask_b32 v115, v26, v115, s[50:51]
    v_cndmask_b32 v127, v26, v127, s[50:51]
    v_max3_f32 v22, v112, v113, v114
    v_max_f32 v22, v22, v115
    v_mov_b32 v23, v22
    s_nop 1
    v_permlane16_swap_b32 v23, v22
    v_max_f32 v22, v22, v23
    v_mov_b32 v23, v22
    s_nop 1
    v_permlane32_swap_b32 v23, v22
    v_max_f32 v22, v22, v23
    v_mul_f32 v22, s42, v22
    v_mov_b32 v27, v22
    v_pk_fma_f32 v[112:113], v[112:113], s[42:43], v[22:23] op_sel_hi:[1,1,0] neg_lo:[0,0,1] neg_hi:[0,0,1]
    v_pk_fma_f32 v[114:115], v[114:115], s[42:43], v[22:23] op_sel_hi:[1,1,0] neg_lo:[0,0,1] neg_hi:[0,0,1]
    v_exp_f32 v112, v112
    v_exp_f32 v113, v113
    v_exp_f32 v114, v114
    v_exp_f32 v115, v115
    s_nop 0
    v_cvt_pk_bf16_f32 v132, v112, v113
    v_cvt_pk_bf16_f32 v133, v114, v115
    v_add_f32 v29, v112, v113
    v_add_f32 v29, v29, v114
    v_add_f32 v29, v29, v115
    v_mov_b32 v4, v29
    s_nop 1
    v_permlane16_swap_b32 v4, v29
    v_add_f32 v29, v29, v4
    v_mov_b32 v4, v29
    s_nop 1
    v_permlane32_swap_b32 v4, v29
    v_add_f32 v29, v29, v4
    v_max3_f32 v22, v120, v121, v122
    v_max3_f32 v22, v22, v123, v124
    v_max3_f32 v22, v22, v125, v126
    v_max_f32 v22, v22, v127
    v_mov_b32 v23, v22
    s_nop 1
    v_permlane16_swap_b32 v23, v22
    v_max_f32 v22, v22, v23
    v_mov_b32 v23, v22
    s_nop 1
    v_permlane32_swap_b32 v23, v22
    v_max_f32 v22, v22, v23
    v_mul_f32 v22, s42, v22
    v_mov_b32 v28, v22
    v_pk_fma_f32 v[120:121], v[120:121], s[42:43], v[22:23] op_sel_hi:[1,1,0] neg_lo:[0,0,1] neg_hi:[0,0,1]
    v_pk_fma_f32 v[122:123], v[122:123], s[42:43], v[22:23] op_sel_hi:[1,1,0] neg_lo:[0,0,1] neg_hi:[0,0,1]
    v_pk_fma_f32 v[124:125], v[124:125], s[42:43], v[22:23] op_sel_hi:[1,1,0] neg_lo:[0,0,1] neg_hi:[0,0,1]
    v_pk_fma_f32 v[126:127], v[126:127], s[42:43], v[22:23] op_sel_hi:[1,1,0] neg_lo:[0,0,1] neg_hi:[0,0,1]
    v_exp_f32 v120, v120
    v_exp_f32 v121, v121
    v_exp_f32 v122, v122
    v_exp_f32 v123, v123
    v_exp_f32 v124, v124
    v_exp_f32 v125, v125
    v_exp_f32 v126, v126
    v_exp_f32 v127, v127
    s_nop 0
    v_cvt_pk_bf16_f32 v136, v120, v121
    v_cvt_pk_bf16_f32 v137, v122, v123
    v_cvt_pk_bf16_f32 v138, v124, v125
    v_cvt_pk_bf16_f32 v139, v126, v127
    v_add_f32 v30, v120, v121
    v_add_f32 v30, v30, v122
    v_add_f32 v30, v30, v123
    v_add_f32 v30, v30, v124
    v_add_f32 v30, v30, v125
    v_add_f32 v30, v30, v126
    v_add_f32 v30, v30, v127
    v_mov_b32 v4, v30
    s_nop 1
    v_permlane16_swap_b32 v4, v30
    v_add_f32 v30, v30, v4
    v_mov_b32 v4, v30
    s_nop 1
    v_permlane32_swap_b32 v4, v30
    v_add_f32 v30, v30, v4
    ds_read_b64_tr_b16 v[148:149], v14 offset:0
    ds_read_b64_tr_b16 v[150:151], v14 offset:256
    ds_read_b64_tr_b16 v[152:153], v14 offset:8
    ds_read_b64_tr_b16 v[154:155], v14 offset:264
    s_waitcnt lgkmcnt(0)
    v_mfma_f32_16x16x32_bf16 v[180:183], v[148:151], v[132:135], 0
    v_mfma_f32_16x16x32_bf16 v[188:191], v[148:151], v[136:139], 0
    v_mfma_f32_16x16x32_bf16 v[184:187], v[152:155], v[132:135], 0
    v_mfma_f32_16x16x32_bf16 v[192:195], v[152:155], v[136:139], 0
    ds_read_b64_tr_b16 v[156:157], v14 offset:2048
    ds_read_b64_tr_b16 v[158:159], v14 offset:2304
    ds_read_b64_tr_b16 v[160:161], v14 offset:2056
    ds_read_b64_tr_b16 v[162:163], v14 offset:2312
    s_waitcnt lgkmcnt(0)
    v_mfma_f32_16x16x32_bf16 v[196:199], v[156:159], v[132:135], 0
    v_mfma_f32_16x16x32_bf16 v[204:207], v[156:159], v[136:139], 0
    v_mfma_f32_16x16x32_bf16 v[200:203], v[160:163], v[132:135], 0
    v_mfma_f32_16x16x32_bf16 v[208:211], v[160:163], v[136:139], 0
    ds_read_b64_tr_b16 v[148:149], v14 offset:4096
    ds_read_b64_tr_b16 v[150:151], v14 offset:4352
    ds_read_b64_tr_b16 v[152:153], v14 offset:4104
    ds_read_b64_tr_b16 v[154:155], v14 offset:4360
    s_waitcnt lgkmcnt(0)
    v_mfma_f32_16x16x32_bf16 v[212:215], v[148:151], v[132:135], 0
    v_mfma_f32_16x16x32_bf16 v[220:223], v[148:151], v[136:139], 0
    v_mfma_f32_16x16x32_bf16 v[216:219], v[152:155], v[132:135], 0
    v_mfma_f32_16x16x32_bf16 v[224:227], v[152:155], v[136:139], 0
    ds_read_b64_tr_b16 v[156:157], v14 offset:6144
    ds_read_b64_tr_b16 v[158:159], v14 offset:6400
    ds_read_b64_tr_b16 v[160:161], v14 offset:6152
    ds_read_b64_tr_b16 v[162:163], v14 offset:6408
    s_waitcnt lgkmcnt(0)
    v_mfma_f32_16x16x32_bf16 v[228:231], v[156:159], v[132:135], 0
    v_mfma_f32_16x16x32_bf16 v[236:239], v[156:159], v[136:139], 0
    v_mfma_f32_16x16x32_bf16 v[232:235], v[160:163], v[132:135], 0
    v_mfma_f32_16x16x32_bf16 v[240:243], v[160:163], v[136:139], 0
    s_add_u32 s54, s37, 1
    s_mov_b32 s30, 105922560
L_x_w2:
    buffer_load_dword v5, v18, s[8:11], s30 offen sc1
    s_waitcnt vmcnt(0)
    v_cmp_gt_u32 vcc, s54, v5
    s_nop 3
    s_and_b64 vcc, vcc, 15
    s_cbranch_vccz L_x_go
    s_cmp_ge_u32 s37, 58
    s_cbranch_scc1 L_x_w2_short
    s_sleep 100
L_x_w2_short:
    s_sleep 1
    s_sub_u32 s22, s22, 1
    s_cbranch_scc0 L_x_w2
    s_branch L_timeout
L_x_go:
    s_lshl_b32 s30, s37, 5
    s_add_u32 s30, s30, s36
    s_lshl_b32 s31, s30, 11
    s_add_u32 s31, s31, 71303168
    buffer_load_dwordx4 v[96:99], v13, s[8:11], s31 offen offset:0 sc1
    buffer_load_dwordx4 v[100:103], v13, s[8:11], s31 offen offset:512 sc1
    buffer_load_dwordx4 v[104:107], v13, s[8:11], s31 offen offset:1024 sc1
    buffer_load_dwordx4 v[108:111], v13, s[8:11], s31 offen offset:1536 sc1
    s_lshl_b32 s31, s30, 12
    s_add_u32 s31, s31, 75497472
    s_add_u32 m0, s52, 8192
    s_add_u32 s32, s31, 0
    buffer_load_dwordx4 v17, s[8:11], s32 offen sc1 lds
    s_add_u32 m0, s52, 9216
    s_add_u32 s32, s31, 1024
    buffer_load_dwordx4 v17, s[8:11], s32 offen sc1 lds
    s_add_u32 m0, s52, 10240
    s_add_u32 s32, s31, 2048
    buffer_load_dwordx4 v17, s[8:11], s32 offen sc1 lds
    s_add_u32 m0, s52, 11264
    s_add_u32 s32, s31, 3072
    buffer_load_dwordx4 v17, s[8:11], s32 offen sc1 lds
    s_waitcnt vmcnt(4)
    v_mfma_f32_16x16x32_bf16 v[116:119], v[96:99], v[32:35], 0
    v_mfma_f32_16x16x32_bf16 v[128:131], v[96:99], v[48:51], 0
    v_mfma_f32_16x16x32_bf16 v[116:119], v[100:103], v[36:39], v[116:119]
    v_mfma_f32_16x16x32_bf16 v[128:131], v[100:103], v[52:55], v[128:131]
    v_mfma_f32_16x16x32_bf16 v[116:119], v[104:107], v[40:43], v[116:119]
    v_mfma_f32_16x16x32_bf16 v[128:131], v[104:107], v[56:59], v[128:131]
    v_mfma_f32_16x16x32_bf16 v[116:119], v[108:111], v[44:47], v[116:119]
    v_mfma_f32_16x16x32_bf16 v[128:131], v[108:111], v[60:63], v[128:131]
    s_nop 7
    v_max3_f32 v22, v116, v117, v118
    v_max_f32 v22, v22, v119
    v_mov_b32 v23, v22
    s_nop 1
    v_permlane16_swap_b32 v23, v22
    v_max_f32 v22, v22, v23
    v_mov_b32 v23, v22
    s_nop 1
    v_permlane32_swap_b32 v23, v22
    v_max_f32 v22, v22, v23
    v_mul_f32 v22, s42, v22
    v_max_f32 v22, v22, v27
    v_sub_f32 v24, v27, v22
    v_pk_fma_f32 v[116:117], v[116:117], s[42:43], v[22:23] op_sel_hi:[1,1,0] neg_lo:[0,0,1] neg_hi:[0,0,1]
    v_pk_fma_f32 v[118:119], v[118:119], s[42:43], v[22:23] op_sel_hi:[1,1,0] neg_lo:[0,0,1] neg_hi:[0,0,1]
    v_exp_f32 v24, v24
    v_exp_f32 v116, v116
    v_exp_f32 v117, v117
    v_exp_f32 v118, v118
    v_exp_f32 v119, v119
    s_nop 0
    v_cvt_pk_bf16_f32 v140, v116, v117
    v_cvt_pk_bf16_f32 v141, v118, v119
    v_add_f32 v4, v116, v117
    v_add_f32 v5, v118, v119
    v_add_f32 v4, v4, v5
    v_mov_b32 v5, v4
    s_nop 1
    v_permlane16_swap_b32 v5, v4
    v_add_f32 v4, v4, v5
    v_mov_b32 v5, v4
    s_nop 1
    v_permlane32_swap_b32 v5, v4
    v_add_f32 v4, v4, v5
    v_mul_f32 v4, 0.5, v4
    v_fma_f32 v4, v24, v29, v4
    v_mul_f32 v4, v4, v20
    v_rcp_f32 v8, v4
    v_max3_f32 v22, v128, v129, v130
    v_max_f32 v22, v22, v131
    v_mov_b32 v23, v22
    s_nop 1
    v_permlane16_swap_b32 v23, v22
    v_max_f32 v22, v22, v23
    v_mov_b32 v23, v22
    s_nop 1
    v_permlane32_swap_b32 v23, v22
    v_max_f32 v22, v22, v23
    v_mul_f32 v22, s42, v22
    v_max_f32 v22, v22, v28
    v_sub_f32 v25, v28, v22
    v_pk_fma_f32 v[128:129], v[128:129], s[42:43], v[22:23] op_sel_hi:[1,1,0] neg_lo:[0,0,1] neg_hi:[0,0,1]
    v_pk_fma_f32 v[130:131], v[130:131], s[42:43], v[22:23] op_sel_hi:[1,1,0] neg_lo:[0,0,1] neg_hi:[0,0,1]
    v_exp_f32 v25, v25
    v_exp_f32 v128, v128
    v_exp_f32 v129, v129
    v_exp_f32 v130, v130
    v_exp_f32 v131, v131
    s_nop 0
    v_cvt_pk_bf16_f32 v144, v128, v129
    v_cvt_pk_bf16_f32 v145, v130, v131
    v_add_f32 v4, v128, v129
    v_add_f32 v5, v130, v131
    v_add_f32 v4, v4, v5
    v_mov_b32 v5, v4
    s_nop 1
    v_permlane16_swap_b32 v5, v4
    v_add_f32 v4, v4, v5
    v_mov_b32 v5, v4
    s_nop 1
    v_permlane32_swap_b32 v5, v4
    v_add_f32 v4, v4, v5
    v_mul_f32 v4, 0.5, v4
    v_fma_f32 v4, v25, v30, v4
    v_mul_f32 v4, v4, v21
    v_rcp_f32 v9, v4
    v_pk_mul_f32 v[180:181], v[180:181], v[24:25] op_sel:[0,0] op_sel_hi:[1,0]
    v_pk_mul_f32 v[182:183], v[182:183], v[24:25] op_sel:[0,0] op_sel_hi:[1,0]
    v_pk_mul_f32 v[184:185], v[184:185], v[24:25] op_sel:[0,0] op_sel_hi:[1,0]
    v_pk_mul_f32 v[186:187], v[186:187], v[24:25] op_sel:[0,0] op_sel_hi:[1,0]
    v_pk_mul_f32 v[188:189], v[188:189], v[24:25] op_sel:[0,1] op_sel_hi:[1,1]
    v_pk_mul_f32 v[190:191], v[190:191], v[24:25] op_sel:[0,1] op_sel_hi:[1,1]
    v_pk_mul_f32 v[192:193], v[192:193], v[24:25] op_sel:[0,1] op_sel_hi:[1,1]
    v_pk_mul_f32 v[194:195], v[194:195], v[24:25] op_sel:[0,1] op_sel_hi:[1,1]
    v_pk_mul_f32 v[196:197], v[196:197], v[24:25] op_sel:[0,0] op_sel_hi:[1,0]
    v_pk_mul_f32 v[198:199], v[198:199], v[24:25] op_sel:[0,0] op_sel_hi:[1,0]
    v_pk_mul_f32 v[200:201], v[200:201], v[24:25] op_sel:[0,0] op_sel_hi:[1,0]
    v_pk_mul_f32 v[202:203], v[202:203], v[24:25] op_sel:[0,0] op_sel_hi:[1,0]
    v_pk_mul_f32 v[204:205], v[204:205], v[24:25] op_sel:[0,1] op_sel_hi:[1,1]
    v_pk_mul_f32 v[206:207], v[206:207], v[24:25] op_sel:[0,1] op_sel_hi:[1,1]
    v_pk_mul_f32 v[208:209], v[208:209], v[24:25] op_sel:[0,1] op_sel_hi:[1,1]
    v_pk_mul_f32 v[210:211], v[210:211], v[24:25] op_sel:[0,1] op_sel_hi:[1,1]
    v_pk_mul_f32 v[212:213], v[212:213], v[24:25] op_sel:[0,0] op_sel_hi:[1,0]
    v_pk_mul_f32 v[214:215], v[214:215], v[24:25] op_sel:[0,0] op_sel_hi:[1,0]
    v_pk_mul_f32 v[216:217], v[216:217], v[24:25] op_sel:[0,0] op_sel_hi:[1,0]
    v_pk_mul_f32 v[218:219], v[218:219], v[24:25] op_sel:[0,0] op_sel_hi:[1,0]
    v_pk_mul_f32 v[220:221], v[220:221], v[24:25] op_sel:[0,1] op_sel_hi:[1,1]
    v_pk_mul_f32 v[222:223], v[222:223], v[24:25] op_sel:[0,1] op_sel_hi:[1,1]
    v_pk_mul_f32 v[224:225], v[224:225], v[24:25] op_sel:[0,1] op_sel_hi:[1,1]
    v_pk_mul_f32 v[226:227], v[226:227], v[24:25] op_sel:[0,1] op_sel_hi:[1,1]
    v_pk_mul_f32 v[228:229], v[228:229], v[24:25] op_sel:[0,0] op_sel_hi:[1,0]
    v_pk_mul_f32 v[230:231], v[230:231], v[24:25] op_sel:[0,0] op_sel_hi:[1,0]
    v_pk_mul_f32 v[232:233], v[232:233], v[24:25] op_sel:[0,0] op_sel_hi:[1,0]
    v_pk_mul_f32 v[234:235], v[234:235], v[24:25] op_sel:[0,0] op_sel_hi:[1,0]
    v_pk_mul_f32 v[236:237], v[236:237], v[24:25] op_sel:[0,1] op_sel_hi:[1,1]
    v_pk_mul_f32 v[238:239], v[238:239], v[24:25] op_sel:[0,1] op_sel_hi:[1,1]
    v_pk_mul_f32 v[240:241], v[240:241], v[24:25] op_sel:[0,1] op_sel_hi:[1,1]
    v_pk_mul_f32 v[242:243], v[242:243], v[24:25] op_sel:[0,1] op_sel_hi:[1,1]
    s_waitcnt vmcnt(0)
    s_mul_i32 s31, s37, 311296
    s_lshl_b32 s32, s36, 13
    s_add_u32 s31, s31, s32
    s_add_u32 s31, s31, 50331648
    ds_read_b64_tr_b16 v[164:165], v15 offset:0
    ds_read_b64_tr_b16 v[168:169], v15 offset:8
    ds_read_b64_tr_b16 v[172:173], v15 offset:512
    ds_read_b64_tr_b16 v[176:177], v15 offset:520
    s_waitcnt lgkmcnt(0)
    v_mfma_f32_16x16x32_bf16 v[180:183], v[164:167], v[140:143], v[180:183]
    v_mfma_f32_16x16x32_bf16 v[188:191], v[164:167], v[144:147], v[188:191]
    v_mfma_f32_16x16x32_bf16 v[184:187], v[168:171], v[140:143], v[184:187]
    v_mfma_f32_16x16x32_bf16 v[192:195], v[168:171], v[144:147], v[192:195]
    v_mfma_f32_16x16x32_bf16 v[196:199], v[172:175], v[140:143], v[196:199]
    v_mfma_f32_16x16x32_bf16 v[204:207], v[172:175], v[144:147], v[204:207]
    v_mfma_f32_16x16x32_bf16 v[200:203], v[176:179], v[140:143], v[200:203]
    v_mfma_f32_16x16x32_bf16 v[208:211], v[176:179], v[144:147], v[208:211]
    ds_read_b64_tr_b16 v[164:165], v15 offset:1024
    ds_read_b64_tr_b16 v[168:169], v15 offset:1032
    ds_read_b64_tr_b16 v[172:173], v15 offset:1536
    ds_read_b64_tr_b16 v[176:177], v15 offset:1544
    s_waitcnt lgkmcnt(0)
    v_mfma_f32_16x16x32_bf16 v[212:215], v[164:167], v[140:143], v[212:215]
    v_mfma_f32_16x16x32_bf16 v[220:223], v[164:167], v[144:147], v[220:223]
    v_mfma_f32_16x16x32_bf16 v[216:219], v[168:171], v[140:143], v[216:219]
    v_mfma_f32_16x16x32_bf16 v[224:227], v[168:171], v[144:147], v[224:227]
    v_mfma_f32_16x16x32_bf16 v[228:231], v[172:175], v[140:143], v[228:231]
    v_mfma_f32_16x16x32_bf16 v[236:239], v[172:175], v[144:147], v[236:239]
    v_mfma_f32_16x16x32_bf16 v[232:235], v[176:179], v[140:143], v[232:235]
    v_mfma_f32_16x16x32_bf16 v[240:243], v[176:179], v[144:147], v[240:243]
    s_nop 7
    v_pk_mul_f32 v[180:181], v[180:181], v[8:9] op_sel:[0,0] op_sel_hi:[1,0]
    v_pk_mul_f32 v[182:183], v[182:183], v[8:9] op_sel:[0,0] op_sel_hi:[1,0]
    v_pk_mul_f32 v[184:185], v[184:185], v[8:9] op_sel:[0,0] op_sel_hi:[1,0]
    v_pk_mul_f32 v[186:187], v[186:187], v[8:9] op_sel:[0,0] op_sel_hi:[1,0]
    v_cvt_pk_bf16_f32 v244, v180, v181
    v_cvt_pk_bf16_f32 v245, v182, v183
    v_cvt_pk_bf16_f32 v246, v184, v185
    v_cvt_pk_bf16_f32 v247, v186, v187
    s_add_u32 s32, s31, 0
    buffer_store_dwordx4 v[244:247], v16, s[8:11], s32 offen sc1
    v_pk_mul_f32 v[188:189], v[188:189], v[8:9] op_sel:[0,1] op_sel_hi:[1,1]
    v_pk_mul_f32 v[190:191], v[190:191], v[8:9] op_sel:[0,1] op_sel_hi:[1,1]
    v_pk_mul_f32 v[192:193], v[192:193], v[8:9] op_sel:[0,1] op_sel_hi:[1,1]
    v_pk_mul_f32 v[194:195], v[194:195], v[8:9] op_sel:[0,1] op_sel_hi:[1,1]
    v_cvt_pk_bf16_f32 v248, v188, v189
    v_cvt_pk_bf16_f32 v249, v190, v191
    v_cvt_pk_bf16_f32 v250, v192, v193
    v_cvt_pk_bf16_f32 v251, v194, v195
    s_add_u32 s32, s31, 256
    buffer_store_dwordx4 v[248:251], v16, s[8:11], s32 offen sc1
    v_pk_mul_f32 v[196:197], v[196:197], v[8:9] op_sel:[0,0] op_sel_hi:[1,0]
    v_pk_mul_f32 v[198:199], v[198:199], v[8:9] op_sel:[0,0] op_sel_hi:[1,0]
    v_pk_mul_f32 v[200:201], v[200:201], v[8:9] op_sel:[0,0] op_sel_hi:[1,0]
    v_pk_mul_f32 v[202:203], v[202:203], v[8:9] op_sel:[0,0] op_sel_hi:[1,0]
    v_cvt_pk_bf16_f32 v244, v196, v197
    v_cvt_pk_bf16_f32 v245, v198, v199
    v_cvt_pk_bf16_f32 v246, v200, v201
    v_cvt_pk_bf16_f32 v247, v202, v203
    s_add_u32 s32, s31, 2048
    buffer_store_dwordx4 v[244:247], v16, s[8:11], s32 offen sc1
    v_pk_mul_f32 v[204:205], v[204:205], v[8:9] op_sel:[0,1] op_sel_hi:[1,1]
    v_pk_mul_f32 v[206:207], v[206:207], v[8:9] op_sel:[0,1] op_sel_hi:[1,1]
    v_pk_mul_f32 v[208:209], v[208:209], v[8:9] op_sel:[0,1] op_sel_hi:[1,1]
    v_pk_mul_f32 v[210:211], v[210:211], v[8:9] op_sel:[0,1] op_sel_hi:[1,1]
    v_cvt_pk_bf16_f32 v248, v204, v205
    v_cvt_pk_bf16_f32 v249, v206, v207
    v_cvt_pk_bf16_f32 v250, v208, v209
    v_cvt_pk_bf16_f32 v251, v210, v211
    s_add_u32 s32, s31, 2304
    buffer_store_dwordx4 v[248:251], v16, s[8:11], s32 offen sc1
    v_pk_mul_f32 v[212:213], v[212:213], v[8:9] op_sel:[0,0] op_sel_hi:[1,0]
    v_pk_mul_f32 v[214:215], v[214:215], v[8:9] op_sel:[0,0] op_sel_hi:[1,0]
    v_pk_mul_f32 v[216:217], v[216:217], v[8:9] op_sel:[0,0] op_sel_hi:[1,0]
    v_pk_mul_f32 v[218:219], v[218:219], v[8:9] op_sel:[0,0] op_sel_hi:[1,0]
    v_cvt_pk_bf16_f32 v244, v212, v213
    v_cvt_pk_bf16_f32 v245, v214, v215
    v_cvt_pk_bf16_f32 v246, v216, v217
    v_cvt_pk_bf16_f32 v247, v218, v219
    s_add_u32 s32, s31, 4096
    buffer_store_dwordx4 v[244:247], v16, s[8:11], s32 offen sc1
    v_pk_mul_f32 v[220:221], v[220:221], v[8:9] op_sel:[0,1] op_sel_hi:[1,1]
    v_pk_mul_f32 v[222:223], v[222:223], v[8:9] op_sel:[0,1] op_sel_hi:[1,1]
    v_pk_mul_f32 v[224:225], v[224:225], v[8:9] op_sel:[0,1] op_sel_hi:[1,1]
    v_pk_mul_f32 v[226:227], v[226:227], v[8:9] op_sel:[0,1] op_sel_hi:[1,1]
    v_cvt_pk_bf16_f32 v248, v220, v221
    v_cvt_pk_bf16_f32 v249, v222, v223
    v_cvt_pk_bf16_f32 v250, v224, v225
    v_cvt_pk_bf16_f32 v251, v226, v227
    s_add_u32 s32, s31, 4352
    buffer_store_dwordx4 v[248:251], v16, s[8:11], s32 offen sc1
    v_pk_mul_f32 v[228:229], v[228:229], v[8:9] op_sel:[0,0] op_sel_hi:[1,0]
    v_pk_mul_f32 v[230:231], v[230:231], v[8:9] op_sel:[0,0] op_sel_hi:[1,0]
    v_pk_mul_f32 v[232:233], v[232:233], v[8:9] op_sel:[0,0] op_sel_hi:[1,0]
    v_pk_mul_f32 v[234:235], v[234:235], v[8:9] op_sel:[0,0] op_sel_hi:[1,0]
    v_cvt_pk_bf16_f32 v244, v228, v229
    v_cvt_pk_bf16_f32 v245, v230, v231
    v_cvt_pk_bf16_f32 v246, v232, v233
    v_cvt_pk_bf16_f32 v247, v234, v235
    s_add_u32 s32, s31, 6144
    buffer_store_dwordx4 v[244:247], v16, s[8:11], s32 offen sc1
    v_pk_mul_f32 v[236:237], v[236:237], v[8:9] op_sel:[0,1] op_sel_hi:[1,1]
    v_pk_mul_f32 v[238:239], v[238:239], v[8:9] op_sel:[0,1] op_sel_hi:[1,1]
    v_pk_mul_f32 v[240:241], v[240:241], v[8:9] op_sel:[0,1] op_sel_hi:[1,1]
    v_pk_mul_f32 v[242:243], v[242:243], v[8:9] op_sel:[0,1] op_sel_hi:[1,1]
    v_cvt_pk_bf16_f32 v248, v236, v237
    v_cvt_pk_bf16_f32 v249, v238, v239
    v_cvt_pk_bf16_f32 v250, v240, v241
    v_cvt_pk_bf16_f32 v251, v242, v243
    s_add_u32 s32, s31, 6400
    buffer_store_dwordx4 v[248:251], v16, s[8:11], s32 offen sc1
    s_waitcnt vmcnt(0)
    s_lshl_b32 s30, s37, 7
    s_add_u32 s31, s30, 105955328
    s_add_u32 s30, s30, 105938944
    v_mov_b32 v4, 0
    v_mov_b32 v5, 1
    s_mov_b64 exec, 1
    buffer_atomic_add v5, v4, s[8:11], s30 offen sc0
    s_waitcnt vmcnt(0)
    v_readfirstlane_b32 s32, v5
    s_cmp_lg_u32 s32, 31
    s_cbranch_scc1 L_x_notlast
    v_mov_b32 v5, 32
    buffer_store_dword v5, v4, s[8:11], s31 offen sc1
L_x_notlast:
    s_mov_b64 exec, -1
    s_add_u32 s37, s37, 6
    s_cmp_lt_u32 s37, 64
    s_cbranch_scc1 L_x_unit
    s_branch L_p3_end
L_p3_out:
    v_and_b32 v1, 63, v0
    s_load_dwordx2 s[4:5], s[0:1], 40
    s_load_dwordx2 s[6:7], s[0:1], 72
    s_waitcnt lgkmcnt(0)
    s_mov_b32 s12, s4
    s_and_b32 s13, s5, 0xffff
    s_mov_b32 s14, 5242880
    s_mov_b32 s15, 0x20000
    s_mov_b32 s24, s6
    s_and_b32 s25, s7, 0xffff
    s_mov_b32 s26, 819200
    s_mov_b32 s27, 0x20000
    s_mul_i32 s52, s20, 38912
    v_lshrrev_b32 v2, 2, v1
    v_and_b32 v3, 3, v1
    s_lshl_b32 s30, s17, 6
    v_lshlrev_b32 v3, 4, v3
    v_add_u32 v3, s30, v3
    v_mul_u32_u24 v4, 1280, v2
    v_add_u32 v4, v4, v3
    v_bfe_u32 v6, v1, 2, 2
    v_and_b32 v7, 3, v1
    v_bfe_u32 v8, v1, 4, 1
    v_lshrrev_b32 v9, 5, v1
    v_lshl_add_u32 v10, v9, 3, v6
    v_lshlrev_b32 v10, 6, v10
    v_lshl_add_u32 v10, v8, 5, v10
    v_lshl_add_u32 v10, v7, 3, v10
    v_add_u32 v10, s52, v10
    s_add_u32 m0, s52, 0
    s_mul_i32 s30, s20, 1556480
    s_add_u32 s30, s30, 0
    buffer_load_dwordx4 v4, s[12:15], s30 offen lds
    s_add_u32 m0, s52, 1024
    s_mul_i32 s30, s20, 1556480
    s_add_u32 s30, s30, 20480
    buffer_load_dwordx4 v4, s[12:15], s30 offen lds
    s_add_u32 m0, s52, 2048
    s_mul_i32 s30, s20, 1556480
    s_add_u32 s30, s30, 40960
    buffer_load_dwordx4 v4, s[12:15], s30 offen lds
    s_add_u32 m0, s52, 3072
    s_mul_i32 s30, s20, 1556480
    s_add_u32 s30, s30, 61440
    buffer_load_dwordx4 v4, s[12:15], s30 offen lds
    s_add_u32 m0, s52, 4096
    s_mul_i32 s30, s20, 1556480
    s_add_u32 s30, s30, 81920
    buffer_load_dwordx4 v4, s[12:15], s30 offen lds
    s_add_u32 m0, s52, 5120
    s_mul_i32 s30, s20, 1556480
    s_add_u32 s30, s30, 102400
    buffer_load_dwordx4 v4, s[12:15], s30 offen lds
    s_add_u32 m0, s52, 6144
    s_mul_i32 s30, s20, 1556480
    s_add_u32 s30, s30, 122880
    buffer_load_dwordx4 v4, s[12:15], s30 offen lds
    s_add_u32 m0, s52, 7168
    s_mul_i32 s30, s20, 1556480
    s_add_u32 s30, s30, 143360
    buffer_load_dwordx4 v4, s[12:15], s30 offen lds
    s_add_u32 m0, s52, 8192
    s_mul_i32 s30, s20, 1556480
    s_add_u32 s30, s30, 163840
    buffer_load_dwordx4 v4, s[12:15], s30 offen lds
    s_add_u32 m0, s52, 9216
    s_mul_i32 s30, s20, 1556480
    s_add_u32 s30, s30, 184320
    buffer_load_dwordx4 v4, s[12:15], s30 offen lds
    s_add_u32 m0, s52, 10240
    s_mul_i32 s30, s20, 1556480
    s_add_u32 s30, s30, 204800
    buffer_load_dwordx4 v4, s[12:15], s30 offen lds
    s_add_u32 m0, s52, 11264
    s_mul_i32 s30, s20, 1556480
    s_add_u32 s30, s30, 225280
    buffer_load_dwordx4 v4, s[12:15], s30 offen lds
    s_add_u32 m0, s52, 12288
    s_mul_i32 s30, s20, 1556480
    s_add_u32 s30, s30, 245760
    buffer_load_dwordx4 v4, s[12:15], s30 offen lds
    s_add_u32 m0, s52, 13312
    s_mul_i32 s30, s20, 1556480
    s_add_u32 s30, s30, 266240
    buffer_load_dwordx4 v4, s[12:15], s30 offen lds
    s_add_u32 m0, s52, 14336
    s_mul_i32 s30, s20, 1556480
    s_add_u32 s30, s30, 286720
    buffer_load_dwordx4 v4, s[12:15], s30 offen lds
    s_add_u32 m0, s52, 15360
    s_mul_i32 s30, s20, 1556480
    s_add_u32 s30, s30, 307200
    buffer_load_dwordx4 v4, s[12:15], s30 offen lds
    s_add_u32 m0, s52, 16384
    s_mul_i32 s30, s20, 1556480
    s_add_u32 s30, s30, 327680
    buffer_load_dwordx4 v4, s[12:15], s30 offen lds
    s_add_u32 m0, s52, 17408
    s_mul_i32 s30, s20, 1556480
    s_add_u32 s30, s30, 348160
    buffer_load_dwordx4 v4, s[12:15], s30 offen lds
    s_add_u32 m0, s52, 18432
    s_mul_i32 s30, s20, 1556480
    s_add_u32 s30, s30, 368640
    buffer_load_dwordx4 v4, s[12:15], s30 offen lds
    s_add_u32 m0, s52, 19456
    s_mul_i32 s30, s20, 1556480
    s_add_u32 s30, s30, 389120
    buffer_load_dwordx4 v4, s[12:15], s30 offen lds
    s_add_u32 m0, s52, 20480
    s_mul_i32 s30, s20, 1556480
    s_add_u32 s30, s30, 409600
    buffer_load_dwordx4 v4, s[12:15], s30 offen lds
    s_add_u32 m0, s52, 21504
    s_mul_i32 s30, s20, 1556480
    s_add_u32 s30, s30, 430080
    buffer_load_dwordx4 v4, s[12:15], s30 offen lds
    s_add_u32 m0, s52, 22528
    s_mul_i32 s30, s20, 1556480
    s_add_u32 s30, s30, 450560
    buffer_load_dwordx4 v4, s[12:15], s30 offen lds
    s_add_u32 m0, s52, 23552
    s_mul_i32 s30, s20, 1556480
    s_add_u32 s30, s30, 471040
    buffer_load_dwordx4 v4, s[12:15], s30 offen lds
    s_add_u32 m0, s52, 24576
    s_mul_i32 s30, s20, 1556480
    s_add_u32 s30, s30, 491520
    buffer_load_dwordx4 v4, s[12:15], s30 offen lds
    s_add_u32 m0, s52, 25600
    s_mul_i32 s30, s20, 1556480
    s_add_u32 s30, s30, 512000
    buffer_load_dwordx4 v4, s[12:15], s30 offen lds
    s_add_u32 m0, s52, 26624
    s_mul_i32 s30, s20, 1556480
    s_add_u32 s30, s30, 532480
    buffer_load_dwordx4 v4, s[12:15], s30 offen lds
    s_add_u32 m0, s52, 27648
    s_mul_i32 s30, s20, 1556480
    s_add_u32 s30, s30, 552960
    buffer_load_dwordx4 v4, s[12:15], s30 offen lds
    s_add_u32 m0, s52, 28672
    s_cmp_eq_u32 s20, 3
    s_cbranch_scc1 L_o_b_9
    s_mul_i32 s30, s20, 1556480
    s_add_u32 s30, s30, 573440
    buffer_load_dwordx4 v4, s[12:15], s30 offen lds
    s_branch L_o_d_10
L_o_b_9:
    v_add_u32 v5, 0, v2
    v_mul_u32_u24 v240, 2731, v5
    v_lshrrev_b32 v240, 16, v240
    v_mul_u32_u24 v241, 24, v240
    v_sub_u32 v241, v5, v241
    v_mul_u32_u24 v240, 20, v240
    v_add_u32 v240, v240, v241
    v_mul_u32_u24 v240, 1280, v240
    v_add_u32 v240, v240, v3
    v_cmp_gt_u32 vcc, 20, v241
    v_mov_b32 v241, 1073741824
    s_nop 0
    v_cndmask_b32 v240, v241, v240, vcc
    buffer_load_dwordx4 v240, s[24:27], 0 offen lds
L_o_d_10:
    s_add_u32 m0, s52, 29696
    s_cmp_eq_u32 s20, 3
    s_cbranch_scc1 L_o_b_11
    s_mul_i32 s30, s20, 1556480
    s_add_u32 s30, s30, 593920
    buffer_load_dwordx4 v4, s[12:15], s30 offen lds
    s_branch L_o_d_12
L_o_b_11:
    v_add_u32 v5, 16, v2
    v_mul_u32_u24 v240, 2731, v5
    v_lshrrev_b32 v240, 16, v240
    v_mul_u32_u24 v241, 24, v240
    v_sub_u32 v241, v5, v241
    v_mul_u32_u24 v240, 20, v240
    v_add_u32 v240, v240, v241
    v_mul_u32_u24 v240, 1280, v240
    v_add_u32 v240, v240, v3
    v_cmp_gt_u32 vcc, 20, v241
    v_mov_b32 v241, 1073741824
    s_nop 0
    v_cndmask_b32 v240, v241, v240, vcc
    buffer_load_dwordx4 v240, s[24:27], 0 offen lds
L_o_d_12:
    s_add_u32 m0, s52, 30720
    s_cmp_eq_u32 s20, 3
    s_cbranch_scc1 L_o_b_13
    s_mul_i32 s30, s20, 1556480
    s_add_u32 s30, s30, 614400
    buffer_load_dwordx4 v4, s[12:15], s30 offen lds
    s_branch L_o_d_14
L_o_b_13:
    v_add_u32 v5, 32, v2
    v_mul_u32_u24 v240, 2731, v5
    v_lshrrev_b32 v240, 16, v240
    v_mul_u32_u24 v241, 24, v240
    v_sub_u32 v241, v5, v241
    v_mul_u32_u24 v240, 20, v240
    v_add_u32 v240, v240, v241
    v_mul_u32_u24 v240, 1280, v240
    v_add_u32 v240, v240, v3
    v_cmp_gt_u32 vcc, 20, v241
    v_mov_b32 v241, 1073741824
    s_nop 0
    v_cndmask_b32 v240, v241, v240, vcc
    buffer_load_dwordx4 v240, s[24:27], 0 offen lds
L_o_d_14:
    s_add_u32 m0, s52, 31744
    s_cmp_eq_u32 s20, 3
    s_cbranch_scc1 L_o_b_15
    s_mul_i32 s30, s20, 1556480
    s_add_u32 s30, s30, 634880
    buffer_load_dwordx4 v4, s[12:15], s30 offen lds
    s_branch L_o_d_16
L_o_b_15:
    v_add_u32 v5, 48, v2
    v_mul_u32_u24 v240, 2731, v5
    v_lshrrev_b32 v240, 16, v240
    v_mul_u32_u24 v241, 24, v240
    v_sub_u32 v241, v5, v241
    v_mul_u32_u24 v240, 20, v240
    v_add_u32 v240, v240, v241
    v_mul_u32_u24 v240, 1280, v240
    v_add_u32 v240, v240, v3
    v_cmp_gt_u32 vcc, 20, v241
    v_mov_b32 v241, 1073741824
    s_nop 0
    v_cndmask_b32 v240, v241, v240, vcc
    buffer_load_dwordx4 v240, s[24:27], 0 offen lds
L_o_d_16:
    s_add_u32 m0, s52, 32768
    s_cmp_eq_u32 s20, 3
    s_cbranch_scc1 L_o_b_17
    s_mul_i32 s30, s20, 1556480
    s_add_u32 s30, s30, 655360
    buffer_load_dwordx4 v4, s[12:15], s30 offen lds
    s_branch L_o_d_18
L_o_b_17:
    v_add_u32 v5, 64, v2
    v_mul_u32_u24 v240, 2731, v5
    v_lshrrev_b32 v240, 16, v240
    v_mul_u32_u24 v241, 24, v240
    v_sub_u32 v241, v5, v241
    v_mul_u32_u24 v240, 20, v240
    v_add_u32 v240, v240, v241
    v_mul_u32_u24 v240, 1280, v240
    v_add_u32 v240, v240, v3
    v_cmp_gt_u32 vcc, 20, v241
    v_mov_b32 v241, 1073741824
    s_nop 0
    v_cndmask_b32 v240, v241, v240, vcc
    buffer_load_dwordx4 v240, s[24:27], 0 offen lds
L_o_d_18:
    s_add_u32 m0, s52, 33792
    s_cmp_eq_u32 s20, 3
    s_cbranch_scc1 L_o_b_19
    s_mul_i32 s30, s20, 1556480
    s_add_u32 s30, s30, 675840
    buffer_load_dwordx4 v4, s[12:15], s30 offen lds
    s_branch L_o_d_20
L_o_b_19:
    v_add_u32 v5, 80, v2
    v_mul_u32_u24 v240, 2731, v5
    v_lshrrev_b32 v240, 16, v240
    v_mul_u32_u24 v241, 24, v240
    v_sub_u32 v241, v5, v241
    v_mul_u32_u24 v240, 20, v240
    v_add_u32 v240, v240, v241
    v_mul_u32_u24 v240, 1280, v240
    v_add_u32 v240, v240, v3
    v_cmp_gt_u32 vcc, 20, v241
    v_mov_b32 v241, 1073741824
    s_nop 0
    v_cndmask_b32 v240, v241, v240, vcc
    buffer_load_dwordx4 v240, s[24:27], 0 offen lds
L_o_d_20:
    s_add_u32 m0, s52, 34816
    s_cmp_eq_u32 s20, 3
    s_cbranch_scc1 L_o_b_21
    s_mul_i32 s30, s20, 1556480
    s_add_u32 s30, s30, 696320
    buffer_load_dwordx4 v4, s[12:15], s30 offen lds
    s_branch L_o_d_22
L_o_b_21:
    v_add_u32 v5, 96, v2
    v_mul_u32_u24 v240, 2731, v5
    v_lshrrev_b32 v240, 16, v240
    v_mul_u32_u24 v241, 24, v240
    v_sub_u32 v241, v5, v241
    v_mul_u32_u24 v240, 20, v240
    v_add_u32 v240, v240, v241
    v_mul_u32_u24 v240, 1280, v240
    v_add_u32 v240, v240, v3
    v_cmp_gt_u32 vcc, 20, v241
    v_mov_b32 v241, 1073741824
    s_nop 0
    v_cndmask_b32 v240, v241, v240, vcc
    buffer_load_dwordx4 v240, s[24:27], 0 offen lds
L_o_d_22:
    s_add_u32 m0, s52, 35840
    s_cmp_eq_u32 s20, 3
    s_cbranch_scc1 L_o_b_23
    s_mul_i32 s30, s20, 1556480
    s_add_u32 s30, s30, 716800
    buffer_load_dwordx4 v4, s[12:15], s30 offen lds
    s_branch L_o_d_24
L_o_b_23:
    v_add_u32 v5, 112, v2
    v_mul_u32_u24 v240, 2731, v5
    v_lshrrev_b32 v240, 16, v240
    v_mul_u32_u24 v241, 24, v240
    v_sub_u32 v241, v5, v241
    v_mul_u32_u24 v240, 20, v240
    v_add_u32 v240, v240, v241
    v_mul_u32_u24 v240, 1280, v240
    v_add_u32 v240, v240, v3
    v_cmp_gt_u32 vcc, 20, v241
    v_mov_b32 v241, 1073741824
    s_nop 0
    v_cndmask_b32 v240, v241, v240, vcc
    buffer_load_dwordx4 v240, s[24:27], 0 offen lds
L_o_d_24:
    s_add_u32 m0, s52, 36864
    s_cmp_eq_u32 s20, 3
    s_cbranch_scc1 L_o_b_25
    s_mul_i32 s30, s20, 1556480
    s_add_u32 s30, s30, 737280
    buffer_load_dwordx4 v4, s[12:15], s30 offen lds
    s_branch L_o_d_26
L_o_b_25:
    v_add_u32 v5, 128, v2
    v_mul_u32_u24 v240, 2731, v5
    v_lshrrev_b32 v240, 16, v240
    v_mul_u32_u24 v241, 24, v240
    v_sub_u32 v241, v5, v241
    v_mul_u32_u24 v240, 20, v240
    v_add_u32 v240, v240, v241
    v_mul_u32_u24 v240, 1280, v240
    v_add_u32 v240, v240, v3
    v_cmp_gt_u32 vcc, 20, v241
    v_mov_b32 v241, 1073741824
    s_nop 0
    v_cndmask_b32 v240, v241, v240, vcc
    buffer_load_dwordx4 v240, s[24:27], 0 offen lds
L_o_d_26:
    s_add_u32 m0, s52, 37888
    s_cmp_eq_u32 s20, 3
    s_cbranch_scc1 L_o_b_27
    s_mul_i32 s30, s20, 1556480
    s_add_u32 s30, s30, 757760
    buffer_load_dwordx4 v4, s[12:15], s30 offen lds
    s_branch L_o_d_28
L_o_b_27:
    v_add_u32 v5, 144, v2
    v_mul_u32_u24 v240, 2731, v5
    v_lshrrev_b32 v240, 16, v240
    v_mul_u32_u24 v241, 24, v240
    v_sub_u32 v241, v5, v241
    v_mul_u32_u24 v240, 20, v240
    v_add_u32 v240, v240, v241
    v_mul_u32_u24 v240, 1280, v240
    v_add_u32 v240, v240, v3
    v_cmp_gt_u32 vcc, 20, v241
    v_mov_b32 v241, 1073741824
    s_nop 0
    v_cndmask_b32 v240, v241, v240, vcc
    buffer_load_dwordx4 v240, s[24:27], 0 offen lds
L_o_d_28:
    s_waitcnt vmcnt(0)
    ds_read_b64_tr_b16 a[0:1], v10 offset:0
    ds_read_b64_tr_b16 a[2:3], v10 offset:256
    ds_read_b64_tr_b16 a[4:5], v10 offset:1024
    ds_read_b64_tr_b16 a[6:7], v10 offset:1280
    ds_read_b64_tr_b16 a[8:9], v10 offset:2048
    ds_read_b64_tr_b16 a[10:11], v10 offset:2304
    ds_read_b64_tr_b16 a[12:13], v10 offset:3072
    ds_read_b64_tr_b16 a[14:15], v10 offset:3328
    s_waitcnt lgkmcnt(0)
    ds_read_b64_tr_b16 a[16:17], v10 offset:4096
    ds_read_b64_tr_b16 a[18:19], v10 offset:4352
    ds_read_b64_tr_b16 a[20:21], v10 offset:5120
    ds_read_b64_tr_b16 a[22:23], v10 offset:5376
    ds_read_b64_tr_b16 a[24:25], v10 offset:6144
    ds_read_b64_tr_b16 a[26:27], v10 offset:6400
    ds_read_b64_tr_b16 a[28:29], v10 offset:7168
    ds_read_b64_tr_b16 a[30:31], v10 offset:7424
    s_waitcnt lgkmcnt(0)
    ds_read_b64_tr_b16 a[32:33], v10 offset:8192
    ds_read_b64_tr_b16 a[34:35], v10 offset:8448
    ds_read_b64_tr_b16 a[36:37], v10 offset:9216
    ds_read_b64_tr_b16 a[38:39], v10 offset:9472
    ds_read_b64_tr_b16 a[40:41], v10 offset:10240
    ds_read_b64_tr_b16 a[42:43], v10 offset:10496
    ds_read_b64_tr_b16 a[44:45], v10 offset:11264
    ds_read_b64_tr_b16 a[46:47], v10 offset:11520
    s_waitcnt lgkmcnt(0)
    ds_read_b64_tr_b16 a[48:49], v10 offset:12288
    ds_read_b64_tr_b16 a[50:51], v10 offset:12544
    ds_read_b64_tr_b16 a[52:53], v10 offset:13312
    ds_read_b64_tr_b16 a[54:55], v10 offset:13568
    ds_read_b64_tr_b16 a[56:57], v10 offset:14336
    ds_read_b64_tr_b16 a[58:59], v10 offset:14592
    ds_read_b64_tr_b16 a[60:61], v10 offset:15360
    ds_read_b64_tr_b16 a[62:63], v10 offset:15616
    s_waitcnt lgkmcnt(0)
    ds_read_b64_tr_b16 a[64:65], v10 offset:16384
    ds_read_b64_tr_b16 a[66:67], v10 offset:16640
    ds_read_b64_tr_b16 a[68:69], v10 offset:17408
    ds_read_b64_tr_b16 a[70:71], v10 offset:17664
    ds_read_b64_tr_b16 a[72:73], v10 offset:18432
    ds_read_b64_tr_b16 a[74:75], v10 offset:18688
    ds_read_b64_tr_b16 a[76:77], v10 offset:19456
    ds_read_b64_tr_b16 a[78:79], v10 offset:19712
    s_waitcnt lgkmcnt(0)
    ds_read_b64_tr_b16 a[80:81], v10 offset:20480
    ds_read_b64_tr_b16 a[82:83], v10 offset:20736
    ds_read_b64_tr_b16 a[84:85], v10 offset:21504
    ds_read_b64_tr_b16 a[86:87], v10 offset:21760
    ds_read_b64_tr_b16 a[88:89], v10 offset:22528
    ds_read_b64_tr_b16 a[90:91], v10 offset:22784
    ds_read_b64_tr_b16 a[92:93], v10 offset:23552
    ds_read_b64_tr_b16 a[94:95], v10 offset:23808
    s_waitcnt lgkmcnt(0)
    ds_read_b64_tr_b16 a[96:97], v10 offset:24576
    ds_read_b64_tr_b16 a[98:99], v10 offset:24832
    ds_read_b64_tr_b16 a[100:101], v10 offset:25600
    ds_read_b64_tr_b16 a[102:103], v10 offset:25856
    ds_read_b64_tr_b16 a[104:105], v10 offset:26624
    ds_read_b64_tr_b16 a[106:107], v10 offset:26880
    ds_read_b64_tr_b16 a[108:109], v10 offset:27648
    ds_read_b64_tr_b16 a[110:111], v10 offset:27904
    s_waitcnt lgkmcnt(0)
    ds_read_b64_tr_b16 a[112:113], v10 offset:28672
    ds_read_b64_tr_b16 a[114:115], v10 offset:28928
    ds_read_b64_tr_b16 a[116:117], v10 offset:29696
    ds_read_b64_tr_b16 a[118:119], v10 offset:29952
    ds_read_b64_tr_b16 a[120:121], v10 offset:30720
    ds_read_b64_tr_b16 a[122:123], v10 offset:30976
    ds_read_b64_tr_b16 a[124:125], v10 offset:31744
    ds_read_b64_tr_b16 a[126:127], v10 offset:32000
    s_waitcnt lgkmcnt(0)
    ds_read_b64_tr_b16 a[128:129], v10 offset:32768
    ds_read_b64_tr_b16 a[130:131], v10 offset:33024
    ds_read_b64_tr_b16 a[132:133], v10 offset:33792
    ds_read_b64_tr_b16 a[134:135], v10 offset:34048
    ds_read_b64_tr_b16 a[136:137], v10 offset:34816
    ds_read_b64_tr_b16 a[138:139], v10 offset:35072
    ds_read_b64_tr_b16 a[140:141], v10 offset:35840
    ds_read_b64_tr_b16 a[142:143], v10 offset:36096
    s_waitcnt lgkmcnt(0)
    ds_read_b64_tr_b16 a[144:145], v10 offset:36864
    ds_read_b64_tr_b16 a[146:147], v10 offset:37120
    ds_read_b64_tr_b16 a[148:149], v10 offset:37888
    ds_read_b64_tr_b16 a[150:151], v10 offset:38144
    s_waitcnt lgkmcnt(0)
    s_add_u32 m0, s52, 0
    s_cmp_eq_u32 s20, 3
    s_cbranch_scc1 L_o_b_29
    s_mul_i32 s30, s20, 1556480
    s_add_u32 s30, s30, 778240
    buffer_load_dwordx4 v4, s[12:15], s30 offen lds
    s_branch L_o_d_30
L_o_b_29:
    v_add_u32 v5, 160, v2
    v_mul_u32_u24 v240, 2731, v5
    v_lshrrev_b32 v240, 16, v240
    v_mul_u32_u24 v241, 24, v240
    v_sub_u32 v241, v5, v241
    v_mul_u32_u24 v240, 20, v240
    v_add_u32 v240, v240, v241
    v_mul_u32_u24 v240, 1280, v240
    v_add_u32 v240, v240, v3
    v_cmp_gt_u32 vcc, 20, v241
    v_mov_b32 v241, 1073741824
    s_nop 0
    v_cndmask_b32 v240, v241, v240, vcc
    buffer_load_dwordx4 v240, s[24:27], 0 offen lds
L_o_d_30:
    s_add_u32 m0, s52, 1024
    s_cmp_eq_u32 s20, 3
    s_cbranch_scc1 L_o_b_31
    s_mul_i32 s30, s20, 1556480
    s_add_u32 s30, s30, 798720
    buffer_load_dwordx4 v4, s[12:15], s30 offen lds
    s_branch L_o_d_32
L_o_b_31:
    v_add_u32 v5, 176, v2
    v_mul_u32_u24 v240, 2731, v5
    v_lshrrev_b32 v240, 16, v240
    v_mul_u32_u24 v241, 24, v240
    v_sub_u32 v241, v5, v241
    v_mul_u32_u24 v240, 20, v240
    v_add_u32 v240, v240, v241
    v_mul_u32_u24 v240, 1280, v240
    v_add_u32 v240, v240, v3
    v_cmp_gt_u32 vcc, 20, v241
    v_mov_b32 v241, 1073741824
    s_nop 0
    v_cndmask_b32 v240, v241, v240, vcc
    buffer_load_dwordx4 v240, s[24:27], 0 offen lds
L_o_d_32:
    s_add_u32 m0, s52, 2048
    s_cmp_eq_u32 s20, 3
    s_cbranch_scc1 L_o_b_33
    s_mul_i32 s30, s20, 1556480
    s_add_u32 s30, s30, 819200
    buffer_load_dwordx4 v4, s[12:15], s30 offen lds
    s_branch L_o_d_34
L_o_b_33:
    v_add_u32 v5, 192, v2
    v_mul_u32_u24 v240, 2731, v5
    v_lshrrev_b32 v240, 16, v240
    v_mul_u32_u24 v241, 24, v240
    v_sub_u32 v241, v5, v241
    v_mul_u32_u24 v240, 20, v240
    v_add_u32 v240, v240, v241
    v_mul_u32_u24 v240, 1280, v240
    v_add_u32 v240, v240, v3
    v_cmp_gt_u32 vcc, 20, v241
    v_mov_b32 v241, 1073741824
    s_nop 0
    v_cndmask_b32 v240, v241, v240, vcc
    buffer_load_dwordx4 v240, s[24:27], 0 offen lds
L_o_d_34:
    s_add_u32 m0, s52, 3072
    s_cmp_eq_u32 s20, 3
    s_cbranch_scc1 L_o_b_35
    s_mul_i32 s30, s20, 1556480
    s_add_u32 s30, s30, 839680
    buffer_load_dwordx4 v4, s[12:15], s30 offen lds
    s_branch L_o_d_36
L_o_b_35:
    v_add_u32 v5, 208, v2
    v_mul_u32_u24 v240, 2731, v5
    v_lshrrev_b32 v240, 16, v240
    v_mul_u32_u24 v241, 24, v240
    v_sub_u32 v241, v5, v241
    v_mul_u32_u24 v240, 20, v240
    v_add_u32 v240, v240, v241
    v_mul_u32_u24 v240, 1280, v240
    v_add_u32 v240, v240, v3
    v_cmp_gt_u32 vcc, 20, v241
    v_mov_b32 v241, 1073741824
    s_nop 0
    v_cndmask_b32 v240, v241, v240, vcc
    buffer_load_dwordx4 v240, s[24:27], 0 offen lds
L_o_d_36:
    s_add_u32 m0, s52, 4096
    s_cmp_eq_u32 s20, 3
    s_cbranch_scc1 L_o_b_37
    s_mul_i32 s30, s20, 1556480
    s_add_u32 s30, s30, 860160
    buffer_load_dwordx4 v4, s[12:15], s30 offen lds
    s_branch L_o_d_38
L_o_b_37:
    v_add_u32 v5, 224, v2
    v_mul_u32_u24 v240, 2731, v5
    v_lshrrev_b32 v240, 16, v240
    v_mul_u32_u24 v241, 24, v240
    v_sub_u32 v241, v5, v241
    v_mul_u32_u24 v240, 20, v240
    v_add_u32 v240, v240, v241
    v_mul_u32_u24 v240, 1280, v240
    v_add_u32 v240, v240, v3
    v_cmp_gt_u32 vcc, 20, v241
    v_mov_b32 v241, 1073741824
    s_nop 0
    v_cndmask_b32 v240, v241, v240, vcc
    buffer_load_dwordx4 v240, s[24:27], 0 offen lds
L_o_d_38:
    s_add_u32 m0, s52, 5120
    s_cmp_eq_u32 s20, 3
    s_cbranch_scc1 L_o_b_39
    s_mul_i32 s30, s20, 1556480
    s_add_u32 s30, s30, 880640
    buffer_load_dwordx4 v4, s[12:15], s30 offen lds
    s_branch L_o_d_40
L_o_b_39:
    v_add_u32 v5, 240, v2
    v_mul_u32_u24 v240, 2731, v5
    v_lshrrev_b32 v240, 16, v240
    v_mul_u32_u24 v241, 24, v240
    v_sub_u32 v241, v5, v241
    v_mul_u32_u24 v240, 20, v240
    v_add_u32 v240, v240, v241
    v_mul_u32_u24 v240, 1280, v240
    v_add_u32 v240, v240, v3
    v_cmp_gt_u32 vcc, 20, v241
    v_mov_b32 v241, 1073741824
    s_nop 0
    v_cndmask_b32 v240, v241, v240, vcc
    buffer_load_dwordx4 v240, s[24:27], 0 offen lds
L_o_d_40:
    s_add_u32 m0, s52, 6144
    s_cmp_eq_u32 s20, 3
    s_cbranch_scc1 L_o_b_41
    s_mul_i32 s30, s20, 1556480
    s_add_u32 s30, s30, 901120
    buffer_load_dwordx4 v4, s[12:15], s30 offen lds
    s_branch L_o_d_42
L_o_b_41:
    v_add_u32 v5, 256, v2
    v_mul_u32_u24 v240, 2731, v5
    v_lshrrev_b32 v240, 16, v240
    v_mul_u32_u24 v241, 24, v240
    v_sub_u32 v241, v5, v241
    v_mul_u32_u24 v240, 20, v240
    v_add_u32 v240, v240, v241
    v_mul_u32_u24 v240, 1280, v240
    v_add_u32 v240, v240, v3
    v_cmp_gt_u32 vcc, 20, v241
    v_mov_b32 v241, 1073741824
    s_nop 0
    v_cndmask_b32 v240, v241, v240, vcc
    buffer_load_dwordx4 v240, s[24:27], 0 offen lds
L_o_d_42:
    s_add_u32 m0, s52, 7168
    s_cmp_eq_u32 s20, 3
    s_cbranch_scc1 L_o_b_43
    s_mul_i32 s30, s20, 1556480
    s_add_u32 s30, s30, 921600
    buffer_load_dwordx4 v4, s[12:15], s30 offen lds
    s_branch L_o_d_44
L_o_b_43:
    v_add_u32 v5, 272, v2
    v_mul_u32_u24 v240, 2731, v5
    v_lshrrev_b32 v240, 16, v240
    v_mul_u32_u24 v241, 24, v240
    v_sub_u32 v241, v5, v241
    v_mul_u32_u24 v240, 20, v240
    v_add_u32 v240, v240, v241
    v_mul_u32_u24 v240, 1280, v240
    v_add_u32 v240, v240, v3
    v_cmp_gt_u32 vcc, 20, v241
    v_mov_b32 v241, 1073741824
    s_nop 0
    v_cndmask_b32 v240, v241, v240, vcc
    buffer_load_dwordx4 v240, s[24:27], 0 offen lds
L_o_d_44:
    s_add_u32 m0, s52, 8192
    s_cmp_eq_u32 s20, 3
    s_cbranch_scc1 L_o_b_45
    s_mul_i32 s30, s20, 1556480
    s_add_u32 s30, s30, 942080
    buffer_load_dwordx4 v4, s[12:15], s30 offen lds
    s_branch L_o_d_46
L_o_b_45:
    v_add_u32 v5, 288, v2
    v_mul_u32_u24 v240, 2731, v5
    v_lshrrev_b32 v240, 16, v240
    v_mul_u32_u24 v241, 24, v240
    v_sub_u32 v241, v5, v241
    v_mul_u32_u24 v240, 20, v240
    v_add_u32 v240, v240, v241
    v_mul_u32_u24 v240, 1280, v240
    v_add_u32 v240, v240, v3
    v_cmp_gt_u32 vcc, 20, v241
    v_mov_b32 v241, 1073741824
    s_nop 0
    v_cndmask_b32 v240, v241, v240, vcc
    buffer_load_dwordx4 v240, s[24:27], 0 offen lds
L_o_d_46:
    s_add_u32 m0, s52, 9216
    s_cmp_eq_u32 s20, 3
    s_cbranch_scc1 L_o_b_47
    s_mul_i32 s30, s20, 1556480
    s_add_u32 s30, s30, 962560
    buffer_load_dwordx4 v4, s[12:15], s30 offen lds
    s_branch L_o_d_48
L_o_b_47:
    v_add_u32 v5, 304, v2
    v_mul_u32_u24 v240, 2731, v5
    v_lshrrev_b32 v240, 16, v240
    v_mul_u32_u24 v241, 24, v240
    v_sub_u32 v241, v5, v241
    v_mul_u32_u24 v240, 20, v240
    v_add_u32 v240, v240, v241
    v_mul_u32_u24 v240, 1280, v240
    v_add_u32 v240, v240, v3
    v_cmp_gt_u32 vcc, 20, v241
    v_mov_b32 v241, 1073741824
    s_nop 0
    v_cndmask_b32 v240, v241, v240, vcc
    buffer_load_dwordx4 v240, s[24:27], 0 offen lds
L_o_d_48:
    s_add_u32 m0, s52, 10240
    s_cmp_eq_u32 s20, 3
    s_cbranch_scc1 L_o_b_49
    s_mul_i32 s30, s20, 1556480
    s_add_u32 s30, s30, 983040
    buffer_load_dwordx4 v4, s[12:15], s30 offen lds
    s_branch L_o_d_50
L_o_b_49:
    v_add_u32 v5, 320, v2
    v_mul_u32_u24 v240, 2731, v5
    v_lshrrev_b32 v240, 16, v240
    v_mul_u32_u24 v241, 24, v240
    v_sub_u32 v241, v5, v241
    v_mul_u32_u24 v240, 20, v240
    v_add_u32 v240, v240, v241
    v_mul_u32_u24 v240, 1280, v240
    v_add_u32 v240, v240, v3
    v_cmp_gt_u32 vcc, 20, v241
    v_mov_b32 v241, 1073741824
    s_nop 0
    v_cndmask_b32 v240, v241, v240, vcc
    buffer_load_dwordx4 v240, s[24:27], 0 offen lds
L_o_d_50:
    s_add_u32 m0, s52, 11264
    s_cmp_eq_u32 s20, 3
    s_cbranch_scc1 L_o_b_51
    s_mul_i32 s30, s20, 1556480
    s_add_u32 s30, s30, 1003520
    buffer_load_dwordx4 v4, s[12:15], s30 offen lds
    s_branch L_o_d_52
L_o_b_51:
    v_add_u32 v5, 336, v2
    v_mul_u32_u24 v240, 2731, v5
    v_lshrrev_b32 v240, 16, v240
    v_mul_u32_u24 v241, 24, v240
    v_sub_u32 v241, v5, v241
    v_mul_u32_u24 v240, 20, v240
    v_add_u32 v240, v240, v241
    v_mul_u32_u24 v240, 1280, v240
    v_add_u32 v240, v240, v3
    v_cmp_gt_u32 vcc, 20, v241
    v_mov_b32 v241, 1073741824
    s_nop 0
    v_cndmask_b32 v240, v241, v240, vcc
    buffer_load_dwordx4 v240, s[24:27], 0 offen lds
L_o_d_52:
    s_add_u32 m0, s52, 12288
    s_cmp_eq_u32 s20, 3
    s_cbranch_scc1 L_o_b_53
    s_mul_i32 s30, s20, 1556480
    s_add_u32 s30, s30, 1024000
    buffer_load_dwordx4 v4, s[12:15], s30 offen lds
    s_branch L_o_d_54
L_o_b_53:
    v_add_u32 v5, 352, v2
    v_mul_u32_u24 v240, 2731, v5
    v_lshrrev_b32 v240, 16, v240
    v_mul_u32_u24 v241, 24, v240
    v_sub_u32 v241, v5, v241
    v_mul_u32_u24 v240, 20, v240
    v_add_u32 v240, v240, v241
    v_mul_u32_u24 v240, 1280, v240
    v_add_u32 v240, v240, v3
    v_cmp_gt_u32 vcc, 20, v241
    v_mov_b32 v241, 1073741824
    s_nop 0
    v_cndmask_b32 v240, v241, v240, vcc
    buffer_load_dwordx4 v240, s[24:27], 0 offen lds
L_o_d_54:
    s_add_u32 m0, s52, 13312
    s_cmp_eq_u32 s20, 3
    s_cbranch_scc1 L_o_b_55
    s_mul_i32 s30, s20, 1556480
    s_add_u32 s30, s30, 1044480
    buffer_load_dwordx4 v4, s[12:15], s30 offen lds
    s_branch L_o_d_56
L_o_b_55:
    v_add_u32 v5, 368, v2
    v_mul_u32_u24 v240, 2731, v5
    v_lshrrev_b32 v240, 16, v240
    v_mul_u32_u24 v241, 24, v240
    v_sub_u32 v241, v5, v241
    v_mul_u32_u24 v240, 20, v240
    v_add_u32 v240, v240, v241
    v_mul_u32_u24 v240, 1280, v240
    v_add_u32 v240, v240, v3
    v_cmp_gt_u32 vcc, 20, v241
    v_mov_b32 v241, 1073741824
    s_nop 0
    v_cndmask_b32 v240, v241, v240, vcc
    buffer_load_dwordx4 v240, s[24:27], 0 offen lds
L_o_d_56:
    s_add_u32 m0, s52, 14336
    s_cmp_eq_u32 s20, 3
    s_cbranch_scc1 L_o_b_57
    s_mul_i32 s30, s20, 1556480
    s_add_u32 s30, s30, 1064960
    buffer_load_dwordx4 v4, s[12:15], s30 offen lds
    s_branch L_o_d_58
L_o_b_57:
    v_add_u32 v5, 384, v2
    v_mul_u32_u24 v240, 2731, v5
    v_lshrrev_b32 v240, 16, v240
    v_mul_u32_u24 v241, 24, v240
    v_sub_u32 v241, v5, v241
    v_mul_u32_u24 v240, 20, v240
    v_add_u32 v240, v240, v241
    v_mul_u32_u24 v240, 1280, v240
    v_add_u32 v240, v240, v3
    v_cmp_gt_u32 vcc, 20, v241
    v_mov_b32 v241, 1073741824
    s_nop 0
    v_cndmask_b32 v240, v241, v240, vcc
    buffer_load_dwordx4 v240, s[24:27], 0 offen lds
L_o_d_58:
    s_add_u32 m0, s52, 15360
    s_cmp_eq_u32 s20, 3
    s_cbranch_scc1 L_o_b_59
    s_mul_i32 s30, s20, 1556480
    s_add_u32 s30, s30, 1085440
    buffer_load_dwordx4 v4, s[12:15], s30 offen lds
    s_branch L_o_d_60
L_o_b_59:
    v_add_u32 v5, 400, v2
    v_mul_u32_u24 v240, 2731, v5
    v_lshrrev_b32 v240, 16, v240
    v_mul_u32_u24 v241, 24, v240
    v_sub_u32 v241, v5, v241
    v_mul_u32_u24 v240, 20, v240
    v_add_u32 v240, v240, v241
    v_mul_u32_u24 v240, 1280, v240
    v_add_u32 v240, v240, v3
    v_cmp_gt_u32 vcc, 20, v241
    v_mov_b32 v241, 1073741824
    s_nop 0
    v_cndmask_b32 v240, v241, v240, vcc
    buffer_load_dwordx4 v240, s[24:27], 0 offen lds
L_o_d_60:
    s_add_u32 m0, s52, 16384
    s_cmp_eq_u32 s20, 3
    s_cbranch_scc1 L_o_b_61
    s_mul_i32 s30, s20, 1556480
    s_add_u32 s30, s30, 1105920
    buffer_load_dwordx4 v4, s[12:15], s30 offen lds
    s_branch L_o_d_62
L_o_b_61:
    v_add_u32 v5, 416, v2
    v_mul_u32_u24 v240, 2731, v5
    v_lshrrev_b32 v240, 16, v240
    v_mul_u32_u24 v241, 24, v240
    v_sub_u32 v241, v5, v241
    v_mul_u32_u24 v240, 20, v240
    v_add_u32 v240, v240, v241
    v_mul_u32_u24 v240, 1280, v240
    v_add_u32 v240, v240, v3
    v_cmp_gt_u32 vcc, 20, v241
    v_mov_b32 v241, 1073741824
    s_nop 0
    v_cndmask_b32 v240, v241, v240, vcc
    buffer_load_dwordx4 v240, s[24:27], 0 offen lds
L_o_d_62:
    s_add_u32 m0, s52, 17408
    s_cmp_eq_u32 s20, 3
    s_cbranch_scc1 L_o_b_63
    s_mul_i32 s30, s20, 1556480
    s_add_u32 s30, s30, 1126400
    buffer_load_dwordx4 v4, s[12:15], s30 offen lds
    s_branch L_o_d_64
L_o_b_63:
    v_add_u32 v5, 432, v2
    v_mul_u32_u24 v240, 2731, v5
    v_lshrrev_b32 v240, 16, v240
    v_mul_u32_u24 v241, 24, v240
    v_sub_u32 v241, v5, v241
    v_mul_u32_u24 v240, 20, v240
    v_add_u32 v240, v240, v241
    v_mul_u32_u24 v240, 1280, v240
    v_add_u32 v240, v240, v3
    v_cmp_gt_u32 vcc, 20, v241
    v_mov_b32 v241, 1073741824
    s_nop 0
    v_cndmask_b32 v240, v241, v240, vcc
    buffer_load_dwordx4 v240, s[24:27], 0 offen lds
L_o_d_64:
    s_add_u32 m0, s52, 18432
    s_cmp_eq_u32 s20, 3
    s_cbranch_scc1 L_o_b_65
    s_mul_i32 s30, s20, 1556480
    s_add_u32 s30, s30, 1146880
    buffer_load_dwordx4 v4, s[12:15], s30 offen lds
    s_branch L_o_d_66
L_o_b_65:
    v_add_u32 v5, 448, v2
    v_mul_u32_u24 v240, 2731, v5
    v_lshrrev_b32 v240, 16, v240
    v_mul_u32_u24 v241, 24, v240
    v_sub_u32 v241, v5, v241
    v_mul_u32_u24 v240, 20, v240
    v_add_u32 v240, v240, v241
    v_mul_u32_u24 v240, 1280, v240
    v_add_u32 v240, v240, v3
    v_cmp_gt_u32 vcc, 20, v241
    v_mov_b32 v241, 1073741824
    s_nop 0
    v_cndmask_b32 v240, v241, v240, vcc
    buffer_load_dwordx4 v240, s[24:27], 0 offen lds
L_o_d_66:
    s_add_u32 m0, s52, 19456
    s_cmp_eq_u32 s20, 3
    s_cbranch_scc1 L_o_b_67
    s_mul_i32 s30, s20, 1556480
    s_add_u32 s30, s30, 1167360
    buffer_load_dwordx4 v4, s[12:15], s30 offen lds
    s_branch L_o_d_68
L_o_b_67:
    v_add_u32 v5, 464, v2
    v_mul_u32_u24 v240, 2731, v5
    v_lshrrev_b32 v240, 16, v240
    v_mul_u32_u24 v241, 24, v240
    v_sub_u32 v241, v5, v241
    v_mul_u32_u24 v240, 20, v240
    v_add_u32 v240, v240, v241
    v_mul_u32_u24 v240, 1280, v240
    v_add_u32 v240, v240, v3
    v_cmp_gt_u32 vcc, 20, v241
    v_mov_b32 v241, 1073741824
    s_nop 0
    v_cndmask_b32 v240, v241, v240, vcc
    buffer_load_dwordx4 v240, s[24:27], 0 offen lds
L_o_d_68:
    s_add_u32 m0, s52, 20480
    s_cmp_eq_u32 s20, 3
    s_cbranch_scc1 L_o_b_69
    s_mul_i32 s30, s20, 1556480
    s_add_u32 s30, s30, 1187840
    buffer_load_dwordx4 v4, s[12:15], s30 offen lds
    s_branch L_o_d_70
L_o_b_69:
    v_add_u32 v5, 480, v2
    v_mul_u32_u24 v240, 2731, v5
    v_lshrrev_b32 v240, 16, v240
    v_mul_u32_u24 v241, 24, v240
    v_sub_u32 v241, v5, v241
    v_mul_u32_u24 v240, 20, v240
    v_add_u32 v240, v240, v241
    v_mul_u32_u24 v240, 1280, v240
    v_add_u32 v240, v240, v3
    v_cmp_gt_u32 vcc, 20, v241
    v_mov_b32 v241, 1073741824
    s_nop 0
    v_cndmask_b32 v240, v241, v240, vcc
    buffer_load_dwordx4 v240, s[24:27], 0 offen lds
L_o_d_70:
    s_add_u32 m0, s52, 21504
    s_cmp_eq_u32 s20, 3
    s_cbranch_scc1 L_o_b_71
    s_mul_i32 s30, s20, 1556480
    s_add_u32 s30, s30, 1208320
    buffer_load_dwordx4 v4, s[12:15], s30 offen lds
    s_branch L_o_d_72
L_o_b_71:
    v_add_u32 v5, 496, v2
    v_mul_u32_u24 v240, 2731, v5
    v_lshrrev_b32 v240, 16, v240
    v_mul_u32_u24 v241, 24, v240
    v_sub_u32 v241, v5, v241
    v_mul_u32_u24 v240, 20, v240
    v_add_u32 v240, v240, v241
    v_mul_u32_u24 v240, 1280, v240
    v_add_u32 v240, v240, v3
    v_cmp_gt_u32 vcc, 20, v241
    v_mov_b32 v241, 1073741824
    s_nop 0
    v_cndmask_b32 v240, v241, v240, vcc
    buffer_load_dwordx4 v240, s[24:27], 0 offen lds
L_o_d_72:
    s_add_u32 m0, s52, 22528
    s_cmp_eq_u32 s20, 3
    s_cbranch_scc1 L_o_b_73
    s_mul_i32 s30, s20, 1556480
    s_add_u32 s30, s30, 1228800
    buffer_load_dwordx4 v4, s[12:15], s30 offen lds
    s_branch L_o_d_74
L_o_b_73:
    v_add_u32 v5, 512, v2
    v_mul_u32_u24 v240, 2731, v5
    v_lshrrev_b32 v240, 16, v240
    v_mul_u32_u24 v241, 24, v240
    v_sub_u32 v241, v5, v241
    v_mul_u32_u24 v240, 20, v240
    v_add_u32 v240, v240, v241
    v_mul_u32_u24 v240, 1280, v240
    v_add_u32 v240, v240, v3
    v_cmp_gt_u32 vcc, 20, v241
    v_mov_b32 v241, 1073741824
    s_nop 0
    v_cndmask_b32 v240, v241, v240, vcc
    buffer_load_dwordx4 v240, s[24:27], 0 offen lds
L_o_d_74:
    s_add_u32 m0, s52, 23552
    s_cmp_eq_u32 s20, 3
    s_cbranch_scc1 L_o_b_75
    s_mul_i32 s30, s20, 1556480
    s_add_u32 s30, s30, 1249280
    buffer_load_dwordx4 v4, s[12:15], s30 offen lds
    s_branch L_o_d_76
L_o_b_75:
    v_add_u32 v5, 528, v2
    v_mul_u32_u24 v240, 2731, v5
    v_lshrrev_b32 v240, 16, v240
    v_mul_u32_u24 v241, 24, v240
    v_sub_u32 v241, v5, v241
    v_mul_u32_u24 v240, 20, v240
    v_add_u32 v240, v240, v241
    v_mul_u32_u24 v240, 1280, v240
    v_add_u32 v240, v240, v3
    v_cmp_gt_u32 vcc, 20, v241
    v_mov_b32 v241, 1073741824
    s_nop 0
    v_cndmask_b32 v240, v241, v240, vcc
    buffer_load_dwordx4 v240, s[24:27], 0 offen lds
L_o_d_76:
    s_add_u32 m0, s52, 24576
    s_cmp_eq_u32 s20, 3
    s_cbranch_scc1 L_o_b_77
    s_mul_i32 s30, s20, 1556480
    s_add_u32 s30, s30, 1269760
    buffer_load_dwordx4 v4, s[12:15], s30 offen lds
    s_branch L_o_d_78
L_o_b_77:
    v_add_u32 v5, 544, v2
    v_mul_u32_u24 v240, 2731, v5
    v_lshrrev_b32 v240, 16, v240
    v_mul_u32_u24 v241, 24, v240
    v_sub_u32 v241, v5, v241
    v_mul_u32_u24 v240, 20, v240
    v_add_u32 v240, v240, v241
    v_mul_u32_u24 v240, 1280, v240
    v_add_u32 v240, v240, v3
    v_cmp_gt_u32 vcc, 20, v241
    v_mov_b32 v241, 1073741824
    s_nop 0
    v_cndmask_b32 v240, v241, v240, vcc
    buffer_load_dwordx4 v240, s[24:27], 0 offen lds
L_o_d_78:
    s_add_u32 m0, s52, 25600
    s_cmp_eq_u32 s20, 3
    s_cbranch_scc1 L_o_b_79
    s_mul_i32 s30, s20, 1556480
    s_add_u32 s30, s30, 1290240
    buffer_load_dwordx4 v4, s[12:15], s30 offen lds
    s_branch L_o_d_80
L_o_b_79:
    v_add_u32 v5, 560, v2
    v_mul_u32_u24 v240, 2731, v5
    v_lshrrev_b32 v240, 16, v240
    v_mul_u32_u24 v241, 24, v240
    v_sub_u32 v241, v5, v241
    v_mul_u32_u24 v240, 20, v240
    v_add_u32 v240, v240, v241
    v_mul_u32_u24 v240, 1280, v240
    v_add_u32 v240, v240, v3
    v_cmp_gt_u32 vcc, 20, v241
    v_mov_b32 v241, 1073741824
    s_nop 0
    v_cndmask_b32 v240, v241, v240, vcc
    buffer_load_dwordx4 v240, s[24:27], 0 offen lds
L_o_d_80:
    s_add_u32 m0, s52, 26624
    s_cmp_eq_u32 s20, 3
    s_cbranch_scc1 L_o_b_81
    s_mul_i32 s30, s20, 1556480
    s_add_u32 s30, s30, 1310720
    buffer_load_dwordx4 v4, s[12:15], s30 offen lds
    s_branch L_o_d_82
L_o_b_81:
    v_add_u32 v5, 576, v2
    v_mul_u32_u24 v240, 2731, v5
    v_lshrrev_b32 v240, 16, v240
    v_mul_u32_u24 v241, 24, v240
    v_sub_u32 v241, v5, v241
    v_mul_u32_u24 v240, 20, v240
    v_add_u32 v240, v240, v241
    v_mul_u32_u24 v240, 1280, v240
    v_add_u32 v240, v240, v3
    v_cmp_gt_u32 vcc, 20, v241
    v_mov_b32 v241, 1073741824
    s_nop 0
    v_cndmask_b32 v240, v241, v240, vcc
    buffer_load_dwordx4 v240, s[24:27], 0 offen lds
L_o_d_82:
    s_add_u32 m0, s52, 27648
    s_cmp_eq_u32 s20, 3
    s_cbranch_scc1 L_o_b_83
    s_mul_i32 s30, s20, 1556480
    s_add_u32 s30, s30, 1331200
    buffer_load_dwordx4 v4, s[12:15], s30 offen lds
    s_branch L_o_d_84
L_o_b_83:
    v_add_u32 v5, 592, v2
    v_mul_u32_u24 v240, 2731, v5
    v_lshrrev_b32 v240, 16, v240
    v_mul_u32_u24 v241, 24, v240
    v_sub_u32 v241, v5, v241
    v_mul_u32_u24 v240, 20, v240
    v_add_u32 v240, v240, v241
    v_mul_u32_u24 v240, 1280, v240
    v_add_u32 v240, v240, v3
    v_cmp_gt_u32 vcc, 20, v241
    v_mov_b32 v241, 1073741824
    s_nop 0
    v_cndmask_b32 v240, v241, v240, vcc
    buffer_load_dwordx4 v240, s[24:27], 0 offen lds
L_o_d_84:
    s_add_u32 m0, s52, 28672
    s_cmp_eq_u32 s20, 3
    s_cbranch_scc1 L_o_b_85
    s_mul_i32 s30, s20, 1556480
    s_add_u32 s30, s30, 1351680
    buffer_load_dwordx4 v4, s[12:15], s30 offen lds
    s_branch L_o_d_86
L_o_b_85:
    v_add_u32 v5, 608, v2
    v_mul_u32_u24 v240, 2731, v5
    v_lshrrev_b32 v240, 16, v240
    v_mul_u32_u24 v241, 24, v240
    v_sub_u32 v241, v5, v241
    v_mul_u32_u24 v240, 20, v240
    v_add_u32 v240, v240, v241
    v_mul_u32_u24 v240, 1280, v240
    v_add_u32 v240, v240, v3
    v_cmp_gt_u32 vcc, 20, v241
    v_mov_b32 v241, 1073741824
    s_nop 0
    v_cndmask_b32 v240, v241, v240, vcc
    buffer_load_dwordx4 v240, s[24:27], 0 offen lds
L_o_d_86:
    s_add_u32 m0, s52, 29696
    s_cmp_eq_u32 s20, 3
    s_cbranch_scc1 L_o_b_87
    s_mul_i32 s30, s20, 1556480
    s_add_u32 s30, s30, 1372160
    buffer_load_dwordx4 v4, s[12:15], s30 offen lds
    s_branch L_o_d_88
L_o_b_87:
    v_add_u32 v5, 624, v2
    v_mul_u32_u24 v240, 2731, v5
    v_lshrrev_b32 v240, 16, v240
    v_mul_u32_u24 v241, 24, v240
    v_sub_u32 v241, v5, v241
    v_mul_u32_u24 v240, 20, v240
    v_add_u32 v240, v240, v241
    v_mul_u32_u24 v240, 1280, v240
    v_add_u32 v240, v240, v3
    v_cmp_gt_u32 vcc, 20, v241
    v_mov_b32 v241, 1073741824
    s_nop 0
    v_cndmask_b32 v240, v241, v240, vcc
    buffer_load_dwordx4 v240, s[24:27], 0 offen lds
L_o_d_88:
    s_add_u32 m0, s52, 30720
    s_cmp_eq_u32 s20, 3
    s_cbranch_scc1 L_o_b_89
    s_mul_i32 s30, s20, 1556480
    s_add_u32 s30, s30, 1392640
    buffer_load_dwordx4 v4, s[12:15], s30 offen lds
    s_branch L_o_d_90
L_o_b_89:
    v_add_u32 v5, 640, v2
    v_mul_u32_u24 v240, 2731, v5
    v_lshrrev_b32 v240, 16, v240
    v_mul_u32_u24 v241, 24, v240
    v_sub_u32 v241, v5, v241
    v_mul_u32_u24 v240, 20, v240
    v_add_u32 v240, v240, v241
    v_mul_u32_u24 v240, 1280, v240
    v_add_u32 v240, v240, v3
    v_cmp_gt_u32 vcc, 20, v241
    v_mov_b32 v241, 1073741824
    s_nop 0
    v_cndmask_b32 v240, v241, v240, vcc
    buffer_load_dwordx4 v240, s[24:27], 0 offen lds
L_o_d_90:
    s_add_u32 m0, s52, 31744
    s_cmp_eq_u32 s20, 3
    s_cbranch_scc1 L_o_b_91
    s_mul_i32 s30, s20, 1556480
    s_add_u32 s30, s30, 1413120
    buffer_load_dwordx4 v4, s[12:15], s30 offen lds
    s_branch L_o_d_92
L_o_b_91:
    v_add_u32 v5, 656, v2
    v_mul_u32_u24 v240, 2731, v5
    v_lshrrev_b32 v240, 16, v240
    v_mul_u32_u24 v241, 24, v240
    v_sub_u32 v241, v5, v241
    v_mul_u32_u24 v240, 20, v240
    v_add_u32 v240, v240, v241
    v_mul_u32_u24 v240, 1280, v240
    v_add_u32 v240, v240, v3
    v_cmp_gt_u32 vcc, 20, v241
    v_mov_b32 v241, 1073741824
    s_nop 0
    v_cndmask_b32 v240, v241, v240, vcc
    buffer_load_dwordx4 v240, s[24:27], 0 offen lds
L_o_d_92:
    s_add_u32 m0, s52, 32768
    s_cmp_eq_u32 s20, 3
    s_cbranch_scc1 L_o_b_93
    s_mul_i32 s30, s20, 1556480
    s_add_u32 s30, s30, 1433600
    buffer_load_dwordx4 v4, s[12:15], s30 offen lds
    s_branch L_o_d_94
L_o_b_93:
    v_add_u32 v5, 672, v2
    v_mul_u32_u24 v240, 2731, v5
    v_lshrrev_b32 v240, 16, v240
    v_mul_u32_u24 v241, 24, v240
    v_sub_u32 v241, v5, v241
    v_mul_u32_u24 v240, 20, v240
    v_add_u32 v240, v240, v241
    v_mul_u32_u24 v240, 1280, v240
    v_add_u32 v240, v240, v3
    v_cmp_gt_u32 vcc, 20, v241
    v_mov_b32 v241, 1073741824
    s_nop 0
    v_cndmask_b32 v240, v241, v240, vcc
    buffer_load_dwordx4 v240, s[24:27], 0 offen lds
L_o_d_94:
    s_add_u32 m0, s52, 33792
    s_cmp_eq_u32 s20, 3
    s_cbranch_scc1 L_o_b_95
    s_mul_i32 s30, s20, 1556480
    s_add_u32 s30, s30, 1454080
    buffer_load_dwordx4 v4, s[12:15], s30 offen lds
    s_branch L_o_d_96
L_o_b_95:
    v_add_u32 v5, 688, v2
    v_mul_u32_u24 v240, 2731, v5
    v_lshrrev_b32 v240, 16, v240
    v_mul_u32_u24 v241, 24, v240
    v_sub_u32 v241, v5, v241
    v_mul_u32_u24 v240, 20, v240
    v_add_u32 v240, v240, v241
    v_mul_u32_u24 v240, 1280, v240
    v_add_u32 v240, v240, v3
    v_cmp_gt_u32 vcc, 20, v241
    v_mov_b32 v241, 1073741824
    s_nop 0
    v_cndmask_b32 v240, v241, v240, vcc
    buffer_load_dwordx4 v240, s[24:27], 0 offen lds
L_o_d_96:
    s_add_u32 m0, s52, 34816
    s_cmp_eq_u32 s20, 3
    s_cbranch_scc1 L_o_b_97
    s_mul_i32 s30, s20, 1556480
    s_add_u32 s30, s30, 1474560
    buffer_load_dwordx4 v4, s[12:15], s30 offen lds
    s_branch L_o_d_98
L_o_b_97:
    v_add_u32 v5, 704, v2
    v_mul_u32_u24 v240, 2731, v5
    v_lshrrev_b32 v240, 16, v240
    v_mul_u32_u24 v241, 24, v240
    v_sub_u32 v241, v5, v241
    v_mul_u32_u24 v240, 20, v240
    v_add_u32 v240, v240, v241
    v_mul_u32_u24 v240, 1280, v240
    v_add_u32 v240, v240, v3
    v_cmp_gt_u32 vcc, 20, v241
    v_mov_b32 v241, 1073741824
    s_nop 0
    v_cndmask_b32 v240, v241, v240, vcc
    buffer_load_dwordx4 v240, s[24:27], 0 offen lds
L_o_d_98:
    s_add_u32 m0, s52, 35840
    s_cmp_eq_u32 s20, 3
    s_cbranch_scc1 L_o_b_99
    s_mul_i32 s30, s20, 1556480
    s_add_u32 s30, s30, 1495040
    buffer_load_dwordx4 v4, s[12:15], s30 offen lds
    s_branch L_o_d_100
L_o_b_99:
    v_add_u32 v5, 720, v2
    v_mul_u32_u24 v240, 2731, v5
    v_lshrrev_b32 v240, 16, v240
    v_mul_u32_u24 v241, 24, v240
    v_sub_u32 v241, v5, v241
    v_mul_u32_u24 v240, 20, v240
    v_add_u32 v240, v240, v241
    v_mul_u32_u24 v240, 1280, v240
    v_add_u32 v240, v240, v3
    v_cmp_gt_u32 vcc, 20, v241
    v_mov_b32 v241, 1073741824
    s_nop 0
    v_cndmask_b32 v240, v241, v240, vcc
    buffer_load_dwordx4 v240, s[24:27], 0 offen lds
L_o_d_100:
    s_add_u32 m0, s52, 36864
    s_cmp_eq_u32 s20, 3
    s_cbranch_scc1 L_o_b_101
    s_mul_i32 s30, s20, 1556480
    s_add_u32 s30, s30, 1515520
    buffer_load_dwordx4 v4, s[12:15], s30 offen lds
    s_branch L_o_d_102
L_o_b_101:
    v_add_u32 v5, 736, v2
    v_mul_u32_u24 v240, 2731, v5
    v_lshrrev_b32 v240, 16, v240
    v_mul_u32_u24 v241, 24, v240
    v_sub_u32 v241, v5, v241
    v_mul_u32_u24 v240, 20, v240
    v_add_u32 v240, v240, v241
    v_mul_u32_u24 v240, 1280, v240
    v_add_u32 v240, v240, v3
    v_cmp_gt_u32 vcc, 20, v241
    v_mov_b32 v241, 1073741824
    s_nop 0
    v_cndmask_b32 v240, v241, v240, vcc
    buffer_load_dwordx4 v240, s[24:27], 0 offen lds
L_o_d_102:
    s_add_u32 m0, s52, 37888
    s_cmp_eq_u32 s20, 3
    s_cbranch_scc1 L_o_b_103
    s_mul_i32 s30, s20, 1556480
    s_add_u32 s30, s30, 1536000
    buffer_load_dwordx4 v4, s[12:15], s30 offen lds
    s_branch L_o_d_104
L_o_b_103:
    v_add_u32 v5, 752, v2
    v_mul_u32_u24 v240, 2731, v5
    v_lshrrev_b32 v240, 16, v240
    v_mul_u32_u24 v241, 24, v240
    v_sub_u32 v241, v5, v241
    v_mul_u32_u24 v240, 20, v240
    v_add_u32 v240, v240, v241
    v_mul_u32_u24 v240, 1280, v240
    v_add_u32 v240, v240, v3
    v_cmp_gt_u32 vcc, 20, v241
    v_mov_b32 v241, 1073741824
    s_nop 0
    v_cndmask_b32 v240, v241, v240, vcc
    buffer_load_dwordx4 v240, s[24:27], 0 offen lds
L_o_d_104:
    s_waitcnt vmcnt(0)
    ds_read_b64_tr_b16 a[152:153], v10 offset:0
    ds_read_b64_tr_b16 a[154:155], v10 offset:256
    ds_read_b64_tr_b16 a[156:157], v10 offset:1024
    ds_read_b64_tr_b16 a[158:159], v10 offset:1280
    ds_read_b64_tr_b16 a[160:161], v10 offset:2048
    ds_read_b64_tr_b16 a[162:163], v10 offset:2304
    ds_read_b64_tr_b16 a[164:165], v10 offset:3072
    ds_read_b64_tr_b16 a[166:167], v10 offset:3328
    s_waitcnt lgkmcnt(0)
    ds_read_b64_tr_b16 a[168:169], v10 offset:4096
    ds_read_b64_tr_b16 a[170:171], v10 offset:4352
    ds_read_b64_tr_b16 a[172:173], v10 offset:5120
    ds_read_b64_tr_b16 a[174:175], v10 offset:5376
    ds_read_b64_tr_b16 a[176:177], v10 offset:6144
    ds_read_b64_tr_b16 a[178:179], v10 offset:6400
    ds_read_b64_tr_b16 a[180:181], v10 offset:7168
    ds_read_b64_tr_b16 a[182:183], v10 offset:7424
    s_waitcnt lgkmcnt(0)
    ds_read_b64_tr_b16 a[184:185], v10 offset:8192
    ds_read_b64_tr_b16 a[186:187], v10 offset:8448
    ds_read_b64_tr_b16 a[188:189], v10 offset:9216
    ds_read_b64_tr_b16 a[190:191], v10 offset:9472
    ds_read_b64_tr_b16 a[192:193], v10 offset:10240
    ds_read_b64_tr_b16 a[194:195], v10 offset:10496
    ds_read_b64_tr_b16 a[196:197], v10 offset:11264
    ds_read_b64_tr_b16 a[198:199], v10 offset:11520
    s_waitcnt lgkmcnt(0)
    ds_read_b64_tr_b16 a[200:201], v10 offset:12288
    ds_read_b64_tr_b16 a[202:203], v10 offset:12544
    ds_read_b64_tr_b16 a[204:205], v10 offset:13312
    ds_read_b64_tr_b16 a[206:207], v10 offset:13568
    ds_read_b64_tr_b16 a[208:209], v10 offset:14336
    ds_read_b64_tr_b16 a[210:211], v10 offset:14592
    ds_read_b64_tr_b16 a[212:213], v10 offset:15360
    ds_read_b64_tr_b16 a[214:215], v10 offset:15616
    s_waitcnt lgkmcnt(0)
    ds_read_b64_tr_b16 a[216:217], v10 offset:16384
    ds_read_b64_tr_b16 a[218:219], v10 offset:16640
    ds_read_b64_tr_b16 a[220:221], v10 offset:17408
    ds_read_b64_tr_b16 a[222:223], v10 offset:17664
    ds_read_b64_tr_b16 a[224:225], v10 offset:18432
    ds_read_b64_tr_b16 a[226:227], v10 offset:18688
    ds_read_b64_tr_b16 a[228:229], v10 offset:19456
    ds_read_b64_tr_b16 a[230:231], v10 offset:19712
    s_waitcnt lgkmcnt(0)
    ds_read_b64_tr_b16 a[232:233], v10 offset:20480
    ds_read_b64_tr_b16 a[234:235], v10 offset:20736
    ds_read_b64_tr_b16 a[236:237], v10 offset:21504
    ds_read_b64_tr_b16 a[238:239], v10 offset:21760
    ds_read_b64_tr_b16 a[240:241], v10 offset:22528
    ds_read_b64_tr_b16 a[242:243], v10 offset:22784
    ds_read_b64_tr_b16 a[244:245], v10 offset:23552
    ds_read_b64_tr_b16 a[246:247], v10 offset:23808
    s_waitcnt lgkmcnt(0)
    ds_read_b64_tr_b16 a[248:249], v10 offset:24576
    ds_read_b64_tr_b16 a[250:251], v10 offset:24832
    ds_read_b64_tr_b16 a[252:253], v10 offset:25600
    ds_read_b64_tr_b16 a[254:255], v10 offset:25856
    ds_read_b64_tr_b16 v[16:17], v10 offset:26624
    ds_read_b64_tr_b16 v[18:19], v10 offset:26880
    ds_read_b64_tr_b16 v[20:21], v10 offset:27648
    ds_read_b64_tr_b16 v[22:23], v10 offset:27904
    s_waitcnt lgkmcnt(0)
    ds_read_b64_tr_b16 v[24:25], v10 offset:28672
    ds_read_b64_tr_b16 v[26:27], v10 offset:28928
    ds_read_b64_tr_b16 v[28:29], v10 offset:29696
    ds_read_b64_tr_b16 v[30:31], v10 offset:29952
    ds_read_b64_tr_b16 v[32:33], v10 offset:30720
    ds_read_b64_tr_b16 v[34:35], v10 offset:30976
    ds_read_b64_tr_b16 v[36:37], v10 offset:31744
    ds_read_b64_tr_b16 v[38:39], v10 offset:32000
    s_waitcnt lgkmcnt(0)
    ds_read_b64_tr_b16 v[40:41], v10 offset:32768
    ds_read_b64_tr_b16 v[42:43], v10 offset:33024
    ds_read_b64_tr_b16 v[44:45], v10 offset:33792
    ds_read_b64_tr_b16 v[46:47], v10 offset:34048
    ds_read_b64_tr_b16 v[48:49], v10 offset:34816
    ds_read_b64_tr_b16 v[50:51], v10 offset:35072
    ds_read_b64_tr_b16 v[52:53], v10 offset:35840
    ds_read_b64_tr_b16 v[54:55], v10 offset:36096
    s_waitcnt lgkmcnt(0)
    ds_read_b64_tr_b16 v[56:57], v10 offset:36864
    ds_read_b64_tr_b16 v[58:59], v10 offset:37120
    ds_read_b64_tr_b16 v[60:61], v10 offset:37888
    ds_read_b64_tr_b16 v[62:63], v10 offset:38144
    s_waitcnt lgkmcnt(0)
    s_barrier
    v_lshlrev_b32 v10, 4, v1
    s_lshl_b32 s30, s20, 12
    v_add_u32 v11, s30, v10
    s_lshl_b32 s30, s20, 10
    v_add_u32 v12, s30, v10
    v_and_b32 v2, 31, v1
    v_mul_u32_u24 v2, 1280, v2
    v_lshrrev_b32 v3, 5, v1
    v_lshl_add_u32 v2, v3, 3, v2
    s_lshl_b32 s30, s17, 6
    s_lshl_b32 s31, s20, 4
    s_add_u32 s30, s30, s31
    v_add_u32 v13, s30, v2
    s_load_dwordx2 s[4:5], s[0:1], 88
    s_waitcnt lgkmcnt(0)
    s_mov_b32 s12, s4
    s_and_b32 s13, s5, 0xffff
    s_mov_b32 s14, 2621440
    s_mov_b32 s15, 0x20000
    v_mov_b32 v2, 0
    s_mov_b32 s30, 105947136
L_o_wb:
    buffer_load_dword v3, v2, s[8:11], s30 offen sc1
    s_waitcnt vmcnt(0)
    v_readfirstlane_b32 s31, v3
    s_cmp_ge_u32 s31, 128
    s_cbranch_scc1 L_o_wb_ok
    s_sleep 32
    s_sub_u32 s22, s22, 1
    s_cbranch_scc0 L_o_wb
    s_branch L_timeout
L_o_wb_ok:
    s_mov_b32 s37, s39
    s_mov_b32 s54, 0
L_o_seg:
    s_lshl_b32 s30, s37, 7
    s_add_u32 s30, s30, 105955328
    v_mov_b32 v2, 0
    s_cmp_lg_u32 s20, 0
    s_cbranch_scc1 L_o_wx_ok
L_o_wx:
    buffer_load_dword v3, v2, s[8:11], s30 offen sc1
    s_waitcnt vmcnt(0)
    v_readfirstlane_b32 s31, v3
    s_cmp_ge_u32 s31, 32
    s_cbranch_scc1 L_o_wx_ok
    s_cmp_ge_u32 s37, 58
    s_cbranch_scc1 L_o_wx_short
    s_sleep 100
L_o_wx_short:
    s_sleep 3
    s_sub_u32 s22, s22, 1
    s_cbranch_scc0 L_o_wx
    s_branch L_timeout
L_o_wx_ok:
    s_barrier
    s_mul_i32 s53, s37, 311296
    s_mul_i32 s30, s20, 77824
    s_add_u32 s53, s53, s30
    s_add_u32 s53, s53, 50331648
    buffer_load_dwordx4 v[64:67], v10, s[8:11], s53 offen offset:0 sc1
    buffer_load_dwordx4 v[68:71], v10, s[8:11], s53 offen offset:1024 sc1
    buffer_load_dwordx4 v[72:75], v10, s[8:11], s53 offen offset:2048 sc1
    buffer_load_dwordx4 v[76:79], v10, s[8:11], s53 offen offset:3072 sc1
    s_add_u32 s53, s53, 4096
    buffer_load_dwordx4 v[80:83], v10, s[8:11], s53 offen offset:0 sc1
    buffer_load_dwordx4 v[84:87], v10, s[8:11], s53 offen offset:1024 sc1
    buffer_load_dwordx4 v[88:91], v10, s[8:11], s53 offen offset:2048 sc1
    buffer_load_dwordx4 v[92:95], v10, s[8:11], s53 offen offset:3072 sc1
    s_add_u32 s53, s53, 4096
    buffer_load_dwordx4 v[96:99], v10, s[8:11], s53 offen offset:0 sc1
    buffer_load_dwordx4 v[100:103], v10, s[8:11], s53 offen offset:1024 sc1
    buffer_load_dwordx4 v[104:107], v10, s[8:11], s53 offen offset:2048 sc1
    buffer_load_dwordx4 v[108:111], v10, s[8:11], s53 offen offset:3072 sc1
    s_add_u32 s53, s53, 4096
    buffer_load_dwordx4 v[112:115], v10, s[8:11], s53 offen offset:0 sc1
    buffer_load_dwordx4 v[116:119], v10, s[8:11], s53 offen offset:1024 sc1
    buffer_load_dwordx4 v[120:123], v10, s[8:11], s53 offen offset:2048 sc1
    buffer_load_dwordx4 v[124:127], v10, s[8:11], s53 offen offset:3072 sc1
    s_add_u32 s53, s53, 4096
    buffer_load_dwordx4 v[128:131], v10, s[8:11], s53 offen offset:0 sc1
    buffer_load_dwordx4 v[132:135], v10, s[8:11], s53 offen offset:1024 sc1
    buffer_load_dwordx4 v[136:139], v10, s[8:11], s53 offen offset:2048 sc1
    buffer_load_dwordx4 v[140:143], v10, s[8:11], s53 offen offset:3072 sc1
    s_add_u32 s53, s53, 4096
    buffer_load_dwordx4 v[144:147], v10, s[8:11], s53 offen offset:0 sc1
    buffer_load_dwordx4 v[148:151], v10, s[8:11], s53 offen offset:1024 sc1
    buffer_load_dwordx4 v[152:155], v10, s[8:11], s53 offen offset:2048 sc1
    buffer_load_dwordx4 v[156:159], v10, s[8:11], s53 offen offset:3072 sc1
    s_add_u32 s53, s53, 4096
    buffer_load_dwordx4 v[160:163], v10, s[8:11], s53 offen offset:0 sc1
    buffer_load_dwordx4 v[164:167], v10, s[8:11], s53 offen offset:1024 sc1
    buffer_load_dwordx4 v[168:171], v10, s[8:11], s53 offen offset:2048 sc1
    buffer_load_dwordx4 v[172:175], v10, s[8:11], s53 offen offset:3072 sc1
    s_add_u32 s53, s53, 4096
    buffer_load_dwordx4 v[176:179], v10, s[8:11], s53 offen offset:0 sc1
    buffer_load_dwordx4 v[180:183], v10, s[8:11], s53 offen offset:1024 sc1
    buffer_load_dwordx4 v[184:187], v10, s[8:11], s53 offen offset:2048 sc1
    buffer_load_dwordx4 v[188:191], v10, s[8:11], s53 offen offset:3072 sc1
    s_add_u32 s53, s53, 4096
    buffer_load_dwordx4 v[192:195], v10, s[8:11], s53 offen offset:0 sc1
    buffer_load_dwordx4 v[196:199], v10, s[8:11], s53 offen offset:1024 sc1
    buffer_load_dwordx4 v[200:203], v10, s[8:11], s53 offen offset:2048 sc1
    buffer_load_dwordx4 v[204:207], v10, s[8:11], s53 offen offset:3072 sc1
    s_add_u32 s53, s53, 4096
    buffer_load_dwordx4 v[208:211], v10, s[8:11], s53 offen offset:0 sc1
    buffer_load_dwordx4 v[212:215], v10, s[8:11], s53 offen offset:1024 sc1
    buffer_load_dwordx4 v[216:219], v10, s[8:11], s53 offen offset:2048 sc1
    buffer_load_dwordx4 v[220:223], v10, s[8:11], s53 offen offset:3072 sc1
    s_waitcnt vmcnt(39)
    v_mfma_f32_32x32x16_bf16 v[224:239], a[0:3], v[64:67], 0
    s_add_u32 s53, s53, 4096
    buffer_load_dwordx4 v[64:67], v10, s[8:11], s53 offen offset:0 sc1
    s_waitcnt vmcnt(39)
    v_mfma_f32_32x32x16_bf16 v[224:239], a[4:7], v[68:71], v[224:239]
    buffer_load_dwordx4 v[68:71], v10, s[8:11], s53 offen offset:1024 sc1
    s_waitcnt vmcnt(39)
    v_mfma_f32_32x32x16_bf16 v[224:239], a[8:11], v[72:75], v[224:239]
    buffer_load_dwordx4 v[72:75], v10, s[8:11], s53 offen offset:2048 sc1
    s_waitcnt vmcnt(39)
    v_mfma_f32_32x32x16_bf16 v[224:239], a[12:15], v[76:79], v[224:239]
    buffer_load_dwordx4 v[76:79], v10, s[8:11], s53 offen offset:3072 sc1
    s_waitcnt vmcnt(39)
    v_mfma_f32_32x32x16_bf16 v[224:239], a[16:19], v[80:83], v[224:239]
    s_add_u32 s53, s53, 4096
    buffer_load_dwordx4 v[80:83], v10, s[8:11], s53 offen offset:0 sc1
    s_waitcnt vmcnt(39)
    v_mfma_f32_32x32x16_bf16 v[224:239], a[20:23], v[84:87], v[224:239]
    buffer_load_dwordx4 v[84:87], v10, s[8:11], s53 offen offset:1024 sc1
    s_waitcnt vmcnt(39)
    v_mfma_f32_32x32x16_bf16 v[224:239], a[24:27], v[88:91], v[224:239]
    buffer_load_dwordx4 v[88:91], v10, s[8:11], s53 offen offset:2048 sc1
    s_waitcnt vmcnt(39)
    v_mfma_f32_32x32x16_bf16 v[224:239], a[28:31], v[92:95], v[224:239]
    buffer_load_dwordx4 v[92:95], v10, s[8:11], s53 offen offset:3072 sc1
    s_waitcnt vmcnt(39)
    v_mfma_f32_32x32x16_bf16 v[224:239], a[32:35], v[96:99], v[224:239]
    s_add_u32 s53, s53, 4096
    buffer_load_dwordx4 v[96:99], v10, s[8:11], s53 offen offset:0 sc1
    s_waitcnt vmcnt(39)
    v_mfma_f32_32x32x16_bf16 v[224:239], a[36:39], v[100:103], v[224:239]
    buffer_load_dwordx4 v[100:103], v10, s[8:11], s53 offen offset:1024 sc1
    s_waitcnt vmcnt(39)
    v_mfma_f32_32x32x16_bf16 v[224:239], a[40:43], v[104:107], v[224:239]
    buffer_load_dwordx4 v[104:107], v10, s[8:11], s53 offen offset:2048 sc1
    s_waitcnt vmcnt(39)
    v_mfma_f32_32x32x16_bf16 v[224:239], a[44:47], v[108:111], v[224:239]
    buffer_load_dwordx4 v[108:111], v10, s[8:11], s53 offen offset:3072 sc1
    s_waitcnt vmcnt(39)
    v_mfma_f32_32x32x16_bf16 v[224:239], a[48:51], v[112:115], v[224:239]
    s_add_u32 s53, s53, 4096
    buffer_load_dwordx4 v[112:115], v10, s[8:11], s53 offen offset:0 sc1
    s_waitcnt vmcnt(39)
    v_mfma_f32_32x32x16_bf16 v[224:239], a[52:55], v[116:119], v[224:239]
    buffer_load_dwordx4 v[116:119], v10, s[8:11], s53 offen offset:1024 sc1
    s_waitcnt vmcnt(39)
    v_mfma_f32_32x32x16_bf16 v[224:239], a[56:59], v[120:123], v[224:239]
    buffer_load_dwordx4 v[120:123], v10, s[8:11], s53 offen offset:2048 sc1
    s_waitcnt vmcnt(39)
    v_mfma_f32_32x32x16_bf16 v[224:239], a[60:63], v[124:127], v[224:239]
    buffer_load_dwordx4 v[124:127], v10, s[8:11], s53 offen offset:3072 sc1
    s_waitcnt vmcnt(39)
    v_mfma_f32_32x32x16_bf16 v[224:239], a[64:67], v[128:131], v[224:239]
    s_add_u32 s53, s53, 4096
    buffer_load_dwordx4 v[128:131], v10, s[8:11], s53 offen offset:0 sc1
    s_waitcnt vmcnt(39)
    v_mfma_f32_32x32x16_bf16 v[224:239], a[68:71], v[132:135], v[224:239]
    buffer_load_dwordx4 v[132:135], v10, s[8:11], s53 offen offset:1024 sc1
    s_waitcnt vmcnt(39)
    v_mfma_f32_32x32x16_bf16 v[224:239], a[72:75], v[136:139], v[224:239]
    buffer_load_dwordx4 v[136:139], v10, s[8:11], s53 offen offset:2048 sc1
    s_waitcnt vmcnt(39)
    v_mfma_f32_32x32x16_bf16 v[224:239], a[76:79], v[140:143], v[224:239]
    buffer_load_dwordx4 v[140:143], v10, s[8:11], s53 offen offset:3072 sc1
    s_waitcnt vmcnt(39)
    v_mfma_f32_32x32x16_bf16 v[224:239], a[80:83], v[144:147], v[224:239]
    s_add_u32 s53, s53, 4096
    buffer_load_dwordx4 v[144:147], v10, s[8:11], s53 offen offset:0 sc1
    s_waitcnt vmcnt(39)
    v_mfma_f32_32x32x16_bf16 v[224:239], a[84:87], v[148:151], v[224:239]
    buffer_load_dwordx4 v[148:151], v10, s[8:11], s53 offen offset:1024 sc1
    s_waitcnt vmcnt(39)
    v_mfma_f32_32x32x16_bf16 v[224:239], a[88:91], v[152:155], v[224:239]
    buffer_load_dwordx4 v[152:155], v10, s[8:11], s53 offen offset:2048 sc1
    s_waitcnt vmcnt(39)
    v_mfma_f32_32x32x16_bf16 v[224:239], a[92:95], v[156:159], v[224:239]
    buffer_load_dwordx4 v[156:159], v10, s[8:11], s53 offen offset:3072 sc1
    s_waitcnt vmcnt(39)
    v_mfma_f32_32x32x16_bf16 v[224:239], a[96:99], v[160:163], v[224:239]
    s_add_u32 s53, s53, 4096
    buffer_load_dwordx4 v[160:163], v10, s[8:11], s53 offen offset:0 sc1
    s_waitcnt vmcnt(39)
    v_mfma_f32_32x32x16_bf16 v[224:239], a[100:103], v[164:167], v[224:239]
    buffer_load_dwordx4 v[164:167], v10, s[8:11], s53 offen offset:1024 sc1
    s_waitcnt vmcnt(39)
    v_mfma_f32_32x32x16_bf16 v[224:239], a[104:107], v[168:171], v[224:239]
    buffer_load_dwordx4 v[168:171], v10, s[8:11], s53 offen offset:2048 sc1
    s_waitcnt vmcnt(39)
    v_mfma_f32_32x32x16_bf16 v[224:239], a[108:111], v[172:175], v[224:239]
    buffer_load_dwordx4 v[172:175], v10, s[8:11], s53 offen offset:3072 sc1
    s_waitcnt vmcnt(39)
    v_mfma_f32_32x32x16_bf16 v[224:239], a[112:115], v[176:179], v[224:239]
    s_add_u32 s53, s53, 4096
    buffer_load_dwordx4 v[176:179], v10, s[8:11], s53 offen offset:0 sc1
    s_waitcnt vmcnt(39)
    v_mfma_f32_32x32x16_bf16 v[224:239], a[116:119], v[180:183], v[224:239]
    buffer_load_dwordx4 v[180:183], v10, s[8:11], s53 offen offset:1024 sc1
    s_waitcnt vmcnt(39)
    v_mfma_f32_32x32x16_bf16 v[224:239], a[120:123], v[184:187], v[224:239]
    buffer_load_dwordx4 v[184:187], v10, s[8:11], s53 offen offset:2048 sc1
    s_waitcnt vmcnt(39)
    v_mfma_f32_32x32x16_bf16 v[224:239], a[124:127], v[188:191], v[224:239]
    buffer_load_dwordx4 v[188:191], v10, s[8:11], s53 offen offset:3072 sc1
    s_waitcnt vmcnt(39)
    v_mfma_f32_32x32x16_bf16 v[224:239], a[128:131], v[192:195], v[224:239]
    s_add_u32 s53, s53, 4096
    buffer_load_dwordx4 v[192:195], v10, s[8:11], s53 offen offset:0 sc1
    s_waitcnt vmcnt(39)
    v_mfma_f32_32x32x16_bf16 v[224:239], a[132:135], v[196:199], v[224:239]
    buffer_load_dwordx4 v[196:199], v10, s[8:11], s53 offen offset:1024 sc1
    s_waitcnt vmcnt(39)
    v_mfma_f32_32x32x16_bf16 v[224:239], a[136:139], v[200:203], v[224:239]
    buffer_load_dwordx4 v[200:203], v10, s[8:11], s53 offen offset:2048 sc1
    s_waitcnt vmcnt(39)
    v_mfma_f32_32x32x16_bf16 v[224:239], a[140:143], v[204:207], v[224:239]
    buffer_load_dwordx4 v[204:207], v10, s[8:11], s53 offen offset:3072 sc1
    s_waitcnt vmcnt(39)
    v_mfma_f32_32x32x16_bf16 v[224:239], a[144:147], v[208:211], v[224:239]
    s_waitcnt vmcnt(38)
    v_mfma_f32_32x32x16_bf16 v[224:239], a[148:151], v[212:215], v[224:239]
    s_waitcnt vmcnt(37)
    v_mfma_f32_32x32x16_bf16 v[224:239], a[152:155], v[216:219], v[224:239]
    s_waitcnt vmcnt(36)
    v_mfma_f32_32x32x16_bf16 v[224:239], a[156:159], v[220:223], v[224:239]
    s_waitcnt vmcnt(35)
    v_mfma_f32_32x32x16_bf16 v[224:239], a[160:163], v[64:67], v[224:239]
    s_waitcnt vmcnt(34)
    v_mfma_f32_32x32x16_bf16 v[224:239], a[164:167], v[68:71], v[224:239]
    s_waitcnt vmcnt(33)
    v_mfma_f32_32x32x16_bf16 v[224:239], a[168:171], v[72:75], v[224:239]
    s_waitcnt vmcnt(32)
    v_mfma_f32_32x32x16_bf16 v[224:239], a[172:175], v[76:79], v[224:239]
    s_waitcnt vmcnt(31)
    v_mfma_f32_32x32x16_bf16 v[224:239], a[176:179], v[80:83], v[224:239]
    s_waitcnt vmcnt(30)
    v_mfma_f32_32x32x16_bf16 v[224:239], a[180:183], v[84:87], v[224:239]
    s_waitcnt vmcnt(29)
    v_mfma_f32_32x32x16_bf16 v[224:239], a[184:187], v[88:91], v[224:239]
    s_waitcnt vmcnt(28)
    v_mfma_f32_32x32x16_bf16 v[224:239], a[188:191], v[92:95], v[224:239]
    s_waitcnt vmcnt(27)
    v_mfma_f32_32x32x16_bf16 v[224:239], a[192:195], v[96:99], v[224:239]
    s_waitcnt vmcnt(26)
    v_mfma_f32_32x32x16_bf16 v[224:239], a[196:199], v[100:103], v[224:239]
    s_waitcnt vmcnt(25)
    v_mfma_f32_32x32x16_bf16 v[224:239], a[200:203], v[104:107], v[224:239]
    s_waitcnt vmcnt(24)
    v_mfma_f32_32x32x16_bf16 v[224:239], a[204:207], v[108:111], v[224:239]
    s_waitcnt vmcnt(23)
    v_mfma_f32_32x32x16_bf16 v[224:239], a[208:211], v[112:115], v[224:239]
    s_waitcnt vmcnt(22)
    v_mfma_f32_32x32x16_bf16 v[224:239], a[212:215], v[116:119], v[224:239]
    s_waitcnt vmcnt(21)
    v_mfma_f32_32x32x16_bf16 v[224:239], a[216:219], v[120:123], v[224:239]
    s_waitcnt vmcnt(20)
    v_mfma_f32_32x32x16_bf16 v[224:239], a[220:223], v[124:127], v[224:239]
    s_waitcnt vmcnt(19)
    v_mfma_f32_32x32x16_bf16 v[224:239], a[224:227], v[128:131], v[224:239]
    s_waitcnt vmcnt(18)
    v_mfma_f32_32x32x16_bf16 v[224:239], a[228:231], v[132:135], v[224:239]
    s_waitcnt vmcnt(17)
    v_mfma_f32_32x32x16_bf16 v[224:239], a[232:235], v[136:139], v[224:239]
    s_waitcnt vmcnt(16)
    v_mfma_f32_32x32x16_bf16 v[224:239], a[236:239], v[140:143], v[224:239]
    s_waitcnt vmcnt(15)
    v_mfma_f32_32x32x16_bf16 v[224:239], a[240:243], v[144:147], v[224:239]
    s_waitcnt vmcnt(14)
    v_mfma_f32_32x32x16_bf16 v[224:239], a[244:247], v[148:151], v[224:239]
    s_waitcnt vmcnt(13)
    v_mfma_f32_32x32x16_bf16 v[224:239], a[248:251], v[152:155], v[224:239]
    s_waitcnt vmcnt(12)
    v_mfma_f32_32x32x16_bf16 v[224:239], a[252:255], v[156:159], v[224:239]
    s_waitcnt vmcnt(11)
    v_mfma_f32_32x32x16_bf16 v[224:239], v[16:19], v[160:163], v[224:239]
    s_waitcnt vmcnt(10)
    v_mfma_f32_32x32x16_bf16 v[224:239], v[20:23], v[164:167], v[224:239]
    s_waitcnt vmcnt(9)
    v_mfma_f32_32x32x16_bf16 v[224:239], v[24:27], v[168:171], v[224:239]
    s_waitcnt vmcnt(8)
    v_mfma_f32_32x32x16_bf16 v[224:239], v[28:31], v[172:175], v[224:239]
    s_waitcnt vmcnt(7)
    v_mfma_f32_32x32x16_bf16 v[224:239], v[32:35], v[176:179], v[224:239]
    s_waitcnt vmcnt(6)
    v_mfma_f32_32x32x16_bf16 v[224:239], v[36:39], v[180:183], v[224:239]
    s_waitcnt vmcnt(5)
    v_mfma_f32_32x32x16_bf16 v[224:239], v[40:43], v[184:187], v[224:239]
    s_waitcnt vmcnt(4)
    v_mfma_f32_32x32x16_bf16 v[224:239], v[44:47], v[188:191], v[224:239]
    s_waitcnt vmcnt(3)
    v_mfma_f32_32x32x16_bf16 v[224:239], v[48:51], v[192:195], v[224:239]
    s_waitcnt vmcnt(2)
    v_mfma_f32_32x32x16_bf16 v[224:239], v[52:55], v[196:199], v[224:239]
    s_waitcnt vmcnt(1)
    v_mfma_f32_32x32x16_bf16 v[224:239], v[56:59], v[200:203], v[224:239]
    s_waitcnt vmcnt(0)
    v_mfma_f32_32x32x16_bf16 v[224:239], v[60:63], v[204:207], v[224:239]
    s_nop 11
    v_add_u32 v2, s54, v11
    ds_write_b128 v2, v[224:227] offset:0
    ds_write_b128 v2, v[228:231] offset:1024
    ds_write_b128 v2, v[232:235] offset:2048
    ds_write_b128 v2, v[236:239] offset:3072
    s_waitcnt lgkmcnt(0)
    s_barrier
    v_add_u32 v2, s54, v12
    ds_read_b128 v[240:243], v2 offset:0
    ds_read_b128 v[244:247], v2 offset:4096
    ds_read_b128 v[248:251], v2 offset:8192
    ds_read_b128 v[252:255], v2 offset:12288
    s_waitcnt lgkmcnt(0)
    v_pk_add_f32 v[240:241], v[240:241], v[244:245]
    v_pk_add_f32 v[248:249], v[248:249], v[252:253]
    v_pk_add_f32 v[242:243], v[242:243], v[246:247]
    v_pk_add_f32 v[250:251], v[250:251], v[254:255]
    v_pk_add_f32 v[240:241], v[240:241], v[248:249]
    v_pk_add_f32 v[242:243], v[242:243], v[250:251]
    v_cvt_pk_bf16_f32 v244, v240, v241
    v_cvt_pk_bf16_f32 v245, v242, v243
    s_mul_i32 s30, s37, 40960
    buffer_store_dwordx2 v[244:245], v13, s[12:15], s30 offen
    s_xor_b32 s54, s54, 16384
    s_add_u32 s37, s37, 4
    s_cmp_lt_u32 s37, 60
    s_cbranch_scc1 L_o_seg
    s_lshr_b32 s37, s39, 1
    s_add_u32 s37, s37, 60
    s_and_b32 s52, s39, 1
    v_bfe_u32 v2, v1, 4, 1
    v_lshlrev_b32 v2, 10, v2
    v_lshrrev_b32 v3, 5, v1
    v_lshl_add_u32 v2, v3, 9, v2
    v_and_b32 v3, 15, v1
    v_lshl_add_u32 v2, v3, 4, v2
    s_lshl_b32 s30, s52, 8
    v_add_u32 v10, s30, v2
    v_mul_u32_u24 v2, 1280, v3
    s_mul_i32 s30, s52, 20480
    v_add_u32 v2, s30, v2
    v_lshrrev_b32 v3, 5, v1
    v_lshl_add_u32 v2, v3, 3, v2
    s_lshl_b32 s30, s17, 6
    s_lshl_b32 s31, s20, 4
    s_add_u32 s30, s30, s31
    v_add_u32 v2, s30, v2
    v_bfe_u32 v3, v1, 4, 1
    v_cmp_eq_u32 s[56:57], 0, v3
    v_mov_b32 v4, 1073741824
    s_nop 1
    v_cndmask_b32 v13, v4, v2, s[56:57]
L_o_tail:
    s_lshl_b32 s30, s37, 7
    s_add_u32 s30, s30, 105955328
    v_mov_b32 v2, 0
    s_cmp_lg_u32 s20, 0
    s_cbranch_scc1 L_o_wxt_ok
L_o_wxt:
    buffer_load_dword v3, v2, s[8:11], s30 offen sc1
    s_waitcnt vmcnt(0)
    v_readfirstlane_b32 s31, v3
    s_cmp_ge_u32 s31, 32
    s_cbranch_scc1 L_o_wxt_ok
    s_cmp_ge_u32 s37, 58
    s_cbranch_scc1 L_o_wxt_short
    s_sleep 100
L_o_wxt_short:
    s_sleep 3
    s_sub_u32 s22, s22, 1
    s_cbranch_scc0 L_o_wxt
    s_branch L_timeout
L_o_wxt_ok:
    s_barrier
    s_mul_i32 s53, s37, 311296
    s_mul_i32 s30, s20, 77824
    s_add_u32 s53, s53, s30
    s_add_u32 s53, s53, 50331648
    buffer_load_dwordx4 v[64:67], v10, s[8:11], s53 offen offset:0 sc1
    buffer_load_dwordx4 v[68:71], v10, s[8:11], s53 offen offset:2048 sc1
    s_add_u32 s53, s53, 4096
    buffer_load_dwordx4 v[72:75], v10, s[8:11], s53 offen offset:0 sc1
    buffer_load_dwordx4 v[76:79], v10, s[8:11], s53 offen offset:2048 sc1
    s_add_u32 s53, s53, 4096
    buffer_load_dwordx4 v[80:83], v10, s[8:11], s53 offen offset:0 sc1
    buffer_load_dwordx4 v[84:87], v10, s[8:11], s53 offen offset:2048 sc1
    s_add_u32 s53, s53, 4096
    buffer_load_dwordx4 v[88:91], v10, s[8:11], s53 offen offset:0 sc1
    buffer_load_dwordx4 v[92:95], v10, s[8:11], s53 offen offset:2048 sc1
    s_add_u32 s53, s53, 4096
    buffer_load_dwordx4 v[96:99], v10, s[8:11], s53 offen offset:0 sc1
    buffer_load_dwordx4 v[100:103], v10, s[8:11], s53 offen offset:2048 sc1
    s_add_u32 s53, s53, 4096
    buffer_load_dwordx4 v[104:107], v10, s[8:11], s53 offen offset:0 sc1
    buffer_load_dwordx4 v[108:111], v10, s[8:11], s53 offen offset:2048 sc1
    s_add_u32 s53, s53, 4096
    buffer_load_dwordx4 v[112:115], v10, s[8:11], s53 offen offset:0 sc1
    buffer_load_dwordx4 v[116:119], v10, s[8:11], s53 offen offset:2048 sc1
    s_add_u32 s53, s53, 4096
    buffer_load_dwordx4 v[120:123], v10, s[8:11], s53 offen offset:0 sc1
    buffer_load_dwordx4 v[124:127], v10, s[8:11], s53 offen offset:2048 sc1
    s_add_u32 s53, s53, 4096
    buffer_load_dwordx4 v[128:131], v10, s[8:11], s53 offen offset:0 sc1
    buffer_load_dwordx4 v[132:135], v10, s[8:11], s53 offen offset:2048 sc1
    s_add_u32 s53, s53, 4096
    buffer_load_dwordx4 v[136:139], v10, s[8:11], s53 offen offset:0 sc1
    buffer_load_dwordx4 v[140:143], v10, s[8:11], s53 offen offset:2048 sc1
    s_add_u32 s53, s53, 4096
    buffer_load_dwordx4 v[144:147], v10, s[8:11], s53 offen offset:0 sc1
    buffer_load_dwordx4 v[148:151], v10, s[8:11], s53 offen offset:2048 sc1
    s_add_u32 s53, s53, 4096
    buffer_load_dwordx4 v[152:155], v10, s[8:11], s53 offen offset:0 sc1
    buffer_load_dwordx4 v[156:159], v10, s[8:11], s53 offen offset:2048 sc1
    s_waitcnt vmcnt(23)
    v_mfma_f32_32x32x16_bf16 v[160:175], a[0:3], v[64:67], 0
    v_mfma_f32_32x32x16_bf16 v[176:191], a[4:7], v[64:67], 0
    s_add_u32 s53, s53, 4096
    buffer_load_dwordx4 v[64:67], v10, s[8:11], s53 offen offset:0 sc1
    s_waitcnt vmcnt(23)
    v_mfma_f32_32x32x16_bf16 v[160:175], a[8:11], v[68:71], v[160:175]
    v_mfma_f32_32x32x16_bf16 v[176:191], a[12:15], v[68:71], v[176:191]
    buffer_load_dwordx4 v[68:71], v10, s[8:11], s53 offen offset:2048 sc1
    s_waitcnt vmcnt(23)
    v_mfma_f32_32x32x16_bf16 v[160:175], a[16:19], v[72:75], v[160:175]
    v_mfma_f32_32x32x16_bf16 v[176:191], a[20:23], v[72:75], v[176:191]
    s_add_u32 s53, s53, 4096
    buffer_load_dwordx4 v[72:75], v10, s[8:11], s53 offen offset:0 sc1
    s_waitcnt vmcnt(23)
    v_mfma_f32_32x32x16_bf16 v[160:175], a[24:27], v[76:79], v[160:175]
    v_mfma_f32_32x32x16_bf16 v[176:191], a[28:31], v[76:79], v[176:191]
    buffer_load_dwordx4 v[76:79], v10, s[8:11], s53 offen offset:2048 sc1
    s_waitcnt vmcnt(23)
    v_mfma_f32_32x32x16_bf16 v[160:175], a[32:35], v[80:83], v[160:175]
    v_mfma_f32_32x32x16_bf16 v[176:191], a[36:39], v[80:83], v[176:191]
    s_add_u32 s53, s53, 4096
    buffer_load_dwordx4 v[80:83], v10, s[8:11], s53 offen offset:0 sc1
    s_waitcnt vmcnt(23)
    v_mfma_f32_32x32x16_bf16 v[160:175], a[40:43], v[84:87], v[160:175]
    v_mfma_f32_32x32x16_bf16 v[176:191], a[44:47], v[84:87], v[176:191]
    buffer_load_dwordx4 v[84:87], v10, s[8:11], s53 offen offset:2048 sc1
    s_waitcnt vmcnt(23)
    v_mfma_f32_32x32x16_bf16 v[160:175], a[48:51], v[88:91], v[160:175]
    v_mfma_f32_32x32x16_bf16 v[176:191], a[52:55], v[88:91], v[176:191]
    s_add_u32 s53, s53, 4096
    buffer_load_dwordx4 v[88:91], v10, s[8:11], s53 offen offset:0 sc1
    s_waitcnt vmcnt(23)
    v_mfma_f32_32x32x16_bf16 v[160:175], a[56:59], v[92:95], v[160:175]
    v_mfma_f32_32x32x16_bf16 v[176:191], a[60:63], v[92:95], v[176:191]
    buffer_load_dwordx4 v[92:95], v10, s[8:11], s53 offen offset:2048 sc1
    s_waitcnt vmcnt(23)
    v_mfma_f32_32x32x16_bf16 v[160:175], a[64:67], v[96:99], v[160:175]
    v_mfma_f32_32x32x16_bf16 v[176:191], a[68:71], v[96:99], v[176:191]
    s_add_u32 s53, s53, 4096
    buffer_load_dwordx4 v[96:99], v10, s[8:11], s53 offen offset:0 sc1
    s_waitcnt vmcnt(23)
    v_mfma_f32_32x32x16_bf16 v[160:175], a[72:75], v[100:103], v[160:175]
    v_mfma_f32_32x32x16_bf16 v[176:191], a[76:79], v[100:103], v[176:191]
    buffer_load_dwordx4 v[100:103], v10, s[8:11], s53 offen offset:2048 sc1
    s_waitcnt vmcnt(23)
    v_mfma_f32_32x32x16_bf16 v[160:175], a[80:83], v[104:107], v[160:175]
    v_mfma_f32_32x32x16_bf16 v[176:191], a[84:87], v[104:107], v[176:191]
    s_add_u32 s53, s53, 4096
    buffer_load_dwordx4 v[104:107], v10, s[8:11], s53 offen offset:0 sc1
    s_waitcnt vmcnt(23)
    v_mfma_f32_32x32x16_bf16 v[160:175], a[88:91], v[108:111], v[160:175]
    v_mfma_f32_32x32x16_bf16 v[176:191], a[92:95], v[108:111], v[176:191]
    buffer_load_dwordx4 v[108:111], v10, s[8:11], s53 offen offset:2048 sc1
    s_waitcnt vmcnt(23)
    v_mfma_f32_32x32x16_bf16 v[160:175], a[96:99], v[112:115], v[160:175]
    v_mfma_f32_32x32x16_bf16 v[176:191], a[100:103], v[112:115], v[176:191]
    s_add_u32 s53, s53, 4096
    buffer_load_dwordx4 v[112:115], v10, s[8:11], s53 offen offset:0 sc1
    s_waitcnt vmcnt(23)
    v_mfma_f32_32x32x16_bf16 v[160:175], a[104:107], v[116:119], v[160:175]
    v_mfma_f32_32x32x16_bf16 v[176:191], a[108:111], v[116:119], v[176:191]
    buffer_load_dwordx4 v[116:119], v10, s[8:11], s53 offen offset:2048 sc1
    s_waitcnt vmcnt(23)
    v_mfma_f32_32x32x16_bf16 v[160:175], a[112:115], v[120:123], v[160:175]
    v_mfma_f32_32x32x16_bf16 v[176:191], a[116:119], v[120:123], v[176:191]
    s_waitcnt vmcnt(22)
    v_mfma_f32_32x32x16_bf16 v[160:175], a[120:123], v[124:127], v[160:175]
    v_mfma_f32_32x32x16_bf16 v[176:191], a[124:127], v[124:127], v[176:191]
    s_waitcnt vmcnt(21)
    v_mfma_f32_32x32x16_bf16 v[160:175], a[128:131], v[128:131], v[160:175]
    v_mfma_f32_32x32x16_bf16 v[176:191], a[132:135], v[128:131], v[176:191]
    s_waitcnt vmcnt(20)
    v_mfma_f32_32x32x16_bf16 v[160:175], a[136:139], v[132:135], v[160:175]
    v_mfma_f32_32x32x16_bf16 v[176:191], a[140:143], v[132:135], v[176:191]
    s_waitcnt vmcnt(19)
    v_mfma_f32_32x32x16_bf16 v[160:175], a[144:147], v[136:139], v[160:175]
    v_mfma_f32_32x32x16_bf16 v[176:191], a[148:151], v[136:139], v[176:191]
    s_waitcnt vmcnt(18)
    v_mfma_f32_32x32x16_bf16 v[160:175], a[152:155], v[140:143], v[160:175]
    v_mfma_f32_32x32x16_bf16 v[176:191], a[156:159], v[140:143], v[176:191]
    s_waitcnt vmcnt(17)
    v_mfma_f32_32x32x16_bf16 v[160:175], a[160:163], v[144:147], v[160:175]
    v_mfma_f32_32x32x16_bf16 v[176:191], a[164:167], v[144:147], v[176:191]
    s_waitcnt vmcnt(16)
    v_mfma_f32_32x32x16_bf16 v[160:175], a[168:171], v[148:151], v[160:175]
    v_mfma_f32_32x32x16_bf16 v[176:191], a[172:175], v[148:151], v[176:191]
    s_waitcnt vmcnt(15)
    v_mfma_f32_32x32x16_bf16 v[160:175], a[176:179], v[152:155], v[160:175]
    v_mfma_f32_32x32x16_bf16 v[176:191], a[180:183], v[152:155], v[176:191]
    s_waitcnt vmcnt(14)
    v_mfma_f32_32x32x16_bf16 v[160:175], a[184:187], v[156:159], v[160:175]
    v_mfma_f32_32x32x16_bf16 v[176:191], a[188:191], v[156:159], v[176:191]
    s_waitcnt vmcnt(13)
    v_mfma_f32_32x32x16_bf16 v[160:175], a[192:195], v[64:67], v[160:175]
    v_mfma_f32_32x32x16_bf16 v[176:191], a[196:199], v[64:67], v[176:191]
    s_waitcnt vmcnt(12)
    v_mfma_f32_32x32x16_bf16 v[160:175], a[200:203], v[68:71], v[160:175]
    v_mfma_f32_32x32x16_bf16 v[176:191], a[204:207], v[68:71], v[176:191]
    s_waitcnt vmcnt(11)
    v_mfma_f32_32x32x16_bf16 v[160:175], a[208:211], v[72:75], v[160:175]
    v_mfma_f32_32x32x16_bf16 v[176:191], a[212:215], v[72:75], v[176:191]
    s_waitcnt vmcnt(10)
    v_mfma_f32_32x32x16_bf16 v[160:175], a[216:219], v[76:79], v[160:175]
    v_mfma_f32_32x32x16_bf16 v[176:191], a[220:223], v[76:79], v[176:191]
    s_waitcnt vmcnt(9)
    v_mfma_f32_32x32x16_bf16 v[160:175], a[224:227], v[80:83], v[160:175]
    v_mfma_f32_32x32x16_bf16 v[176:191], a[228:231], v[80:83], v[176:191]
    s_waitcnt vmcnt(8)
    v_mfma_f32_32x32x16_bf16 v[160:175], a[232:235], v[84:87], v[160:175]
    v_mfma_f32_32x32x16_bf16 v[176:191], a[236:239], v[84:87], v[176:191]
    s_waitcnt vmcnt(7)
    v_mfma_f32_32x32x16_bf16 v[160:175], a[240:243], v[88:91], v[160:175]
    v_mfma_f32_32x32x16_bf16 v[176:191], a[244:247], v[88:91], v[176:191]
    s_waitcnt vmcnt(6)
    v_mfma_f32_32x32x16_bf16 v[160:175], a[248:251], v[92:95], v[160:175]
    v_mfma_f32_32x32x16_bf16 v[176:191], a[252:255], v[92:95], v[176:191]
    s_waitcnt vmcnt(5)
    v_mfma_f32_32x32x16_bf16 v[160:175], v[16:19], v[96:99], v[160:175]
    v_mfma_f32_32x32x16_bf16 v[176:191], v[20:23], v[96:99], v[176:191]
    s_waitcnt vmcnt(4)
    v_mfma_f32_32x32x16_bf16 v[160:175], v[24:27], v[100:103], v[160:175]
    v_mfma_f32_32x32x16_bf16 v[176:191], v[28:31], v[100:103], v[176:191]
    s_waitcnt vmcnt(3)
    v_mfma_f32_32x32x16_bf16 v[160:175], v[32:35], v[104:107], v[160:175]
    v_mfma_f32_32x32x16_bf16 v[176:191], v[36:39], v[104:107], v[176:191]
    s_waitcnt vmcnt(2)
    v_mfma_f32_32x32x16_bf16 v[160:175], v[40:43], v[108:111], v[160:175]
    v_mfma_f32_32x32x16_bf16 v[176:191], v[44:47], v[108:111], v[176:191]
    s_waitcnt vmcnt(1)
    v_mfma_f32_32x32x16_bf16 v[160:175], v[48:51], v[112:115], v[160:175]
    v_mfma_f32_32x32x16_bf16 v[176:191], v[52:55], v[112:115], v[176:191]
    s_waitcnt vmcnt(0)
    v_mfma_f32_32x32x16_bf16 v[160:175], v[56:59], v[116:119], v[160:175]
    v_mfma_f32_32x32x16_bf16 v[176:191], v[60:63], v[116:119], v[176:191]
    s_nop 11
    v_cndmask_b32 v224, v176, v160, s[56:57]
    v_cndmask_b32 v225, v177, v161, s[56:57]
    v_cndmask_b32 v226, v178, v162, s[56:57]
    v_cndmask_b32 v227, v179, v163, s[56:57]
    v_cndmask_b32 v228, v180, v164, s[56:57]
    v_cndmask_b32 v229, v181, v165, s[56:57]
    v_cndmask_b32 v230, v182, v166, s[56:57]
    v_cndmask_b32 v231, v183, v167, s[56:57]
    v_cndmask_b32 v232, v184, v168, s[56:57]
    v_cndmask_b32 v233, v185, v169, s[56:57]
    v_cndmask_b32 v234, v186, v170, s[56:57]
    v_cndmask_b32 v235, v187, v171, s[56:57]
    v_cndmask_b32 v236, v188, v172, s[56:57]
    v_cndmask_b32 v237, v189, v173, s[56:57]
    v_cndmask_b32 v238, v190, v174, s[56:57]
    v_cndmask_b32 v239, v191, v175, s[56:57]
    v_add_u32 v2, s54, v11
    ds_write_b128 v2, v[224:227] offset:0
    ds_write_b128 v2, v[228:231] offset:1024
    ds_write_b128 v2, v[232:235] offset:2048
    ds_write_b128 v2, v[236:239] offset:3072
    s_waitcnt lgkmcnt(0)
    s_barrier
    v_add_u32 v2, s54, v12
    ds_read_b128 v[192:195], v2 offset:0
    ds_read_b128 v[196:199], v2 offset:256
    ds_read_b128 v[200:203], v2 offset:4096
    ds_read_b128 v[204:207], v2 offset:4352
    ds_read_b128 v[208:211], v2 offset:8192
    ds_read_b128 v[212:215], v2 offset:8448
    ds_read_b128 v[216:219], v2 offset:12288
    ds_read_b128 v[220:223], v2 offset:12544
    s_waitcnt lgkmcnt(0)
    v_pk_add_f32 v[192:193], v[192:193], v[196:197]
    v_pk_add_f32 v[194:195], v[194:195], v[198:199]
    v_pk_add_f32 v[192:193], v[192:193], v[200:201]
    v_pk_add_f32 v[194:195], v[194:195], v[202:203]
    v_pk_add_f32 v[192:193], v[192:193], v[204:205]
    v_pk_add_f32 v[194:195], v[194:195], v[206:207]
    v_pk_add_f32 v[192:193], v[192:193], v[208:209]
    v_pk_add_f32 v[194:195], v[194:195], v[210:211]
    v_pk_add_f32 v[192:193], v[192:193], v[212:213]
    v_pk_add_f32 v[194:195], v[194:195], v[214:215]
    v_pk_add_f32 v[192:193], v[192:193], v[216:217]
    v_pk_add_f32 v[194:195], v[194:195], v[218:219]
    v_pk_add_f32 v[192:193], v[192:193], v[220:221]
    v_pk_add_f32 v[194:195], v[194:195], v[222:223]
    v_cvt_pk_bf16_f32 v244, v192, v193
    v_cvt_pk_bf16_f32 v245, v194, v195
    s_mul_i32 s30, s37, 40960
    buffer_store_dwordx2 v[244:245], v13, s[12:15], s30 offen
    s_xor_b32 s54, s54, 16384
    s_add_u32 s37, s37, 2
    s_cmp_lt_u32 s37, 64
    s_cbranch_scc1 L_o_tail
L_p3_end:
    s_waitcnt vmcnt(0)
L_end:
    s_endpgm
L_overfull:
L_fallback:
    s_waitcnt vmcnt(0) lgkmcnt(0)
L_fb_poll:
    v_and_b32 v240, 7, v0
    v_lshlrev_b32 v240, 2, v240
    global_load_dword v241, v240, s[28:29] sc1
    s_waitcnt vmcnt(0)
    v_readlane_b32 s4, v241, 0
    v_readlane_b32 s5, v241, 1
    v_readlane_b32 s6, v241, 2
    v_readlane_b32 s7, v241, 3
    v_readlane_b32 s80, v241, 4
    v_readlane_b32 s81, v241, 5
    v_readlane_b32 s82, v241, 6
    v_readlane_b32 s83, v241, 7
    s_add_u32 s78, s4, s5
    s_add_u32 s78, s78, s6
    s_add_u32 s78, s78, s7
    s_add_u32 s78, s78, s80
    s_add_u32 s78, s78, s81
    s_add_u32 s78, s78, s82
    s_add_u32 s78, s78, s83
    s_cmp_ge_u32 s78, 256
    s_cbranch_scc1 L_fb_full
    s_sleep 4
    s_sub_u32 s22, s22, 1
    s_cbranch_scc0 L_fb_poll
    s_branch L_timeout
L_fb_full:
    s_mov_b32 s78, s17
    s_cmp_gt_u32 s16, 0
    s_cselect_b32 s79, s4, 0
    s_add_u32 s78, s78, s79
    s_cmp_gt_u32 s16, 1
    s_cselect_b32 s79, s5, 0
    s_add_u32 s78, s78, s79
    s_cmp_gt_u32 s16, 2
    s_cselect_b32 s79, s6, 0
    s_add_u32 s78, s78, s79
    s_cmp_gt_u32 s16, 3
    s_cselect_b32 s79, s7, 0
    s_add_u32 s78, s78, s79
    s_cmp_gt_u32 s16, 4
    s_cselect_b32 s79, s80, 0
    s_add_u32 s78, s78, s79
    s_cmp_gt_u32 s16, 5
    s_cselect_b32 s79, s81, 0
    s_add_u32 s78, s78, s79
    s_cmp_gt_u32 s16, 6
    s_cselect_b32 s79, s82, 0
    s_add_u32 s78, s78, s79
    s_lshr_b32 s16, s78, 5
    s_and_b32 s17, s78, 31
    s_mov_b32 s3, 1
    s_barrier
    s_branch L_role
L_chain:
    s_lshr_b32 s30, s17, 2
    s_lshl_b32 s18, s16, 3
    s_add_u32 s18, s18, s30
    s_and_b32 s19, s17, 3
    s_mov_b32 s38, 0x3e0293ee
    s_mov_b32 s39, 0x3e0293ee
    v_and_b32 v20, 63, v0
    v_and_b32 v21, 15, v0
    v_bfe_u32 v22, v0, 4, 2
    v_and_b32 v26, 7, v21
    s_load_dwordx4 s[4:7], s[0:1], 16
    s_waitcnt lgkmcnt(0)
    v_lshrrev_b32 v23, 2, v20
    v_lshlrev_b32 v23, 13, v23
    v_and_b32 v24, 3, v20
    v_lshlrev_b32 v24, 4, v24
    v_add_u32 v23, v23, v24
    s_lshl_b32 s30, s18, 8
    s_lshl_b32 s31, s19, 6
    s_add_u32 s30, s30, s31
    v_add_u32 v23, s30, v23
    s_mov_b32 s12, s6
    s_and_b32 s13, s7, 0xffff
    s_mov_b32 s14, 5242880
    s_mov_b32 s15, 0x20000
    s_add_u32 s31, s19, 2
    s_and_b32 s31, s31, 3
    s_sub_u32 s31, s31, s19
    s_lshl_b32 s31, s31, 6
    v_add_u32 v27, s31, v23
    s_lshl_b32 s30, s20, 17
    s_lshl_b32 s31, s20, 10
    s_add_u32 s31, s31, 40960
    s_mov_b32 m0, s31
    s_add_u32 s31, s31, 4096
    buffer_load_dwordx4 v27, s[12:15], s30 offen lds
    s_add_u32 s30, s30, 524288
    s_mov_b32 m0, s31
    s_add_u32 s31, s31, 4096
    buffer_load_dwordx4 v27, s[12:15], s30 offen lds
    s_add_u32 s30, s30, 524288
    s_mov_b32 m0, s31
    s_add_u32 s31, s31, 4096
    buffer_load_dwordx4 v27, s[12:15], s30 offen lds
    s_add_u32 s30, s30, 524288
    s_mov_b32 m0, s31
    s_add_u32 s31, s31, 4096
    buffer_load_dwordx4 v27, s[12:15], s30 offen lds
    s_add_u32 s30, s30, 524288
    s_mov_b32 m0, s31
    s_add_u32 s31, s31, 4096
    buffer_load_dwordx4 v27, s[12:15], s30 offen lds
    s_add_u32 s30, s30, 524288
    s_mov_b32 m0, s31
    s_add_u32 s31, s31, 4096
    buffer_load_dwordx4 v27, s[12:15], s30 offen lds
    s_add_u32 s30, s30, 524288
    s_mov_b32 m0, s31
    s_add_u32 s31, s31, 4096
    buffer_load_dwordx4 v27, s[12:15], s30 offen lds
    s_add_u32 s30, s30, 524288
    s_mov_b32 m0, s31
    s_add_u32 s31, s31, 4096
    buffer_load_dwordx4 v27, s[12:15], s30 offen lds
    s_add_u32 s30, s30, 524288
    s_mov_b32 m0, s31
    s_add_u32 s31, s31, 4096
    buffer_load_dwordx4 v27, s[12:15], s30 offen lds
    s_add_u32 s30, s30, 524288
    s_mov_b32 m0, s31
    s_add_u32 s31, s31, 4096
    buffer_load_dwordx4 v27, s[12:15], s30 offen lds
    s_add_u32 s30, s30, 524288
    s_load_dwordx4 s[80:83], s[0:1], 32
    s_waitcnt lgkmcnt(0)
    s_mov_b32 s12, s80
    s_and_b32 s13, s81, 0xffff
    s_mov_b32 s14, 5242880
    s_mov_b32 s15, 0x20000
    s_add_u32 s31, s19, 1
    s_and_b32 s31, s31, 3
    s_sub_u32 s31, s31, s19
    s_lshl_b32 s31, s31, 6
    v_add_u32 v27, s31, v23
    s_lshl_b32 s30, s20, 17
    s_lshl_b32 s31, s20, 10
    s_add_u32 s31, s31, 81920
    s_mov_b32 m0, s31
    s_add_u32 s31, s31, 4096
    buffer_load_dwordx4 v27, s[12:15], s30 offen lds
    s_add_u32 s30, s30, 524288
    s_mov_b32 m0, s31
    s_add_u32 s31, s31, 4096
    buffer_load_dwordx4 v27, s[12:15], s30 offen lds
    s_add_u32 s30, s30, 524288
    s_mov_b32 m0, s31
    s_add_u32 s31, s31, 4096
    buffer_load_dwordx4 v27, s[12:15], s30 offen lds
    s_add_u32 s30, s30, 524288
    s_mov_b32 m0, s31
    s_add_u32 s31, s31, 4096
    buffer_load_dwordx4 v27, s[12:15], s30 offen lds
    s_add_u32 s30, s30, 524288
    s_mov_b32 m0, s31
    s_add_u32 s31, s31, 4096
    buffer_load_dwordx4 v27, s[12:15], s30 offen lds
    s_add_u32 s30, s30, 524288
    s_mov_b32 m0, s31
    s_add_u32 s31, s31, 4096
    buffer_load_dwordx4 v27, s[12:15], s30 offen lds
    s_add_u32 s30, s30, 524288
    s_mov_b32 m0, s31
    s_add_u32 s31, s31, 4096
    buffer_load_dwordx4 v27, s[12:15], s30 offen lds
    s_add_u32 s30, s30, 524288
    s_mov_b32 m0, s31
    s_add_u32 s31, s31, 4096
    buffer_load_dwordx4 v27, s[12:15], s30 offen lds
    s_add_u32 s30, s30, 524288
    s_mov_b32 m0, s31
    s_add_u32 s31, s31, 4096
    buffer_load_dwordx4 v27, s[12:15], s30 offen lds
    s_add_u32 s30, s30, 524288
    s_mov_b32 m0, s31
    s_add_u32 s31, s31, 4096
    buffer_load_dwordx4 v27, s[12:15], s30 offen lds
    s_add_u32 s30, s30, 524288
    s_mov_b32 s12, s4
    s_and_b32 s13, s5, 0xffff
    s_mov_b32 s14, 5242880
    s_mov_b32 s15, 0x20000
    s_add_u32 s31, s19, 0
    s_and_b32 s31, s31, 3
    s_sub_u32 s31, s31, s19
    s_lshl_b32 s31, s31, 6
    v_add_u32 v27, s31, v23
    s_lshl_b32 s30, s20, 17
    s_lshl_b32 s31, s20, 10
    s_add_u32 s31, s31, 0
    s_mov_b32 m0, s31
    s_add_u32 s31, s31, 4096
    buffer_load_dwordx4 v27, s[12:15], s30 offen lds
    s_add_u32 s30, s30, 524288
    s_mov_b32 m0, s31
    s_add_u32 s31, s31, 4096
    buffer_load_dwordx4 v27, s[12:15], s30 offen lds
    s_add_u32 s30, s30, 524288
    s_mov_b32 m0, s31
    s_add_u32 s31, s31, 4096
    buffer_load_dwordx4 v27, s[12:15], s30 offen lds
    s_add_u32 s30, s30, 524288
    s_mov_b32 m0, s31
    s_add_u32 s31, s31, 4096
    buffer_load_dwordx4 v27, s[12:15], s30 offen lds
    s_add_u32 s30, s30, 524288
    s_mov_b32 m0, s31
    s_add_u32 s31, s31, 4096
    buffer_load_dwordx4 v27, s[12:15], s30 offen lds
    s_add_u32 s30, s30, 524288
    s_mov_b32 m0, s31
    s_add_u32 s31, s31, 4096
    buffer_load_dwordx4 v27, s[12:15], s30 offen lds
    s_add_u32 s30, s30, 524288
    s_mov_b32 m0, s31
    s_add_u32 s31, s31, 4096
    buffer_load_dwordx4 v27, s[12:15], s30 offen lds
    s_add_u32 s30, s30, 524288
    s_mov_b32 m0, s31
    s_add_u32 s31, s31, 4096
    buffer_load_dwordx4 v27, s[12:15], s30 offen lds
    s_add_u32 s30, s30, 524288
    s_mov_b32 m0, s31
    s_add_u32 s31, s31, 4096
    buffer_load_dwordx4 v27, s[12:15], s30 offen lds
    s_add_u32 s30, s30, 524288
    s_mov_b32 m0, s31
    s_add_u32 s31, s31, 4096
    buffer_load_dwordx4 v27, s[12:15], s30 offen lds
    s_add_u32 s30, s30, 524288
    s_mov_b32 s12, s82
    s_and_b32 s13, s83, 0xffff
    s_mov_b32 s14, 5242880
    s_mov_b32 s15, 0x20000
    v_add_u32 v24, 0, v20
    v_mul_u32_u24 v25, 3277, v24
    v_lshrrev_b32 v25, 16, v25
    v_mul_u32_u24 v40, 20, v25
    v_sub_u32 v40, v24, v40
    v_lshlrev_b32 v40, 4, v40
    v_mul_u32_u24 v25, 1280, v25
    v_add_u32 v40, v40, v25
    v_add_u32 v24, 64, v20
    v_mul_u32_u24 v25, 3277, v24
    v_lshrrev_b32 v25, 16, v25
    v_mul_u32_u24 v41, 20, v25
    v_sub_u32 v41, v24, v41
    v_lshlrev_b32 v41, 4, v41
    v_mul_u32_u24 v25, 1280, v25
    v_add_u32 v41, v41, v25
    v_add_u32 v24, 128, v20
    v_mul_u32_u24 v25, 3277, v24
    v_lshrrev_b32 v25, 16, v25
    v_mul_u32_u24 v42, 20, v25
    v_sub_u32 v42, v24, v42
    v_lshlrev_b32 v42, 4, v42
    v_mul_u32_u24 v25, 1280, v25
    v_add_u32 v42, v42, v25
    v_add_u32 v24, 192, v20
    v_mul_u32_u24 v25, 3277, v24
    v_lshrrev_b32 v25, 16, v25
    v_mul_u32_u24 v43, 20, v25
    v_sub_u32 v43, v24, v43
    v_lshlrev_b32 v43, 4, v43
    v_mul_u32_u24 v25, 1280, v25
    v_add_u32 v43, v43, v25
    v_add_u32 v24, 256, v20
    v_mul_u32_u24 v25, 3277, v24
    v_lshrrev_b32 v25, 16, v25
    v_mul_u32_u24 v44, 20, v25
    v_sub_u32 v44, v24, v44
    v_lshlrev_b32 v44, 4, v44
    v_mul_u32_u24 v25, 1280, v25
    v_add_u32 v44, v44, v25
    s_mul_i32 s30, s18, 163840
    s_mul_i32 s31, s19, 320
    s_add_u32 s30, s30, s31
    s_mul_i32 s31, s20, 20480
    s_add_u32 s30, s30, s31
    s_mul_i32 s31, s20, 5120
    s_add_u32 s31, s31, 122880
    s_add_u32 m0, s31, 0
    s_add_u32 s32, s30, 0
    buffer_load_dwordx4 v40, s[12:15], s32 offen lds
    s_add_u32 m0, s31, 1024
    s_add_u32 s32, s30, 0
    buffer_load_dwordx4 v41, s[12:15], s32 offen lds
    s_add_u32 m0, s31, 2048
    s_add_u32 s32, s30, 0
    buffer_load_dwordx4 v42, s[12:15], s32 offen lds
    s_add_u32 m0, s31, 3072
    s_add_u32 s32, s30, 0
    buffer_load_dwordx4 v43, s[12:15], s32 offen lds
    s_add_u32 m0, s31, 4096
    s_add_u32 s32, s30, 0
    buffer_load_dwordx4 v44, s[12:15], s32 offen lds
    s_add_u32 m0, s31, 20480
    s_add_u32 s32, s30, 81920
    buffer_load_dwordx4 v40, s[12:15], s32 offen lds
    s_add_u32 m0, s31, 21504
    s_add_u32 s32, s30, 81920
    buffer_load_dwordx4 v41, s[12:15], s32 offen lds
    s_add_u32 m0, s31, 22528
    s_add_u32 s32, s30, 81920
    buffer_load_dwordx4 v42, s[12:15], s32 offen lds
    s_add_u32 m0, s31, 23552
    s_add_u32 s32, s30, 81920
    buffer_load_dwordx4 v43, s[12:15], s32 offen lds
    s_add_u32 m0, s31, 24576
    s_add_u32 s32, s30, 81920
    buffer_load_dwordx4 v44, s[12:15], s32 offen lds
    s_load_dwordx2 s[4:5], s[0:1], 8
    s_waitcnt lgkmcnt(0)
    s_mov_b32 s12, s4
    s_and_b32 s13, s5, 0xffff
    s_mov_b32 s14, 10240
    s_mov_b32 s15, 0x20000
    v_add_u32 v23, 0, v20
    v_cmp_le_u32 vcc, 80, v23
    v_subrev_u32 v24, 80, v23
    s_nop 0
    v_cndmask_b32 v23, v23, v24, vcc
    v_cndmask_b32 v24, 0, 1, vcc
    s_lshl_b32 s30, s20, 1
    v_add_u32 v24, s30, v24
    v_lshlrev_b32 v23, 4, v23
    v_mul_u32_u24 v25, 1280, v24
    v_add_u32 v25, v25, v23
    buffer_load_dwordx4 v[128:131], v25, s[12:15], 0 offen
    v_add_u32 v143, 128, v23
    v_cmp_le_u32 vcc, 640, v23
    v_mul_u32_u24 v24, 1568, v24
    s_nop 0
    v_cndmask_b32 v23, v23, v143, vcc
    v_add_u32 v140, v24, v23
    v_add_u32 v140, 65536, v140
    v_add_u32 v23, 64, v20
    v_cmp_le_u32 vcc, 80, v23
    v_subrev_u32 v24, 80, v23
    s_nop 0
    v_cndmask_b32 v23, v23, v24, vcc
    v_cndmask_b32 v24, 0, 1, vcc
    s_lshl_b32 s30, s20, 1
    v_add_u32 v24, s30, v24
    v_lshlrev_b32 v23, 4, v23
    v_mul_u32_u24 v25, 1280, v24
    v_add_u32 v25, v25, v23
    buffer_load_dwordx4 v[132:135], v25, s[12:15], 0 offen
    v_add_u32 v143, 128, v23
    v_cmp_le_u32 vcc, 640, v23
    v_mul_u32_u24 v24, 1568, v24
    s_nop 0
    v_cndmask_b32 v23, v23, v143, vcc
    v_add_u32 v141, v24, v23
    v_add_u32 v141, 65536, v141
    v_add_u32 v23, 128, v20
    v_cmp_le_u32 vcc, 160, v23
    v_subrev_u32 v24, 32, v23
    s_nop 0
    v_cndmask_b32 v23, v23, v24, vcc
    v_cmp_le_u32 vcc, 80, v23
    v_subrev_u32 v24, 80, v23
    s_nop 0
    v_cndmask_b32 v23, v23, v24, vcc
    v_cndmask_b32 v24, 0, 1, vcc
    s_lshl_b32 s30, s20, 1
    v_add_u32 v24, s30, v24
    v_lshlrev_b32 v23, 4, v23
    v_mul_u32_u24 v25, 1280, v24
    v_add_u32 v25, v25, v23
    buffer_load_dwordx4 v[136:139], v25, s[12:15], 0 offen
    v_add_u32 v143, 128, v23
    v_cmp_le_u32 vcc, 640, v23
    v_mul_u32_u24 v24, 1568, v24
    s_nop 0
    v_cndmask_b32 v23, v23, v143, vcc
    v_add_u32 v142, v24, v23
    v_add_u32 v142, 65536, v142
    v_cmp_gt_u32 s[76:77], 8, v21
    v_mov_b32 v25, 1073741824
    s_lshr_b32 s31, s20, 1
    s_lshl_b32 s30, s31, 11
    s_lshl_b32 s31, s19, 9
    s_add_u32 s30, s30, s31
    s_and_b32 s31, s20, 1
    s_lshl_b32 s31, s31, 8
    s_add_u32 s30, s30, s31
    v_lshlrev_b32 v48, 5, v26
    v_lshl_add_u32 v48, v22, 3, v48
    v_add_u32 v48, s30, v48
    s_lshr_b32 s30, s18, 1
    s_lshl_b32 s30, s30, 14
    s_and_b32 s31, s18, 1
    s_lshl_b32 s31, s31, 12
    s_add_u32 s68, s30, s31
    s_add_u32 s30, s19, 2
    s_and_b32 s30, s30, 3
    s_sub_u32 s30, s30, s19
    s_lshl_b32 s30, s30, 9
    s_cmp_ge_u32 s20, 2
    s_cselect_b32 s30, s30, 0
    s_add_u32 s30, s30, s68
    v_add_u32 v23, s30, v48
    v_cndmask_b32 v1, v25, v23, s[76:77]
    s_cmp_ge_u32 s20, 2
    s_cselect_b64 s[72:73], -1, 0
    s_xor_b64 s[72:73], s[72:73], s[76:77]
    s_add_u32 s30, s19, 1
    s_and_b32 s30, s30, 3
    s_sub_u32 s30, s30, s19
    s_lshl_b32 s30, s30, 9
    s_add_u32 s30, s30, s68
    v_add_u32 v23, s30, v48
    v_add_u32 v23, 1048576, v23
    v_cndmask_b32 v2, v25, v23, s[72:73]
    v_lshlrev_b32 v23, 4, v20
    v_cmp_gt_u32 vcc, 32, v20
    s_lshl_b32 s30, s19, 9
    s_lshl_b32 s31, s18, 11
    s_add_u32 s31, s31, s30
    v_add_u32 v24, s31, v23
    v_cndmask_b32 v80, v25, v24, vcc
    s_add_u32 s31, s68, s30
    s_add_u32 s31, s31, 2048
    v_add_u32 v24, s31, v23
    v_cndmask_b32 v83, v25, v24, vcc
    s_lshl_b32 s30, s19, 10
    s_lshl_b32 s31, s18, 12
    s_add_u32 s31, s31, s30
    v_add_u32 v81, s31, v23
    s_add_u32 s31, s68, s30
    s_add_u32 s31, s31, 1048576
    v_add_u32 v98, s31, v23
    s_lshl_b32 s31, s20, 10
    s_add_u32 s30, s68, s31
    v_add_u32 v3, s30, v23
    s_add_u32 s31, s31, 81920
    v_add_u32 v17, s31, v23
    v_lshrrev_b32 v23, 3, v21
    v_lshlrev_b32 v23, 11, v23
    v_lshrrev_b32 v24, 1, v22
    v_lshl_add_u32 v23, v24, 8, v23
    v_lshl_add_u32 v23, v26, 5, v23
    v_and_b32 v24, 1, v22
    v_lshl_add_u32 v23, v24, 4, v23
    v_add_u32 v18, 81920, v23
    v_and_b32 v19, 2047, v23
    v_add_u32 v19, 83968, v19
    s_add_u32 s30, s68, 1048576
    v_add_u32 v4, s30, v23
    s_mul_i32 s30, s18, 10240
    s_mul_i32 s31, s19, 2560
    s_add_u32 s30, s30, s31
    s_lshl_b32 s31, s20, 9
    s_add_u32 s31, s31, s30
    v_lshlrev_b32 v23, 6, v21
    v_lshl_add_u32 v23, v22, 4, v23
    v_add_u32 v23, s31, v23
    v_lshrrev_b32 v24, 13, v23
    v_lshlrev_b32 v24, 14, v24
    v_and_b32 v23, 8191, v23
    v_add_u32 v23, v23, v24
    v_cndmask_b32 v5, v25, v23, s[76:77]
    s_lshl_b32 s31, s20, 8
    s_add_u32 s31, s31, 2048
    s_add_u32 s31, s31, s30
    v_lshlrev_b32 v23, 5, v21
    v_lshl_add_u32 v23, v22, 3, v23
    v_add_u32 v23, s31, v23
    v_lshrrev_b32 v24, 13, v23
    v_lshlrev_b32 v24, 14, v24
    v_and_b32 v23, 8191, v23
    v_add_u32 v23, v23, v24
    s_cmp_lt_u32 s20, 2
    s_cselect_b64 s[32:33], s[76:77], 0
    v_cndmask_b32 v6, v25, v23, s[32:33]
    s_lshl_b32 s30, s20, 5
    s_add_u32 s30, s30, s17
    s_cmp_lt_u32 s30, 80
    s_cselect_b32 s23, 1, 0
    s_cselect_b32 s30, s30, 0
    s_lshl_b32 s31, s30, 7
    s_cmp_eq_u32 s23, 1
    s_cselect_b64 s[72:73], -1, 0
    v_add_u32 v23, 0, v22
    s_lshl_b32 s32, s16, 3
    v_add_u32 v23, s32, v23
    v_mul_u32_u24 v23, 10240, v23
    v_lshl_add_u32 v23, v21, 3, v23
    v_add_u32 v23, s31, v23
    v_lshrrev_b32 v24, 13, v23
    v_lshlrev_b32 v24, 14, v24
    v_and_b32 v23, 8191, v23
    v_add_u32 v23, v23, v24
    v_cndmask_b32 v7, v25, v23, s[72:73]
    v_add_u32 v23, 4, v22
    s_lshl_b32 s32, s16, 3
    v_add_u32 v23, s32, v23
    v_mul_u32_u24 v23, 10240, v23
    v_lshl_add_u32 v23, v21, 3, v23
    v_add_u32 v23, s31, v23
    v_lshrrev_b32 v24, 13, v23
    v_lshlrev_b32 v24, 14, v24
    v_and_b32 v23, 8191, v23
    v_add_u32 v23, v23, v24
    v_cndmask_b32 v8, v25, v23, s[72:73]
    v_cmp_eq_u32 vcc, 0, v22
    s_nop 3
    s_and_b64 s[72:73], s[72:73], vcc
    s_mul_i32 s32, s16, 10240
    s_add_u32 s32, s32, s31
    v_lshlrev_b32 v23, 3, v21
    v_add_u32 v23, s32, v23
    v_lshrrev_b32 v24, 13, v23
    v_lshlrev_b32 v24, 14, v24
    v_and_b32 v23, 8191, v23
    v_add_u32 v23, v23, v24
    v_cndmask_b32 v9, v25, v23, s[72:73]
    s_add_u32 s32, s16, 0
    s_and_b32 s32, s32, 3
    s_mul_i32 s32, s32, 20480
    s_lshl_b32 s33, s31, 1
    s_add_u32 s32, s32, s33
    v_lshlrev_b32 v23, 4, v21
    v_add_u32 v23, s32, v23
    v_lshrrev_b32 v24, 13, v23
    v_lshlrev_b32 v24, 14, v24
    v_and_b32 v23, 8191, v23
    v_add_u32 v23, v23, v24
    v_cndmask_b32 v82, v25, v23, s[72:73]
    s_add_u32 s32, s16, 1
    s_and_b32 s32, s32, 3
    s_mul_i32 s32, s32, 20480
    s_lshl_b32 s33, s31, 1
    s_add_u32 s32, s32, s33
    v_lshlrev_b32 v23, 4, v21
    v_add_u32 v23, s32, v23
    v_lshrrev_b32 v24, 13, v23
    v_lshlrev_b32 v24, 14, v24
    v_and_b32 v23, 8191, v23
    v_add_u32 v23, v23, v24
    v_cndmask_b32 v104, v25, v23, s[72:73]
    s_add_u32 s32, s16, 2
    s_and_b32 s32, s32, 3
    s_mul_i32 s32, s32, 20480
    s_lshl_b32 s33, s31, 1
    s_add_u32 s32, s32, s33
    v_lshlrev_b32 v23, 4, v21
    v_add_u32 v23, s32, v23
    v_lshrrev_b32 v24, 13, v23
    v_lshlrev_b32 v24, 14, v24
    v_and_b32 v23, 8191, v23
    v_add_u32 v23, v23, v24
    v_cndmask_b32 v105, v25, v23, s[72:73]
    s_add_u32 s32, s16, 3
    s_and_b32 s32, s32, 3
    s_mul_i32 s32, s32, 20480
    s_lshl_b32 s33, s31, 1
    s_add_u32 s32, s32, s33
    v_lshlrev_b32 v23, 4, v21
    v_add_u32 v23, s32, v23
    v_lshrrev_b32 v24, 13, v23
    v_lshlrev_b32 v24, 14, v24
    v_and_b32 v23, 8191, v23
    v_add_u32 v23, v23, v24
    v_cndmask_b32 v106, v25, v23, s[72:73]
    v_mov_b32 v99, 0
    v_lshlrev_b32 v23, 5, v22
    v_add_u32 v23, s17, v23
    v_cmp_gt_u32 vcc, 80, v23
    v_lshlrev_b32 v23, 8, v23
    v_lshl_add_u32 v23, v21, 4, v23
    s_mul_i32 s32, s16, 20480
    v_add_u32 v23, s32, v23
    v_lshrrev_b32 v24, 13, v23
    v_lshlrev_b32 v24, 14, v24
    v_and_b32 v23, 8191, v23
    v_add_u32 v23, v23, v24
    s_cmp_eq_u32 s20, 3
    s_cselect_b64 s[32:33], vcc, 0
    v_cndmask_b32 v107, v25, v23, s[32:33]
    s_mul_i32 s30, s20, 160
    s_add_u32 s30, s30, 0
    v_add_u32 v48, s30, v20
    s_mul_i32 s30, s16, 10240
    v_lshlrev_b32 v10, 4, v48
    v_add_u32 v10, s30, v10
    v_lshrrev_b32 v24, 13, v10
    v_lshlrev_b32 v24, 14, v24
    v_and_b32 v10, 8191, v10
    v_add_u32 v10, v10, v24
    v_lshrrev_b32 v49, 3, v48
    v_and_b32 v50, 7, v48
    v_mul_u32_u24 v23, 3277, v49
    v_lshrrev_b32 v23, 16, v23
    v_mul_u32_u24 v24, 20, v23
    v_sub_u32 v49, v49, v24
    v_mul_u32_u24 v52, 160, v23
    v_and_b32 v23, 3, v49
    v_lshlrev_b32 v23, 1, v23
    v_lshrrev_b32 v24, 2, v50
    v_add_u32 v51, v23, v24
    v_lshrrev_b32 v23, 2, v49
    v_lshlrev_b32 v23, 5, v23
    v_and_b32 v24, 3, v50
    v_lshl_add_u32 v23, v24, 3, v23
    v_subrev_u32 v53, 16, v49
    v_and_b32 v54, 1, v53
    v_lshlrev_b32 v54, 2, v54
    v_lshrrev_b32 v24, 1, v50
    v_add_u32 v54, v54, v24
    v_lshrrev_b32 v55, 1, v53
    v_lshlrev_b32 v55, 4, v55
    v_and_b32 v24, 1, v50
    v_lshl_add_u32 v55, v24, 3, v55
    v_add_u32 v55, 128, v55
    v_cmp_le_u32 vcc, 16, v49
    s_nop 1
    v_cndmask_b32 v51, v51, v54, vcc
    v_cndmask_b32 v23, v23, v55, vcc
    v_add_u32 v52, v52, v23
    v_lshlrev_b32 v23, 1, v52
    v_add_u32 v24, 128, v23
    v_cmp_le_u32 vcc, 320, v52
    v_mul_u32_u24 v51, 1568, v51
    s_nop 0
    v_cndmask_b32 v23, v23, v24, vcc
    v_add_u32 v100, v51, v23
    v_add_u32 v100, 65536, v100
    s_mul_i32 s30, s20, 160
    s_add_u32 s30, s30, 64
    v_add_u32 v48, s30, v20
    s_mul_i32 s30, s16, 10240
    v_lshlrev_b32 v11, 4, v48
    v_add_u32 v11, s30, v11
    v_lshrrev_b32 v24, 13, v11
    v_lshlrev_b32 v24, 14, v24
    v_and_b32 v11, 8191, v11
    v_add_u32 v11, v11, v24
    v_lshrrev_b32 v49, 3, v48
    v_and_b32 v50, 7, v48
    v_mul_u32_u24 v23, 3277, v49
    v_lshrrev_b32 v23, 16, v23
    v_mul_u32_u24 v24, 20, v23
    v_sub_u32 v49, v49, v24
    v_mul_u32_u24 v52, 160, v23
    v_and_b32 v23, 3, v49
    v_lshlrev_b32 v23, 1, v23
    v_lshrrev_b32 v24, 2, v50
    v_add_u32 v51, v23, v24
    v_lshrrev_b32 v23, 2, v49
    v_lshlrev_b32 v23, 5, v23
    v_and_b32 v24, 3, v50
    v_lshl_add_u32 v23, v24, 3, v23
    v_subrev_u32 v53, 16, v49
    v_and_b32 v54, 1, v53
    v_lshlrev_b32 v54, 2, v54
    v_lshrrev_b32 v24, 1, v50
    v_add_u32 v54, v54, v24
    v_lshrrev_b32 v55, 1, v53
    v_lshlrev_b32 v55, 4, v55
    v_and_b32 v24, 1, v50
    v_lshl_add_u32 v55, v24, 3, v55
    v_add_u32 v55, 128, v55
    v_cmp_le_u32 vcc, 16, v49
    s_nop 1
    v_cndmask_b32 v51, v51, v54, vcc
    v_cndmask_b32 v23, v23, v55, vcc
    v_add_u32 v52, v52, v23
    v_lshlrev_b32 v23, 1, v52
    v_add_u32 v24, 128, v23
    v_cmp_le_u32 vcc, 320, v52
    v_mul_u32_u24 v51, 1568, v51
    s_nop 0
    v_cndmask_b32 v23, v23, v24, vcc
    v_add_u32 v101, v51, v23
    v_add_u32 v101, 65536, v101
    s_mul_i32 s30, s20, 160
    s_add_u32 s30, s30, 128
    v_add_u32 v48, s30, v20
    v_cmp_le_u32 vcc, 32, v20
    v_subrev_u32 v24, 32, v48
    s_nop 0
    v_cndmask_b32 v48, v48, v24, vcc
    s_mul_i32 s30, s16, 10240
    v_lshlrev_b32 v12, 4, v48
    v_add_u32 v12, s30, v12
    v_lshrrev_b32 v24, 13, v12
    v_lshlrev_b32 v24, 14, v24
    v_and_b32 v12, 8191, v12
    v_add_u32 v12, v12, v24
    v_lshrrev_b32 v49, 3, v48
    v_and_b32 v50, 7, v48
    v_mul_u32_u24 v23, 3277, v49
    v_lshrrev_b32 v23, 16, v23
    v_mul_u32_u24 v24, 20, v23
    v_sub_u32 v49, v49, v24
    v_mul_u32_u24 v52, 160, v23
    v_and_b32 v23, 3, v49
    v_lshlrev_b32 v23, 1, v23
    v_lshrrev_b32 v24, 2, v50
    v_add_u32 v51, v23, v24
    v_lshrrev_b32 v23, 2, v49
    v_lshlrev_b32 v23, 5, v23
    v_and_b32 v24, 3, v50
    v_lshl_add_u32 v23, v24, 3, v23
    v_subrev_u32 v53, 16, v49
    v_and_b32 v54, 1, v53
    v_lshlrev_b32 v54, 2, v54
    v_lshrrev_b32 v24, 1, v50
    v_add_u32 v54, v54, v24
    v_lshrrev_b32 v55, 1, v53
    v_lshlrev_b32 v55, 4, v55
    v_and_b32 v24, 1, v50
    v_lshl_add_u32 v55, v24, 3, v55
    v_add_u32 v55, 128, v55
    v_cmp_le_u32 vcc, 16, v49
    s_nop 1
    v_cndmask_b32 v51, v51, v54, vcc
    v_cndmask_b32 v23, v23, v55, vcc
    v_add_u32 v52, v52, v23
    v_lshlrev_b32 v23, 1, v52
    v_add_u32 v24, 128, v23
    v_cmp_le_u32 vcc, 320, v52
    v_mul_u32_u24 v51, 1568, v51
    s_nop 0
    v_cndmask_b32 v23, v23, v24, vcc
    v_add_u32 v102, v51, v23
    v_add_u32 v102, 65536, v102
    v_mul_u32_u24 v23, 1568, v26
    v_lshrrev_b32 v24, 3, v21
    v_mul_u32_u24 v24, 768, v24
    v_add_u32 v23, v23, v24
    v_lshl_add_u32 v16, v22, 4, v23
    v_add_u32 v16, 65536, v16
    v_lshrrev_b32 v23, 1, v22
    v_lshlrev_b32 v23, 10, v23
    v_and_b32 v24, 1, v22
    v_lshl_add_u32 v23, v24, 9, v23
    v_lshl_add_u32 v36, v21, 4, v23
    v_lshlrev_b32 v96, 4, v20
    v_lshlrev_b32 v23, 12, v20
    s_lshl_b32 s30, s18, 7
    v_add_u32 v23, s30, v23
    v_cmp_gt_u32 vcc, 2, v20
    v_mov_b32 v24, 1073741824
    s_nop 0
    v_cndmask_b32 v37, v24, v23, vcc
    s_lshl_b32 s30, s18, 2
    s_add_u32 s30, s30, s19
    s_lshl_b32 s30, s30, 7
    v_mov_b32 v23, s30
    v_cmp_eq_u32 vcc, 192, v0
    s_nop 1
    v_cndmask_b32 v38, v24, v23, vcc
    v_mov_b32 v28, -1
    v_mov_b32 v29, -1
    v_mov_b32 v30, -1
    v_mov_b32 v31, -1
    v_mov_b32 v32, 0
    v_mov_b32 v33, 0
    v_cmp_eq_u32 vcc, 0, v21
    v_mov_b32 v23, 0x3f80
    s_nop 0
    v_cndmask_b32 v32, v32, v23, vcc
    v_cmp_eq_u32 vcc, 1, v21
    v_mov_b32 v23, 0x3f800000
    s_nop 0
    v_cndmask_b32 v32, v32, v23, vcc
    v_cmp_eq_u32 vcc, 2, v21
    v_mov_b32 v23, 0x3f80
    s_nop 0
    v_cndmask_b32 v33, v33, v23, vcc
    v_cmp_eq_u32 vcc, 3, v21
    v_mov_b32 v23, 0x3f800000
    s_nop 0
    v_cndmask_b32 v33, v33, v23, vcc
    v_mov_b32 v34, v32
    v_mov_b32 v35, v33
    v_mov_b32 v218, 0
    v_mov_b32 v219, 0
    v_mov_b32 v222, 0
    v_mov_b32 v223, 0
    v_mov_b32 v226, 0
    v_mov_b32 v227, 0
    v_mov_b32 v234, 0
    v_mov_b32 v235, 0
    v_mov_b32 v23, 0x3f803f80
    v_mov_b32 v24, 0x3f003f00
    v_accvgpr_write_b32 a168, v23
    v_accvgpr_write_b32 a172, v24
    v_accvgpr_write_b32 a169, v23
    v_accvgpr_write_b32 a173, v24
    v_accvgpr_write_b32 a170, v23
    v_accvgpr_write_b32 a174, v24
    v_accvgpr_write_b32 a171, v23
    v_accvgpr_write_b32 a175, v24
    v_mov_b32 v39, 0
    s_mov_b32 s30, 105922560
    buffer_store_dword v39, v38, s[8:11], s30 offen sc1
    s_mov_b32 s30, 83886080
    buffer_store_dwordx2 v[28:29], v1, s[8:11], s30 offen sc1
    buffer_store_dwordx2 v[28:29], v2, s[8:11], s30 offen sc1
    s_mov_b32 s30, 85983232
    buffer_store_dwordx4 v[28:31], v5, s[8:11], s30 offen sc1
    buffer_store_dwordx2 v[28:29], v6, s[8:11], s30 offen sc1
    s_mov_b32 s30, 88735744
    buffer_store_dwordx2 v[28:29], v9, s[8:11], s30 offen sc1
    s_mov_b32 s30, 89063424
    buffer_store_dwordx4 v[28:31], v82, s[8:11], s30 offen sc1
    s_mov_b32 s30, 89071616
    buffer_store_dwordx4 v[28:31], v82, s[8:11], s30 offen sc1
    s_mov_b32 s30, 84148224
    buffer_store_dwordx2 v[28:29], v1, s[8:11], s30 offen sc1
    buffer_store_dwordx2 v[28:29], v2, s[8:11], s30 offen sc1
    s_mov_b32 s30, 86638592
    buffer_store_dwordx4 v[28:31], v5, s[8:11], s30 offen sc1
    buffer_store_dwordx2 v[28:29], v6, s[8:11], s30 offen sc1
    s_mov_b32 s30, 88817664
    buffer_store_dwordx2 v[28:29], v9, s[8:11], s30 offen sc1
    s_mov_b32 s30, 89227264
    buffer_store_dwordx4 v[28:31], v82, s[8:11], s30 offen sc1
    s_mov_b32 s30, 89235456
    buffer_store_dwordx4 v[28:31], v82, s[8:11], s30 offen sc1
    s_waitcnt vmcnt(30)
    s_mov_b32 s30, 84410368
    buffer_store_dwordx2 v[28:29], v1, s[8:11], s30 offen sc1
    buffer_store_dwordx2 v[28:29], v2, s[8:11], s30 offen sc1
    s_mov_b32 s30, 87293952
    buffer_store_dwordx4 v[28:31], v5, s[8:11], s30 offen sc1
    buffer_store_dwordx2 v[28:29], v6, s[8:11], s30 offen sc1
    s_mov_b32 s30, 88899584
    buffer_store_dwordx2 v[28:29], v9, s[8:11], s30 offen sc1
    s_mov_b32 s30, 89391104
    buffer_store_dwordx4 v[28:31], v82, s[8:11], s30 offen sc1
    s_mov_b32 s30, 89399296
    buffer_store_dwordx4 v[28:31], v82, s[8:11], s30 offen sc1
    s_mov_b32 s30, 84672512
    buffer_store_dwordx2 v[28:29], v1, s[8:11], s30 offen sc1
    buffer_store_dwordx2 v[28:29], v2, s[8:11], s30 offen sc1
    s_mov_b32 s30, 88080384
    buffer_store_dwordx4 v[28:31], v5, s[8:11], s30 offen sc1
    buffer_store_dwordx2 v[28:29], v6, s[8:11], s30 offen sc1
    s_mov_b32 s30, 88981504
    buffer_store_dwordx2 v[28:29], v9, s[8:11], s30 offen sc1
    s_mov_b32 s30, 89554944
    buffer_store_dwordx4 v[28:31], v82, s[8:11], s30 offen sc1
    s_mov_b32 s30, 89563136
    buffer_store_dwordx4 v[28:31], v82, s[8:11], s30 offen sc1
    s_waitcnt vmcnt(6)
    s_cmp_lg_u32 s20, 0
    s_cbranch_scc1 L_vic
    v_and_b32 v240, 7, v0
    v_lshlrev_b32 v240, 2, v240
    global_load_dword v241, v240, s[28:29] sc1
L_vic:
    s_waitcnt vmcnt(0)
    s_barrier
    s_cmp_lg_u32 s20, 0
    s_cbranch_scc1 L_c_arrived
    s_mov_b32 s79, 0
    s_cmp_eq_u32 s3, 1
    s_cbranch_scc1 L_vdc_ok
L_vdc:
    v_readlane_b32 s4, v241, 0
    v_readlane_b32 s5, v241, 1
    v_readlane_b32 s6, v241, 2
    v_readlane_b32 s7, v241, 3
    v_readlane_b32 s80, v241, 4
    v_readlane_b32 s81, v241, 5
    v_readlane_b32 s82, v241, 6
    v_readlane_b32 s83, v241, 7
    s_add_u32 s78, s4, s5
    s_add_u32 s78, s78, s6
    s_add_u32 s78, s78, s7
    s_add_u32 s78, s78, s80
    s_add_u32 s78, s78, s81
    s_add_u32 s78, s78, s82
    s_add_u32 s78, s78, s83
    s_cmp_ge_u32 s78, 256
    s_cbranch_scc1 L_vdc_full
    s_sleep 16
    v_and_b32 v240, 7, v0
    v_lshlrev_b32 v240, 2, v240
    global_load_dword v241, v240, s[28:29] sc1
    s_waitcnt vmcnt(0)
    s_sub_u32 s22, s22, 1
    s_cbranch_scc0 L_vdc
    s_branch L_timeout
L_vdc_full:
    s_cmp_lg_u32 s4, 32
    s_cselect_b32 s79, 1, s79
    s_cmp_lg_u32 s5, 32
    s_cselect_b32 s79, 1, s79
    s_cmp_lg_u32 s6, 32
    s_cselect_b32 s79, 1, s79
    s_cmp_lg_u32 s7, 32
    s_cselect_b32 s79, 1, s79
    s_cmp_lg_u32 s80, 32
    s_cselect_b32 s79, 1, s79
    s_cmp_lg_u32 s81, 32
    s_cselect_b32 s79, 1, s79
    s_cmp_lg_u32 s82, 32
    s_cselect_b32 s79, 1, s79
    s_cmp_lg_u32 s83, 32
    s_cselect_b32 s79, 1, s79
L_vdc_ok:
    s_cmp_lg_u32 s79, 0
    s_cbranch_scc1 L_c_arrived
    v_mov_b32 v238, 192
    v_mov_b32 v239, 1
    s_mov_b64 exec, 1
    global_atomic_add v239, v238, v239, s[28:29] sc0
    s_mov_b64 exec, -1
L_c_arrived:
    v_bfe_u32 v26, v20, 2, 2
    v_and_b32 v27, 3, v20
    v_lshl_add_u32 v23, v22, 3, v26
    v_lshlrev_b32 v23, 6, v23
    v_lshl_add_u32 v23, v27, 3, v23
    s_and_b32 s30, s20, 1
    s_lshl_b32 s30, s30, 5
    v_add_u32 v23, s30, v23
    s_lshr_b32 s31, s20, 1
    s_mul_i32 s32, s31, 40960
    v_add_u32 v24, s32, v23
    ds_read_b64_tr_b16 a[0:1], v24 offset:0
    ds_read_b64_tr_b16 a[2:3], v24 offset:256
    ds_read_b64_tr_b16 a[4:5], v24 offset:2048
    ds_read_b64_tr_b16 a[6:7], v24 offset:2304
    ds_read_b64_tr_b16 a[8:9], v24 offset:4096
    ds_read_b64_tr_b16 a[10:11], v24 offset:4352
    ds_read_b64_tr_b16 a[12:13], v24 offset:6144
    ds_read_b64_tr_b16 a[14:15], v24 offset:6400
    s_waitcnt lgkmcnt(0)
    ds_read_b64_tr_b16 a[16:17], v24 offset:8192
    ds_read_b64_tr_b16 a[18:19], v24 offset:8448
    ds_read_b64_tr_b16 a[20:21], v24 offset:10240
    ds_read_b64_tr_b16 a[22:23], v24 offset:10496
    ds_read_b64_tr_b16 a[24:25], v24 offset:12288
    ds_read_b64_tr_b16 a[26:27], v24 offset:12544
    ds_read_b64_tr_b16 a[28:29], v24 offset:14336
    ds_read_b64_tr_b16 a[30:31], v24 offset:14592
    s_waitcnt lgkmcnt(0)
    ds_read_b64_tr_b16 a[32:33], v24 offset:16384
    ds_read_b64_tr_b16 a[34:35], v24 offset:16640
    ds_read_b64_tr_b16 a[36:37], v24 offset:18432
    ds_read_b64_tr_b16 a[38:39], v24 offset:18688
    ds_read_b64_tr_b16 a[40:41], v24 offset:20480
    ds_read_b64_tr_b16 a[42:43], v24 offset:20736
    ds_read_b64_tr_b16 a[44:45], v24 offset:22528
    ds_read_b64_tr_b16 a[46:47], v24 offset:22784
    s_waitcnt lgkmcnt(0)
    ds_read_b64_tr_b16 a[48:49], v24 offset:24576
    ds_read_b64_tr_b16 a[50:51], v24 offset:24832
    ds_read_b64_tr_b16 a[52:53], v24 offset:26624
    ds_read_b64_tr_b16 a[54:55], v24 offset:26880
    ds_read_b64_tr_b16 a[56:57], v24 offset:28672
    ds_read_b64_tr_b16 a[58:59], v24 offset:28928
    ds_read_b64_tr_b16 a[60:61], v24 offset:30720
    ds_read_b64_tr_b16 a[62:63], v24 offset:30976
    s_waitcnt lgkmcnt(0)
    ds_read_b64_tr_b16 a[64:65], v24 offset:32768
    ds_read_b64_tr_b16 a[66:67], v24 offset:33024
    ds_read_b64_tr_b16 a[68:69], v24 offset:34816
    ds_read_b64_tr_b16 a[70:71], v24 offset:35072
    ds_read_b64_tr_b16 a[72:73], v24 offset:36864
    ds_read_b64_tr_b16 a[74:75], v24 offset:37120
    ds_read_b64_tr_b16 a[76:77], v24 offset:38912
    ds_read_b64_tr_b16 a[78:79], v24 offset:39168
    s_waitcnt lgkmcnt(0)
    s_cmp_lg_u32 s20, 0
    s_cbranch_scc1 L_afc
    s_cmp_lg_u32 s79, 0
    s_cbranch_scc1 L_afc
    s_waitcnt vmcnt(0)
    v_readfirstlane_b32 s78, v239
    s_cmp_lg_u32 s78, 255
    s_cbranch_scc1 L_afc
    v_mov_b32 v238, 96
    v_mov_b32 v239, 1
    global_store_dword v238, v239, s[28:29] sc1
L_afc:
    s_lshr_b32 s31, s20, 1
    s_mul_i32 s33, s31, 20480
    s_add_u32 s33, s33, 81920
    v_add_u32 v24, s33, v23
    ds_read_b64_tr_b16 a[80:81], v24 offset:0
    ds_read_b64_tr_b16 a[82:83], v24 offset:256
    ds_read_b64_tr_b16 a[84:85], v24 offset:2048
    ds_read_b64_tr_b16 a[86:87], v24 offset:2304
    ds_read_b64_tr_b16 a[88:89], v24 offset:4096
    ds_read_b64_tr_b16 a[90:91], v24 offset:4352
    ds_read_b64_tr_b16 a[92:93], v24 offset:6144
    ds_read_b64_tr_b16 a[94:95], v24 offset:6400
    s_waitcnt lgkmcnt(0)
    ds_read_b64_tr_b16 a[96:97], v24 offset:8192
    ds_read_b64_tr_b16 a[98:99], v24 offset:8448
    ds_read_b64_tr_b16 a[100:101], v24 offset:10240
    ds_read_b64_tr_b16 a[102:103], v24 offset:10496
    ds_read_b64_tr_b16 a[104:105], v24 offset:12288
    ds_read_b64_tr_b16 a[106:107], v24 offset:12544
    ds_read_b64_tr_b16 a[108:109], v24 offset:14336
    ds_read_b64_tr_b16 a[110:111], v24 offset:14592
    s_waitcnt lgkmcnt(0)
    ds_read_b64_tr_b16 a[112:113], v24 offset:16384
    ds_read_b64_tr_b16 a[114:115], v24 offset:16640
    ds_read_b64_tr_b16 a[116:117], v24 offset:18432
    ds_read_b64_tr_b16 a[118:119], v24 offset:18688
    s_waitcnt lgkmcnt(0)
    v_lshl_add_u32 v23, v22, 3, v26
    v_mul_u32_u24 v23, 320, v23
    v_add_u32 v23, 122880, v23
    s_lshl_b32 s30, s20, 6
    v_lshl_add_u32 v24, v27, 4, v23
    v_add_u32 v24, s30, v24
    s_and_b32 s30, s20, 1
    s_lshl_b32 s30, s30, 5
    s_add_u32 s30, s30, 256
    v_lshl_add_u32 v25, v27, 3, v23
    v_add_u32 v25, s30, v25
    ds_read_b64_tr_b16 a[120:121], v24 offset:0
    ds_read_b64_tr_b16 a[122:123], v24 offset:1280
    ds_read_b64_tr_b16 a[124:125], v24 offset:10240
    ds_read_b64_tr_b16 a[126:127], v24 offset:11520
    ds_read_b64_tr_b16 a[128:129], v24 offset:20480
    ds_read_b64_tr_b16 a[130:131], v24 offset:21760
    ds_read_b64_tr_b16 a[132:133], v24 offset:30720
    ds_read_b64_tr_b16 a[134:135], v24 offset:32000
    s_waitcnt lgkmcnt(0)
    ds_read_b64_tr_b16 a[136:137], v24 offset:8
    ds_read_b64_tr_b16 a[138:139], v24 offset:1288
    ds_read_b64_tr_b16 a[140:141], v24 offset:10248
    ds_read_b64_tr_b16 a[142:143], v24 offset:11528
    ds_read_b64_tr_b16 a[144:145], v24 offset:20488
    ds_read_b64_tr_b16 a[146:147], v24 offset:21768
    ds_read_b64_tr_b16 a[148:149], v24 offset:30728
    ds_read_b64_tr_b16 a[150:151], v24 offset:32008
    s_waitcnt lgkmcnt(0)
    ds_read_b64_tr_b16 a[152:153], v25 offset:0
    ds_read_b64_tr_b16 a[154:155], v25 offset:1280
    ds_read_b64_tr_b16 a[156:157], v25 offset:10240
    ds_read_b64_tr_b16 a[158:159], v25 offset:11520
    ds_read_b64_tr_b16 a[160:161], v25 offset:20480
    ds_read_b64_tr_b16 a[162:163], v25 offset:21760
    ds_read_b64_tr_b16 a[164:165], v25 offset:30720
    ds_read_b64_tr_b16 a[166:167], v25 offset:32000
    s_waitcnt lgkmcnt(0)
    s_barrier
    s_cmp_lg_u32 s20, 0
    s_cbranch_scc1 L_vbc
    v_mov_b32 v240, 0
    v_mov_b32 v241, s79
    ds_write_b32 v240, v241
    s_waitcnt lgkmcnt(0)
L_vbc:
    s_barrier
    v_mov_b32 v240, 0
    ds_read_b32 v241, v240
    s_waitcnt lgkmcnt(0)
    v_readfirstlane_b32 s79, v241
    s_barrier
    s_cmp_lg_u32 s79, 0
    s_cbranch_scc1 L_fallback
    s_mov_b32 s21, 0
    ds_write_b128 v140, v[128:131]
    ds_write_b128 v141, v[132:135]
    ds_write_b128 v142, v[136:139]
    s_waitcnt lgkmcnt(0)
    s_cmp_lg_u32 s20, 0
    s_cbranch_scc1 L_c_census_done
    v_cmp_eq_u32 vcc, 1, v20
    v_mov_b32 v23, 96
    v_mov_b32 v24, 64
    v_cndmask_b32 v23, v23, v24, vcc
L_c_census:
    global_load_dword v24, v23, s[28:29] sc1
    s_waitcnt vmcnt(0)
    v_readfirstlane_b32 s30, v24
    s_cmp_lg_u32 s30, 0
    s_cbranch_scc1 L_c_census_seen
    s_sleep 2
    s_sub_u32 s22, s22, 1
    s_cbranch_scc0 L_c_census
    s_branch L_timeout
L_c_census_seen:
    v_readlane_b32 s30, v24, 1
    v_mov_b32 v23, 81920
    s_nop 0
    v_mov_b32 v24, s30
    ds_write_b32 v23, v24
    s_waitcnt lgkmcnt(0)
L_c_census_done:
    s_barrier
    v_mov_b32 v23, 81920
    ds_read_b32 v24, v23
    s_waitcnt lgkmcnt(0)
    v_readfirstlane_b32 s34, v24
    s_and_b32 s34, s34, 1
    s_lshl_b32 s34, s34, 13
    s_mov_b32 s84, 83886080
    s_mov_b32 s85, 84148224
    s_mov_b32 s86, 84410368
    s_mov_b32 s87, 84672512
    s_mov_b32 s88, 85983232
    s_mov_b32 s89, 86638592
    s_mov_b32 s90, 87293952
    s_mov_b32 s91, 88080384
    s_mov_b32 s92, 88735744
    s_mov_b32 s93, 88817664
    s_mov_b32 s94, 88899584
    s_mov_b32 s95, 88981504
    s_add_u32 s96, s34, 89063424
    s_add_u32 s97, s34, 89227264
    s_add_u32 s98, s34, 89391104
    s_add_u32 s99, s34, 89554944
    s_mov_b32 s30, 105906176
L_c_w01:
    buffer_load_dword v24, v37, s[8:11], s30 offen sc1
    s_waitcnt vmcnt(0)
    v_cmp_gt_u32 vcc, 2, v24
    s_nop 3
    s_and_b64 vcc, vcc, 3
    s_cbranch_vccz L_c_w01_ok
    s_sleep 2
    s_sub_u32 s22, s22, 1
    s_cbranch_scc0 L_c_w01
    s_branch L_timeout
L_c_w01_ok:
    s_lshl_b32 s33, s18, 13
    s_lshl_b32 s31, s20, 11
    s_add_u32 m0, s31, 0
    s_add_u32 s32, s31, s33
    s_add_u32 s32, s32, 16777216
    buffer_load_dwordx4 v96, s[8:11], s32 offen sc1 lds
    s_add_u32 m0, s31, 1024
    s_add_u32 s32, s31, s33
    s_add_u32 s32, s32, 16778240
    buffer_load_dwordx4 v96, s[8:11], s32 offen sc1 lds
    s_add_u32 m0, s31, 8192
    s_add_u32 s32, s31, s33
    s_add_u32 s32, s32, 33554432
    buffer_load_dwordx4 v96, s[8:11], s32 offen sc1 lds
    s_add_u32 m0, s31, 9216
    s_add_u32 s32, s31, s33
    s_add_u32 s32, s32, 33555456
    buffer_load_dwordx4 v96, s[8:11], s32 offen sc1 lds
    s_add_u32 m0, s31, 16384
    s_add_u32 s32, s31, s33
    s_add_u32 s32, s32, 17039360
    buffer_load_dwordx4 v96, s[8:11], s32 offen sc1 lds
    s_add_u32 m0, s31, 17408
    s_add_u32 s32, s31, s33
    s_add_u32 s32, s32, 17040384
    buffer_load_dwordx4 v96, s[8:11], s32 offen sc1 lds
    s_add_u32 m0, s31, 24576
    s_add_u32 s32, s31, s33
    s_add_u32 s32, s32, 33816576
    buffer_load_dwordx4 v96, s[8:11], s32 offen sc1 lds
    s_add_u32 m0, s31, 25600
    s_add_u32 s32, s31, s33
    s_add_u32 s32, s32, 33817600
    buffer_load_dwordx4 v96, s[8:11], s32 offen sc1 lds
    s_waitcnt vmcnt(0)
    s_barrier
    ds_read_b128 v[160:163], v36 offset:8192
    ds_read_b128 v[164:167], v36 offset:10240
    ds_read_b128 v[168:171], v36 offset:12288
    ds_read_b128 v[172:175], v36 offset:14336
    ds_read_b128 v[176:179], v36 offset:8448
    ds_read_b128 v[180:183], v36 offset:10496
    ds_read_b128 v[184:187], v36 offset:12544
    ds_read_b128 v[188:191], v36 offset:14592
    s_waitcnt lgkmcnt(0)
    v_mfma_f32_16x16x32_bf16 v[236:239], v[160:163], a[120:123], 0
    v_mfma_f32_16x16x32_bf16 v[240:243], v[176:179], a[120:123], 0
    v_mfma_f32_16x16x32_bf16 v[236:239], v[164:167], a[124:127], v[236:239]
    v_mfma_f32_16x16x32_bf16 v[240:243], v[180:183], a[124:127], v[240:243]
    v_mfma_f32_16x16x32_bf16 v[236:239], v[168:171], a[128:131], v[236:239]
    v_mfma_f32_16x16x32_bf16 v[240:243], v[184:187], a[128:131], v[240:243]
    v_mfma_f32_16x16x32_bf16 v[236:239], v[172:175], a[132:135], v[236:239]
    v_mfma_f32_16x16x32_bf16 v[240:243], v[188:191], a[132:135], v[240:243]
    v_mfma_f32_16x16x32_bf16 v[120:123], v[160:163], a[136:139], 0
    v_mfma_f32_16x16x32_bf16 v[124:127], v[176:179], a[136:139], 0
    v_mfma_f32_16x16x32_bf16 v[120:123], v[164:167], a[140:143], v[120:123]
    v_mfma_f32_16x16x32_bf16 v[124:127], v[180:183], a[140:143], v[124:127]
    v_mfma_f32_16x16x32_bf16 v[120:123], v[168:171], a[144:147], v[120:123]
    v_mfma_f32_16x16x32_bf16 v[124:127], v[184:187], a[144:147], v[124:127]
    v_mfma_f32_16x16x32_bf16 v[120:123], v[172:175], a[148:151], v[120:123]
    v_mfma_f32_16x16x32_bf16 v[124:127], v[188:191], a[148:151], v[124:127]
    v_cvt_pk_bf16_f32 v204, v236, v237
    v_cvt_pk_bf16_f32 v205, v238, v239
    v_cvt_pk_bf16_f32 v206, v240, v241
    v_cvt_pk_bf16_f32 v207, v242, v243
    v_mfma_f32_16x16x32_bf16 v[236:239], v[160:163], a[152:155], 0
    v_mfma_f32_16x16x32_bf16 v[240:243], v[176:179], a[152:155], 0
    v_mfma_f32_16x16x32_bf16 v[236:239], v[164:167], a[156:159], v[236:239]
    v_mfma_f32_16x16x32_bf16 v[240:243], v[180:183], a[156:159], v[240:243]
    v_mfma_f32_16x16x32_bf16 v[236:239], v[168:171], a[160:163], v[236:239]
    v_mfma_f32_16x16x32_bf16 v[240:243], v[184:187], a[160:163], v[240:243]
    v_mfma_f32_16x16x32_bf16 v[236:239], v[172:175], a[164:167], v[236:239]
    v_mfma_f32_16x16x32_bf16 v[240:243], v[188:191], a[164:167], v[240:243]
    v_cvt_pk_bf16_f32 v208, v120, v121
    v_cvt_pk_bf16_f32 v209, v122, v123
    v_cvt_pk_bf16_f32 v210, v124, v125
    v_cvt_pk_bf16_f32 v211, v126, v127
    s_nop 7
    v_cvt_pk_bf16_f32 v212, v236, v237
    v_cvt_pk_bf16_f32 v213, v238, v239
    v_cvt_pk_bf16_f32 v214, v240, v241
    v_cvt_pk_bf16_f32 v215, v242, v243
    s_mov_b32 s44, 105922560
    s_mov_b32 s40, 71303168
    s_mov_b32 s41, 75497472
    s_lshl_b32 s42, s18, 13
    s_add_u32 s42, s42, 524288
    s_cmp_eq_u32 s3, 1
    s_cbranch_scc1 L_c_afterA0s_far
    s_branch L_c_afterA0
L_c_afterA0s_far:
    s_branch L_c_afterA0s
.p2align 6
L_c_loop_0:
    buffer_load_dwordx4 v[144:147], v10, s[8:11], s92 offen sc1
    buffer_load_dwordx4 v[148:151], v11, s[8:11], s92 offen sc1
    buffer_load_dwordx4 v[152:155], v12, s[8:11], s92 offen sc1
    s_nop 15
    s_nop 15
    s_nop 7
    buffer_load_dwordx4 v[128:131], v10, s[8:11], s92 offen sc1
    buffer_load_dwordx4 v[132:135], v11, s[8:11], s92 offen sc1
    buffer_load_dwordx4 v[136:139], v12, s[8:11], s92 offen sc1
    s_waitcnt vmcnt(3)
    ds_write_b128 v100, v[144:147]
    ds_write_b128 v101, v[148:151]
    ds_write_b128 v102, v[152:155]
    v_max3_u32 v20, v144, v145, v146
    v_max3_u32 v21, v147, v148, v149
    v_max3_u32 v20, v20, v150, v151
    v_max3_u32 v21, v21, v152, v153
    v_max3_u32 v20, v20, v154, v155
    v_max_u32 v20, v20, v21
    v_cmp_eq_u32 vcc, -1, v20
    s_cbranch_vccnz L_c_A_0_retry
L_c_A_0_done:
    s_waitcnt lgkmcnt(0)
    s_barrier
L_c_afterA0:
    ds_read_b128 v[40:43], v16 offset:0
    ds_read_b128 v[44:47], v16 offset:64
    ds_read_b128 v[48:51], v16 offset:128
    ds_read_b128 v[52:55], v16 offset:192
    ds_read_b128 v[56:59], v16 offset:256
    ds_read_b128 v[60:63], v16 offset:320
    ds_read_b128 v[64:67], v16 offset:384
    ds_read_b128 v[68:71], v16 offset:448
    ds_read_b128 v[72:75], v16 offset:512
    ds_read_b128 v[76:79], v16 offset:576
    s_waitcnt lgkmcnt(9)
    v_mfma_f32_16x16x32_bf16 v[120:123], a[0:3], v[40:43], 0
    v_mfma_f32_16x16x32_bf16 v[124:127], a[40:43], v[40:43], 0
    s_waitcnt lgkmcnt(8)
    v_mfma_f32_16x16x32_bf16 v[120:123], a[4:7], v[44:47], v[120:123]
    v_mfma_f32_16x16x32_bf16 v[124:127], a[44:47], v[44:47], v[124:127]
    s_waitcnt lgkmcnt(7)
    v_mfma_f32_16x16x32_bf16 v[120:123], a[8:11], v[48:51], v[120:123]
    v_mfma_f32_16x16x32_bf16 v[124:127], a[48:51], v[48:51], v[124:127]
    s_waitcnt lgkmcnt(6)
    v_mfma_f32_16x16x32_bf16 v[120:123], a[12:15], v[52:55], v[120:123]
    v_mfma_f32_16x16x32_bf16 v[124:127], a[52:55], v[52:55], v[124:127]
    s_waitcnt lgkmcnt(5)
    v_mfma_f32_16x16x32_bf16 v[120:123], a[16:19], v[56:59], v[120:123]
    v_mfma_f32_16x16x32_bf16 v[124:127], a[56:59], v[56:59], v[124:127]
    s_waitcnt lgkmcnt(4)
    v_mfma_f32_16x16x32_bf16 v[120:123], a[20:23], v[60:63], v[120:123]
    v_mfma_f32_16x16x32_bf16 v[124:127], a[60:63], v[60:63], v[124:127]
    s_waitcnt lgkmcnt(3)
    v_mfma_f32_16x16x32_bf16 v[120:123], a[24:27], v[64:67], v[120:123]
    v_mfma_f32_16x16x32_bf16 v[124:127], a[64:67], v[64:67], v[124:127]
    s_waitcnt lgkmcnt(2)
    v_mfma_f32_16x16x32_bf16 v[120:123], a[28:31], v[68:71], v[120:123]
    v_mfma_f32_16x16x32_bf16 v[124:127], a[68:71], v[68:71], v[124:127]
    s_waitcnt lgkmcnt(1)
    v_mfma_f32_16x16x32_bf16 v[120:123], a[32:35], v[72:75], v[120:123]
    v_mfma_f32_16x16x32_bf16 v[124:127], a[72:75], v[72:75], v[124:127]
    s_waitcnt lgkmcnt(0)
    v_mfma_f32_16x16x32_bf16 v[120:123], a[36:39], v[76:79], v[120:123]
    v_mfma_f32_16x16x32_bf16 v[124:127], a[76:79], v[76:79], v[124:127]
    v_mfma_f32_16x16x32_bf16 v[84:87], a[80:83], v[40:43], 0
    v_mfma_f32_16x16x32_bf16 v[84:87], a[84:87], v[44:47], v[84:87]
    s_nop 5
    v_add_f32_dpp v120, v124, v120 row_ror:8 row_mask:0xf bank_mask:0xf
    v_add_f32_dpp v121, v125, v121 row_ror:8 row_mask:0xf bank_mask:0xf
    v_add_f32_dpp v122, v126, v122 row_ror:8 row_mask:0xf bank_mask:0xf
    v_add_f32_dpp v123, v127, v123 row_ror:8 row_mask:0xf bank_mask:0xf
    v_cvt_pk_bf16_f32 v248, v120, v121
    v_cvt_pk_bf16_f32 v249, v122, v123
    buffer_store_dwordx2 v[248:249], v1, s[8:11], s84 offen
    v_mfma_f32_16x16x32_bf16 v[84:87], a[88:91], v[48:51], v[84:87]
    v_mfma_f32_16x16x32_bf16 v[84:87], a[92:95], v[52:55], v[84:87]
    v_mfma_f32_16x16x32_bf16 v[84:87], a[96:99], v[56:59], v[84:87]
    v_mfma_f32_16x16x32_bf16 v[84:87], a[100:103], v[60:63], v[84:87]
    v_mfma_f32_16x16x32_bf16 v[84:87], a[104:107], v[64:67], v[84:87]
    v_mfma_f32_16x16x32_bf16 v[84:87], a[108:111], v[68:71], v[84:87]
    v_mfma_f32_16x16x32_bf16 v[84:87], a[112:115], v[72:75], v[84:87]
    v_mfma_f32_16x16x32_bf16 v[84:87], a[116:119], v[76:79], v[84:87]
    ds_read_b128 v[160:163], v36 offset:0
    ds_read_b128 v[164:167], v36 offset:2048
    ds_read_b128 v[168:171], v36 offset:4096
    ds_read_b128 v[172:175], v36 offset:6144
    ds_read_b128 v[176:179], v36 offset:256
    ds_read_b128 v[180:183], v36 offset:2304
    ds_read_b128 v[184:187], v36 offset:4352
    ds_read_b128 v[188:191], v36 offset:6400
    v_cvt_pk_bf16_f32 v250, v84, v85
    v_cvt_pk_bf16_f32 v251, v86, v87
    buffer_store_dwordx2 v[250:251], v2, s[8:11], s84 offen
    buffer_load_dwordx4 v[40:43], v3, s[8:11], s84 offen sc1
    s_nop 15
    s_nop 3
    buffer_load_dwordx4 v[44:47], v3, s[8:11], s84 offen sc1
    s_waitcnt vmcnt(1)
    ds_write_b128 v17, v[40:43]
    v_max3_u32 v20, v40, v41, v42
    v_max_u32 v20, v20, v43
    v_cmp_eq_u32 vcc, -1, v20
    s_cbranch_vccnz L_c_R_0_retry
L_c_R_0_done:
    s_nop 11
    buffer_load_dwordx4 v[144:147], v4, s[8:11], s84 offen offset:0 sc1
    buffer_load_dwordx4 v[148:151], v4, s[8:11], s84 offen offset:512 sc1
    buffer_load_dwordx4 v[152:155], v4, s[8:11], s84 offen offset:1024 sc1
    buffer_load_dwordx4 v[156:159], v4, s[8:11], s84 offen offset:1536 sc1
L_c_Rv_0:
    s_waitcnt lgkmcnt(0)
    s_barrier
    ds_read_b128 v[128:131], v18 offset:0
    ds_read_b128 v[60:63], v19 offset:0
    ds_read_b128 v[132:135], v18 offset:512
    ds_read_b128 v[64:67], v19 offset:512
    ds_read_b128 v[136:139], v18 offset:1024
    ds_read_b128 v[68:71], v19 offset:1024
    ds_read_b128 v[140:143], v18 offset:1536
    ds_read_b128 v[72:75], v19 offset:1536
    s_waitcnt lgkmcnt(6)
    v_mfma_f32_16x16x32_bf16 v[192:195], v[160:163], v[128:131], 0
    v_mov_b32 v39, s21
    v_mfma_f32_16x16x32_bf16 v[196:199], v[176:179], v[128:131], 0
    buffer_store_dword v39, v38, s[8:11], s44 offen sc1
    v_mfma_f32_16x16x32_bf16 v[200:203], v[60:63], v[128:131], 0
    s_waitcnt lgkmcnt(4)
    v_mfma_f32_16x16x32_bf16 v[192:195], v[164:167], v[132:135], v[192:195]
    buffer_store_dwordx2 v[28:29], v1, s[8:11], s86 offen
    v_mfma_f32_16x16x32_bf16 v[196:199], v[180:183], v[132:135], v[196:199]
    buffer_store_dwordx2 v[28:29], v2, s[8:11], s86 offen
    v_mfma_f32_16x16x32_bf16 v[200:203], v[64:67], v[132:135], v[200:203]
    s_waitcnt lgkmcnt(2)
    v_mfma_f32_16x16x32_bf16 v[192:195], v[168:171], v[136:139], v[192:195]
    buffer_store_dwordx4 v[28:31], v5, s[8:11], s90 offen
    v_mfma_f32_16x16x32_bf16 v[196:199], v[184:187], v[136:139], v[196:199]
    buffer_store_dwordx2 v[28:29], v6, s[8:11], s90 offen
    v_mfma_f32_16x16x32_bf16 v[200:203], v[68:71], v[136:139], v[200:203]
    s_waitcnt lgkmcnt(0)
    v_mfma_f32_16x16x32_bf16 v[192:195], v[172:175], v[140:143], v[192:195]
    buffer_store_dwordx2 v[28:29], v9, s[8:11], s95 offen
    v_mfma_f32_16x16x32_bf16 v[196:199], v[188:191], v[140:143], v[196:199]
    v_mfma_f32_16x16x32_bf16 v[200:203], v[72:75], v[140:143], v[200:203]
    s_waitcnt vmcnt(6)
    v_max3_u32 v20, v144, v145, v146
    v_max3_u32 v21, v147, v148, v149
    v_max3_u32 v20, v20, v150, v151
    v_max3_u32 v21, v21, v152, v153
    v_max3_u32 v20, v20, v154, v155
    v_max3_u32 v21, v21, v156, v157
    v_max3_u32 v20, v20, v158, v159
    v_max_u32 v20, v20, v21
    v_cmp_eq_u32 vcc, -1, v20
    s_cbranch_vccnz L_c_pollV_0
L_c_okV_0:
    v_max3_f32 v24, v192, v193, v194
    v_max3_f32 v25, v195, v196, v197
    v_mfma_f32_16x16x32_bf16 v[236:239], v[144:147], a[120:123], 0
    v_max3_f32 v24, v24, v198, v199
    v_max3_f32 v25, v25, v200, v201
    v_max3_f32 v24, v24, v202, v203
    v_max_f32 v24, v24, v25
    v_mov_b32 v25, v24
    v_mfma_f32_16x16x32_bf16 v[240:243], v[144:147], a[136:139], 0
    s_nop 0
    v_permlane16_swap_b32 v25, v24
    v_max_f32 v24, v24, v25
    v_mov_b32 v25, v24
    v_mfma_f32_16x16x32_bf16 v[244:247], v[144:147], a[152:155], 0
    s_nop 0
    v_permlane32_swap_b32 v25, v24
    v_max_f32 v24, v24, v25
    v_mul_f32 v24, s38, v24
    v_mfma_f32_16x16x32_bf16 v[236:239], v[148:151], a[124:127], v[236:239]
    v_pk_fma_f32 v[192:193], v[192:193], s[38:39], v[24:25] op_sel_hi:[1,1,0] neg_lo:[0,0,1] neg_hi:[0,0,1]
    v_pk_fma_f32 v[194:195], v[194:195], s[38:39], v[24:25] op_sel_hi:[1,1,0] neg_lo:[0,0,1] neg_hi:[0,0,1]
    v_mfma_f32_16x16x32_bf16 v[240:243], v[148:151], a[140:143], v[240:243]
    v_pk_fma_f32 v[196:197], v[196:197], s[38:39], v[24:25] op_sel_hi:[1,1,0] neg_lo:[0,0,1] neg_hi:[0,0,1]
    v_pk_fma_f32 v[198:199], v[198:199], s[38:39], v[24:25] op_sel_hi:[1,1,0] neg_lo:[0,0,1] neg_hi:[0,0,1]
    v_mfma_f32_16x16x32_bf16 v[244:247], v[148:151], a[156:159], v[244:247]
    v_pk_fma_f32 v[200:201], v[200:201], s[38:39], v[24:25] op_sel_hi:[1,1,0] neg_lo:[0,0,1] neg_hi:[0,0,1]
    v_pk_fma_f32 v[202:203], v[202:203], s[38:39], v[24:25] op_sel_hi:[1,1,0] neg_lo:[0,0,1] neg_hi:[0,0,1]
    v_mfma_f32_16x16x32_bf16 v[236:239], v[152:155], a[128:131], v[236:239]
    v_exp_f32 v192, v192
    v_exp_f32 v193, v193
    v_mfma_f32_16x16x32_bf16 v[240:243], v[152:155], a[144:147], v[240:243]
    v_exp_f32 v194, v194
    v_exp_f32 v195, v195
    v_mfma_f32_16x16x32_bf16 v[244:247], v[152:155], a[160:163], v[244:247]
    v_exp_f32 v196, v196
    v_exp_f32 v197, v197
    v_mfma_f32_16x16x32_bf16 v[236:239], v[156:159], a[132:135], v[236:239]
    v_exp_f32 v198, v198
    v_exp_f32 v199, v199
    v_mfma_f32_16x16x32_bf16 v[240:243], v[156:159], a[148:151], v[240:243]
    v_exp_f32 v200, v200
    v_exp_f32 v201, v201
    v_mfma_f32_16x16x32_bf16 v[244:247], v[156:159], a[164:167], v[244:247]
    v_exp_f32 v202, v202
    v_exp_f32 v203, v203
    v_cvt_pk_bf16_f32 v228, v192, v193
    v_cvt_pk_bf16_f32 v229, v194, v195
    v_cvt_pk_bf16_f32 v230, v196, v197
    v_cvt_pk_bf16_f32 v231, v198, v199
    v_cvt_pk_bf16_f32 v232, v200, v201
    v_cvt_pk_bf16_f32 v233, v202, v203
    v_mfma_f32_16x16x32_bf16 v[20:23], a[168:171], v[228:231], 0
    v_mfma_f32_16x16x32_bf16 v[120:123], v[204:207], v[228:231], 0
    v_mfma_f32_16x16x32_bf16 v[124:127], v[208:211], v[228:231], 0
    v_mfma_f32_16x16x32_bf16 v[84:87], v[212:215], v[228:231], 0
    v_cvt_pk_bf16_f32 v216, v236, v237
    v_cvt_pk_bf16_f32 v217, v238, v239
    v_cvt_pk_bf16_f32 v220, v240, v241
    v_cvt_pk_bf16_f32 v221, v242, v243
    v_cvt_pk_bf16_f32 v224, v244, v245
    v_cvt_pk_bf16_f32 v225, v246, v247
    v_mfma_f32_16x16x32_bf16 v[20:23], a[172:175], v[232:235], v[20:23]
    v_mfma_f32_16x16x32_bf16 v[120:123], v[216:219], v[232:235], v[120:123]
    v_mfma_f32_16x16x32_bf16 v[124:127], v[220:223], v[232:235], v[124:127]
    v_mfma_f32_16x16x32_bf16 v[84:87], v[224:227], v[232:235], v[84:87]
    s_nop 4
    v_rcp_f32 v26, v20
    s_nop 1
    v_pk_mul_f32 v[120:121], v[120:121], v[26:27] op_sel_hi:[1,0]
    v_pk_mul_f32 v[122:123], v[122:123], v[26:27] op_sel_hi:[1,0]
    v_cvt_pk_bf16_f32 v56, v120, v121
    v_cvt_pk_bf16_f32 v57, v122, v123
    v_pk_mul_f32 v[124:125], v[124:125], v[26:27] op_sel_hi:[1,0]
    v_pk_mul_f32 v[126:127], v[126:127], v[26:27] op_sel_hi:[1,0]
    v_cvt_pk_bf16_f32 v58, v124, v125
    v_cvt_pk_bf16_f32 v59, v126, v127
    buffer_store_dwordx4 v[56:59], v5, s[8:11], s88 offen
    v_pk_mul_f32 v[84:85], v[84:85], v[26:27] op_sel_hi:[1,0]
    v_pk_mul_f32 v[86:87], v[86:87], v[26:27] op_sel_hi:[1,0]
    v_cvt_pk_bf16_f32 v254, v84, v85
    v_cvt_pk_bf16_f32 v255, v86, v87
    buffer_store_dwordx2 v[254:255], v6, s[8:11], s88 offen
    ds_read_b128 v[160:163], v36 offset:24576
    ds_read_b128 v[164:167], v36 offset:26624
    ds_read_b128 v[168:171], v36 offset:28672
    ds_read_b128 v[172:175], v36 offset:30720
    ds_read_b128 v[176:179], v36 offset:24832
    ds_read_b128 v[180:183], v36 offset:26880
    ds_read_b128 v[184:187], v36 offset:28928
    ds_read_b128 v[188:191], v36 offset:30976
    s_cmp_eq_u32 s23, 0
    s_cbranch_scc1 L_c_noitem_0
    s_nop 15
    s_nop 13
    buffer_load_dwordx2 v[88:89], v7, s[8:11], s88 offen sc1
    buffer_load_dwordx2 v[90:91], v8, s[8:11], s88 offen sc1
    s_nop 14
    buffer_load_dwordx2 v[60:61], v7, s[8:11], s88 offen sc1
    buffer_load_dwordx2 v[62:63], v8, s[8:11], s88 offen sc1
    s_nop 14
    buffer_load_dwordx2 v[64:65], v7, s[8:11], s88 offen sc1
    buffer_load_dwordx2 v[66:67], v8, s[8:11], s88 offen sc1
    s_waitcnt vmcnt(4)
    v_mfma_f32_16x16x32_bf16 v[92:95], v[32:35], v[88:91], 0
    v_max3_u32 v20, v88, v89, v90
    v_max_u32 v20, v20, v91
    v_cmp_eq_u32 vcc, -1, v20
    s_cbranch_vccnz L_c_RS_0_retry
L_c_RS_0_done:
    s_nop 3
    buffer_store_dwordx4 v[92:95], v82, s[8:11], s96 offen sc1
    buffer_store_dwordx4 v[28:31], v82, s[8:11], s98 offen sc1
    s_waitcnt lgkmcnt(0)
    v_mfma_f32_16x16x32_bf16 v[236:239], v[160:163], a[120:123], 0
    v_mfma_f32_16x16x32_bf16 v[240:243], v[176:179], a[120:123], 0
    v_mfma_f32_16x16x32_bf16 v[236:239], v[164:167], a[124:127], v[236:239]
    v_mfma_f32_16x16x32_bf16 v[240:243], v[180:183], a[124:127], v[240:243]
    v_mfma_f32_16x16x32_bf16 v[236:239], v[168:171], a[128:131], v[236:239]
    v_mfma_f32_16x16x32_bf16 v[240:243], v[184:187], a[128:131], v[240:243]
    v_mfma_f32_16x16x32_bf16 v[236:239], v[172:175], a[132:135], v[236:239]
    v_mfma_f32_16x16x32_bf16 v[240:243], v[188:191], a[132:135], v[240:243]
    v_mfma_f32_16x16x32_bf16 v[120:123], v[160:163], a[136:139], 0
    v_mfma_f32_16x16x32_bf16 v[124:127], v[176:179], a[136:139], 0
    v_mfma_f32_16x16x32_bf16 v[120:123], v[164:167], a[140:143], v[120:123]
    v_mfma_f32_16x16x32_bf16 v[124:127], v[180:183], a[140:143], v[124:127]
    v_mfma_f32_16x16x32_bf16 v[120:123], v[168:171], a[144:147], v[120:123]
    v_mfma_f32_16x16x32_bf16 v[124:127], v[184:187], a[144:147], v[124:127]
    v_mfma_f32_16x16x32_bf16 v[120:123], v[172:175], a[148:151], v[120:123]
    v_mfma_f32_16x16x32_bf16 v[124:127], v[188:191], a[148:151], v[124:127]
    v_cvt_pk_bf16_f32 v204, v236, v237
    v_cvt_pk_bf16_f32 v205, v238, v239
    v_cvt_pk_bf16_f32 v206, v240, v241
    v_cvt_pk_bf16_f32 v207, v242, v243
    v_mfma_f32_16x16x32_bf16 v[236:239], v[160:163], a[152:155], 0
    v_mfma_f32_16x16x32_bf16 v[240:243], v[176:179], a[152:155], 0
    v_mfma_f32_16x16x32_bf16 v[236:239], v[164:167], a[156:159], v[236:239]
    v_mfma_f32_16x16x32_bf16 v[240:243], v[180:183], a[156:159], v[240:243]
    v_mfma_f32_16x16x32_bf16 v[236:239], v[168:171], a[160:163], v[236:239]
    v_mfma_f32_16x16x32_bf16 v[240:243], v[184:187], a[160:163], v[240:243]
    v_mfma_f32_16x16x32_bf16 v[236:239], v[172:175], a[164:167], v[236:239]
    v_mfma_f32_16x16x32_bf16 v[240:243], v[188:191], a[164:167], v[240:243]
    v_cvt_pk_bf16_f32 v208, v120, v121
    v_cvt_pk_bf16_f32 v209, v122, v123
    v_cvt_pk_bf16_f32 v210, v124, v125
    v_cvt_pk_bf16_f32 v211, v126, v127
    s_nop 6
    v_cvt_pk_bf16_f32 v212, v236, v237
    v_cvt_pk_bf16_f32 v213, v238, v239
    v_cvt_pk_bf16_f32 v214, v240, v241
    v_cvt_pk_bf16_f32 v215, v242, v243
    buffer_load_dwordx4 v[108:111], v104, s[8:11], s96 offen sc1
    buffer_load_dwordx4 v[112:115], v105, s[8:11], s96 offen sc1
    buffer_load_dwordx4 v[116:119], v106, s[8:11], s96 offen sc1
    s_nop 15
    s_nop 15
    s_nop 7
    buffer_load_dwordx4 v[68:71], v104, s[8:11], s96 offen sc1
    buffer_load_dwordx4 v[72:75], v105, s[8:11], s96 offen sc1
    buffer_load_dwordx4 v[76:79], v106, s[8:11], s96 offen sc1
    s_waitcnt vmcnt(3)
    v_max3_u32 v20, v108, v109, v110
    v_max3_u32 v21, v111, v112, v113
    v_max3_u32 v20, v20, v114, v115
    v_max3_u32 v21, v21, v116, v117
    v_max3_u32 v20, v20, v118, v119
    v_max_u32 v20, v20, v21
    v_cmp_eq_u32 vcc, -1, v20
    s_cbranch_vccnz L_c_X_0_retry
    v_pk_add_f32 v[20:21], v[108:109], v[116:117]
    v_pk_add_f32 v[92:93], v[92:93], v[112:113]
    v_pk_add_f32 v[22:23], v[110:111], v[118:119]
    v_pk_add_f32 v[94:95], v[94:95], v[114:115]
L_c_X_0_done:
    v_pk_add_f32 v[92:93], v[92:93], v[20:21]
    v_pk_add_f32 v[94:95], v[94:95], v[22:23]
    v_cvt_pk_bf16_f32 v254, v92, v93
    v_cvt_pk_bf16_f32 v255, v94, v95
    buffer_store_dwordx2 v[254:255], v9, s[8:11], s93 offen
L_c_stepend_0:
    s_add_u32 s40, s40, 65536
    s_add_u32 s41, s41, 131072
    s_add_u32 s42, s42, 262144
    s_add_u32 s21, s21, 1
    s_barrier
L_c_loop_1:
    buffer_load_dwordx4 v[144:147], v10, s[8:11], s93 offen sc1
    buffer_load_dwordx4 v[148:151], v11, s[8:11], s93 offen sc1
    buffer_load_dwordx4 v[152:155], v12, s[8:11], s93 offen sc1
    s_nop 15
    s_nop 15
    s_nop 7
    buffer_load_dwordx4 v[128:131], v10, s[8:11], s93 offen sc1
    buffer_load_dwordx4 v[132:135], v11, s[8:11], s93 offen sc1
    buffer_load_dwordx4 v[136:139], v12, s[8:11], s93 offen sc1
    s_waitcnt vmcnt(3)
    ds_write_b128 v100, v[144:147]
    ds_write_b128 v101, v[148:151]
    ds_write_b128 v102, v[152:155]
    v_max3_u32 v20, v144, v145, v146
    v_max3_u32 v21, v147, v148, v149
    v_max3_u32 v20, v20, v150, v151
    v_max3_u32 v21, v21, v152, v153
    v_max3_u32 v20, v20, v154, v155
    v_max_u32 v20, v20, v21
    v_cmp_eq_u32 vcc, -1, v20
    s_cbranch_vccnz L_c_A_1_retry
L_c_A_1_done:
    s_waitcnt lgkmcnt(0)
    s_barrier
    ds_read_b128 v[40:43], v16 offset:0
    ds_read_b128 v[44:47], v16 offset:64
    ds_read_b128 v[48:51], v16 offset:128
    ds_read_b128 v[52:55], v16 offset:192
    ds_read_b128 v[56:59], v16 offset:256
    ds_read_b128 v[60:63], v16 offset:320
    ds_read_b128 v[64:67], v16 offset:384
    ds_read_b128 v[68:71], v16 offset:448
    ds_read_b128 v[72:75], v16 offset:512
    ds_read_b128 v[76:79], v16 offset:576
    s_waitcnt lgkmcnt(9)
    v_mfma_f32_16x16x32_bf16 v[120:123], a[0:3], v[40:43], 0
    v_mfma_f32_16x16x32_bf16 v[124:127], a[40:43], v[40:43], 0
    s_waitcnt lgkmcnt(8)
    v_mfma_f32_16x16x32_bf16 v[120:123], a[4:7], v[44:47], v[120:123]
    v_mfma_f32_16x16x32_bf16 v[124:127], a[44:47], v[44:47], v[124:127]
    s_waitcnt lgkmcnt(7)
    v_mfma_f32_16x16x32_bf16 v[120:123], a[8:11], v[48:51], v[120:123]
    v_mfma_f32_16x16x32_bf16 v[124:127], a[48:51], v[48:51], v[124:127]
    s_waitcnt lgkmcnt(6)
    v_mfma_f32_16x16x32_bf16 v[120:123], a[12:15], v[52:55], v[120:123]
    v_mfma_f32_16x16x32_bf16 v[124:127], a[52:55], v[52:55], v[124:127]
    s_waitcnt lgkmcnt(5)
    v_mfma_f32_16x16x32_bf16 v[120:123], a[16:19], v[56:59], v[120:123]
    v_mfma_f32_16x16x32_bf16 v[124:127], a[56:59], v[56:59], v[124:127]
    s_waitcnt lgkmcnt(4)
    v_mfma_f32_16x16x32_bf16 v[120:123], a[20:23], v[60:63], v[120:123]
    v_mfma_f32_16x16x32_bf16 v[124:127], a[60:63], v[60:63], v[124:127]
    s_waitcnt lgkmcnt(3)
    v_mfma_f32_16x16x32_bf16 v[120:123], a[24:27], v[64:67], v[120:123]
    v_mfma_f32_16x16x32_bf16 v[124:127], a[64:67], v[64:67], v[124:127]
    s_waitcnt lgkmcnt(2)
    v_mfma_f32_16x16x32_bf16 v[120:123], a[28:31], v[68:71], v[120:123]
    v_mfma_f32_16x16x32_bf16 v[124:127], a[68:71], v[68:71], v[124:127]
    s_waitcnt lgkmcnt(1)
    v_mfma_f32_16x16x32_bf16 v[120:123], a[32:35], v[72:75], v[120:123]
    v_mfma_f32_16x16x32_bf16 v[124:127], a[72:75], v[72:75], v[124:127]
    s_waitcnt lgkmcnt(0)
    v_mfma_f32_16x16x32_bf16 v[120:123], a[36:39], v[76:79], v[120:123]
    v_mfma_f32_16x16x32_bf16 v[124:127], a[76:79], v[76:79], v[124:127]
    v_mfma_f32_16x16x32_bf16 v[84:87], a[80:83], v[40:43], 0
    v_mfma_f32_16x16x32_bf16 v[84:87], a[84:87], v[44:47], v[84:87]
    s_nop 5
    v_add_f32_dpp v120, v124, v120 row_ror:8 row_mask:0xf bank_mask:0xf
    v_add_f32_dpp v121, v125, v121 row_ror:8 row_mask:0xf bank_mask:0xf
    v_add_f32_dpp v122, v126, v122 row_ror:8 row_mask:0xf bank_mask:0xf
    v_add_f32_dpp v123, v127, v123 row_ror:8 row_mask:0xf bank_mask:0xf
    v_cvt_pk_bf16_f32 v248, v120, v121
    v_cvt_pk_bf16_f32 v249, v122, v123
    buffer_store_dwordx2 v[248:249], v1, s[8:11], s85 offen
    v_mfma_f32_16x16x32_bf16 v[84:87], a[88:91], v[48:51], v[84:87]
    v_mfma_f32_16x16x32_bf16 v[84:87], a[92:95], v[52:55], v[84:87]
    v_mfma_f32_16x16x32_bf16 v[84:87], a[96:99], v[56:59], v[84:87]
    v_mfma_f32_16x16x32_bf16 v[84:87], a[100:103], v[60:63], v[84:87]
    v_mfma_f32_16x16x32_bf16 v[84:87], a[104:107], v[64:67], v[84:87]
    v_mfma_f32_16x16x32_bf16 v[84:87], a[108:111], v[68:71], v[84:87]
    v_mfma_f32_16x16x32_bf16 v[84:87], a[112:115], v[72:75], v[84:87]
    v_mfma_f32_16x16x32_bf16 v[84:87], a[116:119], v[76:79], v[84:87]
    ds_read_b128 v[160:163], v36 offset:16384
    ds_read_b128 v[164:167], v36 offset:18432
    ds_read_b128 v[168:171], v36 offset:20480
    ds_read_b128 v[172:175], v36 offset:22528
    ds_read_b128 v[176:179], v36 offset:16640
    ds_read_b128 v[180:183], v36 offset:18688
    ds_read_b128 v[184:187], v36 offset:20736
    ds_read_b128 v[188:191], v36 offset:22784
    v_cvt_pk_bf16_f32 v250, v84, v85
    v_cvt_pk_bf16_f32 v251, v86, v87
    buffer_store_dwordx2 v[250:251], v2, s[8:11], s85 offen
    buffer_load_dwordx4 v[40:43], v3, s[8:11], s85 offen sc1
    s_nop 15
    s_nop 3
    buffer_load_dwordx4 v[44:47], v3, s[8:11], s85 offen sc1
    s_waitcnt vmcnt(1)
    ds_write_b128 v17, v[40:43]
    v_max3_u32 v20, v40, v41, v42
    v_max_u32 v20, v20, v43
    v_cmp_eq_u32 vcc, -1, v20
    s_cbranch_vccnz L_c_R_1_retry
L_c_R_1_done:
    s_nop 11
    buffer_load_dwordx4 v[144:147], v4, s[8:11], s85 offen offset:0 sc1
    buffer_load_dwordx4 v[148:151], v4, s[8:11], s85 offen offset:512 sc1
    buffer_load_dwordx4 v[152:155], v4, s[8:11], s85 offen offset:1024 sc1
    buffer_load_dwordx4 v[156:159], v4, s[8:11], s85 offen offset:1536 sc1
L_c_Rv_1:
    s_waitcnt lgkmcnt(0)
    s_barrier
    ds_read_b128 v[128:131], v18 offset:0
    ds_read_b128 v[60:63], v19 offset:0
    ds_read_b128 v[132:135], v18 offset:512
    ds_read_b128 v[64:67], v19 offset:512
    ds_read_b128 v[136:139], v18 offset:1024
    ds_read_b128 v[68:71], v19 offset:1024
    ds_read_b128 v[140:143], v18 offset:1536
    ds_read_b128 v[72:75], v19 offset:1536
    s_waitcnt lgkmcnt(6)
    v_mfma_f32_16x16x32_bf16 v[192:195], v[160:163], v[128:131], 0
    v_mov_b32 v39, s21
    v_mfma_f32_16x16x32_bf16 v[196:199], v[176:179], v[128:131], 0
    buffer_store_dword v39, v38, s[8:11], s44 offen sc1
    v_mfma_f32_16x16x32_bf16 v[200:203], v[60:63], v[128:131], 0
    s_waitcnt lgkmcnt(4)
    v_mfma_f32_16x16x32_bf16 v[192:195], v[164:167], v[132:135], v[192:195]
    buffer_store_dwordx2 v[28:29], v1, s[8:11], s87 offen
    v_mfma_f32_16x16x32_bf16 v[196:199], v[180:183], v[132:135], v[196:199]
    buffer_store_dwordx2 v[28:29], v2, s[8:11], s87 offen
    v_mfma_f32_16x16x32_bf16 v[200:203], v[64:67], v[132:135], v[200:203]
    s_waitcnt lgkmcnt(2)
    v_mfma_f32_16x16x32_bf16 v[192:195], v[168:171], v[136:139], v[192:195]
    buffer_store_dwordx4 v[28:31], v5, s[8:11], s91 offen
    v_mfma_f32_16x16x32_bf16 v[196:199], v[184:187], v[136:139], v[196:199]
    buffer_store_dwordx2 v[28:29], v6, s[8:11], s91 offen
    v_mfma_f32_16x16x32_bf16 v[200:203], v[68:71], v[136:139], v[200:203]
    s_waitcnt lgkmcnt(0)
    v_mfma_f32_16x16x32_bf16 v[192:195], v[172:175], v[140:143], v[192:195]
    buffer_store_dwordx2 v[28:29], v9, s[8:11], s92 offen
    v_mfma_f32_16x16x32_bf16 v[196:199], v[188:191], v[140:143], v[196:199]
    v_mfma_f32_16x16x32_bf16 v[200:203], v[72:75], v[140:143], v[200:203]
    s_waitcnt vmcnt(6)
    v_max3_u32 v20, v144, v145, v146
    v_max3_u32 v21, v147, v148, v149
    v_max3_u32 v20, v20, v150, v151
    v_max3_u32 v21, v21, v152, v153
    v_max3_u32 v20, v20, v154, v155
    v_max3_u32 v21, v21, v156, v157
    v_max3_u32 v20, v20, v158, v159
    v_max_u32 v20, v20, v21
    v_cmp_eq_u32 vcc, -1, v20
    s_cbranch_vccnz L_c_pollV_1
L_c_okV_1:
    v_max3_f32 v24, v192, v193, v194
    v_max3_f32 v25, v195, v196, v197
    v_mfma_f32_16x16x32_bf16 v[236:239], v[144:147], a[120:123], 0
    v_max3_f32 v24, v24, v198, v199
    v_max3_f32 v25, v25, v200, v201
    v_max3_f32 v24, v24, v202, v203
    v_max_f32 v24, v24, v25
    v_mov_b32 v25, v24
    v_mfma_f32_16x16x32_bf16 v[240:243], v[144:147], a[136:139], 0
    s_nop 0
    v_permlane16_swap_b32 v25, v24
    v_max_f32 v24, v24, v25
    v_mov_b32 v25, v24
    v_mfma_f32_16x16x32_bf16 v[244:247], v[144:147], a[152:155], 0
    s_nop 0
    v_permlane32_swap_b32 v25, v24
    v_max_f32 v24, v24, v25
    v_mul_f32 v24, s38, v24
    v_mfma_f32_16x16x32_bf16 v[236:239], v[148:151], a[124:127], v[236:239]
    v_pk_fma_f32 v[192:193], v[192:193], s[38:39], v[24:25] op_sel_hi:[1,1,0] neg_lo:[0,0,1] neg_hi:[0,0,1]
    v_pk_fma_f32 v[194:195], v[194:195], s[38:39], v[24:25] op_sel_hi:[1,1,0] neg_lo:[0,0,1] neg_hi:[0,0,1]
    v_mfma_f32_16x16x32_bf16 v[240:243], v[148:151], a[140:143], v[240:243]
    v_pk_fma_f32 v[196:197], v[196:197], s[38:39], v[24:25] op_sel_hi:[1,1,0] neg_lo:[0,0,1] neg_hi:[0,0,1]
    v_pk_fma_f32 v[198:199], v[198:199], s[38:39], v[24:25] op_sel_hi:[1,1,0] neg_lo:[0,0,1] neg_hi:[0,0,1]
    v_mfma_f32_16x16x32_bf16 v[244:247], v[148:151], a[156:159], v[244:247]
    v_pk_fma_f32 v[200:201], v[200:201], s[38:39], v[24:25] op_sel_hi:[1,1,0] neg_lo:[0,0,1] neg_hi:[0,0,1]
    v_pk_fma_f32 v[202:203], v[202:203], s[38:39], v[24:25] op_sel_hi:[1,1,0] neg_lo:[0,0,1] neg_hi:[0,0,1]
    v_mfma_f32_16x16x32_bf16 v[236:239], v[152:155], a[128:131], v[236:239]
    v_exp_f32 v192, v192
    v_exp_f32 v193, v193
    v_mfma_f32_16x16x32_bf16 v[240:243], v[152:155], a[144:147], v[240:243]
    v_exp_f32 v194, v194
    v_exp_f32 v195, v195
    v_mfma_f32_16x16x32_bf16 v[244:247], v[152:155], a[160:163], v[244:247]
    v_exp_f32 v196, v196
    v_exp_f32 v197, v197
    v_mfma_f32_16x16x32_bf16 v[236:239], v[156:159], a[132:135], v[236:239]
    v_exp_f32 v198, v198
    v_exp_f32 v199, v199
    v_mfma_f32_16x16x32_bf16 v[240:243], v[156:159], a[148:151], v[240:243]
    v_exp_f32 v200, v200
    v_exp_f32 v201, v201
    v_mfma_f32_16x16x32_bf16 v[244:247], v[156:159], a[164:167], v[244:247]
    v_exp_f32 v202, v202
    v_exp_f32 v203, v203
    v_cvt_pk_bf16_f32 v228, v192, v193
    v_cvt_pk_bf16_f32 v229, v194, v195
    v_cvt_pk_bf16_f32 v230, v196, v197
    v_cvt_pk_bf16_f32 v231, v198, v199
    v_cvt_pk_bf16_f32 v232, v200, v201
    v_cvt_pk_bf16_f32 v233, v202, v203
    v_mfma_f32_16x16x32_bf16 v[20:23], a[168:171], v[228:231], 0
    v_mfma_f32_16x16x32_bf16 v[120:123], v[204:207], v[228:231], 0
    v_mfma_f32_16x16x32_bf16 v[124:127], v[208:211], v[228:231], 0
    v_mfma_f32_16x16x32_bf16 v[84:87], v[212:215], v[228:231], 0
    v_cvt_pk_bf16_f32 v216, v236, v237
    v_cvt_pk_bf16_f32 v217, v238, v239
    v_cvt_pk_bf16_f32 v220, v240, v241
    v_cvt_pk_bf16_f32 v221, v242, v243
    v_cvt_pk_bf16_f32 v224, v244, v245
    v_cvt_pk_bf16_f32 v225, v246, v247
    v_mfma_f32_16x16x32_bf16 v[20:23], a[172:175], v[232:235], v[20:23]
    v_mfma_f32_16x16x32_bf16 v[120:123], v[216:219], v[232:235], v[120:123]
    v_mfma_f32_16x16x32_bf16 v[124:127], v[220:223], v[232:235], v[124:127]
    v_mfma_f32_16x16x32_bf16 v[84:87], v[224:227], v[232:235], v[84:87]
    s_nop 4
    v_rcp_f32 v26, v20
    s_nop 1
    v_pk_mul_f32 v[120:121], v[120:121], v[26:27] op_sel_hi:[1,0]
    v_pk_mul_f32 v[122:123], v[122:123], v[26:27] op_sel_hi:[1,0]
    v_cvt_pk_bf16_f32 v56, v120, v121
    v_cvt_pk_bf16_f32 v57, v122, v123
    v_pk_mul_f32 v[124:125], v[124:125], v[26:27] op_sel_hi:[1,0]
    v_pk_mul_f32 v[126:127], v[126:127], v[26:27] op_sel_hi:[1,0]
    v_cvt_pk_bf16_f32 v58, v124, v125
    v_cvt_pk_bf16_f32 v59, v126, v127
    buffer_store_dwordx4 v[56:59], v5, s[8:11], s89 offen
    v_pk_mul_f32 v[84:85], v[84:85], v[26:27] op_sel_hi:[1,0]
    v_pk_mul_f32 v[86:87], v[86:87], v[26:27] op_sel_hi:[1,0]
    v_cvt_pk_bf16_f32 v254, v84, v85
    v_cvt_pk_bf16_f32 v255, v86, v87
    buffer_store_dwordx2 v[254:255], v6, s[8:11], s89 offen
    ds_read_b128 v[160:163], v36 offset:40960
    ds_read_b128 v[164:167], v36 offset:43008
    ds_read_b128 v[168:171], v36 offset:45056
    ds_read_b128 v[172:175], v36 offset:47104
    ds_read_b128 v[176:179], v36 offset:41216
    ds_read_b128 v[180:183], v36 offset:43264
    ds_read_b128 v[184:187], v36 offset:45312
    ds_read_b128 v[188:191], v36 offset:47360
    s_cmp_eq_u32 s23, 0
    s_cbranch_scc1 L_c_noitem_1
    s_nop 15
    s_nop 13
    buffer_load_dwordx2 v[88:89], v7, s[8:11], s89 offen sc1
    buffer_load_dwordx2 v[90:91], v8, s[8:11], s89 offen sc1
    s_nop 14
    buffer_load_dwordx2 v[60:61], v7, s[8:11], s89 offen sc1
    buffer_load_dwordx2 v[62:63], v8, s[8:11], s89 offen sc1
    s_nop 14
    buffer_load_dwordx2 v[64:65], v7, s[8:11], s89 offen sc1
    buffer_load_dwordx2 v[66:67], v8, s[8:11], s89 offen sc1
    s_waitcnt vmcnt(4)
    v_mfma_f32_16x16x32_bf16 v[92:95], v[32:35], v[88:91], 0
    v_max3_u32 v20, v88, v89, v90
    v_max_u32 v20, v20, v91
    v_cmp_eq_u32 vcc, -1, v20
    s_cbranch_vccnz L_c_RS_1_retry
L_c_RS_1_done:
    s_nop 3
    buffer_store_dwordx4 v[92:95], v82, s[8:11], s97 offen sc1
    buffer_store_dwordx4 v[28:31], v82, s[8:11], s99 offen sc1
    s_waitcnt lgkmcnt(0)
    v_mfma_f32_16x16x32_bf16 v[236:239], v[160:163], a[120:123], 0
    v_mfma_f32_16x16x32_bf16 v[240:243], v[176:179], a[120:123], 0
    v_mfma_f32_16x16x32_bf16 v[236:239], v[164:167], a[124:127], v[236:239]
    v_mfma_f32_16x16x32_bf16 v[240:243], v[180:183], a[124:127], v[240:243]
    v_mfma_f32_16x16x32_bf16 v[236:239], v[168:171], a[128:131], v[236:239]
    v_mfma_f32_16x16x32_bf16 v[240:243], v[184:187], a[128:131], v[240:243]
    v_mfma_f32_16x16x32_bf16 v[236:239], v[172:175], a[132:135], v[236:239]
    v_mfma_f32_16x16x32_bf16 v[240:243], v[188:191], a[132:135], v[240:243]
    v_mfma_f32_16x16x32_bf16 v[120:123], v[160:163], a[136:139], 0
    v_mfma_f32_16x16x32_bf16 v[124:127], v[176:179], a[136:139], 0
    v_mfma_f32_16x16x32_bf16 v[120:123], v[164:167], a[140:143], v[120:123]
    v_mfma_f32_16x16x32_bf16 v[124:127], v[180:183], a[140:143], v[124:127]
    v_mfma_f32_16x16x32_bf16 v[120:123], v[168:171], a[144:147], v[120:123]
    v_mfma_f32_16x16x32_bf16 v[124:127], v[184:187], a[144:147], v[124:127]
    v_mfma_f32_16x16x32_bf16 v[120:123], v[172:175], a[148:151], v[120:123]
    v_mfma_f32_16x16x32_bf16 v[124:127], v[188:191], a[148:151], v[124:127]
    v_cvt_pk_bf16_f32 v204, v236, v237
    v_cvt_pk_bf16_f32 v205, v238, v239
    v_cvt_pk_bf16_f32 v206, v240, v241
    v_cvt_pk_bf16_f32 v207, v242, v243
    v_mfma_f32_16x16x32_bf16 v[236:239], v[160:163], a[152:155], 0
    v_mfma_f32_16x16x32_bf16 v[240:243], v[176:179], a[152:155], 0
    v_mfma_f32_16x16x32_bf16 v[236:239], v[164:167], a[156:159], v[236:239]
    v_mfma_f32_16x16x32_bf16 v[240:243], v[180:183], a[156:159], v[240:243]
    v_mfma_f32_16x16x32_bf16 v[236:239], v[168:171], a[160:163], v[236:239]
    v_mfma_f32_16x16x32_bf16 v[240:243], v[184:187], a[160:163], v[240:243]
    v_mfma_f32_16x16x32_bf16 v[236:239], v[172:175], a[164:167], v[236:239]
    v_mfma_f32_16x16x32_bf16 v[240:243], v[188:191], a[164:167], v[240:243]
    v_cvt_pk_bf16_f32 v208, v120, v121
    v_cvt_pk_bf16_f32 v209, v122, v123
    v_cvt_pk_bf16_f32 v210, v124, v125
    v_cvt_pk_bf16_f32 v211, v126, v127
    s_nop 6
    v_cvt_pk_bf16_f32 v212, v236, v237
    v_cvt_pk_bf16_f32 v213, v238, v239
    v_cvt_pk_bf16_f32 v214, v240, v241
    v_cvt_pk_bf16_f32 v215, v242, v243
    buffer_load_dwordx4 v[108:111], v104, s[8:11], s97 offen sc1
    buffer_load_dwordx4 v[112:115], v105, s[8:11], s97 offen sc1
    buffer_load_dwordx4 v[116:119], v106, s[8:11], s97 offen sc1
    s_nop 15
    s_nop 15
    s_nop 7
    buffer_load_dwordx4 v[68:71], v104, s[8:11], s97 offen sc1
    buffer_load_dwordx4 v[72:75], v105, s[8:11], s97 offen sc1
    buffer_load_dwordx4 v[76:79], v106, s[8:11], s97 offen sc1
    s_waitcnt vmcnt(3)
    v_max3_u32 v20, v108, v109, v110
    v_max3_u32 v21, v111, v112, v113
    v_max3_u32 v20, v20, v114, v115
    v_max3_u32 v21, v21, v116, v117
    v_max3_u32 v20, v20, v118, v119
    v_max_u32 v20, v20, v21
    v_cmp_eq_u32 vcc, -1, v20
    s_cbranch_vccnz L_c_X_1_retry
    v_pk_add_f32 v[20:21], v[108:109], v[116:117]
    v_pk_add_f32 v[92:93], v[92:93], v[112:113]
    v_pk_add_f32 v[22:23], v[110:111], v[118:119]
    v_pk_add_f32 v[94:95], v[94:95], v[114:115]
L_c_X_1_done:
    v_pk_add_f32 v[92:93], v[92:93], v[20:21]
    v_pk_add_f32 v[94:95], v[94:95], v[22:23]
    v_cvt_pk_bf16_f32 v254, v92, v93
    v_cvt_pk_bf16_f32 v255, v94, v95
    buffer_store_dwordx2 v[254:255], v9, s[8:11], s94 offen
L_c_stepend_1:
    s_add_u32 s40, s40, 65536
    s_add_u32 s41, s41, 131072
    s_add_u32 s42, s42, 262144
    s_add_u32 s21, s21, 1
    s_barrier
L_c_loop_2:
    buffer_load_dwordx4 v[144:147], v10, s[8:11], s94 offen sc1
    buffer_load_dwordx4 v[148:151], v11, s[8:11], s94 offen sc1
    buffer_load_dwordx4 v[152:155], v12, s[8:11], s94 offen sc1
    s_nop 15
    s_nop 15
    s_nop 7
    buffer_load_dwordx4 v[128:131], v10, s[8:11], s94 offen sc1
    buffer_load_dwordx4 v[132:135], v11, s[8:11], s94 offen sc1
    buffer_load_dwordx4 v[136:139], v12, s[8:11], s94 offen sc1
    s_waitcnt vmcnt(3)
    ds_write_b128 v100, v[144:147]
    ds_write_b128 v101, v[148:151]
    ds_write_b128 v102, v[152:155]
    v_max3_u32 v20, v144, v145, v146
    v_max3_u32 v21, v147, v148, v149
    v_max3_u32 v20, v20, v150, v151
    v_max3_u32 v21, v21, v152, v153
    v_max3_u32 v20, v20, v154, v155
    v_max_u32 v20, v20, v21
    v_cmp_eq_u32 vcc, -1, v20
    s_cbranch_vccnz L_c_A_2_retry
L_c_A_2_done:
    s_waitcnt lgkmcnt(0)
    s_barrier
    ds_read_b128 v[40:43], v16 offset:0
    ds_read_b128 v[44:47], v16 offset:64
    ds_read_b128 v[48:51], v16 offset:128
    ds_read_b128 v[52:55], v16 offset:192
    ds_read_b128 v[56:59], v16 offset:256
    ds_read_b128 v[60:63], v16 offset:320
    ds_read_b128 v[64:67], v16 offset:384
    ds_read_b128 v[68:71], v16 offset:448
    ds_read_b128 v[72:75], v16 offset:512
    ds_read_b128 v[76:79], v16 offset:576
    s_waitcnt lgkmcnt(9)
    v_mfma_f32_16x16x32_bf16 v[120:123], a[0:3], v[40:43], 0
    v_mfma_f32_16x16x32_bf16 v[124:127], a[40:43], v[40:43], 0
    s_waitcnt lgkmcnt(8)
    v_mfma_f32_16x16x32_bf16 v[120:123], a[4:7], v[44:47], v[120:123]
    v_mfma_f32_16x16x32_bf16 v[124:127], a[44:47], v[44:47], v[124:127]
    s_waitcnt lgkmcnt(7)
    v_mfma_f32_16x16x32_bf16 v[120:123], a[8:11], v[48:51], v[120:123]
    v_mfma_f32_16x16x32_bf16 v[124:127], a[48:51], v[48:51], v[124:127]
    s_waitcnt lgkmcnt(6)
    v_mfma_f32_16x16x32_bf16 v[120:123], a[12:15], v[52:55], v[120:123]
    v_mfma_f32_16x16x32_bf16 v[124:127], a[52:55], v[52:55], v[124:127]
    s_waitcnt lgkmcnt(5)
    v_mfma_f32_16x16x32_bf16 v[120:123], a[16:19], v[56:59], v[120:123]
    v_mfma_f32_16x16x32_bf16 v[124:127], a[56:59], v[56:59], v[124:127]
    s_waitcnt lgkmcnt(4)
    v_mfma_f32_16x16x32_bf16 v[120:123], a[20:23], v[60:63], v[120:123]
    v_mfma_f32_16x16x32_bf16 v[124:127], a[60:63], v[60:63], v[124:127]
    s_waitcnt lgkmcnt(3)
    v_mfma_f32_16x16x32_bf16 v[120:123], a[24:27], v[64:67], v[120:123]
    v_mfma_f32_16x16x32_bf16 v[124:127], a[64:67], v[64:67], v[124:127]
    s_waitcnt lgkmcnt(2)
    v_mfma_f32_16x16x32_bf16 v[120:123], a[28:31], v[68:71], v[120:123]
    v_mfma_f32_16x16x32_bf16 v[124:127], a[68:71], v[68:71], v[124:127]
    s_waitcnt lgkmcnt(1)
    v_mfma_f32_16x16x32_bf16 v[120:123], a[32:35], v[72:75], v[120:123]
    v_mfma_f32_16x16x32_bf16 v[124:127], a[72:75], v[72:75], v[124:127]
    s_waitcnt lgkmcnt(0)
    v_mfma_f32_16x16x32_bf16 v[120:123], a[36:39], v[76:79], v[120:123]
    v_mfma_f32_16x16x32_bf16 v[124:127], a[76:79], v[76:79], v[124:127]
    v_mfma_f32_16x16x32_bf16 v[84:87], a[80:83], v[40:43], 0
    v_mfma_f32_16x16x32_bf16 v[84:87], a[84:87], v[44:47], v[84:87]
    s_nop 5
    v_add_f32_dpp v120, v124, v120 row_ror:8 row_mask:0xf bank_mask:0xf
    v_add_f32_dpp v121, v125, v121 row_ror:8 row_mask:0xf bank_mask:0xf
    v_add_f32_dpp v122, v126, v122 row_ror:8 row_mask:0xf bank_mask:0xf
    v_add_f32_dpp v123, v127, v123 row_ror:8 row_mask:0xf bank_mask:0xf
    v_cvt_pk_bf16_f32 v248, v120, v121
    v_cvt_pk_bf16_f32 v249, v122, v123
    buffer_store_dwordx2 v[248:249], v1, s[8:11], s86 offen
    v_mfma_f32_16x16x32_bf16 v[84:87], a[88:91], v[48:51], v[84:87]
    v_mfma_f32_16x16x32_bf16 v[84:87], a[92:95], v[52:55], v[84:87]
    v_mfma_f32_16x16x32_bf16 v[84:87], a[96:99], v[56:59], v[84:87]
    v_mfma_f32_16x16x32_bf16 v[84:87], a[100:103], v[60:63], v[84:87]
    v_mfma_f32_16x16x32_bf16 v[84:87], a[104:107], v[64:67], v[84:87]
    v_mfma_f32_16x16x32_bf16 v[84:87], a[108:111], v[68:71], v[84:87]
    v_mfma_f32_16x16x32_bf16 v[84:87], a[112:115], v[72:75], v[84:87]
    v_mfma_f32_16x16x32_bf16 v[84:87], a[116:119], v[76:79], v[84:87]
    ds_read_b128 v[160:163], v36 offset:32768
    ds_read_b128 v[164:167], v36 offset:34816
    ds_read_b128 v[168:171], v36 offset:36864
    ds_read_b128 v[172:175], v36 offset:38912
    ds_read_b128 v[176:179], v36 offset:33024
    ds_read_b128 v[180:183], v36 offset:35072
    ds_read_b128 v[184:187], v36 offset:37120
    ds_read_b128 v[188:191], v36 offset:39168
    v_cvt_pk_bf16_f32 v250, v84, v85
    v_cvt_pk_bf16_f32 v251, v86, v87
    buffer_store_dwordx2 v[250:251], v2, s[8:11], s86 offen
    buffer_load_dwordx4 v[40:43], v3, s[8:11], s86 offen sc1
    s_nop 15
    s_nop 3
    buffer_load_dwordx4 v[44:47], v3, s[8:11], s86 offen sc1
    s_waitcnt vmcnt(1)
    ds_write_b128 v17, v[40:43]
    v_max3_u32 v20, v40, v41, v42
    v_max_u32 v20, v20, v43
    v_cmp_eq_u32 vcc, -1, v20
    s_cbranch_vccnz L_c_R_2_retry
L_c_R_2_done:
    s_nop 11
    buffer_load_dwordx4 v[144:147], v4, s[8:11], s86 offen offset:0 sc1
    buffer_load_dwordx4 v[148:151], v4, s[8:11], s86 offen offset:512 sc1
    buffer_load_dwordx4 v[152:155], v4, s[8:11], s86 offen offset:1024 sc1
    buffer_load_dwordx4 v[156:159], v4, s[8:11], s86 offen offset:1536 sc1
L_c_Rv_2:
    s_waitcnt lgkmcnt(0)
    s_barrier
    ds_read_b128 v[128:131], v18 offset:0
    ds_read_b128 v[60:63], v19 offset:0
    ds_read_b128 v[132:135], v18 offset:512
    ds_read_b128 v[64:67], v19 offset:512
    ds_read_b128 v[136:139], v18 offset:1024
    ds_read_b128 v[68:71], v19 offset:1024
    ds_read_b128 v[140:143], v18 offset:1536
    ds_read_b128 v[72:75], v19 offset:1536
    s_waitcnt lgkmcnt(6)
    v_mfma_f32_16x16x32_bf16 v[192:195], v[160:163], v[128:131], 0
    v_mov_b32 v39, s21
    v_mfma_f32_16x16x32_bf16 v[196:199], v[176:179], v[128:131], 0
    buffer_store_dword v39, v38, s[8:11], s44 offen sc1
    v_mfma_f32_16x16x32_bf16 v[200:203], v[60:63], v[128:131], 0
    s_waitcnt lgkmcnt(4)
    v_mfma_f32_16x16x32_bf16 v[192:195], v[164:167], v[132:135], v[192:195]
    buffer_store_dwordx2 v[28:29], v1, s[8:11], s84 offen
    v_mfma_f32_16x16x32_bf16 v[196:199], v[180:183], v[132:135], v[196:199]
    buffer_store_dwordx2 v[28:29], v2, s[8:11], s84 offen
    v_mfma_f32_16x16x32_bf16 v[200:203], v[64:67], v[132:135], v[200:203]
    s_waitcnt lgkmcnt(2)
    v_mfma_f32_16x16x32_bf16 v[192:195], v[168:171], v[136:139], v[192:195]
    buffer_store_dwordx4 v[28:31], v5, s[8:11], s88 offen
    v_mfma_f32_16x16x32_bf16 v[196:199], v[184:187], v[136:139], v[196:199]
    buffer_store_dwordx2 v[28:29], v6, s[8:11], s88 offen
    v_mfma_f32_16x16x32_bf16 v[200:203], v[68:71], v[136:139], v[200:203]
    s_waitcnt lgkmcnt(0)
    v_mfma_f32_16x16x32_bf16 v[192:195], v[172:175], v[140:143], v[192:195]
    buffer_store_dwordx2 v[28:29], v9, s[8:11], s93 offen
    v_mfma_f32_16x16x32_bf16 v[196:199], v[188:191], v[140:143], v[196:199]
    v_mfma_f32_16x16x32_bf16 v[200:203], v[72:75], v[140:143], v[200:203]
    s_waitcnt vmcnt(6)
    v_max3_u32 v20, v144, v145, v146
    v_max3_u32 v21, v147, v148, v149
    v_max3_u32 v20, v20, v150, v151
    v_max3_u32 v21, v21, v152, v153
    v_max3_u32 v20, v20, v154, v155
    v_max3_u32 v21, v21, v156, v157
    v_max3_u32 v20, v20, v158, v159
    v_max_u32 v20, v20, v21
    v_cmp_eq_u32 vcc, -1, v20
    s_cbranch_vccnz L_c_pollV_2
L_c_okV_2:
    v_max3_f32 v24, v192, v193, v194
    v_max3_f32 v25, v195, v196, v197
    v_mfma_f32_16x16x32_bf16 v[236:239], v[144:147], a[120:123], 0
    v_max3_f32 v24, v24, v198, v199
    v_max3_f32 v25, v25, v200, v201
    v_max3_f32 v24, v24, v202, v203
    v_max_f32 v24, v24, v25
    v_mov_b32 v25, v24
    v_mfma_f32_16x16x32_bf16 v[240:243], v[144:147], a[136:139], 0
    s_nop 0
    v_permlane16_swap_b32 v25, v24
    v_max_f32 v24, v24, v25
    v_mov_b32 v25, v24
    v_mfma_f32_16x16x32_bf16 v[244:247], v[144:147], a[152:155], 0
    s_nop 0
    v_permlane32_swap_b32 v25, v24
    v_max_f32 v24, v24, v25
    v_mul_f32 v24, s38, v24
    v_mfma_f32_16x16x32_bf16 v[236:239], v[148:151], a[124:127], v[236:239]
    v_pk_fma_f32 v[192:193], v[192:193], s[38:39], v[24:25] op_sel_hi:[1,1,0] neg_lo:[0,0,1] neg_hi:[0,0,1]
    v_pk_fma_f32 v[194:195], v[194:195], s[38:39], v[24:25] op_sel_hi:[1,1,0] neg_lo:[0,0,1] neg_hi:[0,0,1]
    v_mfma_f32_16x16x32_bf16 v[240:243], v[148:151], a[140:143], v[240:243]
    v_pk_fma_f32 v[196:197], v[196:197], s[38:39], v[24:25] op_sel_hi:[1,1,0] neg_lo:[0,0,1] neg_hi:[0,0,1]
    v_pk_fma_f32 v[198:199], v[198:199], s[38:39], v[24:25] op_sel_hi:[1,1,0] neg_lo:[0,0,1] neg_hi:[0,0,1]
    v_mfma_f32_16x16x32_bf16 v[244:247], v[148:151], a[156:159], v[244:247]
    v_pk_fma_f32 v[200:201], v[200:201], s[38:39], v[24:25] op_sel_hi:[1,1,0] neg_lo:[0,0,1] neg_hi:[0,0,1]
    v_pk_fma_f32 v[202:203], v[202:203], s[38:39], v[24:25] op_sel_hi:[1,1,0] neg_lo:[0,0,1] neg_hi:[0,0,1]
    v_mfma_f32_16x16x32_bf16 v[236:239], v[152:155], a[128:131], v[236:239]
    v_exp_f32 v192, v192
    v_exp_f32 v193, v193
    v_mfma_f32_16x16x32_bf16 v[240:243], v[152:155], a[144:147], v[240:243]
    v_exp_f32 v194, v194
    v_exp_f32 v195, v195
    v_mfma_f32_16x16x32_bf16 v[244:247], v[152:155], a[160:163], v[244:247]
    v_exp_f32 v196, v196
    v_exp_f32 v197, v197
    v_mfma_f32_16x16x32_bf16 v[236:239], v[156:159], a[132:135], v[236:239]
    v_exp_f32 v198, v198
    v_exp_f32 v199, v199
    v_mfma_f32_16x16x32_bf16 v[240:243], v[156:159], a[148:151], v[240:243]
    v_exp_f32 v200, v200
    v_exp_f32 v201, v201
    v_mfma_f32_16x16x32_bf16 v[244:247], v[156:159], a[164:167], v[244:247]
    v_exp_f32 v202, v202
    v_exp_f32 v203, v203
    v_cvt_pk_bf16_f32 v228, v192, v193
    v_cvt_pk_bf16_f32 v229, v194, v195
    v_cvt_pk_bf16_f32 v230, v196, v197
    v_cvt_pk_bf16_f32 v231, v198, v199
    v_cvt_pk_bf16_f32 v232, v200, v201
    v_cvt_pk_bf16_f32 v233, v202, v203
    v_mfma_f32_16x16x32_bf16 v[20:23], a[168:171], v[228:231], 0
    v_mfma_f32_16x16x32_bf16 v[120:123], v[204:207], v[228:231], 0
    v_mfma_f32_16x16x32_bf16 v[124:127], v[208:211], v[228:231], 0
    v_mfma_f32_16x16x32_bf16 v[84:87], v[212:215], v[228:231], 0
    v_cvt_pk_bf16_f32 v216, v236, v237
    v_cvt_pk_bf16_f32 v217, v238, v239
    v_cvt_pk_bf16_f32 v220, v240, v241
    v_cvt_pk_bf16_f32 v221, v242, v243
    v_cvt_pk_bf16_f32 v224, v244, v245
    v_cvt_pk_bf16_f32 v225, v246, v247
    v_mfma_f32_16x16x32_bf16 v[20:23], a[172:175], v[232:235], v[20:23]
    v_mfma_f32_16x16x32_bf16 v[120:123], v[216:219], v[232:235], v[120:123]
    v_mfma_f32_16x16x32_bf16 v[124:127], v[220:223], v[232:235], v[124:127]
    v_mfma_f32_16x16x32_bf16 v[84:87], v[224:227], v[232:235], v[84:87]
    s_nop 4
    v_rcp_f32 v26, v20
    s_nop 1
    v_pk_mul_f32 v[120:121], v[120:121], v[26:27] op_sel_hi:[1,0]
    v_pk_mul_f32 v[122:123], v[122:123], v[26:27] op_sel_hi:[1,0]
    v_cvt_pk_bf16_f32 v56, v120, v121
    v_cvt_pk_bf16_f32 v57, v122, v123
    v_pk_mul_f32 v[124:125], v[124:125], v[26:27] op_sel_hi:[1,0]
    v_pk_mul_f32 v[126:127], v[126:127], v[26:27] op_sel_hi:[1,0]
    v_cvt_pk_bf16_f32 v58, v124, v125
    v_cvt_pk_bf16_f32 v59, v126, v127
    buffer_store_dwordx4 v[56:59], v5, s[8:11], s90 offen
    v_pk_mul_f32 v[84:85], v[84:85], v[26:27] op_sel_hi:[1,0]
    v_pk_mul_f32 v[86:87], v[86:87], v[26:27] op_sel_hi:[1,0]
    v_cvt_pk_bf16_f32 v254, v84, v85
    v_cvt_pk_bf16_f32 v255, v86, v87
    buffer_store_dwordx2 v[254:255], v6, s[8:11], s90 offen
    ds_read_b128 v[160:163], v36 offset:57344
    ds_read_b128 v[164:167], v36 offset:59392
    ds_read_b128 v[168:171], v36 offset:61440
    ds_read_b128 v[172:175], v36 offset:63488
    ds_read_b128 v[176:179], v36 offset:57600
    ds_read_b128 v[180:183], v36 offset:59648
    ds_read_b128 v[184:187], v36 offset:61696
    ds_read_b128 v[188:191], v36 offset:63744
    s_cmp_eq_u32 s23, 0
    s_cbranch_scc1 L_c_noitem_2
    s_nop 15
    s_nop 13
    buffer_load_dwordx2 v[88:89], v7, s[8:11], s90 offen sc1
    buffer_load_dwordx2 v[90:91], v8, s[8:11], s90 offen sc1
    s_nop 14
    buffer_load_dwordx2 v[60:61], v7, s[8:11], s90 offen sc1
    buffer_load_dwordx2 v[62:63], v8, s[8:11], s90 offen sc1
    s_nop 14
    buffer_load_dwordx2 v[64:65], v7, s[8:11], s90 offen sc1
    buffer_load_dwordx2 v[66:67], v8, s[8:11], s90 offen sc1
    s_waitcnt vmcnt(4)
    v_mfma_f32_16x16x32_bf16 v[92:95], v[32:35], v[88:91], 0
    v_max3_u32 v20, v88, v89, v90
    v_max_u32 v20, v20, v91
    v_cmp_eq_u32 vcc, -1, v20
    s_cbranch_vccnz L_c_RS_2_retry
L_c_RS_2_done:
    s_nop 3
    buffer_store_dwordx4 v[92:95], v82, s[8:11], s98 offen sc1
    buffer_store_dwordx4 v[28:31], v82, s[8:11], s96 offen sc1
    s_waitcnt lgkmcnt(0)
    v_mfma_f32_16x16x32_bf16 v[236:239], v[160:163], a[120:123], 0
    v_mfma_f32_16x16x32_bf16 v[240:243], v[176:179], a[120:123], 0
    v_mfma_f32_16x16x32_bf16 v[236:239], v[164:167], a[124:127], v[236:239]
    v_mfma_f32_16x16x32_bf16 v[240:243], v[180:183], a[124:127], v[240:243]
    v_mfma_f32_16x16x32_bf16 v[236:239], v[168:171], a[128:131], v[236:239]
    v_mfma_f32_16x16x32_bf16 v[240:243], v[184:187], a[128:131], v[240:243]
    v_mfma_f32_16x16x32_bf16 v[236:239], v[172:175], a[132:135], v[236:239]
    v_mfma_f32_16x16x32_bf16 v[240:243], v[188:191], a[132:135], v[240:243]
    v_mfma_f32_16x16x32_bf16 v[120:123], v[160:163], a[136:139], 0
    v_mfma_f32_16x16x32_bf16 v[124:127], v[176:179], a[136:139], 0
    v_mfma_f32_16x16x32_bf16 v[120:123], v[164:167], a[140:143], v[120:123]
    v_mfma_f32_16x16x32_bf16 v[124:127], v[180:183], a[140:143], v[124:127]
    v_mfma_f32_16x16x32_bf16 v[120:123], v[168:171], a[144:147], v[120:123]
    v_mfma_f32_16x16x32_bf16 v[124:127], v[184:187], a[144:147], v[124:127]
    v_mfma_f32_16x16x32_bf16 v[120:123], v[172:175], a[148:151], v[120:123]
    v_mfma_f32_16x16x32_bf16 v[124:127], v[188:191], a[148:151], v[124:127]
    v_cvt_pk_bf16_f32 v204, v236, v237
    v_cvt_pk_bf16_f32 v205, v238, v239
    v_cvt_pk_bf16_f32 v206, v240, v241
    v_cvt_pk_bf16_f32 v207, v242, v243
    v_mfma_f32_16x16x32_bf16 v[236:239], v[160:163], a[152:155], 0
    v_mfma_f32_16x16x32_bf16 v[240:243], v[176:179], a[152:155], 0
    v_mfma_f32_16x16x32_bf16 v[236:239], v[164:167], a[156:159], v[236:239]
    v_mfma_f32_16x16x32_bf16 v[240:243], v[180:183], a[156:159], v[240:243]
    v_mfma_f32_16x16x32_bf16 v[236:239], v[168:171], a[160:163], v[236:239]
    v_mfma_f32_16x16x32_bf16 v[240:243], v[184:187], a[160:163], v[240:243]
    v_mfma_f32_16x16x32_bf16 v[236:239], v[172:175], a[164:167], v[236:239]
    v_mfma_f32_16x16x32_bf16 v[240:243], v[188:191], a[164:167], v[240:243]
    v_cvt_pk_bf16_f32 v208, v120, v121
    v_cvt_pk_bf16_f32 v209, v122, v123
    v_cvt_pk_bf16_f32 v210, v124, v125
    v_cvt_pk_bf16_f32 v211, v126, v127
    s_nop 6
    v_cvt_pk_bf16_f32 v212, v236, v237
    v_cvt_pk_bf16_f32 v213, v238, v239
    v_cvt_pk_bf16_f32 v214, v240, v241
    v_cvt_pk_bf16_f32 v215, v242, v243
    buffer_load_dwordx4 v[108:111], v104, s[8:11], s98 offen sc1
    buffer_load_dwordx4 v[112:115], v105, s[8:11], s98 offen sc1
    buffer_load_dwordx4 v[116:119], v106, s[8:11], s98 offen sc1
    s_nop 15
    s_nop 15
    s_nop 7
    buffer_load_dwordx4 v[68:71], v104, s[8:11], s98 offen sc1
    buffer_load_dwordx4 v[72:75], v105, s[8:11], s98 offen sc1
    buffer_load_dwordx4 v[76:79], v106, s[8:11], s98 offen sc1
    s_waitcnt vmcnt(3)
    v_max3_u32 v20, v108, v109, v110
    v_max3_u32 v21, v111, v112, v113
    v_max3_u32 v20, v20, v114, v115
    v_max3_u32 v21, v21, v116, v117
    v_max3_u32 v20, v20, v118, v119
    v_max_u32 v20, v20, v21
    v_cmp_eq_u32 vcc, -1, v20
    s_cbranch_vccnz L_c_X_2_retry
    v_pk_add_f32 v[20:21], v[108:109], v[116:117]
    v_pk_add_f32 v[92:93], v[92:93], v[112:113]
    v_pk_add_f32 v[22:23], v[110:111], v[118:119]
    v_pk_add_f32 v[94:95], v[94:95], v[114:115]
L_c_X_2_done:
    v_pk_add_f32 v[92:93], v[92:93], v[20:21]
    v_pk_add_f32 v[94:95], v[94:95], v[22:23]
    v_cvt_pk_bf16_f32 v254, v92, v93
    v_cvt_pk_bf16_f32 v255, v94, v95
    buffer_store_dwordx2 v[254:255], v9, s[8:11], s95 offen
L_c_stepend_2:
    s_add_u32 s40, s40, 65536
    s_add_u32 s41, s41, 131072
    s_add_u32 s42, s42, 262144
    s_add_u32 s21, s21, 1
    s_barrier
L_c_loop_3:
    buffer_load_dwordx4 v[144:147], v10, s[8:11], s95 offen sc1
    buffer_load_dwordx4 v[148:151], v11, s[8:11], s95 offen sc1
    buffer_load_dwordx4 v[152:155], v12, s[8:11], s95 offen sc1
    s_nop 15
    s_nop 15
    s_nop 7
    buffer_load_dwordx4 v[128:131], v10, s[8:11], s95 offen sc1
    buffer_load_dwordx4 v[132:135], v11, s[8:11], s95 offen sc1
    buffer_load_dwordx4 v[136:139], v12, s[8:11], s95 offen sc1
    s_waitcnt vmcnt(3)
    ds_write_b128 v100, v[144:147]
    ds_write_b128 v101, v[148:151]
    ds_write_b128 v102, v[152:155]
    v_max3_u32 v20, v144, v145, v146
    v_max3_u32 v21, v147, v148, v149
    v_max3_u32 v20, v20, v150, v151
    v_max3_u32 v21, v21, v152, v153
    v_max3_u32 v20, v20, v154, v155
    v_max_u32 v20, v20, v21
    v_cmp_eq_u32 vcc, -1, v20
    s_cbranch_vccnz L_c_A_3_retry
L_c_A_3_done:
    s_waitcnt lgkmcnt(0)
    s_barrier
    ds_read_b128 v[40:43], v16 offset:0
    ds_read_b128 v[44:47], v16 offset:64
    ds_read_b128 v[48:51], v16 offset:128
    ds_read_b128 v[52:55], v16 offset:192
    ds_read_b128 v[56:59], v16 offset:256
    ds_read_b128 v[60:63], v16 offset:320
    ds_read_b128 v[64:67], v16 offset:384
    ds_read_b128 v[68:71], v16 offset:448
    ds_read_b128 v[72:75], v16 offset:512
    ds_read_b128 v[76:79], v16 offset:576
    s_waitcnt lgkmcnt(9)
    v_mfma_f32_16x16x32_bf16 v[120:123], a[0:3], v[40:43], 0
    v_mfma_f32_16x16x32_bf16 v[124:127], a[40:43], v[40:43], 0
    s_waitcnt lgkmcnt(8)
    v_mfma_f32_16x16x32_bf16 v[120:123], a[4:7], v[44:47], v[120:123]
    v_mfma_f32_16x16x32_bf16 v[124:127], a[44:47], v[44:47], v[124:127]
    s_waitcnt lgkmcnt(7)
    v_mfma_f32_16x16x32_bf16 v[120:123], a[8:11], v[48:51], v[120:123]
    v_mfma_f32_16x16x32_bf16 v[124:127], a[48:51], v[48:51], v[124:127]
    s_waitcnt lgkmcnt(6)
    v_mfma_f32_16x16x32_bf16 v[120:123], a[12:15], v[52:55], v[120:123]
    v_mfma_f32_16x16x32_bf16 v[124:127], a[52:55], v[52:55], v[124:127]
    s_waitcnt lgkmcnt(5)
    v_mfma_f32_16x16x32_bf16 v[120:123], a[16:19], v[56:59], v[120:123]
    v_mfma_f32_16x16x32_bf16 v[124:127], a[56:59], v[56:59], v[124:127]
    s_waitcnt lgkmcnt(4)
    v_mfma_f32_16x16x32_bf16 v[120:123], a[20:23], v[60:63], v[120:123]
    v_mfma_f32_16x16x32_bf16 v[124:127], a[60:63], v[60:63], v[124:127]
    s_waitcnt lgkmcnt(3)
    v_mfma_f32_16x16x32_bf16 v[120:123], a[24:27], v[64:67], v[120:123]
    v_mfma_f32_16x16x32_bf16 v[124:127], a[64:67], v[64:67], v[124:127]
    s_waitcnt lgkmcnt(2)
    v_mfma_f32_16x16x32_bf16 v[120:123], a[28:31], v[68:71], v[120:123]
    v_mfma_f32_16x16x32_bf16 v[124:127], a[68:71], v[68:71], v[124:127]
    s_waitcnt lgkmcnt(1)
    v_mfma_f32_16x16x32_bf16 v[120:123], a[32:35], v[72:75], v[120:123]
    v_mfma_f32_16x16x32_bf16 v[124:127], a[72:75], v[72:75], v[124:127]
    s_waitcnt lgkmcnt(0)
    v_mfma_f32_16x16x32_bf16 v[120:123], a[36:39], v[76:79], v[120:123]
    v_mfma_f32_16x16x32_bf16 v[124:127], a[76:79], v[76:79], v[124:127]
    v_mfma_f32_16x16x32_bf16 v[84:87], a[80:83], v[40:43], 0
    v_mfma_f32_16x16x32_bf16 v[84:87], a[84:87], v[44:47], v[84:87]
    s_nop 5
    v_add_f32_dpp v120, v124, v120 row_ror:8 row_mask:0xf bank_mask:0xf
    v_add_f32_dpp v121, v125, v121 row_ror:8 row_mask:0xf bank_mask:0xf
    v_add_f32_dpp v122, v126, v122 row_ror:8 row_mask:0xf bank_mask:0xf
    v_add_f32_dpp v123, v127, v123 row_ror:8 row_mask:0xf bank_mask:0xf
    v_cvt_pk_bf16_f32 v248, v120, v121
    v_cvt_pk_bf16_f32 v249, v122, v123
    buffer_store_dwordx2 v[248:249], v1, s[8:11], s87 offen
    v_mfma_f32_16x16x32_bf16 v[84:87], a[88:91], v[48:51], v[84:87]
    v_mfma_f32_16x16x32_bf16 v[84:87], a[92:95], v[52:55], v[84:87]
    v_mfma_f32_16x16x32_bf16 v[84:87], a[96:99], v[56:59], v[84:87]
    v_mfma_f32_16x16x32_bf16 v[84:87], a[100:103], v[60:63], v[84:87]
    v_mfma_f32_16x16x32_bf16 v[84:87], a[104:107], v[64:67], v[84:87]
    v_mfma_f32_16x16x32_bf16 v[84:87], a[108:111], v[68:71], v[84:87]
    v_mfma_f32_16x16x32_bf16 v[84:87], a[112:115], v[72:75], v[84:87]
    v_mfma_f32_16x16x32_bf16 v[84:87], a[116:119], v[76:79], v[84:87]
    ds_read_b128 v[160:163], v36 offset:49152
    ds_read_b128 v[164:167], v36 offset:51200
    ds_read_b128 v[168:171], v36 offset:53248
    ds_read_b128 v[172:175], v36 offset:55296
    ds_read_b128 v[176:179], v36 offset:49408
    ds_read_b128 v[180:183], v36 offset:51456
    ds_read_b128 v[184:187], v36 offset:53504
    ds_read_b128 v[188:191], v36 offset:55552
    v_cvt_pk_bf16_f32 v250, v84, v85
    v_cvt_pk_bf16_f32 v251, v86, v87
    buffer_store_dwordx2 v[250:251], v2, s[8:11], s87 offen
    s_cmp_eq_u32 s21, 63
    s_cbranch_scc1 L_c_final2
    buffer_load_dwordx4 v[40:43], v3, s[8:11], s87 offen sc1
    s_nop 15
    s_nop 3
    buffer_load_dwordx4 v[44:47], v3, s[8:11], s87 offen sc1
    s_waitcnt vmcnt(1)
    ds_write_b128 v17, v[40:43]
    v_max3_u32 v20, v40, v41, v42
    v_max_u32 v20, v20, v43
    v_cmp_eq_u32 vcc, -1, v20
    s_cbranch_vccnz L_c_R_3_retry
L_c_R_3_done:
    s_nop 11
    buffer_load_dwordx4 v[144:147], v4, s[8:11], s87 offen offset:0 sc1
    buffer_load_dwordx4 v[148:151], v4, s[8:11], s87 offen offset:512 sc1
    buffer_load_dwordx4 v[152:155], v4, s[8:11], s87 offen offset:1024 sc1
    buffer_load_dwordx4 v[156:159], v4, s[8:11], s87 offen offset:1536 sc1
L_c_Rv_3:
    s_waitcnt lgkmcnt(0)
    s_barrier
    ds_read_b128 v[128:131], v18 offset:0
    ds_read_b128 v[60:63], v19 offset:0
    ds_read_b128 v[132:135], v18 offset:512
    ds_read_b128 v[64:67], v19 offset:512
    ds_read_b128 v[136:139], v18 offset:1024
    ds_read_b128 v[68:71], v19 offset:1024
    ds_read_b128 v[140:143], v18 offset:1536
    ds_read_b128 v[72:75], v19 offset:1536
    s_waitcnt lgkmcnt(6)
    v_mfma_f32_16x16x32_bf16 v[192:195], v[160:163], v[128:131], 0
    v_mov_b32 v39, s21
    v_mfma_f32_16x16x32_bf16 v[196:199], v[176:179], v[128:131], 0
    buffer_store_dword v39, v38, s[8:11], s44 offen sc1
    v_mfma_f32_16x16x32_bf16 v[200:203], v[60:63], v[128:131], 0
    s_waitcnt lgkmcnt(4)
    v_mfma_f32_16x16x32_bf16 v[192:195], v[164:167], v[132:135], v[192:195]
    buffer_store_dwordx2 v[28:29], v1, s[8:11], s85 offen
    v_mfma_f32_16x16x32_bf16 v[196:199], v[180:183], v[132:135], v[196:199]
    buffer_store_dwordx2 v[28:29], v2, s[8:11], s85 offen
    v_mfma_f32_16x16x32_bf16 v[200:203], v[64:67], v[132:135], v[200:203]
    s_waitcnt lgkmcnt(2)
    v_mfma_f32_16x16x32_bf16 v[192:195], v[168:171], v[136:139], v[192:195]
    buffer_store_dwordx4 v[28:31], v5, s[8:11], s89 offen
    v_mfma_f32_16x16x32_bf16 v[196:199], v[184:187], v[136:139], v[196:199]
    buffer_store_dwordx2 v[28:29], v6, s[8:11], s89 offen
    v_mfma_f32_16x16x32_bf16 v[200:203], v[68:71], v[136:139], v[200:203]
    s_waitcnt lgkmcnt(0)
    v_mfma_f32_16x16x32_bf16 v[192:195], v[172:175], v[140:143], v[192:195]
    buffer_store_dwordx2 v[28:29], v9, s[8:11], s94 offen
    v_mfma_f32_16x16x32_bf16 v[196:199], v[188:191], v[140:143], v[196:199]
    v_mfma_f32_16x16x32_bf16 v[200:203], v[72:75], v[140:143], v[200:203]
    s_waitcnt vmcnt(6)
    v_max3_u32 v20, v144, v145, v146
    v_max3_u32 v21, v147, v148, v149
    v_max3_u32 v20, v20, v150, v151
    v_max3_u32 v21, v21, v152, v153
    v_max3_u32 v20, v20, v154, v155
    v_max3_u32 v21, v21, v156, v157
    v_max3_u32 v20, v20, v158, v159
    v_max_u32 v20, v20, v21
    v_cmp_eq_u32 vcc, -1, v20
    s_cbranch_vccnz L_c_pollV_3
L_c_okV_3:
    s_cmp_eq_u32 s21, 63
    s_cbranch_scc1 L_c_final
    v_max3_f32 v24, v192, v193, v194
    v_max3_f32 v25, v195, v196, v197
    v_mfma_f32_16x16x32_bf16 v[236:239], v[144:147], a[120:123], 0
    v_max3_f32 v24, v24, v198, v199
    v_max3_f32 v25, v25, v200, v201
    v_max3_f32 v24, v24, v202, v203
    v_max_f32 v24, v24, v25
    v_mov_b32 v25, v24
    v_mfma_f32_16x16x32_bf16 v[240:243], v[144:147], a[136:139], 0
    s_nop 0
    v_permlane16_swap_b32 v25, v24
    v_max_f32 v24, v24, v25
    v_mov_b32 v25, v24
    v_mfma_f32_16x16x32_bf16 v[244:247], v[144:147], a[152:155], 0
    s_nop 0
    v_permlane32_swap_b32 v25, v24
    v_max_f32 v24, v24, v25
    v_mul_f32 v24, s38, v24
    v_mfma_f32_16x16x32_bf16 v[236:239], v[148:151], a[124:127], v[236:239]
    v_pk_fma_f32 v[192:193], v[192:193], s[38:39], v[24:25] op_sel_hi:[1,1,0] neg_lo:[0,0,1] neg_hi:[0,0,1]
    v_pk_fma_f32 v[194:195], v[194:195], s[38:39], v[24:25] op_sel_hi:[1,1,0] neg_lo:[0,0,1] neg_hi:[0,0,1]
    v_mfma_f32_16x16x32_bf16 v[240:243], v[148:151], a[140:143], v[240:243]
    v_pk_fma_f32 v[196:197], v[196:197], s[38:39], v[24:25] op_sel_hi:[1,1,0] neg_lo:[0,0,1] neg_hi:[0,0,1]
    v_pk_fma_f32 v[198:199], v[198:199], s[38:39], v[24:25] op_sel_hi:[1,1,0] neg_lo:[0,0,1] neg_hi:[0,0,1]
    v_mfma_f32_16x16x32_bf16 v[244:247], v[148:151], a[156:159], v[244:247]
    v_pk_fma_f32 v[200:201], v[200:201], s[38:39], v[24:25] op_sel_hi:[1,1,0] neg_lo:[0,0,1] neg_hi:[0,0,1]
    v_pk_fma_f32 v[202:203], v[202:203], s[38:39], v[24:25] op_sel_hi:[1,1,0] neg_lo:[0,0,1] neg_hi:[0,0,1]
    v_mfma_f32_16x16x32_bf16 v[236:239], v[152:155], a[128:131], v[236:239]
    v_exp_f32 v192, v192
    v_exp_f32 v193, v193
    v_mfma_f32_16x16x32_bf16 v[240:243], v[152:155], a[144:147], v[240:243]
    v_exp_f32 v194, v194
    v_exp_f32 v195, v195
    v_mfma_f32_16x16x32_bf16 v[244:247], v[152:155], a[160:163], v[244:247]
    v_exp_f32 v196, v196
    v_exp_f32 v197, v197
    v_mfma_f32_16x16x32_bf16 v[236:239], v[156:159], a[132:135], v[236:239]
    v_exp_f32 v198, v198
    v_exp_f32 v199, v199
    v_mfma_f32_16x16x32_bf16 v[240:243], v[156:159], a[148:151], v[240:243]
    v_exp_f32 v200, v200
    v_exp_f32 v201, v201
    v_mfma_f32_16x16x32_bf16 v[244:247], v[156:159], a[164:167], v[244:247]
    v_exp_f32 v202, v202
    v_exp_f32 v203, v203
    v_cvt_pk_bf16_f32 v228, v192, v193
    v_cvt_pk_bf16_f32 v229, v194, v195
    v_cvt_pk_bf16_f32 v230, v196, v197
    v_cvt_pk_bf16_f32 v231, v198, v199
    v_cvt_pk_bf16_f32 v232, v200, v201
    v_cvt_pk_bf16_f32 v233, v202, v203
    v_mfma_f32_16x16x32_bf16 v[20:23], a[168:171], v[228:231], 0
    v_mfma_f32_16x16x32_bf16 v[120:123], v[204:207], v[228:231], 0
    v_mfma_f32_16x16x32_bf16 v[124:127], v[208:211], v[228:231], 0
    v_mfma_f32_16x16x32_bf16 v[84:87], v[212:215], v[228:231], 0
    v_cvt_pk_bf16_f32 v216, v236, v237
    v_cvt_pk_bf16_f32 v217, v238, v239
    v_cvt_pk_bf16_f32 v220, v240, v241
    v_cvt_pk_bf16_f32 v221, v242, v243
    v_cvt_pk_bf16_f32 v224, v244, v245
    v_cvt_pk_bf16_f32 v225, v246, v247
    v_mfma_f32_16x16x32_bf16 v[20:23], a[172:175], v[232:235], v[20:23]
    v_mfma_f32_16x16x32_bf16 v[120:123], v[216:219], v[232:235], v[120:123]
    v_mfma_f32_16x16x32_bf16 v[124:127], v[220:223], v[232:235], v[124:127]
    v_mfma_f32_16x16x32_bf16 v[84:87], v[224:227], v[232:235], v[84:87]
    s_nop 4
    v_rcp_f32 v26, v20
    s_nop 1
    v_pk_mul_f32 v[120:121], v[120:121], v[26:27] op_sel_hi:[1,0]
    v_pk_mul_f32 v[122:123], v[122:123], v[26:27] op_sel_hi:[1,0]
    v_cvt_pk_bf16_f32 v56, v120, v121
    v_cvt_pk_bf16_f32 v57, v122, v123
    v_pk_mul_f32 v[124:125], v[124:125], v[26:27] op_sel_hi:[1,0]
    v_pk_mul_f32 v[126:127], v[126:127], v[26:27] op_sel_hi:[1,0]
    v_cvt_pk_bf16_f32 v58, v124, v125
    v_cvt_pk_bf16_f32 v59, v126, v127
    buffer_store_dwordx4 v[56:59], v5, s[8:11], s91 offen
    v_pk_mul_f32 v[84:85], v[84:85], v[26:27] op_sel_hi:[1,0]
    v_pk_mul_f32 v[86:87], v[86:87], v[26:27] op_sel_hi:[1,0]
    v_cvt_pk_bf16_f32 v254, v84, v85
    v_cvt_pk_bf16_f32 v255, v86, v87
    buffer_store_dwordx2 v[254:255], v6, s[8:11], s91 offen
    ds_read_b128 v[160:163], v36 offset:8192
    ds_read_b128 v[164:167], v36 offset:10240
    ds_read_b128 v[168:171], v36 offset:12288
    ds_read_b128 v[172:175], v36 offset:14336
    ds_read_b128 v[176:179], v36 offset:8448
    ds_read_b128 v[180:183], v36 offset:10496
    ds_read_b128 v[184:187], v36 offset:12544
    ds_read_b128 v[188:191], v36 offset:14592
    s_cmp_eq_u32 s23, 0
    s_cbranch_scc1 L_c_noitem_3
    s_nop 15
    s_nop 13
    buffer_load_dwordx2 v[88:89], v7, s[8:11], s91 offen sc1
    buffer_load_dwordx2 v[90:91], v8, s[8:11], s91 offen sc1
    s_nop 14
    buffer_load_dwordx2 v[60:61], v7, s[8:11], s91 offen sc1
    buffer_load_dwordx2 v[62:63], v8, s[8:11], s91 offen sc1
    s_nop 14
    buffer_load_dwordx2 v[64:65], v7, s[8:11], s91 offen sc1
    buffer_load_dwordx2 v[66:67], v8, s[8:11], s91 offen sc1
    s_waitcnt vmcnt(4)
    v_mfma_f32_16x16x32_bf16 v[92:95], v[32:35], v[88:91], 0
    v_max3_u32 v20, v88, v89, v90
    v_max_u32 v20, v20, v91
    v_cmp_eq_u32 vcc, -1, v20
    s_cbranch_vccnz L_c_RS_3_retry
L_c_RS_3_done:
    s_nop 3
    buffer_store_dwordx4 v[92:95], v82, s[8:11], s99 offen sc1
    buffer_store_dwordx4 v[28:31], v82, s[8:11], s97 offen sc1
    s_waitcnt lgkmcnt(0)
    v_mfma_f32_16x16x32_bf16 v[236:239], v[160:163], a[120:123], 0
    v_mfma_f32_16x16x32_bf16 v[240:243], v[176:179], a[120:123], 0
    v_mfma_f32_16x16x32_bf16 v[236:239], v[164:167], a[124:127], v[236:239]
    v_mfma_f32_16x16x32_bf16 v[240:243], v[180:183], a[124:127], v[240:243]
    v_mfma_f32_16x16x32_bf16 v[236:239], v[168:171], a[128:131], v[236:239]
    v_mfma_f32_16x16x32_bf16 v[240:243], v[184:187], a[128:131], v[240:243]
    v_mfma_f32_16x16x32_bf16 v[236:239], v[172:175], a[132:135], v[236:239]
    v_mfma_f32_16x16x32_bf16 v[240:243], v[188:191], a[132:135], v[240:243]
    v_mfma_f32_16x16x32_bf16 v[120:123], v[160:163], a[136:139], 0
    v_mfma_f32_16x16x32_bf16 v[124:127], v[176:179], a[136:139], 0
    v_mfma_f32_16x16x32_bf16 v[120:123], v[164:167], a[140:143], v[120:123]
    v_mfma_f32_16x16x32_bf16 v[124:127], v[180:183], a[140:143], v[124:127]
    v_mfma_f32_16x16x32_bf16 v[120:123], v[168:171], a[144:147], v[120:123]
    v_mfma_f32_16x16x32_bf16 v[124:127], v[184:187], a[144:147], v[124:127]
    v_mfma_f32_16x16x32_bf16 v[120:123], v[172:175], a[148:151], v[120:123]
    v_mfma_f32_16x16x32_bf16 v[124:127], v[188:191], a[148:151], v[124:127]
    v_cvt_pk_bf16_f32 v204, v236, v237
    v_cvt_pk_bf16_f32 v205, v238, v239
    v_cvt_pk_bf16_f32 v206, v240, v241
    v_cvt_pk_bf16_f32 v207, v242, v243
    v_mfma_f32_16x16x32_bf16 v[236:239], v[160:163], a[152:155], 0
    v_mfma_f32_16x16x32_bf16 v[240:243], v[176:179], a[152:155], 0
    v_mfma_f32_16x16x32_bf16 v[236:239], v[164:167], a[156:159], v[236:239]
    v_mfma_f32_16x16x32_bf16 v[240:243], v[180:183], a[156:159], v[240:243]
    v_mfma_f32_16x16x32_bf16 v[236:239], v[168:171], a[160:163], v[236:239]
    v_mfma_f32_16x16x32_bf16 v[240:243], v[184:187], a[160:163], v[240:243]
    v_mfma_f32_16x16x32_bf16 v[236:239], v[172:175], a[164:167], v[236:239]
    v_mfma_f32_16x16x32_bf16 v[240:243], v[188:191], a[164:167], v[240:243]
    v_cvt_pk_bf16_f32 v208, v120, v121
    v_cvt_pk_bf16_f32 v209, v122, v123
    v_cvt_pk_bf16_f32 v210, v124, v125
    v_cvt_pk_bf16_f32 v211, v126, v127
    s_nop 6
    v_cvt_pk_bf16_f32 v212, v236, v237
    v_cvt_pk_bf16_f32 v213, v238, v239
    v_cvt_pk_bf16_f32 v214, v240, v241
    v_cvt_pk_bf16_f32 v215, v242, v243
    buffer_load_dwordx4 v[108:111], v104, s[8:11], s99 offen sc1
    buffer_load_dwordx4 v[112:115], v105, s[8:11], s99 offen sc1
    buffer_load_dwordx4 v[116:119], v106, s[8:11], s99 offen sc1
    s_nop 15
    s_nop 15
    s_nop 7
    buffer_load_dwordx4 v[68:71], v104, s[8:11], s99 offen sc1
    buffer_load_dwordx4 v[72:75], v105, s[8:11], s99 offen sc1
    buffer_load_dwordx4 v[76:79], v106, s[8:11], s99 offen sc1
    s_waitcnt vmcnt(3)
    v_max3_u32 v20, v108, v109, v110
    v_max3_u32 v21, v111, v112, v113
    v_max3_u32 v20, v20, v114, v115
    v_max3_u32 v21, v21, v116, v117
    v_max3_u32 v20, v20, v118, v119
    v_max_u32 v20, v20, v21
    v_cmp_eq_u32 vcc, -1, v20
    s_cbranch_vccnz L_c_X_3_retry
    v_pk_add_f32 v[20:21], v[108:109], v[116:117]
    v_pk_add_f32 v[92:93], v[92:93], v[112:113]
    v_pk_add_f32 v[22:23], v[110:111], v[118:119]
    v_pk_add_f32 v[94:95], v[94:95], v[114:115]
L_c_X_3_done:
    v_pk_add_f32 v[92:93], v[92:93], v[20:21]
    v_pk_add_f32 v[94:95], v[94:95], v[22:23]
    v_cvt_pk_bf16_f32 v254, v92, v93
    v_cvt_pk_bf16_f32 v255, v94, v95
    buffer_store_dwordx2 v[254:255], v9, s[8:11], s92 offen
L_c_stepend_3:
    s_add_u32 s40, s40, 65536
    s_add_u32 s41, s41, 131072
    s_add_u32 s42, s42, 262144
    s_add_u32 s21, s21, 1
    s_barrier
    s_branch L_c_loop_0
L_c_A_0_retry:
    buffer_load_dwordx4 v[144:147], v10, s[8:11], s92 offen sc1
    buffer_load_dwordx4 v[148:151], v11, s[8:11], s92 offen sc1
    buffer_load_dwordx4 v[152:155], v12, s[8:11], s92 offen sc1
L_c_A_0_loop:
    s_waitcnt vmcnt(3)
    ds_write_b128 v100, v[128:131]
    ds_write_b128 v101, v[132:135]
    ds_write_b128 v102, v[136:139]
    v_max3_u32 v20, v128, v129, v130
    v_max3_u32 v21, v131, v132, v133
    v_max3_u32 v20, v20, v134, v135
    v_max3_u32 v21, v21, v136, v137
    v_max3_u32 v20, v20, v138, v139
    v_max_u32 v20, v20, v21
    v_cmp_eq_u32 vcc, -1, v20
    s_cbranch_vccz L_c_A_0_ok1
    buffer_load_dwordx4 v[128:131], v10, s[8:11], s92 offen sc1
    buffer_load_dwordx4 v[132:135], v11, s[8:11], s92 offen sc1
    buffer_load_dwordx4 v[136:139], v12, s[8:11], s92 offen sc1
    s_waitcnt vmcnt(3)
    ds_write_b128 v100, v[144:147]
    ds_write_b128 v101, v[148:151]
    ds_write_b128 v102, v[152:155]
    v_max3_u32 v20, v144, v145, v146
    v_max3_u32 v21, v147, v148, v149
    v_max3_u32 v20, v20, v150, v151
    v_max3_u32 v21, v21, v152, v153
    v_max3_u32 v20, v20, v154, v155
    v_max_u32 v20, v20, v21
    v_cmp_eq_u32 vcc, -1, v20
    s_cbranch_vccz L_c_A_0_ok0
    buffer_load_dwordx4 v[144:147], v10, s[8:11], s92 offen sc1
    buffer_load_dwordx4 v[148:151], v11, s[8:11], s92 offen sc1
    buffer_load_dwordx4 v[152:155], v12, s[8:11], s92 offen sc1
    s_sub_u32 s22, s22, 1
    s_cbranch_scc0 L_c_A_0_loop
    s_branch L_timeout
L_c_A_0_ok0:
    s_branch L_c_A_0_done
L_c_A_0_ok1:
    s_branch L_c_A_0_done
L_c_R_0_retry:
    buffer_load_dwordx4 v[40:43], v3, s[8:11], s84 offen sc1
L_c_R_0_loop:
    s_waitcnt vmcnt(1)
    ds_write_b128 v17, v[44:47]
    v_max3_u32 v20, v44, v45, v46
    v_max_u32 v20, v20, v47
    v_cmp_eq_u32 vcc, -1, v20
    s_cbranch_vccz L_c_R_0_ok1
    buffer_load_dwordx4 v[44:47], v3, s[8:11], s84 offen sc1
    s_waitcnt vmcnt(1)
    ds_write_b128 v17, v[40:43]
    v_max3_u32 v20, v40, v41, v42
    v_max_u32 v20, v20, v43
    v_cmp_eq_u32 vcc, -1, v20
    s_cbranch_vccz L_c_R_0_ok0
    buffer_load_dwordx4 v[40:43], v3, s[8:11], s84 offen sc1
    s_sub_u32 s22, s22, 1
    s_cbranch_scc0 L_c_R_0_loop
    s_branch L_timeout
L_c_R_0_ok0:
    s_branch L_c_R_0_done
L_c_R_0_ok1:
    s_branch L_c_R_0_done
L_c_pollV_0:
    buffer_load_dwordx4 v[144:147], v4, s[8:11], s84 offen offset:0 sc1
    buffer_load_dwordx4 v[148:151], v4, s[8:11], s84 offen offset:512 sc1
    buffer_load_dwordx4 v[152:155], v4, s[8:11], s84 offen offset:1024 sc1
    buffer_load_dwordx4 v[156:159], v4, s[8:11], s84 offen offset:1536 sc1
    s_waitcnt vmcnt(0)
    v_max3_u32 v20, v144, v145, v146
    v_max3_u32 v21, v147, v148, v149
    v_max3_u32 v20, v20, v150, v151
    v_max3_u32 v21, v21, v152, v153
    v_max3_u32 v20, v20, v154, v155
    v_max3_u32 v21, v21, v156, v157
    v_max3_u32 v20, v20, v158, v159
    v_max_u32 v20, v20, v21
    v_cmp_eq_u32 vcc, -1, v20
    s_cbranch_vccz L_c_okV_0
    s_sub_u32 s22, s22, 1
    s_cbranch_scc0 L_c_pollV_0
    s_branch L_timeout
L_c_RS_0_retry:
    buffer_load_dwordx2 v[88:89], v7, s[8:11], s88 offen sc1
    buffer_load_dwordx2 v[90:91], v8, s[8:11], s88 offen sc1
L_c_RS_0_loop:
    s_waitcnt vmcnt(4)
    v_mfma_f32_16x16x32_bf16 v[92:95], v[32:35], v[60:63], 0
    v_max3_u32 v20, v60, v61, v62
    v_max_u32 v20, v20, v63
    v_cmp_eq_u32 vcc, -1, v20
    s_cbranch_vccz L_c_RS_0_ok1
    buffer_load_dwordx2 v[60:61], v7, s[8:11], s88 offen sc1
    buffer_load_dwordx2 v[62:63], v8, s[8:11], s88 offen sc1
    s_waitcnt vmcnt(4)
    v_mfma_f32_16x16x32_bf16 v[92:95], v[32:35], v[64:67], 0
    v_max3_u32 v20, v64, v65, v66
    v_max_u32 v20, v20, v67
    v_cmp_eq_u32 vcc, -1, v20
    s_cbranch_vccz L_c_RS_0_ok2
    buffer_load_dwordx2 v[64:65], v7, s[8:11], s88 offen sc1
    buffer_load_dwordx2 v[66:67], v8, s[8:11], s88 offen sc1
    s_waitcnt vmcnt(4)
    v_mfma_f32_16x16x32_bf16 v[92:95], v[32:35], v[88:91], 0
    v_max3_u32 v20, v88, v89, v90
    v_max_u32 v20, v20, v91
    v_cmp_eq_u32 vcc, -1, v20
    s_cbranch_vccz L_c_RS_0_ok0
    buffer_load_dwordx2 v[88:89], v7, s[8:11], s88 offen sc1
    buffer_load_dwordx2 v[90:91], v8, s[8:11], s88 offen sc1
    s_sub_u32 s22, s22, 1
    s_cbranch_scc0 L_c_RS_0_loop
    s_branch L_timeout
L_c_RS_0_ok0:
    s_branch L_c_RS_0_done
L_c_RS_0_ok1:
    s_branch L_c_RS_0_done
L_c_RS_0_ok2:
    s_branch L_c_RS_0_done
L_c_X_0_retry:
    buffer_load_dwordx4 v[108:111], v104, s[8:11], s96 offen sc1
    buffer_load_dwordx4 v[112:115], v105, s[8:11], s96 offen sc1
    buffer_load_dwordx4 v[116:119], v106, s[8:11], s96 offen sc1
L_c_X_0_loop:
    s_waitcnt vmcnt(3)
    v_max3_u32 v20, v68, v69, v70
    v_max3_u32 v21, v71, v72, v73
    v_max3_u32 v20, v20, v74, v75
    v_max3_u32 v21, v21, v76, v77
    v_max3_u32 v20, v20, v78, v79
    v_max_u32 v20, v20, v21
    v_cmp_eq_u32 vcc, -1, v20
    s_cbranch_vccz L_c_X_0_ok1
    buffer_load_dwordx4 v[68:71], v104, s[8:11], s96 offen sc1
    buffer_load_dwordx4 v[72:75], v105, s[8:11], s96 offen sc1
    buffer_load_dwordx4 v[76:79], v106, s[8:11], s96 offen sc1
    s_waitcnt vmcnt(3)
    v_max3_u32 v20, v108, v109, v110
    v_max3_u32 v21, v111, v112, v113
    v_max3_u32 v20, v20, v114, v115
    v_max3_u32 v21, v21, v116, v117
    v_max3_u32 v20, v20, v118, v119
    v_max_u32 v20, v20, v21
    v_cmp_eq_u32 vcc, -1, v20
    s_cbranch_vccz L_c_X_0_ok0
    buffer_load_dwordx4 v[108:111], v104, s[8:11], s96 offen sc1
    buffer_load_dwordx4 v[112:115], v105, s[8:11], s96 offen sc1
    buffer_load_dwordx4 v[116:119], v106, s[8:11], s96 offen sc1
    s_sub_u32 s22, s22, 1
    s_cbranch_scc0 L_c_X_0_loop
    s_branch L_timeout
L_c_X_0_ok0:
    v_pk_add_f32 v[20:21], v[108:109], v[116:117]
    v_pk_add_f32 v[92:93], v[92:93], v[112:113]
    v_pk_add_f32 v[22:23], v[110:111], v[118:119]
    v_pk_add_f32 v[94:95], v[94:95], v[114:115]
    s_branch L_c_X_0_done
L_c_X_0_ok1:
    v_pk_add_f32 v[20:21], v[68:69], v[76:77]
    v_pk_add_f32 v[92:93], v[92:93], v[72:73]
    v_pk_add_f32 v[22:23], v[70:71], v[78:79]
    v_pk_add_f32 v[94:95], v[94:95], v[74:75]
    s_branch L_c_X_0_done
L_c_noitem_0:
    s_cmp_lg_u32 s20, 3
    s_cbranch_scc1 L_c_w2_0
    s_mov_b32 s30, 105906176
    buffer_load_dword v24, v37, s[8:11], s30 offen sc1
    buffer_load_dwordx4 v[40:43], v83, s[8:11], s84 offen sc1
    buffer_load_dwordx4 v[44:47], v98, s[8:11], s84 offen sc1
    s_waitcnt vmcnt(0)
    buffer_store_dwordx4 v[40:43], v80, s[8:11], s40 offen sc1
    buffer_store_dwordx4 v[44:47], v81, s[8:11], s41 offen sc1
    s_cmp_gt_u32 s21, 60
    s_cbranch_scc1 L_c_kvskip_105
    s_add_u32 s31, s21, 3
L_c_wk_0:
    v_cmp_gt_u32 vcc, s31, v24
    s_nop 3
    s_and_b64 vcc, vcc, 3
    s_cbranch_vccz L_c_wk_0_ok
    s_mov_b32 s30, 105906176
    buffer_load_dword v24, v37, s[8:11], s30 offen sc1
    s_waitcnt vmcnt(0)
    s_sub_u32 s22, s22, 1
    s_cbranch_scc0 L_c_wk_0
    s_branch L_timeout
L_c_wk_0_ok:
    s_mov_b32 m0, 32768
    s_add_u32 s32, s42, 16777216
    buffer_load_dwordx4 v96, s[8:11], s32 offen sc1 lds
    s_mov_b32 m0, 33792
    s_add_u32 s32, s42, 16778240
    buffer_load_dwordx4 v96, s[8:11], s32 offen sc1 lds
    s_mov_b32 m0, 34816
    s_add_u32 s32, s42, 16779264
    buffer_load_dwordx4 v96, s[8:11], s32 offen sc1 lds
    s_mov_b32 m0, 35840
    s_add_u32 s32, s42, 16780288
    buffer_load_dwordx4 v96, s[8:11], s32 offen sc1 lds
    s_mov_b32 m0, 36864
    s_add_u32 s32, s42, 16781312
    buffer_load_dwordx4 v96, s[8:11], s32 offen sc1 lds
    s_mov_b32 m0, 37888
    s_add_u32 s32, s42, 16782336
    buffer_load_dwordx4 v96, s[8:11], s32 offen sc1 lds
    s_mov_b32 m0, 38912
    s_add_u32 s32, s42, 16783360
    buffer_load_dwordx4 v96, s[8:11], s32 offen sc1 lds
    s_mov_b32 m0, 39936
    s_add_u32 s32, s42, 16784384
    buffer_load_dwordx4 v96, s[8:11], s32 offen sc1 lds
    s_mov_b32 m0, 40960
    s_add_u32 s32, s42, 33554432
    buffer_load_dwordx4 v96, s[8:11], s32 offen sc1 lds
    s_mov_b32 m0, 41984
    s_add_u32 s32, s42, 33555456
    buffer_load_dwordx4 v96, s[8:11], s32 offen sc1 lds
    s_mov_b32 m0, 43008
    s_add_u32 s32, s42, 33556480
    buffer_load_dwordx4 v96, s[8:11], s32 offen sc1 lds
    s_mov_b32 m0, 44032
    s_add_u32 s32, s42, 33557504
    buffer_load_dwordx4 v96, s[8:11], s32 offen sc1 lds
    s_mov_b32 m0, 45056
    s_add_u32 s32, s42, 33558528
    buffer_load_dwordx4 v96, s[8:11], s32 offen sc1 lds
    s_mov_b32 m0, 46080
    s_add_u32 s32, s42, 33559552
    buffer_load_dwordx4 v96, s[8:11], s32 offen sc1 lds
    s_mov_b32 m0, 47104
    s_add_u32 s32, s42, 33560576
    buffer_load_dwordx4 v96, s[8:11], s32 offen sc1 lds
    s_mov_b32 m0, 48128
    s_add_u32 s32, s42, 33561600
    buffer_load_dwordx4 v96, s[8:11], s32 offen sc1 lds
L_c_kvskip_105:
    s_waitcnt lgkmcnt(0)
    v_mfma_f32_16x16x32_bf16 v[236:239], v[160:163], a[120:123], 0
    v_mfma_f32_16x16x32_bf16 v[240:243], v[176:179], a[120:123], 0
    v_mfma_f32_16x16x32_bf16 v[236:239], v[164:167], a[124:127], v[236:239]
    v_mfma_f32_16x16x32_bf16 v[240:243], v[180:183], a[124:127], v[240:243]
    v_mfma_f32_16x16x32_bf16 v[236:239], v[168:171], a[128:131], v[236:239]
    v_mfma_f32_16x16x32_bf16 v[240:243], v[184:187], a[128:131], v[240:243]
    v_mfma_f32_16x16x32_bf16 v[236:239], v[172:175], a[132:135], v[236:239]
    v_mfma_f32_16x16x32_bf16 v[240:243], v[188:191], a[132:135], v[240:243]
    v_mfma_f32_16x16x32_bf16 v[120:123], v[160:163], a[136:139], 0
    v_mfma_f32_16x16x32_bf16 v[124:127], v[176:179], a[136:139], 0
    v_mfma_f32_16x16x32_bf16 v[120:123], v[164:167], a[140:143], v[120:123]
    v_mfma_f32_16x16x32_bf16 v[124:127], v[180:183], a[140:143], v[124:127]
    v_mfma_f32_16x16x32_bf16 v[120:123], v[168:171], a[144:147], v[120:123]
    v_mfma_f32_16x16x32_bf16 v[124:127], v[184:187], a[144:147], v[124:127]
    v_mfma_f32_16x16x32_bf16 v[120:123], v[172:175], a[148:151], v[120:123]
    v_mfma_f32_16x16x32_bf16 v[124:127], v[188:191], a[148:151], v[124:127]
    v_cvt_pk_bf16_f32 v204, v236, v237
    v_cvt_pk_bf16_f32 v205, v238, v239
    v_cvt_pk_bf16_f32 v206, v240, v241
    v_cvt_pk_bf16_f32 v207, v242, v243
    v_mfma_f32_16x16x32_bf16 v[236:239], v[160:163], a[152:155], 0
    v_mfma_f32_16x16x32_bf16 v[240:243], v[176:179], a[152:155], 0
    v_mfma_f32_16x16x32_bf16 v[236:239], v[164:167], a[156:159], v[236:239]
    v_mfma_f32_16x16x32_bf16 v[240:243], v[180:183], a[156:159], v[240:243]
    v_mfma_f32_16x16x32_bf16 v[236:239], v[168:171], a[160:163], v[236:239]
    v_mfma_f32_16x16x32_bf16 v[240:243], v[184:187], a[160:163], v[240:243]
    v_mfma_f32_16x16x32_bf16 v[236:239], v[172:175], a[164:167], v[236:239]
    v_mfma_f32_16x16x32_bf16 v[240:243], v[188:191], a[164:167], v[240:243]
    v_cvt_pk_bf16_f32 v208, v120, v121
    v_cvt_pk_bf16_f32 v209, v122, v123
    v_cvt_pk_bf16_f32 v210, v124, v125
    v_cvt_pk_bf16_f32 v211, v126, v127
    s_nop 7
    v_cvt_pk_bf16_f32 v212, v236, v237
    v_cvt_pk_bf16_f32 v213, v238, v239
    v_cvt_pk_bf16_f32 v214, v240, v241
    v_cvt_pk_bf16_f32 v215, v242, v243
    s_branch L_c_stepend_0
L_c_w2_0:
    s_waitcnt lgkmcnt(0)
    v_mfma_f32_16x16x32_bf16 v[236:239], v[160:163], a[120:123], 0
    v_mfma_f32_16x16x32_bf16 v[240:243], v[176:179], a[120:123], 0
    v_mfma_f32_16x16x32_bf16 v[236:239], v[164:167], a[124:127], v[236:239]
    v_mfma_f32_16x16x32_bf16 v[240:243], v[180:183], a[124:127], v[240:243]
    v_mfma_f32_16x16x32_bf16 v[236:239], v[168:171], a[128:131], v[236:239]
    v_mfma_f32_16x16x32_bf16 v[240:243], v[184:187], a[128:131], v[240:243]
    v_mfma_f32_16x16x32_bf16 v[236:239], v[172:175], a[132:135], v[236:239]
    v_mfma_f32_16x16x32_bf16 v[240:243], v[188:191], a[132:135], v[240:243]
    v_mfma_f32_16x16x32_bf16 v[120:123], v[160:163], a[136:139], 0
    v_mfma_f32_16x16x32_bf16 v[124:127], v[176:179], a[136:139], 0
    v_mfma_f32_16x16x32_bf16 v[120:123], v[164:167], a[140:143], v[120:123]
    v_mfma_f32_16x16x32_bf16 v[124:127], v[180:183], a[140:143], v[124:127]
    v_mfma_f32_16x16x32_bf16 v[120:123], v[168:171], a[144:147], v[120:123]
    v_mfma_f32_16x16x32_bf16 v[124:127], v[184:187], a[144:147], v[124:127]
    v_mfma_f32_16x16x32_bf16 v[120:123], v[172:175], a[148:151], v[120:123]
    v_mfma_f32_16x16x32_bf16 v[124:127], v[188:191], a[148:151], v[124:127]
    v_cvt_pk_bf16_f32 v204, v236, v237
    v_cvt_pk_bf16_f32 v205, v238, v239
    v_cvt_pk_bf16_f32 v206, v240, v241
    v_cvt_pk_bf16_f32 v207, v242, v243
    v_mfma_f32_16x16x32_bf16 v[236:239], v[160:163], a[152:155], 0
    v_mfma_f32_16x16x32_bf16 v[240:243], v[176:179], a[152:155], 0
    v_mfma_f32_16x16x32_bf16 v[236:239], v[164:167], a[156:159], v[236:239]
    v_mfma_f32_16x16x32_bf16 v[240:243], v[180:183], a[156:159], v[240:243]
    v_mfma_f32_16x16x32_bf16 v[236:239], v[168:171], a[160:163], v[236:239]
    v_mfma_f32_16x16x32_bf16 v[240:243], v[184:187], a[160:163], v[240:243]
    v_mfma_f32_16x16x32_bf16 v[236:239], v[172:175], a[164:167], v[236:239]
    v_mfma_f32_16x16x32_bf16 v[240:243], v[188:191], a[164:167], v[240:243]
    v_cvt_pk_bf16_f32 v208, v120, v121
    v_cvt_pk_bf16_f32 v209, v122, v123
    v_cvt_pk_bf16_f32 v210, v124, v125
    v_cvt_pk_bf16_f32 v211, v126, v127
    s_nop 7
    v_cvt_pk_bf16_f32 v212, v236, v237
    v_cvt_pk_bf16_f32 v213, v238, v239
    v_cvt_pk_bf16_f32 v214, v240, v241
    v_cvt_pk_bf16_f32 v215, v242, v243
    s_branch L_c_stepend_0
L_c_A_1_retry:
    buffer_load_dwordx4 v[144:147], v10, s[8:11], s93 offen sc1
    buffer_load_dwordx4 v[148:151], v11, s[8:11], s93 offen sc1
    buffer_load_dwordx4 v[152:155], v12, s[8:11], s93 offen sc1
L_c_A_1_loop:
    s_waitcnt vmcnt(3)
    ds_write_b128 v100, v[128:131]
    ds_write_b128 v101, v[132:135]
    ds_write_b128 v102, v[136:139]
    v_max3_u32 v20, v128, v129, v130
    v_max3_u32 v21, v131, v132, v133
    v_max3_u32 v20, v20, v134, v135
    v_max3_u32 v21, v21, v136, v137
    v_max3_u32 v20, v20, v138, v139
    v_max_u32 v20, v20, v21
    v_cmp_eq_u32 vcc, -1, v20
    s_cbranch_vccz L_c_A_1_ok1
    buffer_load_dwordx4 v[128:131], v10, s[8:11], s93 offen sc1
    buffer_load_dwordx4 v[132:135], v11, s[8:11], s93 offen sc1
    buffer_load_dwordx4 v[136:139], v12, s[8:11], s93 offen sc1
    s_waitcnt vmcnt(3)
    ds_write_b128 v100, v[144:147]
    ds_write_b128 v101, v[148:151]
    ds_write_b128 v102, v[152:155]
    v_max3_u32 v20, v144, v145, v146
    v_max3_u32 v21, v147, v148, v149
    v_max3_u32 v20, v20, v150, v151
    v_max3_u32 v21, v21, v152, v153
    v_max3_u32 v20, v20, v154, v155
    v_max_u32 v20, v20, v21
    v_cmp_eq_u32 vcc, -1, v20
    s_cbranch_vccz L_c_A_1_ok0
    buffer_load_dwordx4 v[144:147], v10, s[8:11], s93 offen sc1
    buffer_load_dwordx4 v[148:151], v11, s[8:11], s93 offen sc1
    buffer_load_dwordx4 v[152:155], v12, s[8:11], s93 offen sc1
    s_sub_u32 s22, s22, 1
    s_cbranch_scc0 L_c_A_1_loop
    s_branch L_timeout
L_c_A_1_ok0:
    s_branch L_c_A_1_done
L_c_A_1_ok1:
    s_branch L_c_A_1_done
L_c_R_1_retry:
    buffer_load_dwordx4 v[40:43], v3, s[8:11], s85 offen sc1
L_c_R_1_loop:
    s_waitcnt vmcnt(1)
    ds_write_b128 v17, v[44:47]
    v_max3_u32 v20, v44, v45, v46
    v_max_u32 v20, v20, v47
    v_cmp_eq_u32 vcc, -1, v20
    s_cbranch_vccz L_c_R_1_ok1
    buffer_load_dwordx4 v[44:47], v3, s[8:11], s85 offen sc1
    s_waitcnt vmcnt(1)
    ds_write_b128 v17, v[40:43]
    v_max3_u32 v20, v40, v41, v42
    v_max_u32 v20, v20, v43
    v_cmp_eq_u32 vcc, -1, v20
    s_cbranch_vccz L_c_R_1_ok0
    buffer_load_dwordx4 v[40:43], v3, s[8:11], s85 offen sc1
    s_sub_u32 s22, s22, 1
    s_cbranch_scc0 L_c_R_1_loop
    s_branch L_timeout
L_c_R_1_ok0:
    s_branch L_c_R_1_done
L_c_R_1_ok1:
    s_branch L_c_R_1_done
L_c_pollV_1:
    buffer_load_dwordx4 v[144:147], v4, s[8:11], s85 offen offset:0 sc1
    buffer_load_dwordx4 v[148:151], v4, s[8:11], s85 offen offset:512 sc1
    buffer_load_dwordx4 v[152:155], v4, s[8:11], s85 offen offset:1024 sc1
    buffer_load_dwordx4 v[156:159], v4, s[8:11], s85 offen offset:1536 sc1
    s_waitcnt vmcnt(0)
    v_max3_u32 v20, v144, v145, v146
    v_max3_u32 v21, v147, v148, v149
    v_max3_u32 v20, v20, v150, v151
    v_max3_u32 v21, v21, v152, v153
    v_max3_u32 v20, v20, v154, v155
    v_max3_u32 v21, v21, v156, v157
    v_max3_u32 v20, v20, v158, v159
    v_max_u32 v20, v20, v21
    v_cmp_eq_u32 vcc, -1, v20
    s_cbranch_vccz L_c_okV_1
    s_sub_u32 s22, s22, 1
    s_cbranch_scc0 L_c_pollV_1
    s_branch L_timeout
L_c_RS_1_retry:
    buffer_load_dwordx2 v[88:89], v7, s[8:11], s89 offen sc1
    buffer_load_dwordx2 v[90:91], v8, s[8:11], s89 offen sc1
L_c_RS_1_loop:
    s_waitcnt vmcnt(4)
    v_mfma_f32_16x16x32_bf16 v[92:95], v[32:35], v[60:63], 0
    v_max3_u32 v20, v60, v61, v62
    v_max_u32 v20, v20, v63
    v_cmp_eq_u32 vcc, -1, v20
    s_cbranch_vccz L_c_RS_1_ok1
    buffer_load_dwordx2 v[60:61], v7, s[8:11], s89 offen sc1
    buffer_load_dwordx2 v[62:63], v8, s[8:11], s89 offen sc1
    s_waitcnt vmcnt(4)
    v_mfma_f32_16x16x32_bf16 v[92:95], v[32:35], v[64:67], 0
    v_max3_u32 v20, v64, v65, v66
    v_max_u32 v20, v20, v67
    v_cmp_eq_u32 vcc, -1, v20
    s_cbranch_vccz L_c_RS_1_ok2
    buffer_load_dwordx2 v[64:65], v7, s[8:11], s89 offen sc1
    buffer_load_dwordx2 v[66:67], v8, s[8:11], s89 offen sc1
    s_waitcnt vmcnt(4)
    v_mfma_f32_16x16x32_bf16 v[92:95], v[32:35], v[88:91], 0
    v_max3_u32 v20, v88, v89, v90
    v_max_u32 v20, v20, v91
    v_cmp_eq_u32 vcc, -1, v20
    s_cbranch_vccz L_c_RS_1_ok0
    buffer_load_dwordx2 v[88:89], v7, s[8:11], s89 offen sc1
    buffer_load_dwordx2 v[90:91], v8, s[8:11], s89 offen sc1
    s_sub_u32 s22, s22, 1
    s_cbranch_scc0 L_c_RS_1_loop
    s_branch L_timeout
L_c_RS_1_ok0:
    s_branch L_c_RS_1_done
L_c_RS_1_ok1:
    s_branch L_c_RS_1_done
L_c_RS_1_ok2:
    s_branch L_c_RS_1_done
L_c_X_1_retry:
    buffer_load_dwordx4 v[108:111], v104, s[8:11], s97 offen sc1
    buffer_load_dwordx4 v[112:115], v105, s[8:11], s97 offen sc1
    buffer_load_dwordx4 v[116:119], v106, s[8:11], s97 offen sc1
L_c_X_1_loop:
    s_waitcnt vmcnt(3)
    v_max3_u32 v20, v68, v69, v70
    v_max3_u32 v21, v71, v72, v73
    v_max3_u32 v20, v20, v74, v75
    v_max3_u32 v21, v21, v76, v77
    v_max3_u32 v20, v20, v78, v79
    v_max_u32 v20, v20, v21
    v_cmp_eq_u32 vcc, -1, v20
    s_cbranch_vccz L_c_X_1_ok1
    buffer_load_dwordx4 v[68:71], v104, s[8:11], s97 offen sc1
    buffer_load_dwordx4 v[72:75], v105, s[8:11], s97 offen sc1
    buffer_load_dwordx4 v[76:79], v106, s[8:11], s97 offen sc1
    s_waitcnt vmcnt(3)
    v_max3_u32 v20, v108, v109, v110
    v_max3_u32 v21, v111, v112, v113
    v_max3_u32 v20, v20, v114, v115
    v_max3_u32 v21, v21, v116, v117
    v_max3_u32 v20, v20, v118, v119
    v_max_u32 v20, v20, v21
    v_cmp_eq_u32 vcc, -1, v20
    s_cbranch_vccz L_c_X_1_ok0
    buffer_load_dwordx4 v[108:111], v104, s[8:11], s97 offen sc1
    buffer_load_dwordx4 v[112:115], v105, s[8:11], s97 offen sc1
    buffer_load_dwordx4 v[116:119], v106, s[8:11], s97 offen sc1
    s_sub_u32 s22, s22, 1
    s_cbranch_scc0 L_c_X_1_loop
    s_branch L_timeout
L_c_X_1_ok0:
    v_pk_add_f32 v[20:21], v[108:109], v[116:117]
    v_pk_add_f32 v[92:93], v[92:93], v[112:113]
    v_pk_add_f32 v[22:23], v[110:111], v[118:119]
    v_pk_add_f32 v[94:95], v[94:95], v[114:115]
    s_branch L_c_X_1_done
L_c_X_1_ok1:
    v_pk_add_f32 v[20:21], v[68:69], v[76:77]
    v_pk_add_f32 v[92:93], v[92:93], v[72:73]
    v_pk_add_f32 v[22:23], v[70:71], v[78:79]
    v_pk_add_f32 v[94:95], v[94:95], v[74:75]
    s_branch L_c_X_1_done
L_c_noitem_1:
    s_cmp_lg_u32 s20, 3
    s_cbranch_scc1 L_c_w2_1
    s_mov_b32 s30, 105906176
    buffer_load_dword v24, v37, s[8:11], s30 offen sc1
    buffer_load_dwordx4 v[40:43], v83, s[8:11], s85 offen sc1
    buffer_load_dwordx4 v[44:47], v98, s[8:11], s85 offen sc1
    s_waitcnt vmcnt(0)
    buffer_store_dwordx4 v[40:43], v80, s[8:11], s40 offen sc1
    buffer_store_dwordx4 v[44:47], v81, s[8:11], s41 offen sc1
    s_cmp_gt_u32 s21, 60
    s_cbranch_scc1 L_c_kvskip_106
    s_add_u32 s31, s21, 3
L_c_wk_1:
    v_cmp_gt_u32 vcc, s31, v24
    s_nop 3
    s_and_b64 vcc, vcc, 3
    s_cbranch_vccz L_c_wk_1_ok
    s_mov_b32 s30, 105906176
    buffer_load_dword v24, v37, s[8:11], s30 offen sc1
    s_waitcnt vmcnt(0)
    s_sub_u32 s22, s22, 1
    s_cbranch_scc0 L_c_wk_1
    s_branch L_timeout
L_c_wk_1_ok:
    s_mov_b32 m0, 49152
    s_add_u32 s32, s42, 16777216
    buffer_load_dwordx4 v96, s[8:11], s32 offen sc1 lds
    s_mov_b32 m0, 50176
    s_add_u32 s32, s42, 16778240
    buffer_load_dwordx4 v96, s[8:11], s32 offen sc1 lds
    s_mov_b32 m0, 51200
    s_add_u32 s32, s42, 16779264
    buffer_load_dwordx4 v96, s[8:11], s32 offen sc1 lds
    s_mov_b32 m0, 52224
    s_add_u32 s32, s42, 16780288
    buffer_load_dwordx4 v96, s[8:11], s32 offen sc1 lds
    s_mov_b32 m0, 53248
    s_add_u32 s32, s42, 16781312
    buffer_load_dwordx4 v96, s[8:11], s32 offen sc1 lds
    s_mov_b32 m0, 54272
    s_add_u32 s32, s42, 16782336
    buffer_load_dwordx4 v96, s[8:11], s32 offen sc1 lds
    s_mov_b32 m0, 55296
    s_add_u32 s32, s42, 16783360
    buffer_load_dwordx4 v96, s[8:11], s32 offen sc1 lds
    s_mov_b32 m0, 56320
    s_add_u32 s32, s42, 16784384
    buffer_load_dwordx4 v96, s[8:11], s32 offen sc1 lds
    s_mov_b32 m0, 57344
    s_add_u32 s32, s42, 33554432
    buffer_load_dwordx4 v96, s[8:11], s32 offen sc1 lds
    s_mov_b32 m0, 58368
    s_add_u32 s32, s42, 33555456
    buffer_load_dwordx4 v96, s[8:11], s32 offen sc1 lds
    s_mov_b32 m0, 59392
    s_add_u32 s32, s42, 33556480
    buffer_load_dwordx4 v96, s[8:11], s32 offen sc1 lds
    s_mov_b32 m0, 60416
    s_add_u32 s32, s42, 33557504
    buffer_load_dwordx4 v96, s[8:11], s32 offen sc1 lds
    s_mov_b32 m0, 61440
    s_add_u32 s32, s42, 33558528
    buffer_load_dwordx4 v96, s[8:11], s32 offen sc1 lds
    s_mov_b32 m0, 62464
    s_add_u32 s32, s42, 33559552
    buffer_load_dwordx4 v96, s[8:11], s32 offen sc1 lds
    s_mov_b32 m0, 63488
    s_add_u32 s32, s42, 33560576
    buffer_load_dwordx4 v96, s[8:11], s32 offen sc1 lds
    s_mov_b32 m0, 64512
    s_add_u32 s32, s42, 33561600
    buffer_load_dwordx4 v96, s[8:11], s32 offen sc1 lds
L_c_kvskip_106:
    s_waitcnt lgkmcnt(0)
    v_mfma_f32_16x16x32_bf16 v[236:239], v[160:163], a[120:123], 0
    v_mfma_f32_16x16x32_bf16 v[240:243], v[176:179], a[120:123], 0
    v_mfma_f32_16x16x32_bf16 v[236:239], v[164:167], a[124:127], v[236:239]
    v_mfma_f32_16x16x32_bf16 v[240:243], v[180:183], a[124:127], v[240:243]
    v_mfma_f32_16x16x32_bf16 v[236:239], v[168:171], a[128:131], v[236:239]
    v_mfma_f32_16x16x32_bf16 v[240:243], v[184:187], a[128:131], v[240:243]
    v_mfma_f32_16x16x32_bf16 v[236:239], v[172:175], a[132:135], v[236:239]
    v_mfma_f32_16x16x32_bf16 v[240:243], v[188:191], a[132:135], v[240:243]
    v_mfma_f32_16x16x32_bf16 v[120:123], v[160:163], a[136:139], 0
    v_mfma_f32_16x16x32_bf16 v[124:127], v[176:179], a[136:139], 0
    v_mfma_f32_16x16x32_bf16 v[120:123], v[164:167], a[140:143], v[120:123]
    v_mfma_f32_16x16x32_bf16 v[124:127], v[180:183], a[140:143], v[124:127]
    v_mfma_f32_16x16x32_bf16 v[120:123], v[168:171], a[144:147], v[120:123]
    v_mfma_f32_16x16x32_bf16 v[124:127], v[184:187], a[144:147], v[124:127]
    v_mfma_f32_16x16x32_bf16 v[120:123], v[172:175], a[148:151], v[120:123]
    v_mfma_f32_16x16x32_bf16 v[124:127], v[188:191], a[148:151], v[124:127]
    v_cvt_pk_bf16_f32 v204, v236, v237
    v_cvt_pk_bf16_f32 v205, v238, v239
    v_cvt_pk_bf16_f32 v206, v240, v241
    v_cvt_pk_bf16_f32 v207, v242, v243
    v_mfma_f32_16x16x32_bf16 v[236:239], v[160:163], a[152:155], 0
    v_mfma_f32_16x16x32_bf16 v[240:243], v[176:179], a[152:155], 0
    v_mfma_f32_16x16x32_bf16 v[236:239], v[164:167], a[156:159], v[236:239]
    v_mfma_f32_16x16x32_bf16 v[240:243], v[180:183], a[156:159], v[240:243]
    v_mfma_f32_16x16x32_bf16 v[236:239], v[168:171], a[160:163], v[236:239]
    v_mfma_f32_16x16x32_bf16 v[240:243], v[184:187], a[160:163], v[240:243]
    v_mfma_f32_16x16x32_bf16 v[236:239], v[172:175], a[164:167], v[236:239]
    v_mfma_f32_16x16x32_bf16 v[240:243], v[188:191], a[164:167], v[240:243]
    v_cvt_pk_bf16_f32 v208, v120, v121
    v_cvt_pk_bf16_f32 v209, v122, v123
    v_cvt_pk_bf16_f32 v210, v124, v125
    v_cvt_pk_bf16_f32 v211, v126, v127
    s_nop 7
    v_cvt_pk_bf16_f32 v212, v236, v237
    v_cvt_pk_bf16_f32 v213, v238, v239
    v_cvt_pk_bf16_f32 v214, v240, v241
    v_cvt_pk_bf16_f32 v215, v242, v243
    s_branch L_c_stepend_1
L_c_w2_1:
    s_waitcnt lgkmcnt(0)
    v_mfma_f32_16x16x32_bf16 v[236:239], v[160:163], a[120:123], 0
    v_mfma_f32_16x16x32_bf16 v[240:243], v[176:179], a[120:123], 0
    v_mfma_f32_16x16x32_bf16 v[236:239], v[164:167], a[124:127], v[236:239]
    v_mfma_f32_16x16x32_bf16 v[240:243], v[180:183], a[124:127], v[240:243]
    v_mfma_f32_16x16x32_bf16 v[236:239], v[168:171], a[128:131], v[236:239]
    v_mfma_f32_16x16x32_bf16 v[240:243], v[184:187], a[128:131], v[240:243]
    v_mfma_f32_16x16x32_bf16 v[236:239], v[172:175], a[132:135], v[236:239]
    v_mfma_f32_16x16x32_bf16 v[240:243], v[188:191], a[132:135], v[240:243]
    v_mfma_f32_16x16x32_bf16 v[120:123], v[160:163], a[136:139], 0
    v_mfma_f32_16x16x32_bf16 v[124:127], v[176:179], a[136:139], 0
    v_mfma_f32_16x16x32_bf16 v[120:123], v[164:167], a[140:143], v[120:123]
    v_mfma_f32_16x16x32_bf16 v[124:127], v[180:183], a[140:143], v[124:127]
    v_mfma_f32_16x16x32_bf16 v[120:123], v[168:171], a[144:147], v[120:123]
    v_mfma_f32_16x16x32_bf16 v[124:127], v[184:187], a[144:147], v[124:127]
    v_mfma_f32_16x16x32_bf16 v[120:123], v[172:175], a[148:151], v[120:123]
    v_mfma_f32_16x16x32_bf16 v[124:127], v[188:191], a[148:151], v[124:127]
    v_cvt_pk_bf16_f32 v204, v236, v237
    v_cvt_pk_bf16_f32 v205, v238, v239
    v_cvt_pk_bf16_f32 v206, v240, v241
    v_cvt_pk_bf16_f32 v207, v242, v243
    v_mfma_f32_16x16x32_bf16 v[236:239], v[160:163], a[152:155], 0
    v_mfma_f32_16x16x32_bf16 v[240:243], v[176:179], a[152:155], 0
    v_mfma_f32_16x16x32_bf16 v[236:239], v[164:167], a[156:159], v[236:239]
    v_mfma_f32_16x16x32_bf16 v[240:243], v[180:183], a[156:159], v[240:243]
    v_mfma_f32_16x16x32_bf16 v[236:239], v[168:171], a[160:163], v[236:239]
    v_mfma_f32_16x16x32_bf16 v[240:243], v[184:187], a[160:163], v[240:243]
    v_mfma_f32_16x16x32_bf16 v[236:239], v[172:175], a[164:167], v[236:239]
    v_mfma_f32_16x16x32_bf16 v[240:243], v[188:191], a[164:167], v[240:243]
    v_cvt_pk_bf16_f32 v208, v120, v121
    v_cvt_pk_bf16_f32 v209, v122, v123
    v_cvt_pk_bf16_f32 v210, v124, v125
    v_cvt_pk_bf16_f32 v211, v126, v127
    s_nop 7
    v_cvt_pk_bf16_f32 v212, v236, v237
    v_cvt_pk_bf16_f32 v213, v238, v239
    v_cvt_pk_bf16_f32 v214, v240, v241
    v_cvt_pk_bf16_f32 v215, v242, v243
    s_branch L_c_stepend_1
L_c_A_2_retry:
    buffer_load_dwordx4 v[144:147], v10, s[8:11], s94 offen sc1
    buffer_load_dwordx4 v[148:151], v11, s[8:11], s94 offen sc1
    buffer_load_dwordx4 v[152:155], v12, s[8:11], s94 offen sc1
L_c_A_2_loop:
    s_waitcnt vmcnt(3)
    ds_write_b128 v100, v[128:131]
    ds_write_b128 v101, v[132:135]
    ds_write_b128 v102, v[136:139]
    v_max3_u32 v20, v128, v129, v130
    v_max3_u32 v21, v131, v132, v133
    v_max3_u32 v20, v20, v134, v135
    v_max3_u32 v21, v21, v136, v137
    v_max3_u32 v20, v20, v138, v139
    v_max_u32 v20, v20, v21
    v_cmp_eq_u32 vcc, -1, v20
    s_cbranch_vccz L_c_A_2_ok1
    buffer_load_dwordx4 v[128:131], v10, s[8:11], s94 offen sc1
    buffer_load_dwordx4 v[132:135], v11, s[8:11], s94 offen sc1
    buffer_load_dwordx4 v[136:139], v12, s[8:11], s94 offen sc1
    s_waitcnt vmcnt(3)
    ds_write_b128 v100, v[144:147]
    ds_write_b128 v101, v[148:151]
    ds_write_b128 v102, v[152:155]
    v_max3_u32 v20, v144, v145, v146
    v_max3_u32 v21, v147, v148, v149
    v_max3_u32 v20, v20, v150, v151
    v_max3_u32 v21, v21, v152, v153
    v_max3_u32 v20, v20, v154, v155
    v_max_u32 v20, v20, v21
    v_cmp_eq_u32 vcc, -1, v20
    s_cbranch_vccz L_c_A_2_ok0
    buffer_load_dwordx4 v[144:147], v10, s[8:11], s94 offen sc1
    buffer_load_dwordx4 v[148:151], v11, s[8:11], s94 offen sc1
    buffer_load_dwordx4 v[152:155], v12, s[8:11], s94 offen sc1
    s_sub_u32 s22, s22, 1
    s_cbranch_scc0 L_c_A_2_loop
    s_branch L_timeout
L_c_A_2_ok0:
    s_branch L_c_A_2_done
L_c_A_2_ok1:
    s_branch L_c_A_2_done
L_c_R_2_retry:
    buffer_load_dwordx4 v[40:43], v3, s[8:11], s86 offen sc1
L_c_R_2_loop:
    s_waitcnt vmcnt(1)
    ds_write_b128 v17, v[44:47]
    v_max3_u32 v20, v44, v45, v46
    v_max_u32 v20, v20, v47
    v_cmp_eq_u32 vcc, -1, v20
    s_cbranch_vccz L_c_R_2_ok1
    buffer_load_dwordx4 v[44:47], v3, s[8:11], s86 offen sc1
    s_waitcnt vmcnt(1)
    ds_write_b128 v17, v[40:43]
    v_max3_u32 v20, v40, v41, v42
    v_max_u32 v20, v20, v43
    v_cmp_eq_u32 vcc, -1, v20
    s_cbranch_vccz L_c_R_2_ok0
    buffer_load_dwordx4 v[40:43], v3, s[8:11], s86 offen sc1
    s_sub_u32 s22, s22, 1
    s_cbranch_scc0 L_c_R_2_loop
    s_branch L_timeout
L_c_R_2_ok0:
    s_branch L_c_R_2_done
L_c_R_2_ok1:
    s_branch L_c_R_2_done
L_c_pollV_2:
    buffer_load_dwordx4 v[144:147], v4, s[8:11], s86 offen offset:0 sc1
    buffer_load_dwordx4 v[148:151], v4, s[8:11], s86 offen offset:512 sc1
    buffer_load_dwordx4 v[152:155], v4, s[8:11], s86 offen offset:1024 sc1
    buffer_load_dwordx4 v[156:159], v4, s[8:11], s86 offen offset:1536 sc1
    s_waitcnt vmcnt(0)
    v_max3_u32 v20, v144, v145, v146
    v_max3_u32 v21, v147, v148, v149
    v_max3_u32 v20, v20, v150, v151
    v_max3_u32 v21, v21, v152, v153
    v_max3_u32 v20, v20, v154, v155
    v_max3_u32 v21, v21, v156, v157
    v_max3_u32 v20, v20, v158, v159
    v_max_u32 v20, v20, v21
    v_cmp_eq_u32 vcc, -1, v20
    s_cbranch_vccz L_c_okV_2
    s_sub_u32 s22, s22, 1
    s_cbranch_scc0 L_c_pollV_2
    s_branch L_timeout
L_c_RS_2_retry:
    buffer_load_dwordx2 v[88:89], v7, s[8:11], s90 offen sc1
    buffer_load_dwordx2 v[90:91], v8, s[8:11], s90 offen sc1
L_c_RS_2_loop:
    s_waitcnt vmcnt(4)
    v_mfma_f32_16x16x32_bf16 v[92:95], v[32:35], v[60:63], 0
    v_max3_u32 v20, v60, v61, v62
    v_max_u32 v20, v20, v63
    v_cmp_eq_u32 vcc, -1, v20
    s_cbranch_vccz L_c_RS_2_ok1
    buffer_load_dwordx2 v[60:61], v7, s[8:11], s90 offen sc1
    buffer_load_dwordx2 v[62:63], v8, s[8:11], s90 offen sc1
    s_waitcnt vmcnt(4)
    v_mfma_f32_16x16x32_bf16 v[92:95], v[32:35], v[64:67], 0
    v_max3_u32 v20, v64, v65, v66
    v_max_u32 v20, v20, v67
    v_cmp_eq_u32 vcc, -1, v20
    s_cbranch_vccz L_c_RS_2_ok2
    buffer_load_dwordx2 v[64:65], v7, s[8:11], s90 offen sc1
    buffer_load_dwordx2 v[66:67], v8, s[8:11], s90 offen sc1
    s_waitcnt vmcnt(4)
    v_mfma_f32_16x16x32_bf16 v[92:95], v[32:35], v[88:91], 0
    v_max3_u32 v20, v88, v89, v90
    v_max_u32 v20, v20, v91
    v_cmp_eq_u32 vcc, -1, v20
    s_cbranch_vccz L_c_RS_2_ok0
    buffer_load_dwordx2 v[88:89], v7, s[8:11], s90 offen sc1
    buffer_load_dwordx2 v[90:91], v8, s[8:11], s90 offen sc1
    s_sub_u32 s22, s22, 1
    s_cbranch_scc0 L_c_RS_2_loop
    s_branch L_timeout
L_c_RS_2_ok0:
    s_branch L_c_RS_2_done
L_c_RS_2_ok1:
    s_branch L_c_RS_2_done
L_c_RS_2_ok2:
    s_branch L_c_RS_2_done
L_c_X_2_retry:
    buffer_load_dwordx4 v[108:111], v104, s[8:11], s98 offen sc1
    buffer_load_dwordx4 v[112:115], v105, s[8:11], s98 offen sc1
    buffer_load_dwordx4 v[116:119], v106, s[8:11], s98 offen sc1
L_c_X_2_loop:
    s_waitcnt vmcnt(3)
    v_max3_u32 v20, v68, v69, v70
    v_max3_u32 v21, v71, v72, v73
    v_max3_u32 v20, v20, v74, v75
    v_max3_u32 v21, v21, v76, v77
    v_max3_u32 v20, v20, v78, v79
    v_max_u32 v20, v20, v21
    v_cmp_eq_u32 vcc, -1, v20
    s_cbranch_vccz L_c_X_2_ok1
    buffer_load_dwordx4 v[68:71], v104, s[8:11], s98 offen sc1
    buffer_load_dwordx4 v[72:75], v105, s[8:11], s98 offen sc1
    buffer_load_dwordx4 v[76:79], v106, s[8:11], s98 offen sc1
    s_waitcnt vmcnt(3)
    v_max3_u32 v20, v108, v109, v110
    v_max3_u32 v21, v111, v112, v113
    v_max3_u32 v20, v20, v114, v115
    v_max3_u32 v21, v21, v116, v117
    v_max3_u32 v20, v20, v118, v119
    v_max_u32 v20, v20, v21
    v_cmp_eq_u32 vcc, -1, v20
    s_cbranch_vccz L_c_X_2_ok0
    buffer_load_dwordx4 v[108:111], v104, s[8:11], s98 offen sc1
    buffer_load_dwordx4 v[112:115], v105, s[8:11], s98 offen sc1
    buffer_load_dwordx4 v[116:119], v106, s[8:11], s98 offen sc1
    s_sub_u32 s22, s22, 1
    s_cbranch_scc0 L_c_X_2_loop
    s_branch L_timeout
L_c_X_2_ok0:
    v_pk_add_f32 v[20:21], v[108:109], v[116:117]
    v_pk_add_f32 v[92:93], v[92:93], v[112:113]
    v_pk_add_f32 v[22:23], v[110:111], v[118:119]
    v_pk_add_f32 v[94:95], v[94:95], v[114:115]
    s_branch L_c_X_2_done
L_c_X_2_ok1:
    v_pk_add_f32 v[20:21], v[68:69], v[76:77]
    v_pk_add_f32 v[92:93], v[92:93], v[72:73]
    v_pk_add_f32 v[22:23], v[70:71], v[78:79]
    v_pk_add_f32 v[94:95], v[94:95], v[74:75]
    s_branch L_c_X_2_done
L_c_noitem_2:
    s_cmp_lg_u32 s20, 3
    s_cbranch_scc1 L_c_w2_2
    s_mov_b32 s30, 105906176
    buffer_load_dword v24, v37, s[8:11], s30 offen sc1
    buffer_load_dwordx4 v[40:43], v83, s[8:11], s86 offen sc1
    buffer_load_dwordx4 v[44:47], v98, s[8:11], s86 offen sc1
    s_waitcnt vmcnt(0)
    buffer_store_dwordx4 v[40:43], v80, s[8:11], s40 offen sc1
    buffer_store_dwordx4 v[44:47], v81, s[8:11], s41 offen sc1
    s_cmp_gt_u32 s21, 60
    s_cbranch_scc1 L_c_kvskip_107
    s_add_u32 s31, s21, 3
L_c_wk_2:
    v_cmp_gt_u32 vcc, s31, v24
    s_nop 3
    s_and_b64 vcc, vcc, 3
    s_cbranch_vccz L_c_wk_2_ok
    s_mov_b32 s30, 105906176
    buffer_load_dword v24, v37, s[8:11], s30 offen sc1
    s_waitcnt vmcnt(0)
    s_sub_u32 s22, s22, 1
    s_cbranch_scc0 L_c_wk_2
    s_branch L_timeout
L_c_wk_2_ok:
    s_mov_b32 m0, 0
    s_add_u32 s32, s42, 16777216
    buffer_load_dwordx4 v96, s[8:11], s32 offen sc1 lds
    s_mov_b32 m0, 1024
    s_add_u32 s32, s42, 16778240
    buffer_load_dwordx4 v96, s[8:11], s32 offen sc1 lds
    s_mov_b32 m0, 2048
    s_add_u32 s32, s42, 16779264
    buffer_load_dwordx4 v96, s[8:11], s32 offen sc1 lds
    s_mov_b32 m0, 3072
    s_add_u32 s32, s42, 16780288
    buffer_load_dwordx4 v96, s[8:11], s32 offen sc1 lds
    s_mov_b32 m0, 4096
    s_add_u32 s32, s42, 16781312
    buffer_load_dwordx4 v96, s[8:11], s32 offen sc1 lds
    s_mov_b32 m0, 5120
    s_add_u32 s32, s42, 16782336
    buffer_load_dwordx4 v96, s[8:11], s32 offen sc1 lds
    s_mov_b32 m0, 6144
    s_add_u32 s32, s42, 16783360
    buffer_load_dwordx4 v96, s[8:11], s32 offen sc1 lds
    s_mov_b32 m0, 7168
    s_add_u32 s32, s42, 16784384
    buffer_load_dwordx4 v96, s[8:11], s32 offen sc1 lds
    s_mov_b32 m0, 8192
    s_add_u32 s32, s42, 33554432
    buffer_load_dwordx4 v96, s[8:11], s32 offen sc1 lds
    s_mov_b32 m0, 9216
    s_add_u32 s32, s42, 33555456
    buffer_load_dwordx4 v96, s[8:11], s32 offen sc1 lds
    s_mov_b32 m0, 10240
    s_add_u32 s32, s42, 33556480
    buffer_load_dwordx4 v96, s[8:11], s32 offen sc1 lds
    s_mov_b32 m0, 11264
    s_add_u32 s32, s42, 33557504
    buffer_load_dwordx4 v96, s[8:11], s32 offen sc1 lds
    s_mov_b32 m0, 12288
    s_add_u32 s32, s42, 33558528
    buffer_load_dwordx4 v96, s[8:11], s32 offen sc1 lds
    s_mov_b32 m0, 13312
    s_add_u32 s32, s42, 33559552
    buffer_load_dwordx4 v96, s[8:11], s32 offen sc1 lds
    s_mov_b32 m0, 14336
    s_add_u32 s32, s42, 33560576
    buffer_load_dwordx4 v96, s[8:11], s32 offen sc1 lds
    s_mov_b32 m0, 15360
    s_add_u32 s32, s42, 33561600
    buffer_load_dwordx4 v96, s[8:11], s32 offen sc1 lds
L_c_kvskip_107:
    s_waitcnt lgkmcnt(0)
    v_mfma_f32_16x16x32_bf16 v[236:239], v[160:163], a[120:123], 0
    v_mfma_f32_16x16x32_bf16 v[240:243], v[176:179], a[120:123], 0
    v_mfma_f32_16x16x32_bf16 v[236:239], v[164:167], a[124:127], v[236:239]
    v_mfma_f32_16x16x32_bf16 v[240:243], v[180:183], a[124:127], v[240:243]
    v_mfma_f32_16x16x32_bf16 v[236:239], v[168:171], a[128:131], v[236:239]
    v_mfma_f32_16x16x32_bf16 v[240:243], v[184:187], a[128:131], v[240:243]
    v_mfma_f32_16x16x32_bf16 v[236:239], v[172:175], a[132:135], v[236:239]
    v_mfma_f32_16x16x32_bf16 v[240:243], v[188:191], a[132:135], v[240:243]
    v_mfma_f32_16x16x32_bf16 v[120:123], v[160:163], a[136:139], 0
    v_mfma_f32_16x16x32_bf16 v[124:127], v[176:179], a[136:139], 0
    v_mfma_f32_16x16x32_bf16 v[120:123], v[164:167], a[140:143], v[120:123]
    v_mfma_f32_16x16x32_bf16 v[124:127], v[180:183], a[140:143], v[124:127]
    v_mfma_f32_16x16x32_bf16 v[120:123], v[168:171], a[144:147], v[120:123]
    v_mfma_f32_16x16x32_bf16 v[124:127], v[184:187], a[144:147], v[124:127]
    v_mfma_f32_16x16x32_bf16 v[120:123], v[172:175], a[148:151], v[120:123]
    v_mfma_f32_16x16x32_bf16 v[124:127], v[188:191], a[148:151], v[124:127]
    v_cvt_pk_bf16_f32 v204, v236, v237
    v_cvt_pk_bf16_f32 v205, v238, v239
    v_cvt_pk_bf16_f32 v206, v240, v241
    v_cvt_pk_bf16_f32 v207, v242, v243
    v_mfma_f32_16x16x32_bf16 v[236:239], v[160:163], a[152:155], 0
    v_mfma_f32_16x16x32_bf16 v[240:243], v[176:179], a[152:155], 0
    v_mfma_f32_16x16x32_bf16 v[236:239], v[164:167], a[156:159], v[236:239]
    v_mfma_f32_16x16x32_bf16 v[240:243], v[180:183], a[156:159], v[240:243]
    v_mfma_f32_16x16x32_bf16 v[236:239], v[168:171], a[160:163], v[236:239]
    v_mfma_f32_16x16x32_bf16 v[240:243], v[184:187], a[160:163], v[240:243]
    v_mfma_f32_16x16x32_bf16 v[236:239], v[172:175], a[164:167], v[236:239]
    v_mfma_f32_16x16x32_bf16 v[240:243], v[188:191], a[164:167], v[240:243]
    v_cvt_pk_bf16_f32 v208, v120, v121
    v_cvt_pk_bf16_f32 v209, v122, v123
    v_cvt_pk_bf16_f32 v210, v124, v125
    v_cvt_pk_bf16_f32 v211, v126, v127
    s_nop 7
    v_cvt_pk_bf16_f32 v212, v236, v237
    v_cvt_pk_bf16_f32 v213, v238, v239
    v_cvt_pk_bf16_f32 v214, v240, v241
    v_cvt_pk_bf16_f32 v215, v242, v243
    s_branch L_c_stepend_2
L_c_w2_2:
    s_waitcnt lgkmcnt(0)
    v_mfma_f32_16x16x32_bf16 v[236:239], v[160:163], a[120:123], 0
    v_mfma_f32_16x16x32_bf16 v[240:243], v[176:179], a[120:123], 0
    v_mfma_f32_16x16x32_bf16 v[236:239], v[164:167], a[124:127], v[236:239]
    v_mfma_f32_16x16x32_bf16 v[240:243], v[180:183], a[124:127], v[240:243]
    v_mfma_f32_16x16x32_bf16 v[236:239], v[168:171], a[128:131], v[236:239]
    v_mfma_f32_16x16x32_bf16 v[240:243], v[184:187], a[128:131], v[240:243]
    v_mfma_f32_16x16x32_bf16 v[236:239], v[172:175], a[132:135], v[236:239]
    v_mfma_f32_16x16x32_bf16 v[240:243], v[188:191], a[132:135], v[240:243]
    v_mfma_f32_16x16x32_bf16 v[120:123], v[160:163], a[136:139], 0
    v_mfma_f32_16x16x32_bf16 v[124:127], v[176:179], a[136:139], 0
    v_mfma_f32_16x16x32_bf16 v[120:123], v[164:167], a[140:143], v[120:123]
    v_mfma_f32_16x16x32_bf16 v[124:127], v[180:183], a[140:143], v[124:127]
    v_mfma_f32_16x16x32_bf16 v[120:123], v[168:171], a[144:147], v[120:123]
    v_mfma_f32_16x16x32_bf16 v[124:127], v[184:187], a[144:147], v[124:127]
    v_mfma_f32_16x16x32_bf16 v[120:123], v[172:175], a[148:151], v[120:123]
    v_mfma_f32_16x16x32_bf16 v[124:127], v[188:191], a[148:151], v[124:127]
    v_cvt_pk_bf16_f32 v204, v236, v237
    v_cvt_pk_bf16_f32 v205, v238, v239
    v_cvt_pk_bf16_f32 v206, v240, v241
    v_cvt_pk_bf16_f32 v207, v242, v243
    v_mfma_f32_16x16x32_bf16 v[236:239], v[160:163], a[152:155], 0
    v_mfma_f32_16x16x32_bf16 v[240:243], v[176:179], a[152:155], 0
    v_mfma_f32_16x16x32_bf16 v[236:239], v[164:167], a[156:159], v[236:239]
    v_mfma_f32_16x16x32_bf16 v[240:243], v[180:183], a[156:159], v[240:243]
    v_mfma_f32_16x16x32_bf16 v[236:239], v[168:171], a[160:163], v[236:239]
    v_mfma_f32_16x16x32_bf16 v[240:243], v[184:187], a[160:163], v[240:243]
    v_mfma_f32_16x16x32_bf16 v[236:239], v[172:175], a[164:167], v[236:239]
    v_mfma_f32_16x16x32_bf16 v[240:243], v[188:191], a[164:167], v[240:243]
    v_cvt_pk_bf16_f32 v208, v120, v121
    v_cvt_pk_bf16_f32 v209, v122, v123
    v_cvt_pk_bf16_f32 v210, v124, v125
    v_cvt_pk_bf16_f32 v211, v126, v127
    s_nop 7
    v_cvt_pk_bf16_f32 v212, v236, v237
    v_cvt_pk_bf16_f32 v213, v238, v239
    v_cvt_pk_bf16_f32 v214, v240, v241
    v_cvt_pk_bf16_f32 v215, v242, v243
    s_branch L_c_stepend_2
L_c_A_3_retry:
    buffer_load_dwordx4 v[144:147], v10, s[8:11], s95 offen sc1
    buffer_load_dwordx4 v[148:151], v11, s[8:11], s95 offen sc1
    buffer_load_dwordx4 v[152:155], v12, s[8:11], s95 offen sc1
L_c_A_3_loop:
    s_waitcnt vmcnt(3)
    ds_write_b128 v100, v[128:131]
    ds_write_b128 v101, v[132:135]
    ds_write_b128 v102, v[136:139]
    v_max3_u32 v20, v128, v129, v130
    v_max3_u32 v21, v131, v132, v133
    v_max3_u32 v20, v20, v134, v135
    v_max3_u32 v21, v21, v136, v137
    v_max3_u32 v20, v20, v138, v139
    v_max_u32 v20, v20, v21
    v_cmp_eq_u32 vcc, -1, v20
    s_cbranch_vccz L_c_A_3_ok1
    buffer_load_dwordx4 v[128:131], v10, s[8:11], s95 offen sc1
    buffer_load_dwordx4 v[132:135], v11, s[8:11], s95 offen sc1
    buffer_load_dwordx4 v[136:139], v12, s[8:11], s95 offen sc1
    s_waitcnt vmcnt(3)
    ds_write_b128 v100, v[144:147]
    ds_write_b128 v101, v[148:151]
    ds_write_b128 v102, v[152:155]
    v_max3_u32 v20, v144, v145, v146
    v_max3_u32 v21, v147, v148, v149
    v_max3_u32 v20, v20, v150, v151
    v_max3_u32 v21, v21, v152, v153
    v_max3_u32 v20, v20, v154, v155
    v_max_u32 v20, v20, v21
    v_cmp_eq_u32 vcc, -1, v20
    s_cbranch_vccz L_c_A_3_ok0
    buffer_load_dwordx4 v[144:147], v10, s[8:11], s95 offen sc1
    buffer_load_dwordx4 v[148:151], v11, s[8:11], s95 offen sc1
    buffer_load_dwordx4 v[152:155], v12, s[8:11], s95 offen sc1
    s_sub_u32 s22, s22, 1
    s_cbranch_scc0 L_c_A_3_loop
    s_branch L_timeout
L_c_A_3_ok0:
    s_branch L_c_A_3_done
L_c_A_3_ok1:
    s_branch L_c_A_3_done
L_c_R_3_retry:
    buffer_load_dwordx4 v[40:43], v3, s[8:11], s87 offen sc1
L_c_R_3_loop:
    s_waitcnt vmcnt(1)
    ds_write_b128 v17, v[44:47]
    v_max3_u32 v20, v44, v45, v46
    v_max_u32 v20, v20, v47
    v_cmp_eq_u32 vcc, -1, v20
    s_cbranch_vccz L_c_R_3_ok1
    buffer_load_dwordx4 v[44:47], v3, s[8:11], s87 offen sc1
    s_waitcnt vmcnt(1)
    ds_write_b128 v17, v[40:43]
    v_max3_u32 v20, v40, v41, v42
    v_max_u32 v20, v20, v43
    v_cmp_eq_u32 vcc, -1, v20
    s_cbranch_vccz L_c_R_3_ok0
    buffer_load_dwordx4 v[40:43], v3, s[8:11], s87 offen sc1
    s_sub_u32 s22, s22, 1
    s_cbranch_scc0 L_c_R_3_loop
    s_branch L_timeout
L_c_R_3_ok0:
    s_branch L_c_R_3_done
L_c_R_3_ok1:
    s_branch L_c_R_3_done
L_c_pollV_3:
    buffer_load_dwordx4 v[144:147], v4, s[8:11], s87 offen offset:0 sc1
    buffer_load_dwordx4 v[148:151], v4, s[8:11], s87 offen offset:512 sc1
    buffer_load_dwordx4 v[152:155], v4, s[8:11], s87 offen offset:1024 sc1
    buffer_load_dwordx4 v[156:159], v4, s[8:11], s87 offen offset:1536 sc1
    s_waitcnt vmcnt(0)
    v_max3_u32 v20, v144, v145, v146
    v_max3_u32 v21, v147, v148, v149
    v_max3_u32 v20, v20, v150, v151
    v_max3_u32 v21, v21, v152, v153
    v_max3_u32 v20, v20, v154, v155
    v_max3_u32 v21, v21, v156, v157
    v_max3_u32 v20, v20, v158, v159
    v_max_u32 v20, v20, v21
    v_cmp_eq_u32 vcc, -1, v20
    s_cbranch_vccz L_c_okV_3
    s_sub_u32 s22, s22, 1
    s_cbranch_scc0 L_c_pollV_3
    s_branch L_timeout
L_c_RS_3_retry:
    buffer_load_dwordx2 v[88:89], v7, s[8:11], s91 offen sc1
    buffer_load_dwordx2 v[90:91], v8, s[8:11], s91 offen sc1
L_c_RS_3_loop:
    s_waitcnt vmcnt(4)
    v_mfma_f32_16x16x32_bf16 v[92:95], v[32:35], v[60:63], 0
    v_max3_u32 v20, v60, v61, v62
    v_max_u32 v20, v20, v63
    v_cmp_eq_u32 vcc, -1, v20
    s_cbranch_vccz L_c_RS_3_ok1
    buffer_load_dwordx2 v[60:61], v7, s[8:11], s91 offen sc1
    buffer_load_dwordx2 v[62:63], v8, s[8:11], s91 offen sc1
    s_waitcnt vmcnt(4)
    v_mfma_f32_16x16x32_bf16 v[92:95], v[32:35], v[64:67], 0
    v_max3_u32 v20, v64, v65, v66
    v_max_u32 v20, v20, v67
    v_cmp_eq_u32 vcc, -1, v20
    s_cbranch_vccz L_c_RS_3_ok2
    buffer_load_dwordx2 v[64:65], v7, s[8:11], s91 offen sc1
    buffer_load_dwordx2 v[66:67], v8, s[8:11], s91 offen sc1
    s_waitcnt vmcnt(4)
    v_mfma_f32_16x16x32_bf16 v[92:95], v[32:35], v[88:91], 0
    v_max3_u32 v20, v88, v89, v90
    v_max_u32 v20, v20, v91
    v_cmp_eq_u32 vcc, -1, v20
    s_cbranch_vccz L_c_RS_3_ok0
    buffer_load_dwordx2 v[88:89], v7, s[8:11], s91 offen sc1
    buffer_load_dwordx2 v[90:91], v8, s[8:11], s91 offen sc1
    s_sub_u32 s22, s22, 1
    s_cbranch_scc0 L_c_RS_3_loop
    s_branch L_timeout
L_c_RS_3_ok0:
    s_branch L_c_RS_3_done
L_c_RS_3_ok1:
    s_branch L_c_RS_3_done
L_c_RS_3_ok2:
    s_branch L_c_RS_3_done
L_c_X_3_retry:
    buffer_load_dwordx4 v[108:111], v104, s[8:11], s99 offen sc1
    buffer_load_dwordx4 v[112:115], v105, s[8:11], s99 offen sc1
    buffer_load_dwordx4 v[116:119], v106, s[8:11], s99 offen sc1
L_c_X_3_loop:
    s_waitcnt vmcnt(3)
    v_max3_u32 v20, v68, v69, v70
    v_max3_u32 v21, v71, v72, v73
    v_max3_u32 v20, v20, v74, v75
    v_max3_u32 v21, v21, v76, v77
    v_max3_u32 v20, v20, v78, v79
    v_max_u32 v20, v20, v21
    v_cmp_eq_u32 vcc, -1, v20
    s_cbranch_vccz L_c_X_3_ok1
    buffer_load_dwordx4 v[68:71], v104, s[8:11], s99 offen sc1
    buffer_load_dwordx4 v[72:75], v105, s[8:11], s99 offen sc1
    buffer_load_dwordx4 v[76:79], v106, s[8:11], s99 offen sc1
    s_waitcnt vmcnt(3)
    v_max3_u32 v20, v108, v109, v110
    v_max3_u32 v21, v111, v112, v113
    v_max3_u32 v20, v20, v114, v115
    v_max3_u32 v21, v21, v116, v117
    v_max3_u32 v20, v20, v118, v119
    v_max_u32 v20, v20, v21
    v_cmp_eq_u32 vcc, -1, v20
    s_cbranch_vccz L_c_X_3_ok0
    buffer_load_dwordx4 v[108:111], v104, s[8:11], s99 offen sc1
    buffer_load_dwordx4 v[112:115], v105, s[8:11], s99 offen sc1
    buffer_load_dwordx4 v[116:119], v106, s[8:11], s99 offen sc1
    s_sub_u32 s22, s22, 1
    s_cbranch_scc0 L_c_X_3_loop
    s_branch L_timeout
L_c_X_3_ok0:
    v_pk_add_f32 v[20:21], v[108:109], v[116:117]
    v_pk_add_f32 v[92:93], v[92:93], v[112:113]
    v_pk_add_f32 v[22:23], v[110:111], v[118:119]
    v_pk_add_f32 v[94:95], v[94:95], v[114:115]
    s_branch L_c_X_3_done
L_c_X_3_ok1:
    v_pk_add_f32 v[20:21], v[68:69], v[76:77]
    v_pk_add_f32 v[92:93], v[92:93], v[72:73]
    v_pk_add_f32 v[22:23], v[70:71], v[78:79]
    v_pk_add_f32 v[94:95], v[94:95], v[74:75]
    s_branch L_c_X_3_done
L_c_noitem_3:
    s_cmp_lg_u32 s20, 3
    s_cbranch_scc1 L_c_w2_3
    s_mov_b32 s30, 105906176
    buffer_load_dword v24, v37, s[8:11], s30 offen sc1
    buffer_load_dwordx4 v[40:43], v83, s[8:11], s87 offen sc1
    buffer_load_dwordx4 v[44:47], v98, s[8:11], s87 offen sc1
    s_waitcnt vmcnt(0)
    buffer_store_dwordx4 v[40:43], v80, s[8:11], s40 offen sc1
    buffer_store_dwordx4 v[44:47], v81, s[8:11], s41 offen sc1
    s_cmp_gt_u32 s21, 60
    s_cbranch_scc1 L_c_kvskip_108
    s_add_u32 s31, s21, 3
L_c_wk_3:
    v_cmp_gt_u32 vcc, s31, v24
    s_nop 3
    s_and_b64 vcc, vcc, 3
    s_cbranch_vccz L_c_wk_3_ok
    s_mov_b32 s30, 105906176
    buffer_load_dword v24, v37, s[8:11], s30 offen sc1
    s_waitcnt vmcnt(0)
    s_sub_u32 s22, s22, 1
    s_cbranch_scc0 L_c_wk_3
    s_branch L_timeout
L_c_wk_3_ok:
    s_mov_b32 m0, 16384
    s_add_u32 s32, s42, 16777216
    buffer_load_dwordx4 v96, s[8:11], s32 offen sc1 lds
    s_mov_b32 m0, 17408
    s_add_u32 s32, s42, 16778240
    buffer_load_dwordx4 v96, s[8:11], s32 offen sc1 lds
    s_mov_b32 m0, 18432
    s_add_u32 s32, s42, 16779264
    buffer_load_dwordx4 v96, s[8:11], s32 offen sc1 lds
    s_mov_b32 m0, 19456
    s_add_u32 s32, s42, 16780288
    buffer_load_dwordx4 v96, s[8:11], s32 offen sc1 lds
    s_mov_b32 m0, 20480
    s_add_u32 s32, s42, 16781312
    buffer_load_dwordx4 v96, s[8:11], s32 offen sc1 lds
    s_mov_b32 m0, 21504
    s_add_u32 s32, s42, 16782336
    buffer_load_dwordx4 v96, s[8:11], s32 offen sc1 lds
    s_mov_b32 m0, 22528
    s_add_u32 s32, s42, 16783360
    buffer_load_dwordx4 v96, s[8:11], s32 offen sc1 lds
    s_mov_b32 m0, 23552
    s_add_u32 s32, s42, 16784384
    buffer_load_dwordx4 v96, s[8:11], s32 offen sc1 lds
    s_mov_b32 m0, 24576
    s_add_u32 s32, s42, 33554432
    buffer_load_dwordx4 v96, s[8:11], s32 offen sc1 lds
    s_mov_b32 m0, 25600
    s_add_u32 s32, s42, 33555456
    buffer_load_dwordx4 v96, s[8:11], s32 offen sc1 lds
    s_mov_b32 m0, 26624
    s_add_u32 s32, s42, 33556480
    buffer_load_dwordx4 v96, s[8:11], s32 offen sc1 lds
    s_mov_b32 m0, 27648
    s_add_u32 s32, s42, 33557504
    buffer_load_dwordx4 v96, s[8:11], s32 offen sc1 lds
    s_mov_b32 m0, 28672
    s_add_u32 s32, s42, 33558528
    buffer_load_dwordx4 v96, s[8:11], s32 offen sc1 lds
    s_mov_b32 m0, 29696
    s_add_u32 s32, s42, 33559552
    buffer_load_dwordx4 v96, s[8:11], s32 offen sc1 lds
    s_mov_b32 m0, 30720
    s_add_u32 s32, s42, 33560576
    buffer_load_dwordx4 v96, s[8:11], s32 offen sc1 lds
    s_mov_b32 m0, 31744
    s_add_u32 s32, s42, 33561600
    buffer_load_dwordx4 v96, s[8:11], s32 offen sc1 lds
L_c_kvskip_108:
    s_waitcnt lgkmcnt(0)
    v_mfma_f32_16x16x32_bf16 v[236:239], v[160:163], a[120:123], 0
    v_mfma_f32_16x16x32_bf16 v[240:243], v[176:179], a[120:123], 0
    v_mfma_f32_16x16x32_bf16 v[236:239], v[164:167], a[124:127], v[236:239]
    v_mfma_f32_16x16x32_bf16 v[240:243], v[180:183], a[124:127], v[240:243]
    v_mfma_f32_16x16x32_bf16 v[236:239], v[168:171], a[128:131], v[236:239]
    v_mfma_f32_16x16x32_bf16 v[240:243], v[184:187], a[128:131], v[240:243]
    v_mfma_f32_16x16x32_bf16 v[236:239], v[172:175], a[132:135], v[236:239]
    v_mfma_f32_16x16x32_bf16 v[240:243], v[188:191], a[132:135], v[240:243]
    v_mfma_f32_16x16x32_bf16 v[120:123], v[160:163], a[136:139], 0
    v_mfma_f32_16x16x32_bf16 v[124:127], v[176:179], a[136:139], 0
    v_mfma_f32_16x16x32_bf16 v[120:123], v[164:167], a[140:143], v[120:123]
    v_mfma_f32_16x16x32_bf16 v[124:127], v[180:183], a[140:143], v[124:127]
    v_mfma_f32_16x16x32_bf16 v[120:123], v[168:171], a[144:147], v[120:123]
    v_mfma_f32_16x16x32_bf16 v[124:127], v[184:187], a[144:147], v[124:127]
    v_mfma_f32_16x16x32_bf16 v[120:123], v[172:175], a[148:151], v[120:123]
    v_mfma_f32_16x16x32_bf16 v[124:127], v[188:191], a[148:151], v[124:127]
    v_cvt_pk_bf16_f32 v204, v236, v237
    v_cvt_pk_bf16_f32 v205, v238, v239
    v_cvt_pk_bf16_f32 v206, v240, v241
    v_cvt_pk_bf16_f32 v207, v242, v243
    v_mfma_f32_16x16x32_bf16 v[236:239], v[160:163], a[152:155], 0
    v_mfma_f32_16x16x32_bf16 v[240:243], v[176:179], a[152:155], 0
    v_mfma_f32_16x16x32_bf16 v[236:239], v[164:167], a[156:159], v[236:239]
    v_mfma_f32_16x16x32_bf16 v[240:243], v[180:183], a[156:159], v[240:243]
    v_mfma_f32_16x16x32_bf16 v[236:239], v[168:171], a[160:163], v[236:239]
    v_mfma_f32_16x16x32_bf16 v[240:243], v[184:187], a[160:163], v[240:243]
    v_mfma_f32_16x16x32_bf16 v[236:239], v[172:175], a[164:167], v[236:239]
    v_mfma_f32_16x16x32_bf16 v[240:243], v[188:191], a[164:167], v[240:243]
    v_cvt_pk_bf16_f32 v208, v120, v121
    v_cvt_pk_bf16_f32 v209, v122, v123
    v_cvt_pk_bf16_f32 v210, v124, v125
    v_cvt_pk_bf16_f32 v211, v126, v127
    s_nop 7
    v_cvt_pk_bf16_f32 v212, v236, v237
    v_cvt_pk_bf16_f32 v213, v238, v239
    v_cvt_pk_bf16_f32 v214, v240, v241
    v_cvt_pk_bf16_f32 v215, v242, v243
    s_branch L_c_stepend_3
L_c_w2_3:
    s_waitcnt lgkmcnt(0)
    v_mfma_f32_16x16x32_bf16 v[236:239], v[160:163], a[120:123], 0
    v_mfma_f32_16x16x32_bf16 v[240:243], v[176:179], a[120:123], 0
    v_mfma_f32_16x16x32_bf16 v[236:239], v[164:167], a[124:127], v[236:239]
    v_mfma_f32_16x16x32_bf16 v[240:243], v[180:183], a[124:127], v[240:243]
    v_mfma_f32_16x16x32_bf16 v[236:239], v[168:171], a[128:131], v[236:239]
    v_mfma_f32_16x16x32_bf16 v[240:243], v[184:187], a[128:131], v[240:243]
    v_mfma_f32_16x16x32_bf16 v[236:239], v[172:175], a[132:135], v[236:239]
    v_mfma_f32_16x16x32_bf16 v[240:243], v[188:191], a[132:135], v[240:243]
    v_mfma_f32_16x16x32_bf16 v[120:123], v[160:163], a[136:139], 0
    v_mfma_f32_16x16x32_bf16 v[124:127], v[176:179], a[136:139], 0
    v_mfma_f32_16x16x32_bf16 v[120:123], v[164:167], a[140:143], v[120:123]
    v_mfma_f32_16x16x32_bf16 v[124:127], v[180:183], a[140:143], v[124:127]
    v_mfma_f32_16x16x32_bf16 v[120:123], v[168:171], a[144:147], v[120:123]
    v_mfma_f32_16x16x32_bf16 v[124:127], v[184:187], a[144:147], v[124:127]
    v_mfma_f32_16x16x32_bf16 v[120:123], v[172:175], a[148:151], v[120:123]
    v_mfma_f32_16x16x32_bf16 v[124:127], v[188:191], a[148:151], v[124:127]
    v_cvt_pk_bf16_f32 v204, v236, v237
    v_cvt_pk_bf16_f32 v205, v238, v239
    v_cvt_pk_bf16_f32 v206, v240, v241
    v_cvt_pk_bf16_f32 v207, v242, v243
    v_mfma_f32_16x16x32_bf16 v[236:239], v[160:163], a[152:155], 0
    v_mfma_f32_16x16x32_bf16 v[240:243], v[176:179], a[152:155], 0
    v_mfma_f32_16x16x32_bf16 v[236:239], v[164:167], a[156:159], v[236:239]
    v_mfma_f32_16x16x32_bf16 v[240:243], v[180:183], a[156:159], v[240:243]
    v_mfma_f32_16x16x32_bf16 v[236:239], v[168:171], a[160:163], v[236:239]
    v_mfma_f32_16x16x32_bf16 v[240:243], v[184:187], a[160:163], v[240:243]
    v_mfma_f32_16x16x32_bf16 v[236:239], v[172:175], a[164:167], v[236:239]
    v_mfma_f32_16x16x32_bf16 v[240:243], v[188:191], a[164:167], v[240:243]
    v_cvt_pk_bf16_f32 v208, v120, v121
    v_cvt_pk_bf16_f32 v209, v122, v123
    v_cvt_pk_bf16_f32 v210, v124, v125
    v_cvt_pk_bf16_f32 v211, v126, v127
    s_nop 7
    v_cvt_pk_bf16_f32 v212, v236, v237
    v_cvt_pk_bf16_f32 v213, v238, v239
    v_cvt_pk_bf16_f32 v214, v240, v241
    v_cvt_pk_bf16_f32 v215, v242, v243
    s_branch L_c_stepend_3
.p2align 6
L_c_loop_s0:
    buffer_load_dwordx4 v[144:147], v10, s[8:11], s92 offen sc1
    buffer_load_dwordx4 v[148:151], v11, s[8:11], s92 offen sc1
    buffer_load_dwordx4 v[152:155], v12, s[8:11], s92 offen sc1
    s_nop 15
    s_nop 15
    s_nop 7
    buffer_load_dwordx4 v[128:131], v10, s[8:11], s92 offen sc1
    buffer_load_dwordx4 v[132:135], v11, s[8:11], s92 offen sc1
    buffer_load_dwordx4 v[136:139], v12, s[8:11], s92 offen sc1
    s_waitcnt vmcnt(3)
    ds_write_b128 v100, v[144:147]
    ds_write_b128 v101, v[148:151]
    ds_write_b128 v102, v[152:155]
    v_max3_u32 v20, v144, v145, v146
    v_max3_u32 v21, v147, v148, v149
    v_max3_u32 v20, v20, v150, v151
    v_max3_u32 v21, v21, v152, v153
    v_max3_u32 v20, v20, v154, v155
    v_max_u32 v20, v20, v21
    v_cmp_eq_u32 vcc, -1, v20
    s_cbranch_vccnz L_c_A_s0_retry
L_c_A_s0_done:
    s_waitcnt lgkmcnt(0)
    s_barrier
L_c_afterA0s:
    ds_read_b128 v[40:43], v16 offset:0
    ds_read_b128 v[44:47], v16 offset:64
    ds_read_b128 v[48:51], v16 offset:128
    ds_read_b128 v[52:55], v16 offset:192
    ds_read_b128 v[56:59], v16 offset:256
    ds_read_b128 v[60:63], v16 offset:320
    ds_read_b128 v[64:67], v16 offset:384
    ds_read_b128 v[68:71], v16 offset:448
    ds_read_b128 v[72:75], v16 offset:512
    ds_read_b128 v[76:79], v16 offset:576
    s_waitcnt lgkmcnt(9)
    v_mfma_f32_16x16x32_bf16 v[120:123], a[0:3], v[40:43], 0
    v_mfma_f32_16x16x32_bf16 v[124:127], a[40:43], v[40:43], 0
    s_waitcnt lgkmcnt(8)
    v_mfma_f32_16x16x32_bf16 v[120:123], a[4:7], v[44:47], v[120:123]
    v_mfma_f32_16x16x32_bf16 v[124:127], a[44:47], v[44:47], v[124:127]
    s_waitcnt lgkmcnt(7)
    v_mfma_f32_16x16x32_bf16 v[120:123], a[8:11], v[48:51], v[120:123]
    v_mfma_f32_16x16x32_bf16 v[124:127], a[48:51], v[48:51], v[124:127]
    s_waitcnt lgkmcnt(6)
    v_mfma_f32_16x16x32_bf16 v[120:123], a[12:15], v[52:55], v[120:123]
    v_mfma_f32_16x16x32_bf16 v[124:127], a[52:55], v[52:55], v[124:127]
    s_waitcnt lgkmcnt(5)
    v_mfma_f32_16x16x32_bf16 v[120:123], a[16:19], v[56:59], v[120:123]
    v_mfma_f32_16x16x32_bf16 v[124:127], a[56:59], v[56:59], v[124:127]
    s_waitcnt lgkmcnt(4)
    v_mfma_f32_16x16x32_bf16 v[120:123], a[20:23], v[60:63], v[120:123]
    v_mfma_f32_16x16x32_bf16 v[124:127], a[60:63], v[60:63], v[124:127]
    s_waitcnt lgkmcnt(3)
    v_mfma_f32_16x16x32_bf16 v[120:123], a[24:27], v[64:67], v[120:123]
    v_mfma_f32_16x16x32_bf16 v[124:127], a[64:67], v[64:67], v[124:127]
    s_waitcnt lgkmcnt(2)
    v_mfma_f32_16x16x32_bf16 v[120:123], a[28:31], v[68:71], v[120:123]
    v_mfma_f32_16x16x32_bf16 v[124:127], a[68:71], v[68:71], v[124:127]
    s_waitcnt lgkmcnt(1)
    v_mfma_f32_16x16x32_bf16 v[120:123], a[32:35], v[72:75], v[120:123]
    v_mfma_f32_16x16x32_bf16 v[124:127], a[72:75], v[72:75], v[124:127]
    s_waitcnt lgkmcnt(0)
    v_mfma_f32_16x16x32_bf16 v[120:123], a[36:39], v[76:79], v[120:123]
    v_mfma_f32_16x16x32_bf16 v[124:127], a[76:79], v[76:79], v[124:127]
    v_mfma_f32_16x16x32_bf16 v[84:87], a[80:83], v[40:43], 0
    v_mfma_f32_16x16x32_bf16 v[84:87], a[84:87], v[44:47], v[84:87]
    s_nop 5
    v_add_f32_dpp v120, v124, v120 row_ror:8 row_mask:0xf bank_mask:0xf
    v_add_f32_dpp v121, v125, v121 row_ror:8 row_mask:0xf bank_mask:0xf
    v_add_f32_dpp v122, v126, v122 row_ror:8 row_mask:0xf bank_mask:0xf
    v_add_f32_dpp v123, v127, v123 row_ror:8 row_mask:0xf bank_mask:0xf
    v_cvt_pk_bf16_f32 v248, v120, v121
    v_cvt_pk_bf16_f32 v249, v122, v123
    buffer_store_dwordx2 v[248:249], v1, s[8:11], s84 offen sc1
    v_mfma_f32_16x16x32_bf16 v[84:87], a[88:91], v[48:51], v[84:87]
    v_mfma_f32_16x16x32_bf16 v[84:87], a[92:95], v[52:55], v[84:87]
    v_mfma_f32_16x16x32_bf16 v[84:87], a[96:99], v[56:59], v[84:87]
    v_mfma_f32_16x16x32_bf16 v[84:87], a[100:103], v[60:63], v[84:87]
    v_mfma_f32_16x16x32_bf16 v[84:87], a[104:107], v[64:67], v[84:87]
    v_mfma_f32_16x16x32_bf16 v[84:87], a[108:111], v[68:71], v[84:87]
    v_mfma_f32_16x16x32_bf16 v[84:87], a[112:115], v[72:75], v[84:87]
    v_mfma_f32_16x16x32_bf16 v[84:87], a[116:119], v[76:79], v[84:87]
    ds_read_b128 v[160:163], v36 offset:0
    ds_read_b128 v[164:167], v36 offset:2048
    ds_read_b128 v[168:171], v36 offset:4096
    ds_read_b128 v[172:175], v36 offset:6144
    ds_read_b128 v[176:179], v36 offset:256
    ds_read_b128 v[180:183], v36 offset:2304
    ds_read_b128 v[184:187], v36 offset:4352
    ds_read_b128 v[188:191], v36 offset:6400
    v_cvt_pk_bf16_f32 v250, v84, v85
    v_cvt_pk_bf16_f32 v251, v86, v87
    buffer_store_dwordx2 v[250:251], v2, s[8:11], s84 offen sc1
    buffer_load_dwordx4 v[40:43], v3, s[8:11], s84 offen sc1
    s_nop 15
    s_nop 3
    buffer_load_dwordx4 v[44:47], v3, s[8:11], s84 offen sc1
    s_waitcnt vmcnt(1)
    ds_write_b128 v17, v[40:43]
    v_max3_u32 v20, v40, v41, v42
    v_max_u32 v20, v20, v43
    v_cmp_eq_u32 vcc, -1, v20
    s_cbranch_vccnz L_c_R_s0_retry
L_c_R_s0_done:
    s_nop 11
    buffer_load_dwordx4 v[144:147], v4, s[8:11], s84 offen offset:0 sc1
    buffer_load_dwordx4 v[148:151], v4, s[8:11], s84 offen offset:512 sc1
    buffer_load_dwordx4 v[152:155], v4, s[8:11], s84 offen offset:1024 sc1
    buffer_load_dwordx4 v[156:159], v4, s[8:11], s84 offen offset:1536 sc1
L_c_Rv_s0:
    s_waitcnt lgkmcnt(0)
    s_barrier
    ds_read_b128 v[128:131], v18 offset:0
    ds_read_b128 v[60:63], v19 offset:0
    ds_read_b128 v[132:135], v18 offset:512
    ds_read_b128 v[64:67], v19 offset:512
    ds_read_b128 v[136:139], v18 offset:1024
    ds_read_b128 v[68:71], v19 offset:1024
    ds_read_b128 v[140:143], v18 offset:1536
    ds_read_b128 v[72:75], v19 offset:1536
    s_waitcnt lgkmcnt(6)
    v_mfma_f32_16x16x32_bf16 v[192:195], v[160:163], v[128:131], 0
    v_mov_b32 v39, s21
    v_mfma_f32_16x16x32_bf16 v[196:199], v[176:179], v[128:131], 0
    buffer_store_dword v39, v38, s[8:11], s44 offen sc1
    v_mfma_f32_16x16x32_bf16 v[200:203], v[60:63], v[128:131], 0
    s_waitcnt lgkmcnt(4)
    v_mfma_f32_16x16x32_bf16 v[192:195], v[164:167], v[132:135], v[192:195]
    buffer_store_dwordx2 v[28:29], v1, s[8:11], s86 offen sc1
    v_mfma_f32_16x16x32_bf16 v[196:199], v[180:183], v[132:135], v[196:199]
    buffer_store_dwordx2 v[28:29], v2, s[8:11], s86 offen sc1
    v_mfma_f32_16x16x32_bf16 v[200:203], v[64:67], v[132:135], v[200:203]
    s_waitcnt lgkmcnt(2)
    v_mfma_f32_16x16x32_bf16 v[192:195], v[168:171], v[136:139], v[192:195]
    buffer_store_dwordx4 v[28:31], v5, s[8:11], s90 offen sc1
    v_mfma_f32_16x16x32_bf16 v[196:199], v[184:187], v[136:139], v[196:199]
    buffer_store_dwordx2 v[28:29], v6, s[8:11], s90 offen sc1
    v_mfma_f32_16x16x32_bf16 v[200:203], v[68:71], v[136:139], v[200:203]
    s_waitcnt lgkmcnt(0)
    v_mfma_f32_16x16x32_bf16 v[192:195], v[172:175], v[140:143], v[192:195]
    buffer_store_dwordx2 v[28:29], v9, s[8:11], s95 offen sc1
    v_mfma_f32_16x16x32_bf16 v[196:199], v[188:191], v[140:143], v[196:199]
    v_mfma_f32_16x16x32_bf16 v[200:203], v[72:75], v[140:143], v[200:203]
    s_waitcnt vmcnt(6)
    v_max3_u32 v20, v144, v145, v146
    v_max3_u32 v21, v147, v148, v149
    v_max3_u32 v20, v20, v150, v151
    v_max3_u32 v21, v21, v152, v153
    v_max3_u32 v20, v20, v154, v155
    v_max3_u32 v21, v21, v156, v157
    v_max3_u32 v20, v20, v158, v159
    v_max_u32 v20, v20, v21
    v_cmp_eq_u32 vcc, -1, v20
    s_cbranch_vccnz L_c_pollV_s0
L_c_okV_s0:
    v_max3_f32 v24, v192, v193, v194
    v_max3_f32 v25, v195, v196, v197
    v_mfma_f32_16x16x32_bf16 v[236:239], v[144:147], a[120:123], 0
    v_max3_f32 v24, v24, v198, v199
    v_max3_f32 v25, v25, v200, v201
    v_max3_f32 v24, v24, v202, v203
    v_max_f32 v24, v24, v25
    v_mov_b32 v25, v24
    v_mfma_f32_16x16x32_bf16 v[240:243], v[144:147], a[136:139], 0
    s_nop 0
    v_permlane16_swap_b32 v25, v24
    v_max_f32 v24, v24, v25
    v_mov_b32 v25, v24
    v_mfma_f32_16x16x32_bf16 v[244:247], v[144:147], a[152:155], 0
    s_nop 0
    v_permlane32_swap_b32 v25, v24
    v_max_f32 v24, v24, v25
    v_mul_f32 v24, s38, v24
    v_mfma_f32_16x16x32_bf16 v[236:239], v[148:151], a[124:127], v[236:239]
    v_pk_fma_f32 v[192:193], v[192:193], s[38:39], v[24:25] op_sel_hi:[1,1,0] neg_lo:[0,0,1] neg_hi:[0,0,1]
    v_pk_fma_f32 v[194:195], v[194:195], s[38:39], v[24:25] op_sel_hi:[1,1,0] neg_lo:[0,0,1] neg_hi:[0,0,1]
    v_mfma_f32_16x16x32_bf16 v[240:243], v[148:151], a[140:143], v[240:243]
    v_pk_fma_f32 v[196:197], v[196:197], s[38:39], v[24:25] op_sel_hi:[1,1,0] neg_lo:[0,0,1] neg_hi:[0,0,1]
    v_pk_fma_f32 v[198:199], v[198:199], s[38:39], v[24:25] op_sel_hi:[1,1,0] neg_lo:[0,0,1] neg_hi:[0,0,1]
    v_mfma_f32_16x16x32_bf16 v[244:247], v[148:151], a[156:159], v[244:247]
    v_pk_fma_f32 v[200:201], v[200:201], s[38:39], v[24:25] op_sel_hi:[1,1,0] neg_lo:[0,0,1] neg_hi:[0,0,1]
    v_pk_fma_f32 v[202:203], v[202:203], s[38:39], v[24:25] op_sel_hi:[1,1,0] neg_lo:[0,0,1] neg_hi:[0,0,1]
    v_mfma_f32_16x16x32_bf16 v[236:239], v[152:155], a[128:131], v[236:239]
    v_exp_f32 v192, v192
    v_exp_f32 v193, v193
    v_mfma_f32_16x16x32_bf16 v[240:243], v[152:155], a[144:147], v[240:243]
    v_exp_f32 v194, v194
    v_exp_f32 v195, v195
    v_mfma_f32_16x16x32_bf16 v[244:247], v[152:155], a[160:163], v[244:247]
    v_exp_f32 v196, v196
    v_exp_f32 v197, v197
    v_mfma_f32_16x16x32_bf16 v[236:239], v[156:159], a[132:135], v[236:239]
    v_exp_f32 v198, v198
    v_exp_f32 v199, v199
    v_mfma_f32_16x16x32_bf16 v[240:243], v[156:159], a[148:151], v[240:243]
    v_exp_f32 v200, v200
    v_exp_f32 v201, v201
    v_mfma_f32_16x16x32_bf16 v[244:247], v[156:159], a[164:167], v[244:247]
    v_exp_f32 v202, v202
    v_exp_f32 v203, v203
    v_cvt_pk_bf16_f32 v228, v192, v193
    v_cvt_pk_bf16_f32 v229, v194, v195
    v_cvt_pk_bf16_f32 v230, v196, v197
    v_cvt_pk_bf16_f32 v231, v198, v199
    v_cvt_pk_bf16_f32 v232, v200, v201
    v_cvt_pk_bf16_f32 v233, v202, v203
    v_mfma_f32_16x16x32_bf16 v[20:23], a[168:171], v[228:231], 0
    v_mfma_f32_16x16x32_bf16 v[120:123], v[204:207], v[228:231], 0
    v_mfma_f32_16x16x32_bf16 v[124:127], v[208:211], v[228:231], 0
    v_mfma_f32_16x16x32_bf16 v[84:87], v[212:215], v[228:231], 0
    v_cvt_pk_bf16_f32 v216, v236, v237
    v_cvt_pk_bf16_f32 v217, v238, v239
    v_cvt_pk_bf16_f32 v220, v240, v241
    v_cvt_pk_bf16_f32 v221, v242, v243
    v_cvt_pk_bf16_f32 v224, v244, v245
    v_cvt_pk_bf16_f32 v225, v246, v247
    v_mfma_f32_16x16x32_bf16 v[20:23], a[172:175], v[232:235], v[20:23]
    v_mfma_f32_16x16x32_bf16 v[120:123], v[216:219], v[232:235], v[120:123]
    v_mfma_f32_16x16x32_bf16 v[124:127], v[220:223], v[232:235], v[124:127]
    v_mfma_f32_16x16x32_bf16 v[84:87], v[224:227], v[232:235], v[84:87]
    s_nop 4
    v_rcp_f32 v26, v20
    s_nop 1
    v_pk_mul_f32 v[120:121], v[120:121], v[26:27] op_sel_hi:[1,0]
    v_pk_mul_f32 v[122:123], v[122:123], v[26:27] op_sel_hi:[1,0]
    v_cvt_pk_bf16_f32 v56, v120, v121
    v_cvt_pk_bf16_f32 v57, v122, v123
    v_pk_mul_f32 v[124:125], v[124:125], v[26:27] op_sel_hi:[1,0]
    v_pk_mul_f32 v[126:127], v[126:127], v[26:27] op_sel_hi:[1,0]
    v_cvt_pk_bf16_f32 v58, v124, v125
    v_cvt_pk_bf16_f32 v59, v126, v127
    buffer_store_dwordx4 v[56:59], v5, s[8:11], s88 offen sc1
    v_pk_mul_f32 v[84:85], v[84:85], v[26:27] op_sel_hi:[1,0]
    v_pk_mul_f32 v[86:87], v[86:87], v[26:27] op_sel_hi:[1,0]
    v_cvt_pk_bf16_f32 v254, v84, v85
    v_cvt_pk_bf16_f32 v255, v86, v87
    buffer_store_dwordx2 v[254:255], v6, s[8:11], s88 offen sc1
    ds_read_b128 v[160:163], v36 offset:24576
    ds_read_b128 v[164:167], v36 offset:26624
    ds_read_b128 v[168:171], v36 offset:28672
    ds_read_b128 v[172:175], v36 offset:30720
    ds_read_b128 v[176:179], v36 offset:24832
    ds_read_b128 v[180:183], v36 offset:26880
    ds_read_b128 v[184:187], v36 offset:28928
    ds_read_b128 v[188:191], v36 offset:30976
    s_cmp_eq_u32 s23, 0
    s_cbranch_scc1 L_c_noitem_s0
    s_nop 15
    s_nop 13
    buffer_load_dwordx2 v[88:89], v7, s[8:11], s88 offen sc1
    buffer_load_dwordx2 v[90:91], v8, s[8:11], s88 offen sc1
    s_nop 14
    buffer_load_dwordx2 v[60:61], v7, s[8:11], s88 offen sc1
    buffer_load_dwordx2 v[62:63], v8, s[8:11], s88 offen sc1
    s_nop 14
    buffer_load_dwordx2 v[64:65], v7, s[8:11], s88 offen sc1
    buffer_load_dwordx2 v[66:67], v8, s[8:11], s88 offen sc1
    s_waitcnt vmcnt(4)
    v_mfma_f32_16x16x32_bf16 v[92:95], v[32:35], v[88:91], 0
    v_max3_u32 v20, v88, v89, v90
    v_max_u32 v20, v20, v91
    v_cmp_eq_u32 vcc, -1, v20
    s_cbranch_vccnz L_c_RS_s0_retry
L_c_RS_s0_done:
    s_nop 3
    buffer_store_dwordx4 v[92:95], v82, s[8:11], s96 offen sc1
    buffer_store_dwordx4 v[28:31], v82, s[8:11], s98 offen sc1
    s_waitcnt lgkmcnt(0)
    v_mfma_f32_16x16x32_bf16 v[236:239], v[160:163], a[120:123], 0
    v_mfma_f32_16x16x32_bf16 v[240:243], v[176:179], a[120:123], 0
    v_mfma_f32_16x16x32_bf16 v[236:239], v[164:167], a[124:127], v[236:239]
    v_mfma_f32_16x16x32_bf16 v[240:243], v[180:183], a[124:127], v[240:243]
    v_mfma_f32_16x16x32_bf16 v[236:239], v[168:171], a[128:131], v[236:239]
    v_mfma_f32_16x16x32_bf16 v[240:243], v[184:187], a[128:131], v[240:243]
    v_mfma_f32_16x16x32_bf16 v[236:239], v[172:175], a[132:135], v[236:239]
    v_mfma_f32_16x16x32_bf16 v[240:243], v[188:191], a[132:135], v[240:243]
    v_mfma_f32_16x16x32_bf16 v[120:123], v[160:163], a[136:139], 0
    v_mfma_f32_16x16x32_bf16 v[124:127], v[176:179], a[136:139], 0
    v_mfma_f32_16x16x32_bf16 v[120:123], v[164:167], a[140:143], v[120:123]
    v_mfma_f32_16x16x32_bf16 v[124:127], v[180:183], a[140:143], v[124:127]
    v_mfma_f32_16x16x32_bf16 v[120:123], v[168:171], a[144:147], v[120:123]
    v_mfma_f32_16x16x32_bf16 v[124:127], v[184:187], a[144:147], v[124:127]
    v_mfma_f32_16x16x32_bf16 v[120:123], v[172:175], a[148:151], v[120:123]
    v_mfma_f32_16x16x32_bf16 v[124:127], v[188:191], a[148:151], v[124:127]
    v_cvt_pk_bf16_f32 v204, v236, v237
    v_cvt_pk_bf16_f32 v205, v238, v239
    v_cvt_pk_bf16_f32 v206, v240, v241
    v_cvt_pk_bf16_f32 v207, v242, v243
    v_mfma_f32_16x16x32_bf16 v[236:239], v[160:163], a[152:155], 0
    v_mfma_f32_16x16x32_bf16 v[240:243], v[176:179], a[152:155], 0
    v_mfma_f32_16x16x32_bf16 v[236:239], v[164:167], a[156:159], v[236:239]
    v_mfma_f32_16x16x32_bf16 v[240:243], v[180:183], a[156:159], v[240:243]
    v_mfma_f32_16x16x32_bf16 v[236:239], v[168:171], a[160:163], v[236:239]
    v_mfma_f32_16x16x32_bf16 v[240:243], v[184:187], a[160:163], v[240:243]
    v_mfma_f32_16x16x32_bf16 v[236:239], v[172:175], a[164:167], v[236:239]
    v_mfma_f32_16x16x32_bf16 v[240:243], v[188:191], a[164:167], v[240:243]
    v_cvt_pk_bf16_f32 v208, v120, v121
    v_cvt_pk_bf16_f32 v209, v122, v123
    v_cvt_pk_bf16_f32 v210, v124, v125
    v_cvt_pk_bf16_f32 v211, v126, v127
    s_nop 6
    v_cvt_pk_bf16_f32 v212, v236, v237
    v_cvt_pk_bf16_f32 v213, v238, v239
    v_cvt_pk_bf16_f32 v214, v240, v241
    v_cvt_pk_bf16_f32 v215, v242, v243
    buffer_load_dwordx4 v[108:111], v104, s[8:11], s96 offen sc1
    buffer_load_dwordx4 v[112:115], v105, s[8:11], s96 offen sc1
    buffer_load_dwordx4 v[116:119], v106, s[8:11], s96 offen sc1
    s_nop 15
    s_nop 15
    s_nop 7
    buffer_load_dwordx4 v[68:71], v104, s[8:11], s96 offen sc1
    buffer_load_dwordx4 v[72:75], v105, s[8:11], s96 offen sc1
    buffer_load_dwordx4 v[76:79], v106, s[8:11], s96 offen sc1
    s_waitcnt vmcnt(3)
    v_max3_u32 v20, v108, v109, v110
    v_max3_u32 v21, v111, v112, v113
    v_max3_u32 v20, v20, v114, v115
    v_max3_u32 v21, v21, v116, v117
    v_max3_u32 v20, v20, v118, v119
    v_max_u32 v20, v20, v21
    v_cmp_eq_u32 vcc, -1, v20
    s_cbranch_vccnz L_c_X_s0_retry
    v_pk_add_f32 v[20:21], v[108:109], v[116:117]
    v_pk_add_f32 v[92:93], v[92:93], v[112:113]
    v_pk_add_f32 v[22:23], v[110:111], v[118:119]
    v_pk_add_f32 v[94:95], v[94:95], v[114:115]
L_c_X_s0_done:
    v_pk_add_f32 v[92:93], v[92:93], v[20:21]
    v_pk_add_f32 v[94:95], v[94:95], v[22:23]
    v_cvt_pk_bf16_f32 v254, v92, v93
    v_cvt_pk_bf16_f32 v255, v94, v95
    buffer_store_dwordx2 v[254:255], v9, s[8:11], s93 offen sc1
L_c_stepend_s0:
    s_add_u32 s40, s40, 65536
    s_add_u32 s41, s41, 131072
    s_add_u32 s42, s42, 262144
    s_add_u32 s21, s21, 1
    s_barrier
L_c_loop_s1:
    buffer_load_dwordx4 v[144:147], v10, s[8:11], s93 offen sc1
    buffer_load_dwordx4 v[148:151], v11, s[8:11], s93 offen sc1
    buffer_load_dwordx4 v[152:155], v12, s[8:11], s93 offen sc1
    s_nop 15
    s_nop 15
    s_nop 7
    buffer_load_dwordx4 v[128:131], v10, s[8:11], s93 offen sc1
    buffer_load_dwordx4 v[132:135], v11, s[8:11], s93 offen sc1
    buffer_load_dwordx4 v[136:139], v12, s[8:11], s93 offen sc1
    s_waitcnt vmcnt(3)
    ds_write_b128 v100, v[144:147]
    ds_write_b128 v101, v[148:151]
    ds_write_b128 v102, v[152:155]
    v_max3_u32 v20, v144, v145, v146
    v_max3_u32 v21, v147, v148, v149
    v_max3_u32 v20, v20, v150, v151
    v_max3_u32 v21, v21, v152, v153
    v_max3_u32 v20, v20, v154, v155
    v_max_u32 v20, v20, v21
    v_cmp_eq_u32 vcc, -1, v20
    s_cbranch_vccnz L_c_A_s1_retry
L_c_A_s1_done:
    s_waitcnt lgkmcnt(0)
    s_barrier
    ds_read_b128 v[40:43], v16 offset:0
    ds_read_b128 v[44:47], v16 offset:64
    ds_read_b128 v[48:51], v16 offset:128
    ds_read_b128 v[52:55], v16 offset:192
    ds_read_b128 v[56:59], v16 offset:256
    ds_read_b128 v[60:63], v16 offset:320
    ds_read_b128 v[64:67], v16 offset:384
    ds_read_b128 v[68:71], v16 offset:448
    ds_read_b128 v[72:75], v16 offset:512
    ds_read_b128 v[76:79], v16 offset:576
    s_waitcnt lgkmcnt(9)
    v_mfma_f32_16x16x32_bf16 v[120:123], a[0:3], v[40:43], 0
    v_mfma_f32_16x16x32_bf16 v[124:127], a[40:43], v[40:43], 0
    s_waitcnt lgkmcnt(8)
    v_mfma_f32_16x16x32_bf16 v[120:123], a[4:7], v[44:47], v[120:123]
    v_mfma_f32_16x16x32_bf16 v[124:127], a[44:47], v[44:47], v[124:127]
    s_waitcnt lgkmcnt(7)
    v_mfma_f32_16x16x32_bf16 v[120:123], a[8:11], v[48:51], v[120:123]
    v_mfma_f32_16x16x32_bf16 v[124:127], a[48:51], v[48:51], v[124:127]
    s_waitcnt lgkmcnt(6)
    v_mfma_f32_16x16x32_bf16 v[120:123], a[12:15], v[52:55], v[120:123]
    v_mfma_f32_16x16x32_bf16 v[124:127], a[52:55], v[52:55], v[124:127]
    s_waitcnt lgkmcnt(5)
    v_mfma_f32_16x16x32_bf16 v[120:123], a[16:19], v[56:59], v[120:123]
    v_mfma_f32_16x16x32_bf16 v[124:127], a[56:59], v[56:59], v[124:127]
    s_waitcnt lgkmcnt(4)
    v_mfma_f32_16x16x32_bf16 v[120:123], a[20:23], v[60:63], v[120:123]
    v_mfma_f32_16x16x32_bf16 v[124:127], a[60:63], v[60:63], v[124:127]
    s_waitcnt lgkmcnt(3)
    v_mfma_f32_16x16x32_bf16 v[120:123], a[24:27], v[64:67], v[120:123]
    v_mfma_f32_16x16x32_bf16 v[124:127], a[64:67], v[64:67], v[124:127]
    s_waitcnt lgkmcnt(2)
    v_mfma_f32_16x16x32_bf16 v[120:123], a[28:31], v[68:71], v[120:123]
    v_mfma_f32_16x16x32_bf16 v[124:127], a[68:71], v[68:71], v[124:127]
    s_waitcnt lgkmcnt(1)
    v_mfma_f32_16x16x32_bf16 v[120:123], a[32:35], v[72:75], v[120:123]
    v_mfma_f32_16x16x32_bf16 v[124:127], a[72:75], v[72:75], v[124:127]
    s_waitcnt lgkmcnt(0)
    v_mfma_f32_16x16x32_bf16 v[120:123], a[36:39], v[76:79], v[120:123]
    v_mfma_f32_16x16x32_bf16 v[124:127], a[76:79], v[76:79], v[124:127]
    v_mfma_f32_16x16x32_bf16 v[84:87], a[80:83], v[40:43], 0
    v_mfma_f32_16x16x32_bf16 v[84:87], a[84:87], v[44:47], v[84:87]
    s_nop 5
    v_add_f32_dpp v120, v124, v120 row_ror:8 row_mask:0xf bank_mask:0xf
    v_add_f32_dpp v121, v125, v121 row_ror:8 row_mask:0xf bank_mask:0xf
    v_add_f32_dpp v122, v126, v122 row_ror:8 row_mask:0xf bank_mask:0xf
    v_add_f32_dpp v123, v127, v123 row_ror:8 row_mask:0xf bank_mask:0xf
    v_cvt_pk_bf16_f32 v248, v120, v121
    v_cvt_pk_bf16_f32 v249, v122, v123
    buffer_store_dwordx2 v[248:249], v1, s[8:11], s85 offen sc1
    v_mfma_f32_16x16x32_bf16 v[84:87], a[88:91], v[48:51], v[84:87]
    v_mfma_f32_16x16x32_bf16 v[84:87], a[92:95], v[52:55], v[84:87]
    v_mfma_f32_16x16x32_bf16 v[84:87], a[96:99], v[56:59], v[84:87]
    v_mfma_f32_16x16x32_bf16 v[84:87], a[100:103], v[60:63], v[84:87]
    v_mfma_f32_16x16x32_bf16 v[84:87], a[104:107], v[64:67], v[84:87]
    v_mfma_f32_16x16x32_bf16 v[84:87], a[108:111], v[68:71], v[84:87]
    v_mfma_f32_16x16x32_bf16 v[84:87], a[112:115], v[72:75], v[84:87]
    v_mfma_f32_16x16x32_bf16 v[84:87], a[116:119], v[76:79], v[84:87]
    ds_read_b128 v[160:163], v36 offset:16384
    ds_read_b128 v[164:167], v36 offset:18432
    ds_read_b128 v[168:171], v36 offset:20480
    ds_read_b128 v[172:175], v36 offset:22528
    ds_read_b128 v[176:179], v36 offset:16640
    ds_read_b128 v[180:183], v36 offset:18688
    ds_read_b128 v[184:187], v36 offset:20736
    ds_read_b128 v[188:191], v36 offset:22784
    v_cvt_pk_bf16_f32 v250, v84, v85
    v_cvt_pk_bf16_f32 v251, v86, v87
    buffer_store_dwordx2 v[250:251], v2, s[8:11], s85 offen sc1
    buffer_load_dwordx4 v[40:43], v3, s[8:11], s85 offen sc1
    s_nop 15
    s_nop 3
    buffer_load_dwordx4 v[44:47], v3, s[8:11], s85 offen sc1
    s_waitcnt vmcnt(1)
    ds_write_b128 v17, v[40:43]
    v_max3_u32 v20, v40, v41, v42
    v_max_u32 v20, v20, v43
    v_cmp_eq_u32 vcc, -1, v20
    s_cbranch_vccnz L_c_R_s1_retry
L_c_R_s1_done:
    s_nop 11
    buffer_load_dwordx4 v[144:147], v4, s[8:11], s85 offen offset:0 sc1
    buffer_load_dwordx4 v[148:151], v4, s[8:11], s85 offen offset:512 sc1
    buffer_load_dwordx4 v[152:155], v4, s[8:11], s85 offen offset:1024 sc1
    buffer_load_dwordx4 v[156:159], v4, s[8:11], s85 offen offset:1536 sc1
L_c_Rv_s1:
    s_waitcnt lgkmcnt(0)
    s_barrier
    ds_read_b128 v[128:131], v18 offset:0
    ds_read_b128 v[60:63], v19 offset:0
    ds_read_b128 v[132:135], v18 offset:512
    ds_read_b128 v[64:67], v19 offset:512
    ds_read_b128 v[136:139], v18 offset:1024
    ds_read_b128 v[68:71], v19 offset:1024
    ds_read_b128 v[140:143], v18 offset:1536
    ds_read_b128 v[72:75], v19 offset:1536
    s_waitcnt lgkmcnt(6)
    v_mfma_f32_16x16x32_bf16 v[192:195], v[160:163], v[128:131], 0
    v_mov_b32 v39, s21
    v_mfma_f32_16x16x32_bf16 v[196:199], v[176:179], v[128:131], 0
    buffer_store_dword v39, v38, s[8:11], s44 offen sc1
    v_mfma_f32_16x16x32_bf16 v[200:203], v[60:63], v[128:131], 0
    s_waitcnt lgkmcnt(4)
    v_mfma_f32_16x16x32_bf16 v[192:195], v[164:167], v[132:135], v[192:195]
    buffer_store_dwordx2 v[28:29], v1, s[8:11], s87 offen sc1
    v_mfma_f32_16x16x32_bf16 v[196:199], v[180:183], v[132:135], v[196:199]
    buffer_store_dwordx2 v[28:29], v2, s[8:11], s87 offen sc1
    v_mfma_f32_16x16x32_bf16 v[200:203], v[64:67], v[132:135], v[200:203]
    s_waitcnt lgkmcnt(2)
    v_mfma_f32_16x16x32_bf16 v[192:195], v[168:171], v[136:139], v[192:195]
    buffer_store_dwordx4 v[28:31], v5, s[8:11], s91 offen sc1
    v_mfma_f32_16x16x32_bf16 v[196:199], v[184:187], v[136:139], v[196:199]
    buffer_store_dwordx2 v[28:29], v6, s[8:11], s91 offen sc1
    v_mfma_f32_16x16x32_bf16 v[200:203], v[68:71], v[136:139], v[200:203]
    s_waitcnt lgkmcnt(0)
    v_mfma_f32_16x16x32_bf16 v[192:195], v[172:175], v[140:143], v[192:195]
    buffer_store_dwordx2 v[28:29], v9, s[8:11], s92 offen sc1
    v_mfma_f32_16x16x32_bf16 v[196:199], v[188:191], v[140:143], v[196:199]
    v_mfma_f32_16x16x32_bf16 v[200:203], v[72:75], v[140:143], v[200:203]
    s_waitcnt vmcnt(6)
    v_max3_u32 v20, v144, v145, v146
    v_max3_u32 v21, v147, v148, v149
    v_max3_u32 v20, v20, v150, v151
    v_max3_u32 v21, v21, v152, v153
    v_max3_u32 v20, v20, v154, v155
    v_max3_u32 v21, v21, v156, v157
    v_max3_u32 v20, v20, v158, v159
    v_max_u32 v20, v20, v21
    v_cmp_eq_u32 vcc, -1, v20
    s_cbranch_vccnz L_c_pollV_s1
L_c_okV_s1:
    v_max3_f32 v24, v192, v193, v194
    v_max3_f32 v25, v195, v196, v197
    v_mfma_f32_16x16x32_bf16 v[236:239], v[144:147], a[120:123], 0
    v_max3_f32 v24, v24, v198, v199
    v_max3_f32 v25, v25, v200, v201
    v_max3_f32 v24, v24, v202, v203
    v_max_f32 v24, v24, v25
    v_mov_b32 v25, v24
    v_mfma_f32_16x16x32_bf16 v[240:243], v[144:147], a[136:139], 0
    s_nop 0
    v_permlane16_swap_b32 v25, v24
    v_max_f32 v24, v24, v25
    v_mov_b32 v25, v24
    v_mfma_f32_16x16x32_bf16 v[244:247], v[144:147], a[152:155], 0
    s_nop 0
    v_permlane32_swap_b32 v25, v24
    v_max_f32 v24, v24, v25
    v_mul_f32 v24, s38, v24
    v_mfma_f32_16x16x32_bf16 v[236:239], v[148:151], a[124:127], v[236:239]
    v_pk_fma_f32 v[192:193], v[192:193], s[38:39], v[24:25] op_sel_hi:[1,1,0] neg_lo:[0,0,1] neg_hi:[0,0,1]
    v_pk_fma_f32 v[194:195], v[194:195], s[38:39], v[24:25] op_sel_hi:[1,1,0] neg_lo:[0,0,1] neg_hi:[0,0,1]
    v_mfma_f32_16x16x32_bf16 v[240:243], v[148:151], a[140:143], v[240:243]
    v_pk_fma_f32 v[196:197], v[196:197], s[38:39], v[24:25] op_sel_hi:[1,1,0] neg_lo:[0,0,1] neg_hi:[0,0,1]
    v_pk_fma_f32 v[198:199], v[198:199], s[38:39], v[24:25] op_sel_hi:[1,1,0] neg_lo:[0,0,1] neg_hi:[0,0,1]
    v_mfma_f32_16x16x32_bf16 v[244:247], v[148:151], a[156:159], v[244:247]
    v_pk_fma_f32 v[200:201], v[200:201], s[38:39], v[24:25] op_sel_hi:[1,1,0] neg_lo:[0,0,1] neg_hi:[0,0,1]
    v_pk_fma_f32 v[202:203], v[202:203], s[38:39], v[24:25] op_sel_hi:[1,1,0] neg_lo:[0,0,1] neg_hi:[0,0,1]
    v_mfma_f32_16x16x32_bf16 v[236:239], v[152:155], a[128:131], v[236:239]
    v_exp_f32 v192, v192
    v_exp_f32 v193, v193
    v_mfma_f32_16x16x32_bf16 v[240:243], v[152:155], a[144:147], v[240:243]
    v_exp_f32 v194, v194
    v_exp_f32 v195, v195
    v_mfma_f32_16x16x32_bf16 v[244:247], v[152:155], a[160:163], v[244:247]
    v_exp_f32 v196, v196
    v_exp_f32 v197, v197
    v_mfma_f32_16x16x32_bf16 v[236:239], v[156:159], a[132:135], v[236:239]
    v_exp_f32 v198, v198
    v_exp_f32 v199, v199
    v_mfma_f32_16x16x32_bf16 v[240:243], v[156:159], a[148:151], v[240:243]
    v_exp_f32 v200, v200
    v_exp_f32 v201, v201
    v_mfma_f32_16x16x32_bf16 v[244:247], v[156:159], a[164:167], v[244:247]
    v_exp_f32 v202, v202
    v_exp_f32 v203, v203
    v_cvt_pk_bf16_f32 v228, v192, v193
    v_cvt_pk_bf16_f32 v229, v194, v195
    v_cvt_pk_bf16_f32 v230, v196, v197
    v_cvt_pk_bf16_f32 v231, v198, v199
    v_cvt_pk_bf16_f32 v232, v200, v201
    v_cvt_pk_bf16_f32 v233, v202, v203
    v_mfma_f32_16x16x32_bf16 v[20:23], a[168:171], v[228:231], 0
    v_mfma_f32_16x16x32_bf16 v[120:123], v[204:207], v[228:231], 0
    v_mfma_f32_16x16x32_bf16 v[124:127], v[208:211], v[228:231], 0
    v_mfma_f32_16x16x32_bf16 v[84:87], v[212:215], v[228:231], 0
    v_cvt_pk_bf16_f32 v216, v236, v237
    v_cvt_pk_bf16_f32 v217, v238, v239
    v_cvt_pk_bf16_f32 v220, v240, v241
    v_cvt_pk_bf16_f32 v221, v242, v243
    v_cvt_pk_bf16_f32 v224, v244, v245
    v_cvt_pk_bf16_f32 v225, v246, v247
    v_mfma_f32_16x16x32_bf16 v[20:23], a[172:175], v[232:235], v[20:23]
    v_mfma_f32_16x16x32_bf16 v[120:123], v[216:219], v[232:235], v[120:123]
    v_mfma_f32_16x16x32_bf16 v[124:127], v[220:223], v[232:235], v[124:127]
    v_mfma_f32_16x16x32_bf16 v[84:87], v[224:227], v[232:235], v[84:87]
    s_nop 4
    v_rcp_f32 v26, v20
    s_nop 1
    v_pk_mul_f32 v[120:121], v[120:121], v[26:27] op_sel_hi:[1,0]
    v_pk_mul_f32 v[122:123], v[122:123], v[26:27] op_sel_hi:[1,0]
    v_cvt_pk_bf16_f32 v56, v120, v121
    v_cvt_pk_bf16_f32 v57, v122, v123
    v_pk_mul_f32 v[124:125], v[124:125], v[26:27] op_sel_hi:[1,0]
    v_pk_mul_f32 v[126:127], v[126:127], v[26:27] op_sel_hi:[1,0]
    v_cvt_pk_bf16_f32 v58, v124, v125
    v_cvt_pk_bf16_f32 v59, v126, v127
    buffer_store_dwordx4 v[56:59], v5, s[8:11], s89 offen sc1
    v_pk_mul_f32 v[84:85], v[84:85], v[26:27] op_sel_hi:[1,0]
    v_pk_mul_f32 v[86:87], v[86:87], v[26:27] op_sel_hi:[1,0]
    v_cvt_pk_bf16_f32 v254, v84, v85
    v_cvt_pk_bf16_f32 v255, v86, v87
    buffer_store_dwordx2 v[254:255], v6, s[8:11], s89 offen sc1
    ds_read_b128 v[160:163], v36 offset:40960
    ds_read_b128 v[164:167], v36 offset:43008
    ds_read_b128 v[168:171], v36 offset:45056
    ds_read_b128 v[172:175], v36 offset:47104
    ds_read_b128 v[176:179], v36 offset:41216
    ds_read_b128 v[180:183], v36 offset:43264
    ds_read_b128 v[184:187], v36 offset:45312
    ds_read_b128 v[188:191], v36 offset:47360
    s_cmp_eq_u32 s23, 0
    s_cbranch_scc1 L_c_noitem_s1
    s_nop 15
    s_nop 13
    buffer_load_dwordx2 v[88:89], v7, s[8:11], s89 offen sc1
    buffer_load_dwordx2 v[90:91], v8, s[8:11], s89 offen sc1
    s_nop 14
    buffer_load_dwordx2 v[60:61], v7, s[8:11], s89 offen sc1
    buffer_load_dwordx2 v[62:63], v8, s[8:11], s89 offen sc1
    s_nop 14
    buffer_load_dwordx2 v[64:65], v7, s[8:11], s89 offen sc1
    buffer_load_dwordx2 v[66:67], v8, s[8:11], s89 offen sc1
    s_waitcnt vmcnt(4)
    v_mfma_f32_16x16x32_bf16 v[92:95], v[32:35], v[88:91], 0
    v_max3_u32 v20, v88, v89, v90
    v_max_u32 v20, v20, v91
    v_cmp_eq_u32 vcc, -1, v20
    s_cbranch_vccnz L_c_RS_s1_retry
L_c_RS_s1_done:
    s_nop 3
    buffer_store_dwordx4 v[92:95], v82, s[8:11], s97 offen sc1
    buffer_store_dwordx4 v[28:31], v82, s[8:11], s99 offen sc1
    s_waitcnt lgkmcnt(0)
    v_mfma_f32_16x16x32_bf16 v[236:239], v[160:163], a[120:123], 0
    v_mfma_f32_16x16x32_bf16 v[240:243], v[176:179], a[120:123], 0
    v_mfma_f32_16x16x32_bf16 v[236:239], v[164:167], a[124:127], v[236:239]
    v_mfma_f32_16x16x32_bf16 v[240:243], v[180:183], a[124:127], v[240:243]
    v_mfma_f32_16x16x32_bf16 v[236:239], v[168:171], a[128:131], v[236:239]
    v_mfma_f32_16x16x32_bf16 v[240:243], v[184:187], a[128:131], v[240:243]
    v_mfma_f32_16x16x32_bf16 v[236:239], v[172:175], a[132:135], v[236:239]
    v_mfma_f32_16x16x32_bf16 v[240:243], v[188:191], a[132:135], v[240:243]
    v_mfma_f32_16x16x32_bf16 v[120:123], v[160:163], a[136:139], 0
    v_mfma_f32_16x16x32_bf16 v[124:127], v[176:179], a[136:139], 0
    v_mfma_f32_16x16x32_bf16 v[120:123], v[164:167], a[140:143], v[120:123]
    v_mfma_f32_16x16x32_bf16 v[124:127], v[180:183], a[140:143], v[124:127]
    v_mfma_f32_16x16x32_bf16 v[120:123], v[168:171], a[144:147], v[120:123]
    v_mfma_f32_16x16x32_bf16 v[124:127], v[184:187], a[144:147], v[124:127]
    v_mfma_f32_16x16x32_bf16 v[120:123], v[172:175], a[148:151], v[120:123]
    v_mfma_f32_16x16x32_bf16 v[124:127], v[188:191], a[148:151], v[124:127]
    v_cvt_pk_bf16_f32 v204, v236, v237
    v_cvt_pk_bf16_f32 v205, v238, v239
    v_cvt_pk_bf16_f32 v206, v240, v241
    v_cvt_pk_bf16_f32 v207, v242, v243
    v_mfma_f32_16x16x32_bf16 v[236:239], v[160:163], a[152:155], 0
    v_mfma_f32_16x16x32_bf16 v[240:243], v[176:179], a[152:155], 0
    v_mfma_f32_16x16x32_bf16 v[236:239], v[164:167], a[156:159], v[236:239]
    v_mfma_f32_16x16x32_bf16 v[240:243], v[180:183], a[156:159], v[240:243]
    v_mfma_f32_16x16x32_bf16 v[236:239], v[168:171], a[160:163], v[236:239]
    v_mfma_f32_16x16x32_bf16 v[240:243], v[184:187], a[160:163], v[240:243]
    v_mfma_f32_16x16x32_bf16 v[236:239], v[172:175], a[164:167], v[236:239]
    v_mfma_f32_16x16x32_bf16 v[240:243], v[188:191], a[164:167], v[240:243]
    v_cvt_pk_bf16_f32 v208, v120, v121
    v_cvt_pk_bf16_f32 v209, v122, v123
    v_cvt_pk_bf16_f32 v210, v124, v125
    v_cvt_pk_bf16_f32 v211, v126, v127
    s_nop 6
    v_cvt_pk_bf16_f32 v212, v236, v237
    v_cvt_pk_bf16_f32 v213, v238, v239
    v_cvt_pk_bf16_f32 v214, v240, v241
    v_cvt_pk_bf16_f32 v215, v242, v243
    buffer_load_dwordx4 v[108:111], v104, s[8:11], s97 offen sc1
    buffer_load_dwordx4 v[112:115], v105, s[8:11], s97 offen sc1
    buffer_load_dwordx4 v[116:119], v106, s[8:11], s97 offen sc1
    s_nop 15
    s_nop 15
    s_nop 7
    buffer_load_dwordx4 v[68:71], v104, s[8:11], s97 offen sc1
    buffer_load_dwordx4 v[72:75], v105, s[8:11], s97 offen sc1
    buffer_load_dwordx4 v[76:79], v106, s[8:11], s97 offen sc1
    s_waitcnt vmcnt(3)
    v_max3_u32 v20, v108, v109, v110
    v_max3_u32 v21, v111, v112, v113
    v_max3_u32 v20, v20, v114, v115
    v_max3_u32 v21, v21, v116, v117
    v_max3_u32 v20, v20, v118, v119
    v_max_u32 v20, v20, v21
    v_cmp_eq_u32 vcc, -1, v20
    s_cbranch_vccnz L_c_X_s1_retry
    v_pk_add_f32 v[20:21], v[108:109], v[116:117]
    v_pk_add_f32 v[92:93], v[92:93], v[112:113]
    v_pk_add_f32 v[22:23], v[110:111], v[118:119]
    v_pk_add_f32 v[94:95], v[94:95], v[114:115]
L_c_X_s1_done:
    v_pk_add_f32 v[92:93], v[92:93], v[20:21]
    v_pk_add_f32 v[94:95], v[94:95], v[22:23]
    v_cvt_pk_bf16_f32 v254, v92, v93
    v_cvt_pk_bf16_f32 v255, v94, v95
    buffer_store_dwordx2 v[254:255], v9, s[8:11], s94 offen sc1
L_c_stepend_s1:
    s_add_u32 s40, s40, 65536
    s_add_u32 s41, s41, 131072
    s_add_u32 s42, s42, 262144
    s_add_u32 s21, s21, 1
    s_barrier
L_c_loop_s2:
    buffer_load_dwordx4 v[144:147], v10, s[8:11], s94 offen sc1
    buffer_load_dwordx4 v[148:151], v11, s[8:11], s94 offen sc1
    buffer_load_dwordx4 v[152:155], v12, s[8:11], s94 offen sc1
    s_nop 15
    s_nop 15
    s_nop 7
    buffer_load_dwordx4 v[128:131], v10, s[8:11], s94 offen sc1
    buffer_load_dwordx4 v[132:135], v11, s[8:11], s94 offen sc1
    buffer_load_dwordx4 v[136:139], v12, s[8:11], s94 offen sc1
    s_waitcnt vmcnt(3)
    ds_write_b128 v100, v[144:147]
    ds_write_b128 v101, v[148:151]
    ds_write_b128 v102, v[152:155]
    v_max3_u32 v20, v144, v145, v146
    v_max3_u32 v21, v147, v148, v149
    v_max3_u32 v20, v20, v150, v151
    v_max3_u32 v21, v21, v152, v153
    v_max3_u32 v20, v20, v154, v155
    v_max_u32 v20, v20, v21
    v_cmp_eq_u32 vcc, -1, v20
    s_cbranch_vccnz L_c_A_s2_retry
L_c_A_s2_done:
    s_waitcnt lgkmcnt(0)
    s_barrier
    ds_read_b128 v[40:43], v16 offset:0
    ds_read_b128 v[44:47], v16 offset:64
    ds_read_b128 v[48:51], v16 offset:128
    ds_read_b128 v[52:55], v16 offset:192
    ds_read_b128 v[56:59], v16 offset:256
    ds_read_b128 v[60:63], v16 offset:320
    ds_read_b128 v[64:67], v16 offset:384
    ds_read_b128 v[68:71], v16 offset:448
    ds_read_b128 v[72:75], v16 offset:512
    ds_read_b128 v[76:79], v16 offset:576
    s_waitcnt lgkmcnt(9)
    v_mfma_f32_16x16x32_bf16 v[120:123], a[0:3], v[40:43], 0
    v_mfma_f32_16x16x32_bf16 v[124:127], a[40:43], v[40:43], 0
    s_waitcnt lgkmcnt(8)
    v_mfma_f32_16x16x32_bf16 v[120:123], a[4:7], v[44:47], v[120:123]
    v_mfma_f32_16x16x32_bf16 v[124:127], a[44:47], v[44:47], v[124:127]
    s_waitcnt lgkmcnt(7)
    v_mfma_f32_16x16x32_bf16 v[120:123], a[8:11], v[48:51], v[120:123]
    v_mfma_f32_16x16x32_bf16 v[124:127], a[48:51], v[48:51], v[124:127]
    s_waitcnt lgkmcnt(6)
    v_mfma_f32_16x16x32_bf16 v[120:123], a[12:15], v[52:55], v[120:123]
    v_mfma_f32_16x16x32_bf16 v[124:127], a[52:55], v[52:55], v[124:127]
    s_waitcnt lgkmcnt(5)
    v_mfma_f32_16x16x32_bf16 v[120:123], a[16:19], v[56:59], v[120:123]
    v_mfma_f32_16x16x32_bf16 v[124:127], a[56:59], v[56:59], v[124:127]
    s_waitcnt lgkmcnt(4)
    v_mfma_f32_16x16x32_bf16 v[120:123], a[20:23], v[60:63], v[120:123]
    v_mfma_f32_16x16x32_bf16 v[124:127], a[60:63], v[60:63], v[124:127]
    s_waitcnt lgkmcnt(3)
    v_mfma_f32_16x16x32_bf16 v[120:123], a[24:27], v[64:67], v[120:123]
    v_mfma_f32_16x16x32_bf16 v[124:127], a[64:67], v[64:67], v[124:127]
    s_waitcnt lgkmcnt(2)
    v_mfma_f32_16x16x32_bf16 v[120:123], a[28:31], v[68:71], v[120:123]
    v_mfma_f32_16x16x32_bf16 v[124:127], a[68:71], v[68:71], v[124:127]
    s_waitcnt lgkmcnt(1)
    v_mfma_f32_16x16x32_bf16 v[120:123], a[32:35], v[72:75], v[120:123]
    v_mfma_f32_16x16x32_bf16 v[124:127], a[72:75], v[72:75], v[124:127]
    s_waitcnt lgkmcnt(0)
    v_mfma_f32_16x16x32_bf16 v[120:123], a[36:39], v[76:79], v[120:123]
    v_mfma_f32_16x16x32_bf16 v[124:127], a[76:79], v[76:79], v[124:127]
    v_mfma_f32_16x16x32_bf16 v[84:87], a[80:83], v[40:43], 0
    v_mfma_f32_16x16x32_bf16 v[84:87], a[84:87], v[44:47], v[84:87]
    s_nop 5
    v_add_f32_dpp v120, v124, v120 row_ror:8 row_mask:0xf bank_mask:0xf
    v_add_f32_dpp v121, v125, v121 row_ror:8 row_mask:0xf bank_mask:0xf
    v_add_f32_dpp v122, v126, v122 row_ror:8 row_mask:0xf bank_mask:0xf
    v_add_f32_dpp v123, v127, v123 row_ror:8 row_mask:0xf bank_mask:0xf
    v_cvt_pk_bf16_f32 v248, v120, v121
    v_cvt_pk_bf16_f32 v249, v122, v123
    buffer_store_dwordx2 v[248:249], v1, s[8:11], s86 offen sc1
    v_mfma_f32_16x16x32_bf16 v[84:87], a[88:91], v[48:51], v[84:87]
    v_mfma_f32_16x16x32_bf16 v[84:87], a[92:95], v[52:55], v[84:87]
    v_mfma_f32_16x16x32_bf16 v[84:87], a[96:99], v[56:59], v[84:87]
    v_mfma_f32_16x16x32_bf16 v[84:87], a[100:103], v[60:63], v[84:87]
    v_mfma_f32_16x16x32_bf16 v[84:87], a[104:107], v[64:67], v[84:87]
    v_mfma_f32_16x16x32_bf16 v[84:87], a[108:111], v[68:71], v[84:87]
    v_mfma_f32_16x16x32_bf16 v[84:87], a[112:115], v[72:75], v[84:87]
    v_mfma_f32_16x16x32_bf16 v[84:87], a[116:119], v[76:79], v[84:87]
    ds_read_b128 v[160:163], v36 offset:32768
    ds_read_b128 v[164:167], v36 offset:34816
    ds_read_b128 v[168:171], v36 offset:36864
    ds_read_b128 v[172:175], v36 offset:38912
    ds_read_b128 v[176:179], v36 offset:33024
    ds_read_b128 v[180:183], v36 offset:35072
    ds_read_b128 v[184:187], v36 offset:37120
    ds_read_b128 v[188:191], v36 offset:39168
    v_cvt_pk_bf16_f32 v250, v84, v85
    v_cvt_pk_bf16_f32 v251, v86, v87
    buffer_store_dwordx2 v[250:251], v2, s[8:11], s86 offen sc1
    buffer_load_dwordx4 v[40:43], v3, s[8:11], s86 offen sc1
    s_nop 15
    s_nop 3
    buffer_load_dwordx4 v[44:47], v3, s[8:11], s86 offen sc1
    s_waitcnt vmcnt(1)
    ds_write_b128 v17, v[40:43]
    v_max3_u32 v20, v40, v41, v42
    v_max_u32 v20, v20, v43
    v_cmp_eq_u32 vcc, -1, v20
    s_cbranch_vccnz L_c_R_s2_retry
L_c_R_s2_done:
    s_nop 11
    buffer_load_dwordx4 v[144:147], v4, s[8:11], s86 offen offset:0 sc1
    buffer_load_dwordx4 v[148:151], v4, s[8:11], s86 offen offset:512 sc1
    buffer_load_dwordx4 v[152:155], v4, s[8:11], s86 offen offset:1024 sc1
    buffer_load_dwordx4 v[156:159], v4, s[8:11], s86 offen offset:1536 sc1
L_c_Rv_s2:
    s_waitcnt lgkmcnt(0)
    s_barrier
    ds_read_b128 v[128:131], v18 offset:0
    ds_read_b128 v[60:63], v19 offset:0
    ds_read_b128 v[132:135], v18 offset:512
    ds_read_b128 v[64:67], v19 offset:512
    ds_read_b128 v[136:139], v18 offset:1024
    ds_read_b128 v[68:71], v19 offset:1024
    ds_read_b128 v[140:143], v18 offset:1536
    ds_read_b128 v[72:75], v19 offset:1536
    s_waitcnt lgkmcnt(6)
    v_mfma_f32_16x16x32_bf16 v[192:195], v[160:163], v[128:131], 0
    v_mov_b32 v39, s21
    v_mfma_f32_16x16x32_bf16 v[196:199], v[176:179], v[128:131], 0
    buffer_store_dword v39, v38, s[8:11], s44 offen sc1
    v_mfma_f32_16x16x32_bf16 v[200:203], v[60:63], v[128:131], 0
    s_waitcnt lgkmcnt(4)
    v_mfma_f32_16x16x32_bf16 v[192:195], v[164:167], v[132:135], v[192:195]
    buffer_store_dwordx2 v[28:29], v1, s[8:11], s84 offen sc1
    v_mfma_f32_16x16x32_bf16 v[196:199], v[180:183], v[132:135], v[196:199]
    buffer_store_dwordx2 v[28:29], v2, s[8:11], s84 offen sc1
    v_mfma_f32_16x16x32_bf16 v[200:203], v[64:67], v[132:135], v[200:203]
    s_waitcnt lgkmcnt(2)
    v_mfma_f32_16x16x32_bf16 v[192:195], v[168:171], v[136:139], v[192:195]
    buffer_store_dwordx4 v[28:31], v5, s[8:11], s88 offen sc1
    v_mfma_f32_16x16x32_bf16 v[196:199], v[184:187], v[136:139], v[196:199]
    buffer_store_dwordx2 v[28:29], v6, s[8:11], s88 offen sc1
    v_mfma_f32_16x16x32_bf16 v[200:203], v[68:71], v[136:139], v[200:203]
    s_waitcnt lgkmcnt(0)
    v_mfma_f32_16x16x32_bf16 v[192:195], v[172:175], v[140:143], v[192:195]
    buffer_store_dwordx2 v[28:29], v9, s[8:11], s93 offen sc1
    v_mfma_f32_16x16x32_bf16 v[196:199], v[188:191], v[140:143], v[196:199]
    v_mfma_f32_16x16x32_bf16 v[200:203], v[72:75], v[140:143], v[200:203]
    s_waitcnt vmcnt(6)
    v_max3_u32 v20, v144, v145, v146
    v_max3_u32 v21, v147, v148, v149
    v_max3_u32 v20, v20, v150, v151
    v_max3_u32 v21, v21, v152, v153
    v_max3_u32 v20, v20, v154, v155
    v_max3_u32 v21, v21, v156, v157
    v_max3_u32 v20, v20, v158, v159
    v_max_u32 v20, v20, v21
    v_cmp_eq_u32 vcc, -1, v20
    s_cbranch_vccnz L_c_pollV_s2
L_c_okV_s2:
    v_max3_f32 v24, v192, v193, v194
    v_max3_f32 v25, v195, v196, v197
    v_mfma_f32_16x16x32_bf16 v[236:239], v[144:147], a[120:123], 0
    v_max3_f32 v24, v24, v198, v199
    v_max3_f32 v25, v25, v200, v201
    v_max3_f32 v24, v24, v202, v203
    v_max_f32 v24, v24, v25
    v_mov_b32 v25, v24
    v_mfma_f32_16x16x32_bf16 v[240:243], v[144:147], a[136:139], 0
    s_nop 0
    v_permlane16_swap_b32 v25, v24
    v_max_f32 v24, v24, v25
    v_mov_b32 v25, v24
    v_mfma_f32_16x16x32_bf16 v[244:247], v[144:147], a[152:155], 0
    s_nop 0
    v_permlane32_swap_b32 v25, v24
    v_max_f32 v24, v24, v25
    v_mul_f32 v24, s38, v24
    v_mfma_f32_16x16x32_bf16 v[236:239], v[148:151], a[124:127], v[236:239]
    v_pk_fma_f32 v[192:193], v[192:193], s[38:39], v[24:25] op_sel_hi:[1,1,0] neg_lo:[0,0,1] neg_hi:[0,0,1]
    v_pk_fma_f32 v[194:195], v[194:195], s[38:39], v[24:25] op_sel_hi:[1,1,0] neg_lo:[0,0,1] neg_hi:[0,0,1]
    v_mfma_f32_16x16x32_bf16 v[240:243], v[148:151], a[140:143], v[240:243]
    v_pk_fma_f32 v[196:197], v[196:197], s[38:39], v[24:25] op_sel_hi:[1,1,0] neg_lo:[0,0,1] neg_hi:[0,0,1]
    v_pk_fma_f32 v[198:199], v[198:199], s[38:39], v[24:25] op_sel_hi:[1,1,0] neg_lo:[0,0,1] neg_hi:[0,0,1]
    v_mfma_f32_16x16x32_bf16 v[244:247], v[148:151], a[156:159], v[244:247]
    v_pk_fma_f32 v[200:201], v[200:201], s[38:39], v[24:25] op_sel_hi:[1,1,0] neg_lo:[0,0,1] neg_hi:[0,0,1]
    v_pk_fma_f32 v[202:203], v[202:203], s[38:39], v[24:25] op_sel_hi:[1,1,0] neg_lo:[0,0,1] neg_hi:[0,0,1]
    v_mfma_f32_16x16x32_bf16 v[236:239], v[152:155], a[128:131], v[236:239]
    v_exp_f32 v192, v192
    v_exp_f32 v193, v193
    v_mfma_f32_16x16x32_bf16 v[240:243], v[152:155], a[144:147], v[240:243]
    v_exp_f32 v194, v194
    v_exp_f32 v195, v195
    v_mfma_f32_16x16x32_bf16 v[244:247], v[152:155], a[160:163], v[244:247]
    v_exp_f32 v196, v196
    v_exp_f32 v197, v197
    v_mfma_f32_16x16x32_bf16 v[236:239], v[156:159], a[132:135], v[236:239]
    v_exp_f32 v198, v198
    v_exp_f32 v199, v199
    v_mfma_f32_16x16x32_bf16 v[240:243], v[156:159], a[148:151], v[240:243]
    v_exp_f32 v200, v200
    v_exp_f32 v201, v201
    v_mfma_f32_16x16x32_bf16 v[244:247], v[156:159], a[164:167], v[244:247]
    v_exp_f32 v202, v202
    v_exp_f32 v203, v203
    v_cvt_pk_bf16_f32 v228, v192, v193
    v_cvt_pk_bf16_f32 v229, v194, v195
    v_cvt_pk_bf16_f32 v230, v196, v197
    v_cvt_pk_bf16_f32 v231, v198, v199
    v_cvt_pk_bf16_f32 v232, v200, v201
    v_cvt_pk_bf16_f32 v233, v202, v203
    v_mfma_f32_16x16x32_bf16 v[20:23], a[168:171], v[228:231], 0
    v_mfma_f32_16x16x32_bf16 v[120:123], v[204:207], v[228:231], 0
    v_mfma_f32_16x16x32_bf16 v[124:127], v[208:211], v[228:231], 0
    v_mfma_f32_16x16x32_bf16 v[84:87], v[212:215], v[228:231], 0
    v_cvt_pk_bf16_f32 v216, v236, v237
    v_cvt_pk_bf16_f32 v217, v238, v239
    v_cvt_pk_bf16_f32 v220, v240, v241
    v_cvt_pk_bf16_f32 v221, v242, v243
    v_cvt_pk_bf16_f32 v224, v244, v245
    v_cvt_pk_bf16_f32 v225, v246, v247
    v_mfma_f32_16x16x32_bf16 v[20:23], a[172:175], v[232:235], v[20:23]
    v_mfma_f32_16x16x32_bf16 v[120:123], v[216:219], v[232:235], v[120:123]
    v_mfma_f32_16x16x32_bf16 v[124:127], v[220:223], v[232:235], v[124:127]
    v_mfma_f32_16x16x32_bf16 v[84:87], v[224:227], v[232:235], v[84:87]
    s_nop 4
    v_rcp_f32 v26, v20
    s_nop 1
    v_pk_mul_f32 v[120:121], v[120:121], v[26:27] op_sel_hi:[1,0]
    v_pk_mul_f32 v[122:123], v[122:123], v[26:27] op_sel_hi:[1,0]
    v_cvt_pk_bf16_f32 v56, v120, v121
    v_cvt_pk_bf16_f32 v57, v122, v123
    v_pk_mul_f32 v[124:125], v[124:125], v[26:27] op_sel_hi:[1,0]
    v_pk_mul_f32 v[126:127], v[126:127], v[26:27] op_sel_hi:[1,0]
    v_cvt_pk_bf16_f32 v58, v124, v125
    v_cvt_pk_bf16_f32 v59, v126, v127
    buffer_store_dwordx4 v[56:59], v5, s[8:11], s90 offen sc1
    v_pk_mul_f32 v[84:85], v[84:85], v[26:27] op_sel_hi:[1,0]
    v_pk_mul_f32 v[86:87], v[86:87], v[26:27] op_sel_hi:[1,0]
    v_cvt_pk_bf16_f32 v254, v84, v85
    v_cvt_pk_bf16_f32 v255, v86, v87
    buffer_store_dwordx2 v[254:255], v6, s[8:11], s90 offen sc1
    ds_read_b128 v[160:163], v36 offset:57344
    ds_read_b128 v[164:167], v36 offset:59392
    ds_read_b128 v[168:171], v36 offset:61440
    ds_read_b128 v[172:175], v36 offset:63488
    ds_read_b128 v[176:179], v36 offset:57600
    ds_read_b128 v[180:183], v36 offset:59648
    ds_read_b128 v[184:187], v36 offset:61696
    ds_read_b128 v[188:191], v36 offset:63744
    s_cmp_eq_u32 s23, 0
    s_cbranch_scc1 L_c_noitem_s2
    s_nop 15
    s_nop 13
    buffer_load_dwordx2 v[88:89], v7, s[8:11], s90 offen sc1
    buffer_load_dwordx2 v[90:91], v8, s[8:11], s90 offen sc1
    s_nop 14
    buffer_load_dwordx2 v[60:61], v7, s[8:11], s90 offen sc1
    buffer_load_dwordx2 v[62:63], v8, s[8:11], s90 offen sc1
    s_nop 14
    buffer_load_dwordx2 v[64:65], v7, s[8:11], s90 offen sc1
    buffer_load_dwordx2 v[66:67], v8, s[8:11], s90 offen sc1
    s_waitcnt vmcnt(4)
    v_mfma_f32_16x16x32_bf16 v[92:95], v[32:35], v[88:91], 0
    v_max3_u32 v20, v88, v89, v90
    v_max_u32 v20, v20, v91
    v_cmp_eq_u32 vcc, -1, v20
    s_cbranch_vccnz L_c_RS_s2_retry
L_c_RS_s2_done:
    s_nop 3
    buffer_store_dwordx4 v[92:95], v82, s[8:11], s98 offen sc1
    buffer_store_dwordx4 v[28:31], v82, s[8:11], s96 offen sc1
    s_waitcnt lgkmcnt(0)
    v_mfma_f32_16x16x32_bf16 v[236:239], v[160:163], a[120:123], 0
    v_mfma_f32_16x16x32_bf16 v[240:243], v[176:179], a[120:123], 0
    v_mfma_f32_16x16x32_bf16 v[236:239], v[164:167], a[124:127], v[236:239]
    v_mfma_f32_16x16x32_bf16 v[240:243], v[180:183], a[124:127], v[240:243]
    v_mfma_f32_16x16x32_bf16 v[236:239], v[168:171], a[128:131], v[236:239]
    v_mfma_f32_16x16x32_bf16 v[240:243], v[184:187], a[128:131], v[240:243]
    v_mfma_f32_16x16x32_bf16 v[236:239], v[172:175], a[132:135], v[236:239]
    v_mfma_f32_16x16x32_bf16 v[240:243], v[188:191], a[132:135], v[240:243]
    v_mfma_f32_16x16x32_bf16 v[120:123], v[160:163], a[136:139], 0
    v_mfma_f32_16x16x32_bf16 v[124:127], v[176:179], a[136:139], 0
    v_mfma_f32_16x16x32_bf16 v[120:123], v[164:167], a[140:143], v[120:123]
    v_mfma_f32_16x16x32_bf16 v[124:127], v[180:183], a[140:143], v[124:127]
    v_mfma_f32_16x16x32_bf16 v[120:123], v[168:171], a[144:147], v[120:123]
    v_mfma_f32_16x16x32_bf16 v[124:127], v[184:187], a[144:147], v[124:127]
    v_mfma_f32_16x16x32_bf16 v[120:123], v[172:175], a[148:151], v[120:123]
    v_mfma_f32_16x16x32_bf16 v[124:127], v[188:191], a[148:151], v[124:127]
    v_cvt_pk_bf16_f32 v204, v236, v237
    v_cvt_pk_bf16_f32 v205, v238, v239
    v_cvt_pk_bf16_f32 v206, v240, v241
    v_cvt_pk_bf16_f32 v207, v242, v243
    v_mfma_f32_16x16x32_bf16 v[236:239], v[160:163], a[152:155], 0
    v_mfma_f32_16x16x32_bf16 v[240:243], v[176:179], a[152:155], 0
    v_mfma_f32_16x16x32_bf16 v[236:239], v[164:167], a[156:159], v[236:239]
    v_mfma_f32_16x16x32_bf16 v[240:243], v[180:183], a[156:159], v[240:243]
    v_mfma_f32_16x16x32_bf16 v[236:239], v[168:171], a[160:163], v[236:239]
    v_mfma_f32_16x16x32_bf16 v[240:243], v[184:187], a[160:163], v[240:243]
    v_mfma_f32_16x16x32_bf16 v[236:239], v[172:175], a[164:167], v[236:239]
    v_mfma_f32_16x16x32_bf16 v[240:243], v[188:191], a[164:167], v[240:243]
    v_cvt_pk_bf16_f32 v208, v120, v121
    v_cvt_pk_bf16_f32 v209, v122, v123
    v_cvt_pk_bf16_f32 v210, v124, v125
    v_cvt_pk_bf16_f32 v211, v126, v127
    s_nop 6
    v_cvt_pk_bf16_f32 v212, v236, v237
    v_cvt_pk_bf16_f32 v213, v238, v239
    v_cvt_pk_bf16_f32 v214, v240, v241
    v_cvt_pk_bf16_f32 v215, v242, v243
    buffer_load_dwordx4 v[108:111], v104, s[8:11], s98 offen sc1
    buffer_load_dwordx4 v[112:115], v105, s[8:11], s98 offen sc1
    buffer_load_dwordx4 v[116:119], v106, s[8:11], s98 offen sc1
    s_nop 15
    s_nop 15
    s_nop 7
    buffer_load_dwordx4 v[68:71], v104, s[8:11], s98 offen sc1
    buffer_load_dwordx4 v[72:75], v105, s[8:11], s98 offen sc1
    buffer_load_dwordx4 v[76:79], v106, s[8:11], s98 offen sc1
    s_waitcnt vmcnt(3)
    v_max3_u32 v20, v108, v109, v110
    v_max3_u32 v21, v111, v112, v113
    v_max3_u32 v20, v20, v114, v115
    v_max3_u32 v21, v21, v116, v117
    v_max3_u32 v20, v20, v118, v119
    v_max_u32 v20, v20, v21
    v_cmp_eq_u32 vcc, -1, v20
    s_cbranch_vccnz L_c_X_s2_retry
    v_pk_add_f32 v[20:21], v[108:109], v[116:117]
    v_pk_add_f32 v[92:93], v[92:93], v[112:113]
    v_pk_add_f32 v[22:23], v[110:111], v[118:119]
    v_pk_add_f32 v[94:95], v[94:95], v[114:115]
L_c_X_s2_done:
    v_pk_add_f32 v[92:93], v[92:93], v[20:21]
    v_pk_add_f32 v[94:95], v[94:95], v[22:23]
    v_cvt_pk_bf16_f32 v254, v92, v93
    v_cvt_pk_bf16_f32 v255, v94, v95
    buffer_store_dwordx2 v[254:255], v9, s[8:11], s95 offen sc1
L_c_stepend_s2:
    s_add_u32 s40, s40, 65536
    s_add_u32 s41, s41, 131072
    s_add_u32 s42, s42, 262144
    s_add_u32 s21, s21, 1
    s_barrier
L_c_loop_s3:
    buffer_load_dwordx4 v[144:147], v10, s[8:11], s95 offen sc1
    buffer_load_dwordx4 v[148:151], v11, s[8:11], s95 offen sc1
    buffer_load_dwordx4 v[152:155], v12, s[8:11], s95 offen sc1
    s_nop 15
    s_nop 15
    s_nop 7
    buffer_load_dwordx4 v[128:131], v10, s[8:11], s95 offen sc1
    buffer_load_dwordx4 v[132:135], v11, s[8:11], s95 offen sc1
    buffer_load_dwordx4 v[136:139], v12, s[8:11], s95 offen sc1
    s_waitcnt vmcnt(3)
    ds_write_b128 v100, v[144:147]
    ds_write_b128 v101, v[148:151]
    ds_write_b128 v102, v[152:155]
    v_max3_u32 v20, v144, v145, v146
    v_max3_u32 v21, v147, v148, v149
    v_max3_u32 v20, v20, v150, v151
    v_max3_u32 v21, v21, v152, v153
    v_max3_u32 v20, v20, v154, v155
    v_max_u32 v20, v20, v21
    v_cmp_eq_u32 vcc, -1, v20
    s_cbranch_vccnz L_c_A_s3_retry
L_c_A_s3_done:
    s_waitcnt lgkmcnt(0)
    s_barrier
    ds_read_b128 v[40:43], v16 offset:0
    ds_read_b128 v[44:47], v16 offset:64
    ds_read_b128 v[48:51], v16 offset:128
    ds_read_b128 v[52:55], v16 offset:192
    ds_read_b128 v[56:59], v16 offset:256
    ds_read_b128 v[60:63], v16 offset:320
    ds_read_b128 v[64:67], v16 offset:384
    ds_read_b128 v[68:71], v16 offset:448
    ds_read_b128 v[72:75], v16 offset:512
    ds_read_b128 v[76:79], v16 offset:576
    s_waitcnt lgkmcnt(9)
    v_mfma_f32_16x16x32_bf16 v[120:123], a[0:3], v[40:43], 0
    v_mfma_f32_16x16x32_bf16 v[124:127], a[40:43], v[40:43], 0
    s_waitcnt lgkmcnt(8)
    v_mfma_f32_16x16x32_bf16 v[120:123], a[4:7], v[44:47], v[120:123]
    v_mfma_f32_16x16x32_bf16 v[124:127], a[44:47], v[44:47], v[124:127]
    s_waitcnt lgkmcnt(7)
    v_mfma_f32_16x16x32_bf16 v[120:123], a[8:11], v[48:51], v[120:123]
    v_mfma_f32_16x16x32_bf16 v[124:127], a[48:51], v[48:51], v[124:127]
    s_waitcnt lgkmcnt(6)
    v_mfma_f32_16x16x32_bf16 v[120:123], a[12:15], v[52:55], v[120:123]
    v_mfma_f32_16x16x32_bf16 v[124:127], a[52:55], v[52:55], v[124:127]
    s_waitcnt lgkmcnt(5)
    v_mfma_f32_16x16x32_bf16 v[120:123], a[16:19], v[56:59], v[120:123]
    v_mfma_f32_16x16x32_bf16 v[124:127], a[56:59], v[56:59], v[124:127]
    s_waitcnt lgkmcnt(4)
    v_mfma_f32_16x16x32_bf16 v[120:123], a[20:23], v[60:63], v[120:123]
    v_mfma_f32_16x16x32_bf16 v[124:127], a[60:63], v[60:63], v[124:127]
    s_waitcnt lgkmcnt(3)
    v_mfma_f32_16x16x32_bf16 v[120:123], a[24:27], v[64:67], v[120:123]
    v_mfma_f32_16x16x32_bf16 v[124:127], a[64:67], v[64:67], v[124:127]
    s_waitcnt lgkmcnt(2)
    v_mfma_f32_16x16x32_bf16 v[120:123], a[28:31], v[68:71], v[120:123]
    v_mfma_f32_16x16x32_bf16 v[124:127], a[68:71], v[68:71], v[124:127]
    s_waitcnt lgkmcnt(1)
    v_mfma_f32_16x16x32_bf16 v[120:123], a[32:35], v[72:75], v[120:123]
    v_mfma_f32_16x16x32_bf16 v[124:127], a[72:75], v[72:75], v[124:127]
    s_waitcnt lgkmcnt(0)
    v_mfma_f32_16x16x32_bf16 v[120:123], a[36:39], v[76:79], v[120:123]
    v_mfma_f32_16x16x32_bf16 v[124:127], a[76:79], v[76:79], v[124:127]
    v_mfma_f32_16x16x32_bf16 v[84:87], a[80:83], v[40:43], 0
    v_mfma_f32_16x16x32_bf16 v[84:87], a[84:87], v[44:47], v[84:87]
    s_nop 5
    v_add_f32_dpp v120, v124, v120 row_ror:8 row_mask:0xf bank_mask:0xf
    v_add_f32_dpp v121, v125, v121 row_ror:8 row_mask:0xf bank_mask:0xf
    v_add_f32_dpp v122, v126, v122 row_ror:8 row_mask:0xf bank_mask:0xf
    v_add_f32_dpp v123, v127, v123 row_ror:8 row_mask:0xf bank_mask:0xf
    v_cvt_pk_bf16_f32 v248, v120, v121
    v_cvt_pk_bf16_f32 v249, v122, v123
    buffer_store_dwordx2 v[248:249], v1, s[8:11], s87 offen sc1
    v_mfma_f32_16x16x32_bf16 v[84:87], a[88:91], v[48:51], v[84:87]
    v_mfma_f32_16x16x32_bf16 v[84:87], a[92:95], v[52:55], v[84:87]
    v_mfma_f32_16x16x32_bf16 v[84:87], a[96:99], v[56:59], v[84:87]
    v_mfma_f32_16x16x32_bf16 v[84:87], a[100:103], v[60:63], v[84:87]
    v_mfma_f32_16x16x32_bf16 v[84:87], a[104:107], v[64:67], v[84:87]
    v_mfma_f32_16x16x32_bf16 v[84:87], a[108:111], v[68:71], v[84:87]
    v_mfma_f32_16x16x32_bf16 v[84:87], a[112:115], v[72:75], v[84:87]
    v_mfma_f32_16x16x32_bf16 v[84:87], a[116:119], v[76:79], v[84:87]
    ds_read_b128 v[160:163], v36 offset:49152
    ds_read_b128 v[164:167], v36 offset:51200
    ds_read_b128 v[168:171], v36 offset:53248
    ds_read_b128 v[172:175], v36 offset:55296
    ds_read_b128 v[176:179], v36 offset:49408
    ds_read_b128 v[180:183], v36 offset:51456
    ds_read_b128 v[184:187], v36 offset:53504
    ds_read_b128 v[188:191], v36 offset:55552
    v_cvt_pk_bf16_f32 v250, v84, v85
    v_cvt_pk_bf16_f32 v251, v86, v87
    buffer_store_dwordx2 v[250:251], v2, s[8:11], s87 offen sc1
    s_cmp_eq_u32 s21, 63
    s_cbranch_scc1 L_c_final2
    buffer_load_dwordx4 v[40:43], v3, s[8:11], s87 offen sc1
    s_nop 15
    s_nop 3
    buffer_load_dwordx4 v[44:47], v3, s[8:11], s87 offen sc1
    s_waitcnt vmcnt(1)
    ds_write_b128 v17, v[40:43]
    v_max3_u32 v20, v40, v41, v42
    v_max_u32 v20, v20, v43
    v_cmp_eq_u32 vcc, -1, v20
    s_cbranch_vccnz L_c_R_s3_retry
L_c_R_s3_done:
    s_nop 11
    buffer_load_dwordx4 v[144:147], v4, s[8:11], s87 offen offset:0 sc1
    buffer_load_dwordx4 v[148:151], v4, s[8:11], s87 offen offset:512 sc1
    buffer_load_dwordx4 v[152:155], v4, s[8:11], s87 offen offset:1024 sc1
    buffer_load_dwordx4 v[156:159], v4, s[8:11], s87 offen offset:1536 sc1
L_c_Rv_s3:
    s_waitcnt lgkmcnt(0)
    s_barrier
    ds_read_b128 v[128:131], v18 offset:0
    ds_read_b128 v[60:63], v19 offset:0
    ds_read_b128 v[132:135], v18 offset:512
    ds_read_b128 v[64:67], v19 offset:512
    ds_read_b128 v[136:139], v18 offset:1024
    ds_read_b128 v[68:71], v19 offset:1024
    ds_read_b128 v[140:143], v18 offset:1536
    ds_read_b128 v[72:75], v19 offset:1536
    s_waitcnt lgkmcnt(6)
    v_mfma_f32_16x16x32_bf16 v[192:195], v[160:163], v[128:131], 0
    v_mov_b32 v39, s21
    v_mfma_f32_16x16x32_bf16 v[196:199], v[176:179], v[128:131], 0
    buffer_store_dword v39, v38, s[8:11], s44 offen sc1
    v_mfma_f32_16x16x32_bf16 v[200:203], v[60:63], v[128:131], 0
    s_waitcnt lgkmcnt(4)
    v_mfma_f32_16x16x32_bf16 v[192:195], v[164:167], v[132:135], v[192:195]
    buffer_store_dwordx2 v[28:29], v1, s[8:11], s85 offen sc1
    v_mfma_f32_16x16x32_bf16 v[196:199], v[180:183], v[132:135], v[196:199]
    buffer_store_dwordx2 v[28:29], v2, s[8:11], s85 offen sc1
    v_mfma_f32_16x16x32_bf16 v[200:203], v[64:67], v[132:135], v[200:203]
    s_waitcnt lgkmcnt(2)
    v_mfma_f32_16x16x32_bf16 v[192:195], v[168:171], v[136:139], v[192:195]
    buffer_store_dwordx4 v[28:31], v5, s[8:11], s89 offen sc1
    v_mfma_f32_16x16x32_bf16 v[196:199], v[184:187], v[136:139], v[196:199]
    buffer_store_dwordx2 v[28:29], v6, s[8:11], s89 offen sc1
    v_mfma_f32_16x16x32_bf16 v[200:203], v[68:71], v[136:139], v[200:203]
    s_waitcnt lgkmcnt(0)
    v_mfma_f32_16x16x32_bf16 v[192:195], v[172:175], v[140:143], v[192:195]
    buffer_store_dwordx2 v[28:29], v9, s[8:11], s94 offen sc1
    v_mfma_f32_16x16x32_bf16 v[196:199], v[188:191], v[140:143], v[196:199]
    v_mfma_f32_16x16x32_bf16 v[200:203], v[72:75], v[140:143], v[200:203]
    s_waitcnt vmcnt(6)
    v_max3_u32 v20, v144, v145, v146
    v_max3_u32 v21, v147, v148, v149
    v_max3_u32 v20, v20, v150, v151
    v_max3_u32 v21, v21, v152, v153
    v_max3_u32 v20, v20, v154, v155
    v_max3_u32 v21, v21, v156, v157
    v_max3_u32 v20, v20, v158, v159
    v_max_u32 v20, v20, v21
    v_cmp_eq_u32 vcc, -1, v20
    s_cbranch_vccnz L_c_pollV_s3
L_c_okV_s3:
    s_cmp_eq_u32 s21, 63
    s_cbranch_scc1 L_c_final
    v_max3_f32 v24, v192, v193, v194
    v_max3_f32 v25, v195, v196, v197
    v_mfma_f32_16x16x32_bf16 v[236:239], v[144:147], a[120:123], 0
    v_max3_f32 v24, v24, v198, v199
    v_max3_f32 v25, v25, v200, v201
    v_max3_f32 v24, v24, v202, v203
    v_max_f32 v24, v24, v25
    v_mov_b32 v25, v24
    v_mfma_f32_16x16x32_bf16 v[240:243], v[144:147], a[136:139], 0
    s_nop 0
    v_permlane16_swap_b32 v25, v24
    v_max_f32 v24, v24, v25
    v_mov_b32 v25, v24
    v_mfma_f32_16x16x32_bf16 v[244:247], v[144:147], a[152:155], 0
    s_nop 0
    v_permlane32_swap_b32 v25, v24
    v_max_f32 v24, v24, v25
    v_mul_f32 v24, s38, v24
    v_mfma_f32_16x16x32_bf16 v[236:239], v[148:151], a[124:127], v[236:239]
    v_pk_fma_f32 v[192:193], v[192:193], s[38:39], v[24:25] op_sel_hi:[1,1,0] neg_lo:[0,0,1] neg_hi:[0,0,1]
    v_pk_fma_f32 v[194:195], v[194:195], s[38:39], v[24:25] op_sel_hi:[1,1,0] neg_lo:[0,0,1] neg_hi:[0,0,1]
    v_mfma_f32_16x16x32_bf16 v[240:243], v[148:151], a[140:143], v[240:243]
    v_pk_fma_f32 v[196:197], v[196:197], s[38:39], v[24:25] op_sel_hi:[1,1,0] neg_lo:[0,0,1] neg_hi:[0,0,1]
    v_pk_fma_f32 v[198:199], v[198:199], s[38:39], v[24:25] op_sel_hi:[1,1,0] neg_lo:[0,0,1] neg_hi:[0,0,1]
    v_mfma_f32_16x16x32_bf16 v[244:247], v[148:151], a[156:159], v[244:247]
    v_pk_fma_f32 v[200:201], v[200:201], s[38:39], v[24:25] op_sel_hi:[1,1,0] neg_lo:[0,0,1] neg_hi:[0,0,1]
    v_pk_fma_f32 v[202:203], v[202:203], s[38:39], v[24:25] op_sel_hi:[1,1,0] neg_lo:[0,0,1] neg_hi:[0,0,1]
    v_mfma_f32_16x16x32_bf16 v[236:239], v[152:155], a[128:131], v[236:239]
    v_exp_f32 v192, v192
    v_exp_f32 v193, v193
    v_mfma_f32_16x16x32_bf16 v[240:243], v[152:155], a[144:147], v[240:243]
    v_exp_f32 v194, v194
    v_exp_f32 v195, v195
    v_mfma_f32_16x16x32_bf16 v[244:247], v[152:155], a[160:163], v[244:247]
    v_exp_f32 v196, v196
    v_exp_f32 v197, v197
    v_mfma_f32_16x16x32_bf16 v[236:239], v[156:159], a[132:135], v[236:239]
    v_exp_f32 v198, v198
    v_exp_f32 v199, v199
    v_mfma_f32_16x16x32_bf16 v[240:243], v[156:159], a[148:151], v[240:243]
    v_exp_f32 v200, v200
    v_exp_f32 v201, v201
    v_mfma_f32_16x16x32_bf16 v[244:247], v[156:159], a[164:167], v[244:247]
    v_exp_f32 v202, v202
    v_exp_f32 v203, v203
    v_cvt_pk_bf16_f32 v228, v192, v193
    v_cvt_pk_bf16_f32 v229, v194, v195
    v_cvt_pk_bf16_f32 v230, v196, v197
    v_cvt_pk_bf16_f32 v231, v198, v199
    v_cvt_pk_bf16_f32 v232, v200, v201
    v_cvt_pk_bf16_f32 v233, v202, v203
    v_mfma_f32_16x16x32_bf16 v[20:23], a[168:171], v[228:231], 0
    v_mfma_f32_16x16x32_bf16 v[120:123], v[204:207], v[228:231], 0
    v_mfma_f32_16x16x32_bf16 v[124:127], v[208:211], v[228:231], 0
    v_mfma_f32_16x16x32_bf16 v[84:87], v[212:215], v[228:231], 0
    v_cvt_pk_bf16_f32 v216, v236, v237
    v_cvt_pk_bf16_f32 v217, v238, v239
    v_cvt_pk_bf16_f32 v220, v240, v241
    v_cvt_pk_bf16_f32 v221, v242, v243
    v_cvt_pk_bf16_f32 v224, v244, v245
    v_cvt_pk_bf16_f32 v225, v246, v247
    v_mfma_f32_16x16x32_bf16 v[20:23], a[172:175], v[232:235], v[20:23]
    v_mfma_f32_16x16x32_bf16 v[120:123], v[216:219], v[232:235], v[120:123]
    v_mfma_f32_16x16x32_bf16 v[124:127], v[220:223], v[232:235], v[124:127]
    v_mfma_f32_16x16x32_bf16 v[84:87], v[224:227], v[232:235], v[84:87]
    s_nop 4
    v_rcp_f32 v26, v20
    s_nop 1
    v_pk_mul_f32 v[120:121], v[120:121], v[26:27] op_sel_hi:[1,0]
    v_pk_mul_f32 v[122:123], v[122:123], v[26:27] op_sel_hi:[1,0]
    v_cvt_pk_bf16_f32 v56, v120, v121
    v_cvt_pk_bf16_f32 v57, v122, v123
    v_pk_mul_f32 v[124:125], v[124:125], v[26:27] op_sel_hi:[1,0]
    v_pk_mul_f32 v[126:127], v[126:127], v[26:27] op_sel_hi:[1,0]
    v_cvt_pk_bf16_f32 v58, v124, v125
    v_cvt_pk_bf16_f32 v59, v126, v127
    buffer_store_dwordx4 v[56:59], v5, s[8:11], s91 offen sc1
    v_pk_mul_f32 v[84:85], v[84:85], v[26:27] op_sel_hi:[1,0]
    v_pk_mul_f32 v[86:87], v[86:87], v[26:27] op_sel_hi:[1,0]
    v_cvt_pk_bf16_f32 v254, v84, v85
    v_cvt_pk_bf16_f32 v255, v86, v87
    buffer_store_dwordx2 v[254:255], v6, s[8:11], s91 offen sc1
    ds_read_b128 v[160:163], v36 offset:8192
    ds_read_b128 v[164:167], v36 offset:10240
    ds_read_b128 v[168:171], v36 offset:12288
    ds_read_b128 v[172:175], v36 offset:14336
    ds_read_b128 v[176:179], v36 offset:8448
    ds_read_b128 v[180:183], v36 offset:10496
    ds_read_b128 v[184:187], v36 offset:12544
    ds_read_b128 v[188:191], v36 offset:14592
    s_cmp_eq_u32 s23, 0
    s_cbranch_scc1 L_c_noitem_s3
    s_nop 15
    s_nop 13
    buffer_load_dwordx2 v[88:89], v7, s[8:11], s91 offen sc1
    buffer_load_dwordx2 v[90:91], v8, s[8:11], s91 offen sc1
    s_nop 14
    buffer_load_dwordx2 v[60:61], v7, s[8:11], s91 offen sc1
    buffer_load_dwordx2 v[62:63], v8, s[8:11], s91 offen sc1
    s_nop 14
    buffer_load_dwordx2 v[64:65], v7, s[8:11], s91 offen sc1
    buffer_load_dwordx2 v[66:67], v8, s[8:11], s91 offen sc1
    s_waitcnt vmcnt(4)
    v_mfma_f32_16x16x32_bf16 v[92:95], v[32:35], v[88:91], 0
    v_max3_u32 v20, v88, v89, v90
    v_max_u32 v20, v20, v91
    v_cmp_eq_u32 vcc, -1, v20
    s_cbranch_vccnz L_c_RS_s3_retry
L_c_RS_s3_done:
    s_nop 3
    buffer_store_dwordx4 v[92:95], v82, s[8:11], s99 offen sc1
    buffer_store_dwordx4 v[28:31], v82, s[8:11], s97 offen sc1
    s_waitcnt lgkmcnt(0)
    v_mfma_f32_16x16x32_bf16 v[236:239], v[160:163], a[120:123], 0
    v_mfma_f32_16x16x32_bf16 v[240:243], v[176:179], a[120:123], 0
    v_mfma_f32_16x16x32_bf16 v[236:239], v[164:167], a[124:127], v[236:239]
    v_mfma_f32_16x16x32_bf16 v[240:243], v[180:183], a[124:127], v[240:243]
    v_mfma_f32_16x16x32_bf16 v[236:239], v[168:171], a[128:131], v[236:239]
    v_mfma_f32_16x16x32_bf16 v[240:243], v[184:187], a[128:131], v[240:243]
    v_mfma_f32_16x16x32_bf16 v[236:239], v[172:175], a[132:135], v[236:239]
    v_mfma_f32_16x16x32_bf16 v[240:243], v[188:191], a[132:135], v[240:243]
    v_mfma_f32_16x16x32_bf16 v[120:123], v[160:163], a[136:139], 0
    v_mfma_f32_16x16x32_bf16 v[124:127], v[176:179], a[136:139], 0
    v_mfma_f32_16x16x32_bf16 v[120:123], v[164:167], a[140:143], v[120:123]
    v_mfma_f32_16x16x32_bf16 v[124:127], v[180:183], a[140:143], v[124:127]
    v_mfma_f32_16x16x32_bf16 v[120:123], v[168:171], a[144:147], v[120:123]
    v_mfma_f32_16x16x32_bf16 v[124:127], v[184:187], a[144:147], v[124:127]
    v_mfma_f32_16x16x32_bf16 v[120:123], v[172:175], a[148:151], v[120:123]
    v_mfma_f32_16x16x32_bf16 v[124:127], v[188:191], a[148:151], v[124:127]
    v_cvt_pk_bf16_f32 v204, v236, v237
    v_cvt_pk_bf16_f32 v205, v238, v239
    v_cvt_pk_bf16_f32 v206, v240, v241
    v_cvt_pk_bf16_f32 v207, v242, v243
    v_mfma_f32_16x16x32_bf16 v[236:239], v[160:163], a[152:155], 0
    v_mfma_f32_16x16x32_bf16 v[240:243], v[176:179], a[152:155], 0
    v_mfma_f32_16x16x32_bf16 v[236:239], v[164:167], a[156:159], v[236:239]
    v_mfma_f32_16x16x32_bf16 v[240:243], v[180:183], a[156:159], v[240:243]
    v_mfma_f32_16x16x32_bf16 v[236:239], v[168:171], a[160:163], v[236:239]
    v_mfma_f32_16x16x32_bf16 v[240:243], v[184:187], a[160:163], v[240:243]
    v_mfma_f32_16x16x32_bf16 v[236:239], v[172:175], a[164:167], v[236:239]
    v_mfma_f32_16x16x32_bf16 v[240:243], v[188:191], a[164:167], v[240:243]
    v_cvt_pk_bf16_f32 v208, v120, v121
    v_cvt_pk_bf16_f32 v209, v122, v123
    v_cvt_pk_bf16_f32 v210, v124, v125
    v_cvt_pk_bf16_f32 v211, v126, v127
    s_nop 6
    v_cvt_pk_bf16_f32 v212, v236, v237
    v_cvt_pk_bf16_f32 v213, v238, v239
    v_cvt_pk_bf16_f32 v214, v240, v241
    v_cvt_pk_bf16_f32 v215, v242, v243
    buffer_load_dwordx4 v[108:111], v104, s[8:11], s99 offen sc1
    buffer_load_dwordx4 v[112:115], v105, s[8:11], s99 offen sc1
    buffer_load_dwordx4 v[116:119], v106, s[8:11], s99 offen sc1
    s_nop 15
    s_nop 15
    s_nop 7
    buffer_load_dwordx4 v[68:71], v104, s[8:11], s99 offen sc1
    buffer_load_dwordx4 v[72:75], v105, s[8:11], s99 offen sc1
    buffer_load_dwordx4 v[76:79], v106, s[8:11], s99 offen sc1
    s_waitcnt vmcnt(3)
    v_max3_u32 v20, v108, v109, v110
    v_max3_u32 v21, v111, v112, v113
    v_max3_u32 v20, v20, v114, v115
    v_max3_u32 v21, v21, v116, v117
    v_max3_u32 v20, v20, v118, v119
    v_max_u32 v20, v20, v21
    v_cmp_eq_u32 vcc, -1, v20
    s_cbranch_vccnz L_c_X_s3_retry
    v_pk_add_f32 v[20:21], v[108:109], v[116:117]
    v_pk_add_f32 v[92:93], v[92:93], v[112:113]
    v_pk_add_f32 v[22:23], v[110:111], v[118:119]
    v_pk_add_f32 v[94:95], v[94:95], v[114:115]
L_c_X_s3_done:
    v_pk_add_f32 v[92:93], v[92:93], v[20:21]
    v_pk_add_f32 v[94:95], v[94:95], v[22:23]
    v_cvt_pk_bf16_f32 v254, v92, v93
    v_cvt_pk_bf16_f32 v255, v94, v95
    buffer_store_dwordx2 v[254:255], v9, s[8:11], s92 offen sc1
L_c_stepend_s3:
    s_add_u32 s40, s40, 65536
    s_add_u32 s41, s41, 131072
    s_add_u32 s42, s42, 262144
    s_add_u32 s21, s21, 1
    s_barrier
    s_branch L_c_loop_s0
L_c_A_s0_retry:
    buffer_load_dwordx4 v[144:147], v10, s[8:11], s92 offen sc1
    buffer_load_dwordx4 v[148:151], v11, s[8:11], s92 offen sc1
    buffer_load_dwordx4 v[152:155], v12, s[8:11], s92 offen sc1
L_c_A_s0_loop:
    s_waitcnt vmcnt(3)
    ds_write_b128 v100, v[128:131]
    ds_write_b128 v101, v[132:135]
    ds_write_b128 v102, v[136:139]
    v_max3_u32 v20, v128, v129, v130
    v_max3_u32 v21, v131, v132, v133
    v_max3_u32 v20, v20, v134, v135
    v_max3_u32 v21, v21, v136, v137
    v_max3_u32 v20, v20, v138, v139
    v_max_u32 v20, v20, v21
    v_cmp_eq_u32 vcc, -1, v20
    s_cbranch_vccz L_c_A_s0_ok1
    buffer_load_dwordx4 v[128:131], v10, s[8:11], s92 offen sc1
    buffer_load_dwordx4 v[132:135], v11, s[8:11], s92 offen sc1
    buffer_load_dwordx4 v[136:139], v12, s[8:11], s92 offen sc1
    s_waitcnt vmcnt(3)
    ds_write_b128 v100, v[144:147]
    ds_write_b128 v101, v[148:151]
    ds_write_b128 v102, v[152:155]
    v_max3_u32 v20, v144, v145, v146
    v_max3_u32 v21, v147, v148, v149
    v_max3_u32 v20, v20, v150, v151
    v_max3_u32 v21, v21, v152, v153
    v_max3_u32 v20, v20, v154, v155
    v_max_u32 v20, v20, v21
    v_cmp_eq_u32 vcc, -1, v20
    s_cbranch_vccz L_c_A_s0_ok0
    buffer_load_dwordx4 v[144:147], v10, s[8:11], s92 offen sc1
    buffer_load_dwordx4 v[148:151], v11, s[8:11], s92 offen sc1
    buffer_load_dwordx4 v[152:155], v12, s[8:11], s92 offen sc1
    s_sub_u32 s22, s22, 1
    s_cbranch_scc0 L_c_A_s0_loop
    s_branch L_timeout
L_c_A_s0_ok0:
    s_branch L_c_A_s0_done
L_c_A_s0_ok1:
    s_branch L_c_A_s0_done
L_c_R_s0_retry:
    buffer_load_dwordx4 v[40:43], v3, s[8:11], s84 offen sc1
L_c_R_s0_loop:
    s_waitcnt vmcnt(1)
    ds_write_b128 v17, v[44:47]
    v_max3_u32 v20, v44, v45, v46
    v_max_u32 v20, v20, v47
    v_cmp_eq_u32 vcc, -1, v20
    s_cbranch_vccz L_c_R_s0_ok1
    buffer_load_dwordx4 v[44:47], v3, s[8:11], s84 offen sc1
    s_waitcnt vmcnt(1)
    ds_write_b128 v17, v[40:43]
    v_max3_u32 v20, v40, v41, v42
    v_max_u32 v20, v20, v43
    v_cmp_eq_u32 vcc, -1, v20
    s_cbranch_vccz L_c_R_s0_ok0
    buffer_load_dwordx4 v[40:43], v3, s[8:11], s84 offen sc1
    s_sub_u32 s22, s22, 1
    s_cbranch_scc0 L_c_R_s0_loop
    s_branch L_timeout
L_c_R_s0_ok0:
    s_branch L_c_R_s0_done
L_c_R_s0_ok1:
    s_branch L_c_R_s0_done
L_c_pollV_s0:
    buffer_load_dwordx4 v[144:147], v4, s[8:11], s84 offen offset:0 sc1
    buffer_load_dwordx4 v[148:151], v4, s[8:11], s84 offen offset:512 sc1
    buffer_load_dwordx4 v[152:155], v4, s[8:11], s84 offen offset:1024 sc1
    buffer_load_dwordx4 v[156:159], v4, s[8:11], s84 offen offset:1536 sc1
    s_waitcnt vmcnt(0)
    v_max3_u32 v20, v144, v145, v146
    v_max3_u32 v21, v147, v148, v149
    v_max3_u32 v20, v20, v150, v151
    v_max3_u32 v21, v21, v152, v153
    v_max3_u32 v20, v20, v154, v155
    v_max3_u32 v21, v21, v156, v157
    v_max3_u32 v20, v20, v158, v159
    v_max_u32 v20, v20, v21
    v_cmp_eq_u32 vcc, -1, v20
    s_cbranch_vccz L_c_okV_s0
    s_sub_u32 s22, s22, 1
    s_cbranch_scc0 L_c_pollV_s0
    s_branch L_timeout
L_c_RS_s0_retry:
    buffer_load_dwordx2 v[88:89], v7, s[8:11], s88 offen sc1
    buffer_load_dwordx2 v[90:91], v8, s[8:11], s88 offen sc1
L_c_RS_s0_loop:
    s_waitcnt vmcnt(4)
    v_mfma_f32_16x16x32_bf16 v[92:95], v[32:35], v[60:63], 0
    v_max3_u32 v20, v60, v61, v62
    v_max_u32 v20, v20, v63
    v_cmp_eq_u32 vcc, -1, v20
    s_cbranch_vccz L_c_RS_s0_ok1
    buffer_load_dwordx2 v[60:61], v7, s[8:11], s88 offen sc1
    buffer_load_dwordx2 v[62:63], v8, s[8:11], s88 offen sc1
    s_waitcnt vmcnt(4)
    v_mfma_f32_16x16x32_bf16 v[92:95], v[32:35], v[64:67], 0
    v_max3_u32 v20, v64, v65, v66
    v_max_u32 v20, v20, v67
    v_cmp_eq_u32 vcc, -1, v20
    s_cbranch_vccz L_c_RS_s0_ok2
    buffer_load_dwordx2 v[64:65], v7, s[8:11], s88 offen sc1
    buffer_load_dwordx2 v[66:67], v8, s[8:11], s88 offen sc1
    s_waitcnt vmcnt(4)
    v_mfma_f32_16x16x32_bf16 v[92:95], v[32:35], v[88:91], 0
    v_max3_u32 v20, v88, v89, v90
    v_max_u32 v20, v20, v91
    v_cmp_eq_u32 vcc, -1, v20
    s_cbranch_vccz L_c_RS_s0_ok0
    buffer_load_dwordx2 v[88:89], v7, s[8:11], s88 offen sc1
    buffer_load_dwordx2 v[90:91], v8, s[8:11], s88 offen sc1
    s_sub_u32 s22, s22, 1
    s_cbranch_scc0 L_c_RS_s0_loop
    s_branch L_timeout
L_c_RS_s0_ok0:
    s_branch L_c_RS_s0_done
L_c_RS_s0_ok1:
    s_branch L_c_RS_s0_done
L_c_RS_s0_ok2:
    s_branch L_c_RS_s0_done
L_c_X_s0_retry:
    buffer_load_dwordx4 v[108:111], v104, s[8:11], s96 offen sc1
    buffer_load_dwordx4 v[112:115], v105, s[8:11], s96 offen sc1
    buffer_load_dwordx4 v[116:119], v106, s[8:11], s96 offen sc1
L_c_X_s0_loop:
    s_waitcnt vmcnt(3)
    v_max3_u32 v20, v68, v69, v70
    v_max3_u32 v21, v71, v72, v73
    v_max3_u32 v20, v20, v74, v75
    v_max3_u32 v21, v21, v76, v77
    v_max3_u32 v20, v20, v78, v79
    v_max_u32 v20, v20, v21
    v_cmp_eq_u32 vcc, -1, v20
    s_cbranch_vccz L_c_X_s0_ok1
    buffer_load_dwordx4 v[68:71], v104, s[8:11], s96 offen sc1
    buffer_load_dwordx4 v[72:75], v105, s[8:11], s96 offen sc1
    buffer_load_dwordx4 v[76:79], v106, s[8:11], s96 offen sc1
    s_waitcnt vmcnt(3)
    v_max3_u32 v20, v108, v109, v110
    v_max3_u32 v21, v111, v112, v113
    v_max3_u32 v20, v20, v114, v115
    v_max3_u32 v21, v21, v116, v117
    v_max3_u32 v20, v20, v118, v119
    v_max_u32 v20, v20, v21
    v_cmp_eq_u32 vcc, -1, v20
    s_cbranch_vccz L_c_X_s0_ok0
    buffer_load_dwordx4 v[108:111], v104, s[8:11], s96 offen sc1
    buffer_load_dwordx4 v[112:115], v105, s[8:11], s96 offen sc1
    buffer_load_dwordx4 v[116:119], v106, s[8:11], s96 offen sc1
    s_sub_u32 s22, s22, 1
    s_cbranch_scc0 L_c_X_s0_loop
    s_branch L_timeout
L_c_X_s0_ok0:
    v_pk_add_f32 v[20:21], v[108:109], v[116:117]
    v_pk_add_f32 v[92:93], v[92:93], v[112:113]
    v_pk_add_f32 v[22:23], v[110:111], v[118:119]
    v_pk_add_f32 v[94:95], v[94:95], v[114:115]
    s_branch L_c_X_s0_done
L_c_X_s0_ok1:
    v_pk_add_f32 v[20:21], v[68:69], v[76:77]
    v_pk_add_f32 v[92:93], v[92:93], v[72:73]
    v_pk_add_f32 v[22:23], v[70:71], v[78:79]
    v_pk_add_f32 v[94:95], v[94:95], v[74:75]
    s_branch L_c_X_s0_done
L_c_noitem_s0:
    s_cmp_lg_u32 s20, 3
    s_cbranch_scc1 L_c_w2_s0
    s_mov_b32 s30, 105906176
    buffer_load_dword v24, v37, s[8:11], s30 offen sc1
    buffer_load_dwordx4 v[40:43], v83, s[8:11], s84 offen sc1
    buffer_load_dwordx4 v[44:47], v98, s[8:11], s84 offen sc1
    s_waitcnt vmcnt(0)
    buffer_store_dwordx4 v[40:43], v80, s[8:11], s40 offen sc1
    buffer_store_dwordx4 v[44:47], v81, s[8:11], s41 offen sc1
    s_cmp_gt_u32 s21, 60
    s_cbranch_scc1 L_c_kvskip_109
    s_add_u32 s31, s21, 3
L_c_wk_s0:
    v_cmp_gt_u32 vcc, s31, v24
    s_nop 3
    s_and_b64 vcc, vcc, 3
    s_cbranch_vccz L_c_wk_s0_ok
    s_mov_b32 s30, 105906176
    buffer_load_dword v24, v37, s[8:11], s30 offen sc1
    s_waitcnt vmcnt(0)
    s_sub_u32 s22, s22, 1
    s_cbranch_scc0 L_c_wk_s0
    s_branch L_timeout
L_c_wk_s0_ok:
    s_mov_b32 m0, 32768
    s_add_u32 s32, s42, 16777216
    buffer_load_dwordx4 v96, s[8:11], s32 offen sc1 lds
    s_mov_b32 m0, 33792
    s_add_u32 s32, s42, 16778240
    buffer_load_dwordx4 v96, s[8:11], s32 offen sc1 lds
    s_mov_b32 m0, 34816
    s_add_u32 s32, s42, 16779264
    buffer_load_dwordx4 v96, s[8:11], s32 offen sc1 lds
    s_mov_b32 m0, 35840
    s_add_u32 s32, s42, 16780288
    buffer_load_dwordx4 v96, s[8:11], s32 offen sc1 lds
    s_mov_b32 m0, 36864
    s_add_u32 s32, s42, 16781312
    buffer_load_dwordx4 v96, s[8:11], s32 offen sc1 lds
    s_mov_b32 m0, 37888
    s_add_u32 s32, s42, 16782336
    buffer_load_dwordx4 v96, s[8:11], s32 offen sc1 lds
    s_mov_b32 m0, 38912
    s_add_u32 s32, s42, 16783360
    buffer_load_dwordx4 v96, s[8:11], s32 offen sc1 lds
    s_mov_b32 m0, 39936
    s_add_u32 s32, s42, 16784384
    buffer_load_dwordx4 v96, s[8:11], s32 offen sc1 lds
    s_mov_b32 m0, 40960
    s_add_u32 s32, s42, 33554432
    buffer_load_dwordx4 v96, s[8:11], s32 offen sc1 lds
    s_mov_b32 m0, 41984
    s_add_u32 s32, s42, 33555456
    buffer_load_dwordx4 v96, s[8:11], s32 offen sc1 lds
    s_mov_b32 m0, 43008
    s_add_u32 s32, s42, 33556480
    buffer_load_dwordx4 v96, s[8:11], s32 offen sc1 lds
    s_mov_b32 m0, 44032
    s_add_u32 s32, s42, 33557504
    buffer_load_dwordx4 v96, s[8:11], s32 offen sc1 lds
    s_mov_b32 m0, 45056
    s_add_u32 s32, s42, 33558528
    buffer_load_dwordx4 v96, s[8:11], s32 offen sc1 lds
    s_mov_b32 m0, 46080
    s_add_u32 s32, s42, 33559552
    buffer_load_dwordx4 v96, s[8:11], s32 offen sc1 lds
    s_mov_b32 m0, 47104
    s_add_u32 s32, s42, 33560576
    buffer_load_dwordx4 v96, s[8:11], s32 offen sc1 lds
    s_mov_b32 m0, 48128
    s_add_u32 s32, s42, 33561600
    buffer_load_dwordx4 v96, s[8:11], s32 offen sc1 lds
L_c_kvskip_109:
    s_waitcnt lgkmcnt(0)
    v_mfma_f32_16x16x32_bf16 v[236:239], v[160:163], a[120:123], 0
    v_mfma_f32_16x16x32_bf16 v[240:243], v[176:179], a[120:123], 0
    v_mfma_f32_16x16x32_bf16 v[236:239], v[164:167], a[124:127], v[236:239]
    v_mfma_f32_16x16x32_bf16 v[240:243], v[180:183], a[124:127], v[240:243]
    v_mfma_f32_16x16x32_bf16 v[236:239], v[168:171], a[128:131], v[236:239]
    v_mfma_f32_16x16x32_bf16 v[240:243], v[184:187], a[128:131], v[240:243]
    v_mfma_f32_16x16x32_bf16 v[236:239], v[172:175], a[132:135], v[236:239]
    v_mfma_f32_16x16x32_bf16 v[240:243], v[188:191], a[132:135], v[240:243]
    v_mfma_f32_16x16x32_bf16 v[120:123], v[160:163], a[136:139], 0
    v_mfma_f32_16x16x32_bf16 v[124:127], v[176:179], a[136:139], 0
    v_mfma_f32_16x16x32_bf16 v[120:123], v[164:167], a[140:143], v[120:123]
    v_mfma_f32_16x16x32_bf16 v[124:127], v[180:183], a[140:143], v[124:127]
    v_mfma_f32_16x16x32_bf16 v[120:123], v[168:171], a[144:147], v[120:123]
    v_mfma_f32_16x16x32_bf16 v[124:127], v[184:187], a[144:147], v[124:127]
    v_mfma_f32_16x16x32_bf16 v[120:123], v[172:175], a[148:151], v[120:123]
    v_mfma_f32_16x16x32_bf16 v[124:127], v[188:191], a[148:151], v[124:127]
    v_cvt_pk_bf16_f32 v204, v236, v237
    v_cvt_pk_bf16_f32 v205, v238, v239
    v_cvt_pk_bf16_f32 v206, v240, v241
    v_cvt_pk_bf16_f32 v207, v242, v243
    v_mfma_f32_16x16x32_bf16 v[236:239], v[160:163], a[152:155], 0
    v_mfma_f32_16x16x32_bf16 v[240:243], v[176:179], a[152:155], 0
    v_mfma_f32_16x16x32_bf16 v[236:239], v[164:167], a[156:159], v[236:239]
    v_mfma_f32_16x16x32_bf16 v[240:243], v[180:183], a[156:159], v[240:243]
    v_mfma_f32_16x16x32_bf16 v[236:239], v[168:171], a[160:163], v[236:239]
    v_mfma_f32_16x16x32_bf16 v[240:243], v[184:187], a[160:163], v[240:243]
    v_mfma_f32_16x16x32_bf16 v[236:239], v[172:175], a[164:167], v[236:239]
    v_mfma_f32_16x16x32_bf16 v[240:243], v[188:191], a[164:167], v[240:243]
    v_cvt_pk_bf16_f32 v208, v120, v121
    v_cvt_pk_bf16_f32 v209, v122, v123
    v_cvt_pk_bf16_f32 v210, v124, v125
    v_cvt_pk_bf16_f32 v211, v126, v127
    s_nop 7
    v_cvt_pk_bf16_f32 v212, v236, v237
    v_cvt_pk_bf16_f32 v213, v238, v239
    v_cvt_pk_bf16_f32 v214, v240, v241
    v_cvt_pk_bf16_f32 v215, v242, v243
    s_branch L_c_stepend_s0
L_c_w2_s0:
    s_waitcnt lgkmcnt(0)
    v_mfma_f32_16x16x32_bf16 v[236:239], v[160:163], a[120:123], 0
    v_mfma_f32_16x16x32_bf16 v[240:243], v[176:179], a[120:123], 0
    v_mfma_f32_16x16x32_bf16 v[236:239], v[164:167], a[124:127], v[236:239]
    v_mfma_f32_16x16x32_bf16 v[240:243], v[180:183], a[124:127], v[240:243]
    v_mfma_f32_16x16x32_bf16 v[236:239], v[168:171], a[128:131], v[236:239]
    v_mfma_f32_16x16x32_bf16 v[240:243], v[184:187], a[128:131], v[240:243]
    v_mfma_f32_16x16x32_bf16 v[236:239], v[172:175], a[132:135], v[236:239]
    v_mfma_f32_16x16x32_bf16 v[240:243], v[188:191], a[132:135], v[240:243]
    v_mfma_f32_16x16x32_bf16 v[120:123], v[160:163], a[136:139], 0
    v_mfma_f32_16x16x32_bf16 v[124:127], v[176:179], a[136:139], 0
    v_mfma_f32_16x16x32_bf16 v[120:123], v[164:167], a[140:143], v[120:123]
    v_mfma_f32_16x16x32_bf16 v[124:127], v[180:183], a[140:143], v[124:127]
    v_mfma_f32_16x16x32_bf16 v[120:123], v[168:171], a[144:147], v[120:123]
    v_mfma_f32_16x16x32_bf16 v[124:127], v[184:187], a[144:147], v[124:127]
    v_mfma_f32_16x16x32_bf16 v[120:123], v[172:175], a[148:151], v[120:123]
    v_mfma_f32_16x16x32_bf16 v[124:127], v[188:191], a[148:151], v[124:127]
    v_cvt_pk_bf16_f32 v204, v236, v237
    v_cvt_pk_bf16_f32 v205, v238, v239
    v_cvt_pk_bf16_f32 v206, v240, v241
    v_cvt_pk_bf16_f32 v207, v242, v243
    v_mfma_f32_16x16x32_bf16 v[236:239], v[160:163], a[152:155], 0
    v_mfma_f32_16x16x32_bf16 v[240:243], v[176:179], a[152:155], 0
    v_mfma_f32_16x16x32_bf16 v[236:239], v[164:167], a[156:159], v[236:239]
    v_mfma_f32_16x16x32_bf16 v[240:243], v[180:183], a[156:159], v[240:243]
    v_mfma_f32_16x16x32_bf16 v[236:239], v[168:171], a[160:163], v[236:239]
    v_mfma_f32_16x16x32_bf16 v[240:243], v[184:187], a[160:163], v[240:243]
    v_mfma_f32_16x16x32_bf16 v[236:239], v[172:175], a[164:167], v[236:239]
    v_mfma_f32_16x16x32_bf16 v[240:243], v[188:191], a[164:167], v[240:243]
    v_cvt_pk_bf16_f32 v208, v120, v121
    v_cvt_pk_bf16_f32 v209, v122, v123
    v_cvt_pk_bf16_f32 v210, v124, v125
    v_cvt_pk_bf16_f32 v211, v126, v127
    s_nop 7
    v_cvt_pk_bf16_f32 v212, v236, v237
    v_cvt_pk_bf16_f32 v213, v238, v239
    v_cvt_pk_bf16_f32 v214, v240, v241
    v_cvt_pk_bf16_f32 v215, v242, v243
    s_branch L_c_stepend_s0
L_c_A_s1_retry:
    buffer_load_dwordx4 v[144:147], v10, s[8:11], s93 offen sc1
    buffer_load_dwordx4 v[148:151], v11, s[8:11], s93 offen sc1
    buffer_load_dwordx4 v[152:155], v12, s[8:11], s93 offen sc1
L_c_A_s1_loop:
    s_waitcnt vmcnt(3)
    ds_write_b128 v100, v[128:131]
    ds_write_b128 v101, v[132:135]
    ds_write_b128 v102, v[136:139]
    v_max3_u32 v20, v128, v129, v130
    v_max3_u32 v21, v131, v132, v133
    v_max3_u32 v20, v20, v134, v135
    v_max3_u32 v21, v21, v136, v137
    v_max3_u32 v20, v20, v138, v139
    v_max_u32 v20, v20, v21
    v_cmp_eq_u32 vcc, -1, v20
    s_cbranch_vccz L_c_A_s1_ok1
    buffer_load_dwordx4 v[128:131], v10, s[8:11], s93 offen sc1
    buffer_load_dwordx4 v[132:135], v11, s[8:11], s93 offen sc1
    buffer_load_dwordx4 v[136:139], v12, s[8:11], s93 offen sc1
    s_waitcnt vmcnt(3)
    ds_write_b128 v100, v[144:147]
    ds_write_b128 v101, v[148:151]
    ds_write_b128 v102, v[152:155]
    v_max3_u32 v20, v144, v145, v146
    v_max3_u32 v21, v147, v148, v149
    v_max3_u32 v20, v20, v150, v151
    v_max3_u32 v21, v21, v152, v153
    v_max3_u32 v20, v20, v154, v155
    v_max_u32 v20, v20, v21
    v_cmp_eq_u32 vcc, -1, v20
    s_cbranch_vccz L_c_A_s1_ok0
    buffer_load_dwordx4 v[144:147], v10, s[8:11], s93 offen sc1
    buffer_load_dwordx4 v[148:151], v11, s[8:11], s93 offen sc1
    buffer_load_dwordx4 v[152:155], v12, s[8:11], s93 offen sc1
    s_sub_u32 s22, s22, 1
    s_cbranch_scc0 L_c_A_s1_loop
    s_branch L_timeout
L_c_A_s1_ok0:
    s_branch L_c_A_s1_done
L_c_A_s1_ok1:
    s_branch L_c_A_s1_done
L_c_R_s1_retry:
    buffer_load_dwordx4 v[40:43], v3, s[8:11], s85 offen sc1
L_c_R_s1_loop:
    s_waitcnt vmcnt(1)
    ds_write_b128 v17, v[44:47]
    v_max3_u32 v20, v44, v45, v46
    v_max_u32 v20, v20, v47
    v_cmp_eq_u32 vcc, -1, v20
    s_cbranch_vccz L_c_R_s1_ok1
    buffer_load_dwordx4 v[44:47], v3, s[8:11], s85 offen sc1
    s_waitcnt vmcnt(1)
    ds_write_b128 v17, v[40:43]
    v_max3_u32 v20, v40, v41, v42
    v_max_u32 v20, v20, v43
    v_cmp_eq_u32 vcc, -1, v20
    s_cbranch_vccz L_c_R_s1_ok0
    buffer_load_dwordx4 v[40:43], v3, s[8:11], s85 offen sc1
    s_sub_u32 s22, s22, 1
    s_cbranch_scc0 L_c_R_s1_loop
    s_branch L_timeout
L_c_R_s1_ok0:
    s_branch L_c_R_s1_done
L_c_R_s1_ok1:
    s_branch L_c_R_s1_done
L_c_pollV_s1:
    buffer_load_dwordx4 v[144:147], v4, s[8:11], s85 offen offset:0 sc1
    buffer_load_dwordx4 v[148:151], v4, s[8:11], s85 offen offset:512 sc1
    buffer_load_dwordx4 v[152:155], v4, s[8:11], s85 offen offset:1024 sc1
    buffer_load_dwordx4 v[156:159], v4, s[8:11], s85 offen offset:1536 sc1
    s_waitcnt vmcnt(0)
    v_max3_u32 v20, v144, v145, v146
    v_max3_u32 v21, v147, v148, v149
    v_max3_u32 v20, v20, v150, v151
    v_max3_u32 v21, v21, v152, v153
    v_max3_u32 v20, v20, v154, v155
    v_max3_u32 v21, v21, v156, v157
    v_max3_u32 v20, v20, v158, v159
    v_max_u32 v20, v20, v21
    v_cmp_eq_u32 vcc, -1, v20
    s_cbranch_vccz L_c_okV_s1
    s_sub_u32 s22, s22, 1
    s_cbranch_scc0 L_c_pollV_s1
    s_branch L_timeout
L_c_RS_s1_retry:
    buffer_load_dwordx2 v[88:89], v7, s[8:11], s89 offen sc1
    buffer_load_dwordx2 v[90:91], v8, s[8:11], s89 offen sc1
L_c_RS_s1_loop:
    s_waitcnt vmcnt(4)
    v_mfma_f32_16x16x32_bf16 v[92:95], v[32:35], v[60:63], 0
    v_max3_u32 v20, v60, v61, v62
    v_max_u32 v20, v20, v63
    v_cmp_eq_u32 vcc, -1, v20
    s_cbranch_vccz L_c_RS_s1_ok1
    buffer_load_dwordx2 v[60:61], v7, s[8:11], s89 offen sc1
    buffer_load_dwordx2 v[62:63], v8, s[8:11], s89 offen sc1
    s_waitcnt vmcnt(4)
    v_mfma_f32_16x16x32_bf16 v[92:95], v[32:35], v[64:67], 0
    v_max3_u32 v20, v64, v65, v66
    v_max_u32 v20, v20, v67
    v_cmp_eq_u32 vcc, -1, v20
    s_cbranch_vccz L_c_RS_s1_ok2
    buffer_load_dwordx2 v[64:65], v7, s[8:11], s89 offen sc1
    buffer_load_dwordx2 v[66:67], v8, s[8:11], s89 offen sc1
    s_waitcnt vmcnt(4)
    v_mfma_f32_16x16x32_bf16 v[92:95], v[32:35], v[88:91], 0
    v_max3_u32 v20, v88, v89, v90
    v_max_u32 v20, v20, v91
    v_cmp_eq_u32 vcc, -1, v20
    s_cbranch_vccz L_c_RS_s1_ok0
    buffer_load_dwordx2 v[88:89], v7, s[8:11], s89 offen sc1
    buffer_load_dwordx2 v[90:91], v8, s[8:11], s89 offen sc1
    s_sub_u32 s22, s22, 1
    s_cbranch_scc0 L_c_RS_s1_loop
    s_branch L_timeout
L_c_RS_s1_ok0:
    s_branch L_c_RS_s1_done
L_c_RS_s1_ok1:
    s_branch L_c_RS_s1_done
L_c_RS_s1_ok2:
    s_branch L_c_RS_s1_done
L_c_X_s1_retry:
    buffer_load_dwordx4 v[108:111], v104, s[8:11], s97 offen sc1
    buffer_load_dwordx4 v[112:115], v105, s[8:11], s97 offen sc1
    buffer_load_dwordx4 v[116:119], v106, s[8:11], s97 offen sc1
L_c_X_s1_loop:
    s_waitcnt vmcnt(3)
    v_max3_u32 v20, v68, v69, v70
    v_max3_u32 v21, v71, v72, v73
    v_max3_u32 v20, v20, v74, v75
    v_max3_u32 v21, v21, v76, v77
    v_max3_u32 v20, v20, v78, v79
    v_max_u32 v20, v20, v21
    v_cmp_eq_u32 vcc, -1, v20
    s_cbranch_vccz L_c_X_s1_ok1
    buffer_load_dwordx4 v[68:71], v104, s[8:11], s97 offen sc1
    buffer_load_dwordx4 v[72:75], v105, s[8:11], s97 offen sc1
    buffer_load_dwordx4 v[76:79], v106, s[8:11], s97 offen sc1
    s_waitcnt vmcnt(3)
    v_max3_u32 v20, v108, v109, v110
    v_max3_u32 v21, v111, v112, v113
    v_max3_u32 v20, v20, v114, v115
    v_max3_u32 v21, v21, v116, v117
    v_max3_u32 v20, v20, v118, v119
    v_max_u32 v20, v20, v21
    v_cmp_eq_u32 vcc, -1, v20
    s_cbranch_vccz L_c_X_s1_ok0
    buffer_load_dwordx4 v[108:111], v104, s[8:11], s97 offen sc1
    buffer_load_dwordx4 v[112:115], v105, s[8:11], s97 offen sc1
    buffer_load_dwordx4 v[116:119], v106, s[8:11], s97 offen sc1
    s_sub_u32 s22, s22, 1
    s_cbranch_scc0 L_c_X_s1_loop
    s_branch L_timeout
L_c_X_s1_ok0:
    v_pk_add_f32 v[20:21], v[108:109], v[116:117]
    v_pk_add_f32 v[92:93], v[92:93], v[112:113]
    v_pk_add_f32 v[22:23], v[110:111], v[118:119]
    v_pk_add_f32 v[94:95], v[94:95], v[114:115]
    s_branch L_c_X_s1_done
L_c_X_s1_ok1:
    v_pk_add_f32 v[20:21], v[68:69], v[76:77]
    v_pk_add_f32 v[92:93], v[92:93], v[72:73]
    v_pk_add_f32 v[22:23], v[70:71], v[78:79]
    v_pk_add_f32 v[94:95], v[94:95], v[74:75]
    s_branch L_c_X_s1_done
L_c_noitem_s1:
    s_cmp_lg_u32 s20, 3
    s_cbranch_scc1 L_c_w2_s1
    s_mov_b32 s30, 105906176
    buffer_load_dword v24, v37, s[8:11], s30 offen sc1
    buffer_load_dwordx4 v[40:43], v83, s[8:11], s85 offen sc1
    buffer_load_dwordx4 v[44:47], v98, s[8:11], s85 offen sc1
    s_waitcnt vmcnt(0)
    buffer_store_dwordx4 v[40:43], v80, s[8:11], s40 offen sc1
    buffer_store_dwordx4 v[44:47], v81, s[8:11], s41 offen sc1
    s_cmp_gt_u32 s21, 60
    s_cbranch_scc1 L_c_kvskip_110
    s_add_u32 s31, s21, 3
L_c_wk_s1:
    v_cmp_gt_u32 vcc, s31, v24
    s_nop 3
    s_and_b64 vcc, vcc, 3
    s_cbranch_vccz L_c_wk_s1_ok
    s_mov_b32 s30, 105906176
    buffer_load_dword v24, v37, s[8:11], s30 offen sc1
    s_waitcnt vmcnt(0)
    s_sub_u32 s22, s22, 1
    s_cbranch_scc0 L_c_wk_s1
    s_branch L_timeout
L_c_wk_s1_ok:
    s_mov_b32 m0, 49152
    s_add_u32 s32, s42, 16777216
    buffer_load_dwordx4 v96, s[8:11], s32 offen sc1 lds
    s_mov_b32 m0, 50176
    s_add_u32 s32, s42, 16778240
    buffer_load_dwordx4 v96, s[8:11], s32 offen sc1 lds
    s_mov_b32 m0, 51200
    s_add_u32 s32, s42, 16779264
    buffer_load_dwordx4 v96, s[8:11], s32 offen sc1 lds
    s_mov_b32 m0, 52224
    s_add_u32 s32, s42, 16780288
    buffer_load_dwordx4 v96, s[8:11], s32 offen sc1 lds
    s_mov_b32 m0, 53248
    s_add_u32 s32, s42, 16781312
    buffer_load_dwordx4 v96, s[8:11], s32 offen sc1 lds
    s_mov_b32 m0, 54272
    s_add_u32 s32, s42, 16782336
    buffer_load_dwordx4 v96, s[8:11], s32 offen sc1 lds
    s_mov_b32 m0, 55296
    s_add_u32 s32, s42, 16783360
    buffer_load_dwordx4 v96, s[8:11], s32 offen sc1 lds
    s_mov_b32 m0, 56320
    s_add_u32 s32, s42, 16784384
    buffer_load_dwordx4 v96, s[8:11], s32 offen sc1 lds
    s_mov_b32 m0, 57344
    s_add_u32 s32, s42, 33554432
    buffer_load_dwordx4 v96, s[8:11], s32 offen sc1 lds
    s_mov_b32 m0, 58368
    s_add_u32 s32, s42, 33555456
    buffer_load_dwordx4 v96, s[8:11], s32 offen sc1 lds
    s_mov_b32 m0, 59392
    s_add_u32 s32, s42, 33556480
    buffer_load_dwordx4 v96, s[8:11], s32 offen sc1 lds
    s_mov_b32 m0, 60416
    s_add_u32 s32, s42, 33557504
    buffer_load_dwordx4 v96, s[8:11], s32 offen sc1 lds
    s_mov_b32 m0, 61440
    s_add_u32 s32, s42, 33558528
    buffer_load_dwordx4 v96, s[8:11], s32 offen sc1 lds
    s_mov_b32 m0, 62464
    s_add_u32 s32, s42, 33559552
    buffer_load_dwordx4 v96, s[8:11], s32 offen sc1 lds
    s_mov_b32 m0, 63488
    s_add_u32 s32, s42, 33560576
    buffer_load_dwordx4 v96, s[8:11], s32 offen sc1 lds
    s_mov_b32 m0, 64512
    s_add_u32 s32, s42, 33561600
    buffer_load_dwordx4 v96, s[8:11], s32 offen sc1 lds
L_c_kvskip_110:
    s_waitcnt lgkmcnt(0)
    v_mfma_f32_16x16x32_bf16 v[236:239], v[160:163], a[120:123], 0
    v_mfma_f32_16x16x32_bf16 v[240:243], v[176:179], a[120:123], 0
    v_mfma_f32_16x16x32_bf16 v[236:239], v[164:167], a[124:127], v[236:239]
    v_mfma_f32_16x16x32_bf16 v[240:243], v[180:183], a[124:127], v[240:243]
    v_mfma_f32_16x16x32_bf16 v[236:239], v[168:171], a[128:131], v[236:239]
    v_mfma_f32_16x16x32_bf16 v[240:243], v[184:187], a[128:131], v[240:243]
    v_mfma_f32_16x16x32_bf16 v[236:239], v[172:175], a[132:135], v[236:239]
    v_mfma_f32_16x16x32_bf16 v[240:243], v[188:191], a[132:135], v[240:243]
    v_mfma_f32_16x16x32_bf16 v[120:123], v[160:163], a[136:139], 0
    v_mfma_f32_16x16x32_bf16 v[124:127], v[176:179], a[136:139], 0
    v_mfma_f32_16x16x32_bf16 v[120:123], v[164:167], a[140:143], v[120:123]
    v_mfma_f32_16x16x32_bf16 v[124:127], v[180:183], a[140:143], v[124:127]
    v_mfma_f32_16x16x32_bf16 v[120:123], v[168:171], a[144:147], v[120:123]
    v_mfma_f32_16x16x32_bf16 v[124:127], v[184:187], a[144:147], v[124:127]
    v_mfma_f32_16x16x32_bf16 v[120:123], v[172:175], a[148:151], v[120:123]
    v_mfma_f32_16x16x32_bf16 v[124:127], v[188:191], a[148:151], v[124:127]
    v_cvt_pk_bf16_f32 v204, v236, v237
    v_cvt_pk_bf16_f32 v205, v238, v239
    v_cvt_pk_bf16_f32 v206, v240, v241
    v_cvt_pk_bf16_f32 v207, v242, v243
    v_mfma_f32_16x16x32_bf16 v[236:239], v[160:163], a[152:155], 0
    v_mfma_f32_16x16x32_bf16 v[240:243], v[176:179], a[152:155], 0
    v_mfma_f32_16x16x32_bf16 v[236:239], v[164:167], a[156:159], v[236:239]
    v_mfma_f32_16x16x32_bf16 v[240:243], v[180:183], a[156:159], v[240:243]
    v_mfma_f32_16x16x32_bf16 v[236:239], v[168:171], a[160:163], v[236:239]
    v_mfma_f32_16x16x32_bf16 v[240:243], v[184:187], a[160:163], v[240:243]
    v_mfma_f32_16x16x32_bf16 v[236:239], v[172:175], a[164:167], v[236:239]
    v_mfma_f32_16x16x32_bf16 v[240:243], v[188:191], a[164:167], v[240:243]
    v_cvt_pk_bf16_f32 v208, v120, v121
    v_cvt_pk_bf16_f32 v209, v122, v123
    v_cvt_pk_bf16_f32 v210, v124, v125
    v_cvt_pk_bf16_f32 v211, v126, v127
    s_nop 7
    v_cvt_pk_bf16_f32 v212, v236, v237
    v_cvt_pk_bf16_f32 v213, v238, v239
    v_cvt_pk_bf16_f32 v214, v240, v241
    v_cvt_pk_bf16_f32 v215, v242, v243
    s_branch L_c_stepend_s1
L_c_w2_s1:
    s_waitcnt lgkmcnt(0)
    v_mfma_f32_16x16x32_bf16 v[236:239], v[160:163], a[120:123], 0
    v_mfma_f32_16x16x32_bf16 v[240:243], v[176:179], a[120:123], 0
    v_mfma_f32_16x16x32_bf16 v[236:239], v[164:167], a[124:127], v[236:239]
    v_mfma_f32_16x16x32_bf16 v[240:243], v[180:183], a[124:127], v[240:243]
    v_mfma_f32_16x16x32_bf16 v[236:239], v[168:171], a[128:131], v[236:239]
    v_mfma_f32_16x16x32_bf16 v[240:243], v[184:187], a[128:131], v[240:243]
    v_mfma_f32_16x16x32_bf16 v[236:239], v[172:175], a[132:135], v[236:239]
    v_mfma_f32_16x16x32_bf16 v[240:243], v[188:191], a[132:135], v[240:243]
    v_mfma_f32_16x16x32_bf16 v[120:123], v[160:163], a[136:139], 0
    v_mfma_f32_16x16x32_bf16 v[124:127], v[176:179], a[136:139], 0
    v_mfma_f32_16x16x32_bf16 v[120:123], v[164:167], a[140:143], v[120:123]
    v_mfma_f32_16x16x32_bf16 v[124:127], v[180:183], a[140:143], v[124:127]
    v_mfma_f32_16x16x32_bf16 v[120:123], v[168:171], a[144:147], v[120:123]
    v_mfma_f32_16x16x32_bf16 v[124:127], v[184:187], a[144:147], v[124:127]
    v_mfma_f32_16x16x32_bf16 v[120:123], v[172:175], a[148:151], v[120:123]
    v_mfma_f32_16x16x32_bf16 v[124:127], v[188:191], a[148:151], v[124:127]
    v_cvt_pk_bf16_f32 v204, v236, v237
    v_cvt_pk_bf16_f32 v205, v238, v239
    v_cvt_pk_bf16_f32 v206, v240, v241
    v_cvt_pk_bf16_f32 v207, v242, v243
    v_mfma_f32_16x16x32_bf16 v[236:239], v[160:163], a[152:155], 0
    v_mfma_f32_16x16x32_bf16 v[240:243], v[176:179], a[152:155], 0
    v_mfma_f32_16x16x32_bf16 v[236:239], v[164:167], a[156:159], v[236:239]
    v_mfma_f32_16x16x32_bf16 v[240:243], v[180:183], a[156:159], v[240:243]
    v_mfma_f32_16x16x32_bf16 v[236:239], v[168:171], a[160:163], v[236:239]
    v_mfma_f32_16x16x32_bf16 v[240:243], v[184:187], a[160:163], v[240:243]
    v_mfma_f32_16x16x32_bf16 v[236:239], v[172:175], a[164:167], v[236:239]
    v_mfma_f32_16x16x32_bf16 v[240:243], v[188:191], a[164:167], v[240:243]
    v_cvt_pk_bf16_f32 v208, v120, v121
    v_cvt_pk_bf16_f32 v209, v122, v123
    v_cvt_pk_bf16_f32 v210, v124, v125
    v_cvt_pk_bf16_f32 v211, v126, v127
    s_nop 7
    v_cvt_pk_bf16_f32 v212, v236, v237
    v_cvt_pk_bf16_f32 v213, v238, v239
    v_cvt_pk_bf16_f32 v214, v240, v241
    v_cvt_pk_bf16_f32 v215, v242, v243
    s_branch L_c_stepend_s1
L_c_A_s2_retry:
    buffer_load_dwordx4 v[144:147], v10, s[8:11], s94 offen sc1
    buffer_load_dwordx4 v[148:151], v11, s[8:11], s94 offen sc1
    buffer_load_dwordx4 v[152:155], v12, s[8:11], s94 offen sc1
L_c_A_s2_loop:
    s_waitcnt vmcnt(3)
    ds_write_b128 v100, v[128:131]
    ds_write_b128 v101, v[132:135]
    ds_write_b128 v102, v[136:139]
    v_max3_u32 v20, v128, v129, v130
    v_max3_u32 v21, v131, v132, v133
    v_max3_u32 v20, v20, v134, v135
    v_max3_u32 v21, v21, v136, v137
    v_max3_u32 v20, v20, v138, v139
    v_max_u32 v20, v20, v21
    v_cmp_eq_u32 vcc, -1, v20
    s_cbranch_vccz L_c_A_s2_ok1
    buffer_load_dwordx4 v[128:131], v10, s[8:11], s94 offen sc1
    buffer_load_dwordx4 v[132:135], v11, s[8:11], s94 offen sc1
    buffer_load_dwordx4 v[136:139], v12, s[8:11], s94 offen sc1
    s_waitcnt vmcnt(3)
    ds_write_b128 v100, v[144:147]
    ds_write_b128 v101, v[148:151]
    ds_write_b128 v102, v[152:155]
    v_max3_u32 v20, v144, v145, v146
    v_max3_u32 v21, v147, v148, v149
    v_max3_u32 v20, v20, v150, v151
    v_max3_u32 v21, v21, v152, v153
    v_max3_u32 v20, v20, v154, v155
    v_max_u32 v20, v20, v21
    v_cmp_eq_u32 vcc, -1, v20
    s_cbranch_vccz L_c_A_s2_ok0
    buffer_load_dwordx4 v[144:147], v10, s[8:11], s94 offen sc1
    buffer_load_dwordx4 v[148:151], v11, s[8:11], s94 offen sc1
    buffer_load_dwordx4 v[152:155], v12, s[8:11], s94 offen sc1
    s_sub_u32 s22, s22, 1
    s_cbranch_scc0 L_c_A_s2_loop
    s_branch L_timeout
L_c_A_s2_ok0:
    s_branch L_c_A_s2_done
L_c_A_s2_ok1:
    s_branch L_c_A_s2_done
L_c_R_s2_retry:
    buffer_load_dwordx4 v[40:43], v3, s[8:11], s86 offen sc1
L_c_R_s2_loop:
    s_waitcnt vmcnt(1)
    ds_write_b128 v17, v[44:47]
    v_max3_u32 v20, v44, v45, v46
    v_max_u32 v20, v20, v47
    v_cmp_eq_u32 vcc, -1, v20
    s_cbranch_vccz L_c_R_s2_ok1
    buffer_load_dwordx4 v[44:47], v3, s[8:11], s86 offen sc1
    s_waitcnt vmcnt(1)
    ds_write_b128 v17, v[40:43]
    v_max3_u32 v20, v40, v41, v42
    v_max_u32 v20, v20, v43
    v_cmp_eq_u32 vcc, -1, v20
    s_cbranch_vccz L_c_R_s2_ok0
    buffer_load_dwordx4 v[40:43], v3, s[8:11], s86 offen sc1
    s_sub_u32 s22, s22, 1
    s_cbranch_scc0 L_c_R_s2_loop
    s_branch L_timeout
L_c_R_s2_ok0:
    s_branch L_c_R_s2_done
L_c_R_s2_ok1:
    s_branch L_c_R_s2_done
L_c_pollV_s2:
    buffer_load_dwordx4 v[144:147], v4, s[8:11], s86 offen offset:0 sc1
    buffer_load_dwordx4 v[148:151], v4, s[8:11], s86 offen offset:512 sc1
    buffer_load_dwordx4 v[152:155], v4, s[8:11], s86 offen offset:1024 sc1
    buffer_load_dwordx4 v[156:159], v4, s[8:11], s86 offen offset:1536 sc1
    s_waitcnt vmcnt(0)
    v_max3_u32 v20, v144, v145, v146
    v_max3_u32 v21, v147, v148, v149
    v_max3_u32 v20, v20, v150, v151
    v_max3_u32 v21, v21, v152, v153
    v_max3_u32 v20, v20, v154, v155
    v_max3_u32 v21, v21, v156, v157
    v_max3_u32 v20, v20, v158, v159
    v_max_u32 v20, v20, v21
    v_cmp_eq_u32 vcc, -1, v20
    s_cbranch_vccz L_c_okV_s2
    s_sub_u32 s22, s22, 1
    s_cbranch_scc0 L_c_pollV_s2
    s_branch L_timeout
L_c_RS_s2_retry:
    buffer_load_dwordx2 v[88:89], v7, s[8:11], s90 offen sc1
    buffer_load_dwordx2 v[90:91], v8, s[8:11], s90 offen sc1
L_c_RS_s2_loop:
    s_waitcnt vmcnt(4)
    v_mfma_f32_16x16x32_bf16 v[92:95], v[32:35], v[60:63], 0
    v_max3_u32 v20, v60, v61, v62
    v_max_u32 v20, v20, v63
    v_cmp_eq_u32 vcc, -1, v20
    s_cbranch_vccz L_c_RS_s2_ok1
    buffer_load_dwordx2 v[60:61], v7, s[8:11], s90 offen sc1
    buffer_load_dwordx2 v[62:63], v8, s[8:11], s90 offen sc1
    s_waitcnt vmcnt(4)
    v_mfma_f32_16x16x32_bf16 v[92:95], v[32:35], v[64:67], 0
    v_max3_u32 v20, v64, v65, v66
    v_max_u32 v20, v20, v67
    v_cmp_eq_u32 vcc, -1, v20
    s_cbranch_vccz L_c_RS_s2_ok2
    buffer_load_dwordx2 v[64:65], v7, s[8:11], s90 offen sc1
    buffer_load_dwordx2 v[66:67], v8, s[8:11], s90 offen sc1
    s_waitcnt vmcnt(4)
    v_mfma_f32_16x16x32_bf16 v[92:95], v[32:35], v[88:91], 0
    v_max3_u32 v20, v88, v89, v90
    v_max_u32 v20, v20, v91
    v_cmp_eq_u32 vcc, -1, v20
    s_cbranch_vccz L_c_RS_s2_ok0
    buffer_load_dwordx2 v[88:89], v7, s[8:11], s90 offen sc1
    buffer_load_dwordx2 v[90:91], v8, s[8:11], s90 offen sc1
    s_sub_u32 s22, s22, 1
    s_cbranch_scc0 L_c_RS_s2_loop
    s_branch L_timeout
L_c_RS_s2_ok0:
    s_branch L_c_RS_s2_done
L_c_RS_s2_ok1:
    s_branch L_c_RS_s2_done
L_c_RS_s2_ok2:
    s_branch L_c_RS_s2_done
L_c_X_s2_retry:
    buffer_load_dwordx4 v[108:111], v104, s[8:11], s98 offen sc1
    buffer_load_dwordx4 v[112:115], v105, s[8:11], s98 offen sc1
    buffer_load_dwordx4 v[116:119], v106, s[8:11], s98 offen sc1
L_c_X_s2_loop:
    s_waitcnt vmcnt(3)
    v_max3_u32 v20, v68, v69, v70
    v_max3_u32 v21, v71, v72, v73
    v_max3_u32 v20, v20, v74, v75
    v_max3_u32 v21, v21, v76, v77
    v_max3_u32 v20, v20, v78, v79
    v_max_u32 v20, v20, v21
    v_cmp_eq_u32 vcc, -1, v20
    s_cbranch_vccz L_c_X_s2_ok1
    buffer_load_dwordx4 v[68:71], v104, s[8:11], s98 offen sc1
    buffer_load_dwordx4 v[72:75], v105, s[8:11], s98 offen sc1
    buffer_load_dwordx4 v[76:79], v106, s[8:11], s98 offen sc1
    s_waitcnt vmcnt(3)
    v_max3_u32 v20, v108, v109, v110
    v_max3_u32 v21, v111, v112, v113
    v_max3_u32 v20, v20, v114, v115
    v_max3_u32 v21, v21, v116, v117
    v_max3_u32 v20, v20, v118, v119
    v_max_u32 v20, v20, v21
    v_cmp_eq_u32 vcc, -1, v20
    s_cbranch_vccz L_c_X_s2_ok0
    buffer_load_dwordx4 v[108:111], v104, s[8:11], s98 offen sc1
    buffer_load_dwordx4 v[112:115], v105, s[8:11], s98 offen sc1
    buffer_load_dwordx4 v[116:119], v106, s[8:11], s98 offen sc1
    s_sub_u32 s22, s22, 1
    s_cbranch_scc0 L_c_X_s2_loop
    s_branch L_timeout
L_c_X_s2_ok0:
    v_pk_add_f32 v[20:21], v[108:109], v[116:117]
    v_pk_add_f32 v[92:93], v[92:93], v[112:113]
    v_pk_add_f32 v[22:23], v[110:111], v[118:119]
    v_pk_add_f32 v[94:95], v[94:95], v[114:115]
    s_branch L_c_X_s2_done
L_c_X_s2_ok1:
    v_pk_add_f32 v[20:21], v[68:69], v[76:77]
    v_pk_add_f32 v[92:93], v[92:93], v[72:73]
    v_pk_add_f32 v[22:23], v[70:71], v[78:79]
    v_pk_add_f32 v[94:95], v[94:95], v[74:75]
    s_branch L_c_X_s2_done
L_c_noitem_s2:
    s_cmp_lg_u32 s20, 3
    s_cbranch_scc1 L_c_w2_s2
    s_mov_b32 s30, 105906176
    buffer_load_dword v24, v37, s[8:11], s30 offen sc1
    buffer_load_dwordx4 v[40:43], v83, s[8:11], s86 offen sc1
    buffer_load_dwordx4 v[44:47], v98, s[8:11], s86 offen sc1
    s_waitcnt vmcnt(0)
    buffer_store_dwordx4 v[40:43], v80, s[8:11], s40 offen sc1
    buffer_store_dwordx4 v[44:47], v81, s[8:11], s41 offen sc1
    s_cmp_gt_u32 s21, 60
    s_cbranch_scc1 L_c_kvskip_111
    s_add_u32 s31, s21, 3
L_c_wk_s2:
    v_cmp_gt_u32 vcc, s31, v24
    s_nop 3
    s_and_b64 vcc, vcc, 3
    s_cbranch_vccz L_c_wk_s2_ok
    s_mov_b32 s30, 105906176
    buffer_load_dword v24, v37, s[8:11], s30 offen sc1
    s_waitcnt vmcnt(0)
    s_sub_u32 s22, s22, 1
    s_cbranch_scc0 L_c_wk_s2
    s_branch L_timeout
L_c_wk_s2_ok:
    s_mov_b32 m0, 0
    s_add_u32 s32, s42, 16777216
    buffer_load_dwordx4 v96, s[8:11], s32 offen sc1 lds
    s_mov_b32 m0, 1024
    s_add_u32 s32, s42, 16778240
    buffer_load_dwordx4 v96, s[8:11], s32 offen sc1 lds
    s_mov_b32 m0, 2048
    s_add_u32 s32, s42, 16779264
    buffer_load_dwordx4 v96, s[8:11], s32 offen sc1 lds
    s_mov_b32 m0, 3072
    s_add_u32 s32, s42, 16780288
    buffer_load_dwordx4 v96, s[8:11], s32 offen sc1 lds
    s_mov_b32 m0, 4096
    s_add_u32 s32, s42, 16781312
    buffer_load_dwordx4 v96, s[8:11], s32 offen sc1 lds
    s_mov_b32 m0, 5120
    s_add_u32 s32, s42, 16782336
    buffer_load_dwordx4 v96, s[8:11], s32 offen sc1 lds
    s_mov_b32 m0, 6144
    s_add_u32 s32, s42, 16783360
    buffer_load_dwordx4 v96, s[8:11], s32 offen sc1 lds
    s_mov_b32 m0, 7168
    s_add_u32 s32, s42, 16784384
    buffer_load_dwordx4 v96, s[8:11], s32 offen sc1 lds
    s_mov_b32 m0, 8192
    s_add_u32 s32, s42, 33554432
    buffer_load_dwordx4 v96, s[8:11], s32 offen sc1 lds
    s_mov_b32 m0, 9216
    s_add_u32 s32, s42, 33555456
    buffer_load_dwordx4 v96, s[8:11], s32 offen sc1 lds
    s_mov_b32 m0, 10240
    s_add_u32 s32, s42, 33556480
    buffer_load_dwordx4 v96, s[8:11], s32 offen sc1 lds
    s_mov_b32 m0, 11264
    s_add_u32 s32, s42, 33557504
    buffer_load_dwordx4 v96, s[8:11], s32 offen sc1 lds
    s_mov_b32 m0, 12288
    s_add_u32 s32, s42, 33558528
    buffer_load_dwordx4 v96, s[8:11], s32 offen sc1 lds
    s_mov_b32 m0, 13312
    s_add_u32 s32, s42, 33559552
    buffer_load_dwordx4 v96, s[8:11], s32 offen sc1 lds
    s_mov_b32 m0, 14336
    s_add_u32 s32, s42, 33560576
    buffer_load_dwordx4 v96, s[8:11], s32 offen sc1 lds
    s_mov_b32 m0, 15360
    s_add_u32 s32, s42, 33561600
    buffer_load_dwordx4 v96, s[8:11], s32 offen sc1 lds
L_c_kvskip_111:
    s_waitcnt lgkmcnt(0)
    v_mfma_f32_16x16x32_bf16 v[236:239], v[160:163], a[120:123], 0
    v_mfma_f32_16x16x32_bf16 v[240:243], v[176:179], a[120:123], 0
    v_mfma_f32_16x16x32_bf16 v[236:239], v[164:167], a[124:127], v[236:239]
    v_mfma_f32_16x16x32_bf16 v[240:243], v[180:183], a[124:127], v[240:243]
    v_mfma_f32_16x16x32_bf16 v[236:239], v[168:171], a[128:131], v[236:239]
    v_mfma_f32_16x16x32_bf16 v[240:243], v[184:187], a[128:131], v[240:243]
    v_mfma_f32_16x16x32_bf16 v[236:239], v[172:175], a[132:135], v[236:239]
    v_mfma_f32_16x16x32_bf16 v[240:243], v[188:191], a[132:135], v[240:243]
    v_mfma_f32_16x16x32_bf16 v[120:123], v[160:163], a[136:139], 0
    v_mfma_f32_16x16x32_bf16 v[124:127], v[176:179], a[136:139], 0
    v_mfma_f32_16x16x32_bf16 v[120:123], v[164:167], a[140:143], v[120:123]
    v_mfma_f32_16x16x32_bf16 v[124:127], v[180:183], a[140:143], v[124:127]
    v_mfma_f32_16x16x32_bf16 v[120:123], v[168:171], a[144:147], v[120:123]
    v_mfma_f32_16x16x32_bf16 v[124:127], v[184:187], a[144:147], v[124:127]
    v_mfma_f32_16x16x32_bf16 v[120:123], v[172:175], a[148:151], v[120:123]
    v_mfma_f32_16x16x32_bf16 v[124:127], v[188:191], a[148:151], v[124:127]
    v_cvt_pk_bf16_f32 v204, v236, v237
    v_cvt_pk_bf16_f32 v205, v238, v239
    v_cvt_pk_bf16_f32 v206, v240, v241
    v_cvt_pk_bf16_f32 v207, v242, v243
    v_mfma_f32_16x16x32_bf16 v[236:239], v[160:163], a[152:155], 0
    v_mfma_f32_16x16x32_bf16 v[240:243], v[176:179], a[152:155], 0
    v_mfma_f32_16x16x32_bf16 v[236:239], v[164:167], a[156:159], v[236:239]
    v_mfma_f32_16x16x32_bf16 v[240:243], v[180:183], a[156:159], v[240:243]
    v_mfma_f32_16x16x32_bf16 v[236:239], v[168:171], a[160:163], v[236:239]
    v_mfma_f32_16x16x32_bf16 v[240:243], v[184:187], a[160:163], v[240:243]
    v_mfma_f32_16x16x32_bf16 v[236:239], v[172:175], a[164:167], v[236:239]
    v_mfma_f32_16x16x32_bf16 v[240:243], v[188:191], a[164:167], v[240:243]
    v_cvt_pk_bf16_f32 v208, v120, v121
    v_cvt_pk_bf16_f32 v209, v122, v123
    v_cvt_pk_bf16_f32 v210, v124, v125
    v_cvt_pk_bf16_f32 v211, v126, v127
    s_nop 7
    v_cvt_pk_bf16_f32 v212, v236, v237
    v_cvt_pk_bf16_f32 v213, v238, v239
    v_cvt_pk_bf16_f32 v214, v240, v241
    v_cvt_pk_bf16_f32 v215, v242, v243
    s_branch L_c_stepend_s2
L_c_w2_s2:
    s_waitcnt lgkmcnt(0)
    v_mfma_f32_16x16x32_bf16 v[236:239], v[160:163], a[120:123], 0
    v_mfma_f32_16x16x32_bf16 v[240:243], v[176:179], a[120:123], 0
    v_mfma_f32_16x16x32_bf16 v[236:239], v[164:167], a[124:127], v[236:239]
    v_mfma_f32_16x16x32_bf16 v[240:243], v[180:183], a[124:127], v[240:243]
    v_mfma_f32_16x16x32_bf16 v[236:239], v[168:171], a[128:131], v[236:239]
    v_mfma_f32_16x16x32_bf16 v[240:243], v[184:187], a[128:131], v[240:243]
    v_mfma_f32_16x16x32_bf16 v[236:239], v[172:175], a[132:135], v[236:239]
    v_mfma_f32_16x16x32_bf16 v[240:243], v[188:191], a[132:135], v[240:243]
    v_mfma_f32_16x16x32_bf16 v[120:123], v[160:163], a[136:139], 0
    v_mfma_f32_16x16x32_bf16 v[124:127], v[176:179], a[136:139], 0
    v_mfma_f32_16x16x32_bf16 v[120:123], v[164:167], a[140:143], v[120:123]
    v_mfma_f32_16x16x32_bf16 v[124:127], v[180:183], a[140:143], v[124:127]
    v_mfma_f32_16x16x32_bf16 v[120:123], v[168:171], a[144:147], v[120:123]
    v_mfma_f32_16x16x32_bf16 v[124:127], v[184:187], a[144:147], v[124:127]
    v_mfma_f32_16x16x32_bf16 v[120:123], v[172:175], a[148:151], v[120:123]
    v_mfma_f32_16x16x32_bf16 v[124:127], v[188:191], a[148:151], v[124:127]
    v_cvt_pk_bf16_f32 v204, v236, v237
    v_cvt_pk_bf16_f32 v205, v238, v239
    v_cvt_pk_bf16_f32 v206, v240, v241
    v_cvt_pk_bf16_f32 v207, v242, v243
    v_mfma_f32_16x16x32_bf16 v[236:239], v[160:163], a[152:155], 0
    v_mfma_f32_16x16x32_bf16 v[240:243], v[176:179], a[152:155], 0
    v_mfma_f32_16x16x32_bf16 v[236:239], v[164:167], a[156:159], v[236:239]
    v_mfma_f32_16x16x32_bf16 v[240:243], v[180:183], a[156:159], v[240:243]
    v_mfma_f32_16x16x32_bf16 v[236:239], v[168:171], a[160:163], v[236:239]
    v_mfma_f32_16x16x32_bf16 v[240:243], v[184:187], a[160:163], v[240:243]
    v_mfma_f32_16x16x32_bf16 v[236:239], v[172:175], a[164:167], v[236:239]
    v_mfma_f32_16x16x32_bf16 v[240:243], v[188:191], a[164:167], v[240:243]
    v_cvt_pk_bf16_f32 v208, v120, v121
    v_cvt_pk_bf16_f32 v209, v122, v123
    v_cvt_pk_bf16_f32 v210, v124, v125
    v_cvt_pk_bf16_f32 v211, v126, v127
    s_nop 7
    v_cvt_pk_bf16_f32 v212, v236, v237
    v_cvt_pk_bf16_f32 v213, v238, v239
    v_cvt_pk_bf16_f32 v214, v240, v241
    v_cvt_pk_bf16_f32 v215, v242, v243
    s_branch L_c_stepend_s2
L_c_A_s3_retry:
    buffer_load_dwordx4 v[144:147], v10, s[8:11], s95 offen sc1
    buffer_load_dwordx4 v[148:151], v11, s[8:11], s95 offen sc1
    buffer_load_dwordx4 v[152:155], v12, s[8:11], s95 offen sc1
L_c_A_s3_loop:
    s_waitcnt vmcnt(3)
    ds_write_b128 v100, v[128:131]
    ds_write_b128 v101, v[132:135]
    ds_write_b128 v102, v[136:139]
    v_max3_u32 v20, v128, v129, v130
    v_max3_u32 v21, v131, v132, v133
    v_max3_u32 v20, v20, v134, v135
    v_max3_u32 v21, v21, v136, v137
    v_max3_u32 v20, v20, v138, v139
    v_max_u32 v20, v20, v21
    v_cmp_eq_u32 vcc, -1, v20
    s_cbranch_vccz L_c_A_s3_ok1
    buffer_load_dwordx4 v[128:131], v10, s[8:11], s95 offen sc1
    buffer_load_dwordx4 v[132:135], v11, s[8:11], s95 offen sc1
    buffer_load_dwordx4 v[136:139], v12, s[8:11], s95 offen sc1
    s_waitcnt vmcnt(3)
    ds_write_b128 v100, v[144:147]
    ds_write_b128 v101, v[148:151]
    ds_write_b128 v102, v[152:155]
    v_max3_u32 v20, v144, v145, v146
    v_max3_u32 v21, v147, v148, v149
    v_max3_u32 v20, v20, v150, v151
    v_max3_u32 v21, v21, v152, v153
    v_max3_u32 v20, v20, v154, v155
    v_max_u32 v20, v20, v21
    v_cmp_eq_u32 vcc, -1, v20
    s_cbranch_vccz L_c_A_s3_ok0
    buffer_load_dwordx4 v[144:147], v10, s[8:11], s95 offen sc1
    buffer_load_dwordx4 v[148:151], v11, s[8:11], s95 offen sc1
    buffer_load_dwordx4 v[152:155], v12, s[8:11], s95 offen sc1
    s_sub_u32 s22, s22, 1
    s_cbranch_scc0 L_c_A_s3_loop
    s_branch L_timeout
L_c_A_s3_ok0:
    s_branch L_c_A_s3_done
L_c_A_s3_ok1:
    s_branch L_c_A_s3_done
L_c_R_s3_retry:
    buffer_load_dwordx4 v[40:43], v3, s[8:11], s87 offen sc1
L_c_R_s3_loop:
    s_waitcnt vmcnt(1)
    ds_write_b128 v17, v[44:47]
    v_max3_u32 v20, v44, v45, v46
    v_max_u32 v20, v20, v47
    v_cmp_eq_u32 vcc, -1, v20
    s_cbranch_vccz L_c_R_s3_ok1
    buffer_load_dwordx4 v[44:47], v3, s[8:11], s87 offen sc1
    s_waitcnt vmcnt(1)
    ds_write_b128 v17, v[40:43]
    v_max3_u32 v20, v40, v41, v42
    v_max_u32 v20, v20, v43
    v_cmp_eq_u32 vcc, -1, v20
    s_cbranch_vccz L_c_R_s3_ok0
    buffer_load_dwordx4 v[40:43], v3, s[8:11], s87 offen sc1
    s_sub_u32 s22, s22, 1
    s_cbranch_scc0 L_c_R_s3_loop
    s_branch L_timeout
L_c_R_s3_ok0:
    s_branch L_c_R_s3_done
L_c_R_s3_ok1:
    s_branch L_c_R_s3_done
L_c_pollV_s3:
    buffer_load_dwordx4 v[144:147], v4, s[8:11], s87 offen offset:0 sc1
    buffer_load_dwordx4 v[148:151], v4, s[8:11], s87 offen offset:512 sc1
    buffer_load_dwordx4 v[152:155], v4, s[8:11], s87 offen offset:1024 sc1
    buffer_load_dwordx4 v[156:159], v4, s[8:11], s87 offen offset:1536 sc1
    s_waitcnt vmcnt(0)
    v_max3_u32 v20, v144, v145, v146
    v_max3_u32 v21, v147, v148, v149
    v_max3_u32 v20, v20, v150, v151
    v_max3_u32 v21, v21, v152, v153
    v_max3_u32 v20, v20, v154, v155
    v_max3_u32 v21, v21, v156, v157
    v_max3_u32 v20, v20, v158, v159
    v_max_u32 v20, v20, v21
    v_cmp_eq_u32 vcc, -1, v20
    s_cbranch_vccz L_c_okV_s3
    s_sub_u32 s22, s22, 1
    s_cbranch_scc0 L_c_pollV_s3
    s_branch L_timeout
L_c_RS_s3_retry:
    buffer_load_dwordx2 v[88:89], v7, s[8:11], s91 offen sc1
    buffer_load_dwordx2 v[90:91], v8, s[8:11], s91 offen sc1
L_c_RS_s3_loop:
    s_waitcnt vmcnt(4)
    v_mfma_f32_16x16x32_bf16 v[92:95], v[32:35], v[60:63], 0
    v_max3_u32 v20, v60, v61, v62
    v_max_u32 v20, v20, v63
    v_cmp_eq_u32 vcc, -1, v20
    s_cbranch_vccz L_c_RS_s3_ok1
    buffer_load_dwordx2 v[60:61], v7, s[8:11], s91 offen sc1
    buffer_load_dwordx2 v[62:63], v8, s[8:11], s91 offen sc1
    s_waitcnt vmcnt(4)
    v_mfma_f32_16x16x32_bf16 v[92:95], v[32:35], v[64:67], 0
    v_max3_u32 v20, v64, v65, v66
    v_max_u32 v20, v20, v67
    v_cmp_eq_u32 vcc, -1, v20
    s_cbranch_vccz L_c_RS_s3_ok2
    buffer_load_dwordx2 v[64:65], v7, s[8:11], s91 offen sc1
    buffer_load_dwordx2 v[66:67], v8, s[8:11], s91 offen sc1
    s_waitcnt vmcnt(4)
    v_mfma_f32_16x16x32_bf16 v[92:95], v[32:35], v[88:91], 0
    v_max3_u32 v20, v88, v89, v90
    v_max_u32 v20, v20, v91
    v_cmp_eq_u32 vcc, -1, v20
    s_cbranch_vccz L_c_RS_s3_ok0
    buffer_load_dwordx2 v[88:89], v7, s[8:11], s91 offen sc1
    buffer_load_dwordx2 v[90:91], v8, s[8:11], s91 offen sc1
    s_sub_u32 s22, s22, 1
    s_cbranch_scc0 L_c_RS_s3_loop
    s_branch L_timeout
L_c_RS_s3_ok0:
    s_branch L_c_RS_s3_done
L_c_RS_s3_ok1:
    s_branch L_c_RS_s3_done
L_c_RS_s3_ok2:
    s_branch L_c_RS_s3_done
L_c_X_s3_retry:
    buffer_load_dwordx4 v[108:111], v104, s[8:11], s99 offen sc1
    buffer_load_dwordx4 v[112:115], v105, s[8:11], s99 offen sc1
    buffer_load_dwordx4 v[116:119], v106, s[8:11], s99 offen sc1
L_c_X_s3_loop:
    s_waitcnt vmcnt(3)
    v_max3_u32 v20, v68, v69, v70
    v_max3_u32 v21, v71, v72, v73
    v_max3_u32 v20, v20, v74, v75
    v_max3_u32 v21, v21, v76, v77
    v_max3_u32 v20, v20, v78, v79
    v_max_u32 v20, v20, v21
    v_cmp_eq_u32 vcc, -1, v20
    s_cbranch_vccz L_c_X_s3_ok1
    buffer_load_dwordx4 v[68:71], v104, s[8:11], s99 offen sc1
    buffer_load_dwordx4 v[72:75], v105, s[8:11], s99 offen sc1
    buffer_load_dwordx4 v[76:79], v106, s[8:11], s99 offen sc1
    s_waitcnt vmcnt(3)
    v_max3_u32 v20, v108, v109, v110
    v_max3_u32 v21, v111, v112, v113
    v_max3_u32 v20, v20, v114, v115
    v_max3_u32 v21, v21, v116, v117
    v_max3_u32 v20, v20, v118, v119
    v_max_u32 v20, v20, v21
    v_cmp_eq_u32 vcc, -1, v20
    s_cbranch_vccz L_c_X_s3_ok0
    buffer_load_dwordx4 v[108:111], v104, s[8:11], s99 offen sc1
    buffer_load_dwordx4 v[112:115], v105, s[8:11], s99 offen sc1
    buffer_load_dwordx4 v[116:119], v106, s[8:11], s99 offen sc1
    s_sub_u32 s22, s22, 1
    s_cbranch_scc0 L_c_X_s3_loop
    s_branch L_timeout
L_c_X_s3_ok0:
    v_pk_add_f32 v[20:21], v[108:109], v[116:117]
    v_pk_add_f32 v[92:93], v[92:93], v[112:113]
    v_pk_add_f32 v[22:23], v[110:111], v[118:119]
    v_pk_add_f32 v[94:95], v[94:95], v[114:115]
    s_branch L_c_X_s3_done
L_c_X_s3_ok1:
    v_pk_add_f32 v[20:21], v[68:69], v[76:77]
    v_pk_add_f32 v[92:93], v[92:93], v[72:73]
    v_pk_add_f32 v[22:23], v[70:71], v[78:79]
    v_pk_add_f32 v[94:95], v[94:95], v[74:75]
    s_branch L_c_X_s3_done
L_c_noitem_s3:
    s_cmp_lg_u32 s20, 3
    s_cbranch_scc1 L_c_w2_s3
    s_mov_b32 s30, 105906176
    buffer_load_dword v24, v37, s[8:11], s30 offen sc1
    buffer_load_dwordx4 v[40:43], v83, s[8:11], s87 offen sc1
    buffer_load_dwordx4 v[44:47], v98, s[8:11], s87 offen sc1
    s_waitcnt vmcnt(0)
    buffer_store_dwordx4 v[40:43], v80, s[8:11], s40 offen sc1
    buffer_store_dwordx4 v[44:47], v81, s[8:11], s41 offen sc1
    s_cmp_gt_u32 s21, 60
    s_cbranch_scc1 L_c_kvskip_112
    s_add_u32 s31, s21, 3
L_c_wk_s3:
    v_cmp_gt_u32 vcc, s31, v24
    s_nop 3
    s_and_b64 vcc, vcc, 3
    s_cbranch_vccz L_c_wk_s3_ok
    s_mov_b32 s30, 105906176
    buffer_load_dword v24, v37, s[8:11], s30 offen sc1
    s_waitcnt vmcnt(0)
    s_sub_u32 s22, s22, 1
    s_cbranch_scc0 L_c_wk_s3
    s_branch L_timeout
L_c_wk_s3_ok:
    s_mov_b32 m0, 16384
    s_add_u32 s32, s42, 16777216
    buffer_load_dwordx4 v96, s[8:11], s32 offen sc1 lds
    s_mov_b32 m0, 17408
    s_add_u32 s32, s42, 16778240
    buffer_load_dwordx4 v96, s[8:11], s32 offen sc1 lds
    s_mov_b32 m0, 18432
    s_add_u32 s32, s42, 16779264
    buffer_load_dwordx4 v96, s[8:11], s32 offen sc1 lds
    s_mov_b32 m0, 19456
    s_add_u32 s32, s42, 16780288
    buffer_load_dwordx4 v96, s[8:11], s32 offen sc1 lds
    s_mov_b32 m0, 20480
    s_add_u32 s32, s42, 16781312
    buffer_load_dwordx4 v96, s[8:11], s32 offen sc1 lds
    s_mov_b32 m0, 21504
    s_add_u32 s32, s42, 16782336
    buffer_load_dwordx4 v96, s[8:11], s32 offen sc1 lds
    s_mov_b32 m0, 22528
    s_add_u32 s32, s42, 16783360
    buffer_load_dwordx4 v96, s[8:11], s32 offen sc1 lds
    s_mov_b32 m0, 23552
    s_add_u32 s32, s42, 16784384
    buffer_load_dwordx4 v96, s[8:11], s32 offen sc1 lds
    s_mov_b32 m0, 24576
    s_add_u32 s32, s42, 33554432
    buffer_load_dwordx4 v96, s[8:11], s32 offen sc1 lds
    s_mov_b32 m0, 25600
    s_add_u32 s32, s42, 33555456
    buffer_load_dwordx4 v96, s[8:11], s32 offen sc1 lds
    s_mov_b32 m0, 26624
    s_add_u32 s32, s42, 33556480
    buffer_load_dwordx4 v96, s[8:11], s32 offen sc1 lds
    s_mov_b32 m0, 27648
    s_add_u32 s32, s42, 33557504
    buffer_load_dwordx4 v96, s[8:11], s32 offen sc1 lds
    s_mov_b32 m0, 28672
    s_add_u32 s32, s42, 33558528
    buffer_load_dwordx4 v96, s[8:11], s32 offen sc1 lds
    s_mov_b32 m0, 29696
    s_add_u32 s32, s42, 33559552
    buffer_load_dwordx4 v96, s[8:11], s32 offen sc1 lds
    s_mov_b32 m0, 30720
    s_add_u32 s32, s42, 33560576
    buffer_load_dwordx4 v96, s[8:11], s32 offen sc1 lds
    s_mov_b32 m0, 31744
    s_add_u32 s32, s42, 33561600
    buffer_load_dwordx4 v96, s[8:11], s32 offen sc1 lds
L_c_kvskip_112:
    s_waitcnt lgkmcnt(0)
    v_mfma_f32_16x16x32_bf16 v[236:239], v[160:163], a[120:123], 0
    v_mfma_f32_16x16x32_bf16 v[240:243], v[176:179], a[120:123], 0
    v_mfma_f32_16x16x32_bf16 v[236:239], v[164:167], a[124:127], v[236:239]
    v_mfma_f32_16x16x32_bf16 v[240:243], v[180:183], a[124:127], v[240:243]
    v_mfma_f32_16x16x32_bf16 v[236:239], v[168:171], a[128:131], v[236:239]
    v_mfma_f32_16x16x32_bf16 v[240:243], v[184:187], a[128:131], v[240:243]
    v_mfma_f32_16x16x32_bf16 v[236:239], v[172:175], a[132:135], v[236:239]
    v_mfma_f32_16x16x32_bf16 v[240:243], v[188:191], a[132:135], v[240:243]
    v_mfma_f32_16x16x32_bf16 v[120:123], v[160:163], a[136:139], 0
    v_mfma_f32_16x16x32_bf16 v[124:127], v[176:179], a[136:139], 0
    v_mfma_f32_16x16x32_bf16 v[120:123], v[164:167], a[140:143], v[120:123]
    v_mfma_f32_16x16x32_bf16 v[124:127], v[180:183], a[140:143], v[124:127]
    v_mfma_f32_16x16x32_bf16 v[120:123], v[168:171], a[144:147], v[120:123]
    v_mfma_f32_16x16x32_bf16 v[124:127], v[184:187], a[144:147], v[124:127]
    v_mfma_f32_16x16x32_bf16 v[120:123], v[172:175], a[148:151], v[120:123]
    v_mfma_f32_16x16x32_bf16 v[124:127], v[188:191], a[148:151], v[124:127]
    v_cvt_pk_bf16_f32 v204, v236, v237
    v_cvt_pk_bf16_f32 v205, v238, v239
    v_cvt_pk_bf16_f32 v206, v240, v241
    v_cvt_pk_bf16_f32 v207, v242, v243
    v_mfma_f32_16x16x32_bf16 v[236:239], v[160:163], a[152:155], 0
    v_mfma_f32_16x16x32_bf16 v[240:243], v[176:179], a[152:155], 0
    v_mfma_f32_16x16x32_bf16 v[236:239], v[164:167], a[156:159], v[236:239]
    v_mfma_f32_16x16x32_bf16 v[240:243], v[180:183], a[156:159], v[240:243]
    v_mfma_f32_16x16x32_bf16 v[236:239], v[168:171], a[160:163], v[236:239]
    v_mfma_f32_16x16x32_bf16 v[240:243], v[184:187], a[160:163], v[240:243]
    v_mfma_f32_16x16x32_bf16 v[236:239], v[172:175], a[164:167], v[236:239]
    v_mfma_f32_16x16x32_bf16 v[240:243], v[188:191], a[164:167], v[240:243]
    v_cvt_pk_bf16_f32 v208, v120, v121
    v_cvt_pk_bf16_f32 v209, v122, v123
    v_cvt_pk_bf16_f32 v210, v124, v125
    v_cvt_pk_bf16_f32 v211, v126, v127
    s_nop 7
    v_cvt_pk_bf16_f32 v212, v236, v237
    v_cvt_pk_bf16_f32 v213, v238, v239
    v_cvt_pk_bf16_f32 v214, v240, v241
    v_cvt_pk_bf16_f32 v215, v242, v243
    s_branch L_c_stepend_s3
L_c_w2_s3:
    s_waitcnt lgkmcnt(0)
    v_mfma_f32_16x16x32_bf16 v[236:239], v[160:163], a[120:123], 0
    v_mfma_f32_16x16x32_bf16 v[240:243], v[176:179], a[120:123], 0
    v_mfma_f32_16x16x32_bf16 v[236:239], v[164:167], a[124:127], v[236:239]
    v_mfma_f32_16x16x32_bf16 v[240:243], v[180:183], a[124:127], v[240:243]
    v_mfma_f32_16x16x32_bf16 v[236:239], v[168:171], a[128:131], v[236:239]
    v_mfma_f32_16x16x32_bf16 v[240:243], v[184:187], a[128:131], v[240:243]
    v_mfma_f32_16x16x32_bf16 v[236:239], v[172:175], a[132:135], v[236:239]
    v_mfma_f32_16x16x32_bf16 v[240:243], v[188:191], a[132:135], v[240:243]
    v_mfma_f32_16x16x32_bf16 v[120:123], v[160:163], a[136:139], 0
    v_mfma_f32_16x16x32_bf16 v[124:127], v[176:179], a[136:139], 0
    v_mfma_f32_16x16x32_bf16 v[120:123], v[164:167], a[140:143], v[120:123]
    v_mfma_f32_16x16x32_bf16 v[124:127], v[180:183], a[140:143], v[124:127]
    v_mfma_f32_16x16x32_bf16 v[120:123], v[168:171], a[144:147], v[120:123]
    v_mfma_f32_16x16x32_bf16 v[124:127], v[184:187], a[144:147], v[124:127]
    v_mfma_f32_16x16x32_bf16 v[120:123], v[172:175], a[148:151], v[120:123]
    v_mfma_f32_16x16x32_bf16 v[124:127], v[188:191], a[148:151], v[124:127]
    v_cvt_pk_bf16_f32 v204, v236, v237
    v_cvt_pk_bf16_f32 v205, v238, v239
    v_cvt_pk_bf16_f32 v206, v240, v241
    v_cvt_pk_bf16_f32 v207, v242, v243
    v_mfma_f32_16x16x32_bf16 v[236:239], v[160:163], a[152:155], 0
    v_mfma_f32_16x16x32_bf16 v[240:243], v[176:179], a[152:155], 0
    v_mfma_f32_16x16x32_bf16 v[236:239], v[164:167], a[156:159], v[236:239]
    v_mfma_f32_16x16x32_bf16 v[240:243], v[180:183], a[156:159], v[240:243]
    v_mfma_f32_16x16x32_bf16 v[236:239], v[168:171], a[160:163], v[236:239]
    v_mfma_f32_16x16x32_bf16 v[240:243], v[184:187], a[160:163], v[240:243]
    v_mfma_f32_16x16x32_bf16 v[236:239], v[172:175], a[164:167], v[236:239]
    v_mfma_f32_16x16x32_bf16 v[240:243], v[188:191], a[164:167], v[240:243]
    v_cvt_pk_bf16_f32 v208, v120, v121
    v_cvt_pk_bf16_f32 v209, v122, v123
    v_cvt_pk_bf16_f32 v210, v124, v125
    v_cvt_pk_bf16_f32 v211, v126, v127
    s_nop 7
    v_cvt_pk_bf16_f32 v212, v236, v237
    v_cvt_pk_bf16_f32 v213, v238, v239
    v_cvt_pk_bf16_f32 v214, v240, v241
    v_cvt_pk_bf16_f32 v215, v242, v243
    s_branch L_c_stepend_s3
L_c_final2:
    s_lshr_b32 s30, s18, 1
    s_lshl_b32 s30, s30, 14
    s_and_b32 s31, s18, 1
    s_lshl_b32 s31, s31, 12
    s_add_u32 s30, s30, s31
    s_lshl_b32 s31, s18, 11
    s_sub_u32 s31, s31, 2048
    s_sub_u32 s31, s31, s30
    s_cmp_ge_u32 s20, 2
    s_cselect_b32 s31, s31, 1073741824
    v_add_u32 v20, s31, v1
    s_lshl_b32 s31, s18, 12
    s_sub_u32 s31, s31, s30
    s_sub_u32 s31, s31, 1048576
    v_add_u32 v21, s31, v2
    buffer_store_dwordx2 v[248:249], v20, s[8:11], s40 offen sc1
    buffer_store_dwordx2 v[250:251], v21, s[8:11], s41 offen sc1
    s_waitcnt vmcnt(0)
    s_barrier
    v_mov_b32 v39, 64
    buffer_store_dword v39, v38, s[8:11], s44 offen sc1
    s_branch L_c_end
L_c_finals:
L_c_final:
    s_cmp_lg_u32 s20, 3
    s_cbranch_scc1 L_c_end
    buffer_load_dwordx4 v[40:43], v83, s[8:11], s87 offen sc1
    buffer_load_dwordx4 v[44:47], v98, s[8:11], s87 offen sc1
    s_waitcnt vmcnt(0)
    buffer_store_dwordx4 v[40:43], v80, s[8:11], s40 offen sc1
    buffer_store_dwordx4 v[44:47], v81, s[8:11], s41 offen sc1
    s_waitcnt vmcnt(0)
    v_mov_b32 v39, 64
    buffer_store_dword v39, v38, s[8:11], s44 offen sc1
L_c_end:
    s_waitcnt vmcnt(0)
    s_endpgm
L_timeout:
    v_mov_b32 v1, 60
    v_mov_b32 v2, 0xdead
    global_store_dword v1, v2, s[28:29]
    s_waitcnt vmcnt(0)
    s_endpgm
.section .rodata,"a"
.p2align 6
.amdhsa_kernel gated_mix__memory_aug_recurrent_mem_tr__sliding_block__prompt_kernel
  .amdhsa_next_free_vgpr 512
  .amdhsa_next_free_sgpr 102
  .amdhsa_accum_offset 256
  .amdhsa_group_segment_fixed_size 0
  .amdhsa_kernarg_size 112
  .amdhsa_user_sgpr_count 2
  .amdhsa_user_sgpr_kernarg_segment_ptr 1
  .amdhsa_system_sgpr_workgroup_id_x 1
.end_amdhsa_kernel
```
